```python
import torch

def _softmax(x, axis=-1):
    return torch.softmax(x, dim=axis)
def _gelu(x):
    return torch.nn.functional.gelu(x, approximate="tanh")
def _silu(x):
    return torch.nn.functional.silu(x)
def _sigmoid(x):
    return torch.sigmoid(x)
def _layernorm(x, axis=-1, eps=1e-5):
    m = x.mean(dim=axis, keepdim=True)
    v = x.var(dim=axis, keepdim=True, unbiased=False)
    return (x - m) / torch.sqrt(v + eps)
def _scatter_add(tgt, idx, src, axis=0):
    return tgt.clone().index_add_(axis, idx, src)
def _segment_sum(src, seg, n):
    out = torch.zeros((n,) + src.shape[1:], dtype=src.dtype)
    return out.index_add_(0, seg, src)
def _pad(x, pw):
    flat = tuple(v for pair in reversed(pw) for v in pair)
    return torch.nn.functional.pad(x, flat)

kernel_name = 'standalone__mha_block_cached__near_ridge'

def setup_inputs():

    _w = (lambda a: (lambda t: t.to(torch.bfloat16) if t.is_floating_point() else t)(torch.as_tensor(a)))
    B, Sq, D = 16, 144, 1024
    H, Sk, Dh = 32, 512, 128
    return {
        "x": _w((lambda *s: torch.randn(*s, dtype=torch.bfloat16) * 0.8)(B, Sq, D)),
        "k_cache": _w((lambda *s: torch.randn(*s, dtype=torch.bfloat16) * 0.8)(B, H, Sk, Dh)),
        "v_cache": _w((lambda *s: torch.randn(*s, dtype=torch.bfloat16) * 0.05)(B, H, Sk, Dh)),
        "wq": _w((lambda *s: torch.randn(*s, dtype=torch.bfloat16) * 0.8)(D, H * Dh) * (D ** -0.5)),
        "wo": _w((lambda *s: torch.randn(*s, dtype=torch.bfloat16) * 0.05)(H * Dh, D) * ((H * Dh) ** -0.5)),
    }

def reference(x, k_cache, v_cache, wq, wo):
    B, Sq, D = x.shape
    H, Dh = 32, 128
    q = (lambda x, *d: x.permute(*d))((x @ wq).reshape(B, Sq, H, Dh), 0, 2, 1, 3)
    scores = torch.einsum("bhqd,bhkd->bhqk", q, k_cache) * (Dh ** -0.5)
    p = _softmax(scores, axis=-1)
    o = torch.einsum("bhqk,bhkd->bhqd", p, v_cache)
    return (lambda x, *d: x.permute(*d))(o, 0, 2, 1, 3).reshape(B, Sq, H * Dh) @ wo
```

```asm
; @launch grid=(256,1,1) block=(256,1,1) lds=163840
.amdgcn_target "amdgcn-amd-amdhsa--gfx950"
.text
.globl standalone__mha_block_cached__near_ridge_kernel
.p2align 8
.type standalone__mha_block_cached__near_ridge_kernel,@function
standalone__mha_block_cached__near_ridge_kernel:
    s_cmp_ge_u32 s2, 0x100
    s_cbranch_scc1 mha_end
    s_load_dwordx16 s[36:51], s[0:1], 0
    v_lshrrev_b32 v10, 6, v0
    v_and_b32 v0, 63, v0
    v_readfirstlane_b32 s56, v10
    v_lshlrev_b32 v4, 4, v0
    v_lshrrev_b32 v12, 4, v0
    v_lshlrev_b32 v13, 1, v12
    v_and_b32 v11, 7, v0
    v_xor_b32 v11, v11, v13
    v_lshlrev_b32 v11, 4, v11
    v_lshrrev_b32 v14, 3, v0
    v_lshl_add_u32 v1, v14, 11, v11
    s_lshr_b32 s57, s56, 1
    s_and_b32 s58, s56, 1
    s_and_b32 s62, s2, 7
    s_lshr_b32 s63, s2, 3
    s_and_b32 s59, s62, 1
    s_lshl_b32 s59, s59, 3
    s_and_b32 s64, s63, 7
    s_add_u32 s59, s59, s64
    s_lshr_b32 s60, s62, 1
    s_lshl_b32 s60, s60, 2
    s_lshr_b32 s64, s63, 3
    s_add_u32 s60, s60, s64
    s_mul_i32 s62, s59, 0x48000
    s_lshl_b32 s63, s56, 16
    s_add_u32 s68, s62, s63
    s_add_u32 s63, s57, 16
    s_lshl_b32 s72, s63, 10
    s_lshl_b32 s63, s63, 14
    s_add_u32 s69, s62, s63
    s_lshl_b32 s71, s56, 12
    s_lshl_b32 s70, s58, 16
    s_lshl_b32 s63, s60, 9
    s_add_u32 s70, s70, s63
    s_lshl_b32 s63, s57, 8
    s_add_u32 s70, s70, s63
    s_lshl_b32 s73, s57, 14
    s_lshl_b32 s63, s58, 11
    s_add_u32 s73, s73, s63
    s_add_u32 s73, s73, 0x4800
    s_xor_b32 s63, s59, s60
    s_max_u32 s79, s63, 0
    s_mov_b32 s80, s68
    s_mov_b32 s81, s69
    s_mov_b32 s82, s70
    s_and_b32 s63, s63, 15
    s_lshl_b32 s64, s63, 7
    s_add_u32 s68, s68, s64
    s_add_u32 s69, s69, s64
    s_lshl_b32 s64, s63, 19
    s_add_u32 s70, s70, s64
    s_cmp_eq_u32 s58, 0
    s_cselect_b32 s66, -1, 0
    s_cselect_b32 s67, 0, -1
    s_lshl_b32 s63, s58, 2
    v_or_b32 v13, s63, v12
    v_lshlrev_b32 v13, 1, v13
    v_and_b32 v14, 15, v0
    v_xor_b32 v13, v13, v14
    v_lshlrev_b32 v13, 4, v13
    v_lshl_add_u32 v2, v12, 13, v13
    s_waitcnt lgkmcnt(0)
    s_mov_b32 s4, s36
    s_mov_b32 s5, s37
    s_mov_b32 s6, 0x480000
    s_mov_b32 s7, 0x20000
    s_mov_b32 s8, s42
    s_mov_b32 s9, s43
    s_mov_b32 s10, 0x800000
    s_mov_b32 s11, 0x20000
    s_mov_b32 s75, 0
    s_add_u32 m0, s75, s71
    s_add_u32 s91, s68, 0
    buffer_load_dwordx4 v1, s[4:7], s91 offen lds
    s_add_u32 m0, m0, 0x400
    s_add_u32 s91, s68, 0x4000
    buffer_load_dwordx4 v1, s[4:7], s91 offen lds
    s_add_u32 m0, m0, 0x400
    s_add_u32 s91, s68, 0x8000
    buffer_load_dwordx4 v1, s[4:7], s91 offen lds
    s_add_u32 m0, m0, 0x400
    s_add_u32 s91, s68, 0xc000
    buffer_load_dwordx4 v1, s[4:7], s91 offen lds
    s_add_u32 m0, s75, s72
    s_mov_b64 exec, s[66:67]
    buffer_load_dwordx4 v1, s[4:7], s69 offen lds
    s_mov_b64 exec, -1
    s_add_u32 m0, s75, s73
    s_add_u32 s91, s70, 0
    buffer_load_dwordx4 v2, s[8:11], s91 offen lds
    s_add_u32 m0, m0, 0x400
    s_add_u32 s91, s70, 0x8000
    buffer_load_dwordx4 v2, s[8:11], s91 offen lds
    s_add_u32 m0, m0, 0xc00
    s_add_u32 s91, s70, 0x20000
    buffer_load_dwordx4 v2, s[8:11], s91 offen lds
    s_add_u32 m0, m0, 0x400
    s_add_u32 s91, s70, 0x28000
    buffer_load_dwordx4 v2, s[8:11], s91 offen lds
    s_add_u32 m0, m0, 0xc00
    s_add_u32 s91, s70, 0x40000
    buffer_load_dwordx4 v2, s[8:11], s91 offen lds
    s_add_u32 m0, m0, 0x400
    s_add_u32 s91, s70, 0x48000
    buffer_load_dwordx4 v2, s[8:11], s91 offen lds
    s_add_u32 m0, m0, 0xc00
    s_add_u32 s91, s70, 0x60000
    buffer_load_dwordx4 v2, s[8:11], s91 offen lds
    s_add_u32 m0, m0, 0x400
    s_add_u32 s91, s70, 0x68000
    buffer_load_dwordx4 v2, s[8:11], s91 offen lds
    s_cmp_gt_u32 s79, 0
    s_cselect_b32 s83, 0, 1
    s_lshl_b32 s84, s83, 7
    s_add_u32 s68, s80, s84
    s_add_u32 s69, s81, s84
    s_lshl_b32 s84, s83, 19
    s_add_u32 s70, s82, s84
    s_getpc_b64 s[16:17]
mha_pc:
    s_and_b32 s17, s17, 0xffff
    s_mov_b32 s18, mha_code_end-mha_pc
    s_mov_b32 s19, 0x20000
    s_lshr_b32 s62, s2, 3
    s_lshl_b32 s62, s62, 2
    s_add_u32 s62, s62, s56
    s_lshl_b32 s62, s62, 7
    v_lshlrev_b32 v10, 14, v0
    buffer_load_dword v200, v10, s[16:19], s62 offen
    s_mov_b32 s75, 0xc800
    s_mov_b32 s12, s38
    s_mov_b32 s13, s39
    s_mov_b32 s14, 0x4000000
    s_mov_b32 s15, 0x20000
    s_mov_b32 s16, s40
    s_mov_b32 s17, s41
    s_mov_b32 s18, 0x4000000
    s_mov_b32 s19, 0x20000
    s_mov_b32 s20, s50
    s_add_u32 m0, s75, s71
    s_add_u32 s91, s68, 0
    buffer_load_dwordx4 v1, s[4:7], s91 offen lds
    s_mov_b32 s21, s51
    s_mov_b32 s22, 0x1810000
    s_mov_b32 s23, 0x20000
    s_mov_b32 s24, s44
    s_mov_b32 s25, s45
    s_mov_b32 s26, 0x800000
    s_mov_b32 s27, 0x20000
    s_mov_b32 s28, s46
    s_mov_b32 s29, s47
    s_add_u32 m0, m0, 0x400
    s_add_u32 s91, s68, 0x4000
    buffer_load_dwordx4 v1, s[4:7], s91 offen lds
    s_mov_b32 s30, 0x480000
    s_mov_b32 s31, 0x20000
    s_mov_b32 s32, s48
    s_mov_b32 s33, s49
    s_mov_b32 s34, 0x100
    s_mov_b32 s35, 0x20000
    v_lshrrev_b32 v13, 1, v14
    v_and_b32 v13, 3, v13
    v_lshlrev_b32 v13, 1, v13
    s_add_u32 m0, m0, 0x400
    s_add_u32 s91, s68, 0x8000
    buffer_load_dwordx4 v1, s[4:7], s91 offen lds
    v_xor_b32 v13, v13, v12
    v_lshlrev_b32 v13, 4, v13
    v_lshrrev_b32 v15, 2, v14
    v_lshlrev_b32 v15, 10, v15
    v_and_b32 v10, 3, v14
    v_lshl_add_u32 v15, v10, 7, v15
    v_add_u32 v15, v15, v13
    s_lshl_b32 s62, s57, 14
    s_add_u32 s62, s62, 0x10000
    s_add_u32 m0, m0, 0x400
    s_add_u32 s91, s68, 0xc000
    buffer_load_dwordx4 v1, s[4:7], s91 offen lds
    v_add_u32 v15, s62, v15
    s_mul_i32 s63, s58, 0x2040
    v_xor_b32 v240, s63, v15
    v_xor_b32 v241, 0x2000, v240
    v_xor_b32 v242, 64, v240
    v_xor_b32 v243, 64, v241
    v_lshl_add_u32 v13, v14, 7, v13
    s_lshl_b32 s63, s58, 13
    v_add_u32 v5, s63, v13
    s_add_u32 m0, s75, s72
    s_mov_b64 exec, s[66:67]
    buffer_load_dwordx4 v1, s[4:7], s69 offen lds
    s_mov_b64 exec, -1
    v_xor_b32 v6, 64, v5
    v_add_u32 v7, 0x4000, v13
    v_xor_b32 v8, 64, v7
    v_bfe_u32 v10, v0, 2, 2
    v_and_b32 v11, 3, v0
    v_and_b32 v13, 1, v12
    v_lshl_add_u32 v13, v13, 2, v10
    s_lshl_b32 s63, s58, 1
    v_xor_b32 v15, s63, v13
    s_add_u32 m0, s75, s73
    s_add_u32 s91, s70, 0
    buffer_load_dwordx4 v2, s[8:11], s91 offen lds
    v_lshlrev_b32 v15, 5, v15
    v_lshlrev_b32 v14, 4, v11
    v_xor_b32 v15, v15, v14
    v_lshl_add_u32 v14, v12, 3, v10
    v_lshl_add_u32 v15, v14, 8, v15
    s_lshl_b32 s62, s57, 14
    s_add_u32 s62, s62, 0x4800
    v_add_u32 v9, s62, v15
    v_lshrrev_b32 v14, 1, v13
    s_add_u32 m0, m0, 0x400
    s_add_u32 s91, s70, 0x8000
    buffer_load_dwordx4 v2, s[8:11], s91 offen lds
    v_xor_b32 v14, s63, v14
    v_lshlrev_b32 v14, 5, v14
    v_lshl_add_u32 v14, v11, 3, v14
    v_lshl_add_u32 v14, v10, 7, v14
    v_lshl_add_u32 v14, v12, 10, v14
    s_lshl_b32 s78, s56, 13
    s_add_u32 s62, s78, 0x20000
    v_add_u32 v244, s62, v14
    v_xor_b32 v245, 0x2000, v244
    s_add_u32 m0, m0, 0xc00
    s_add_u32 s91, s70, 0x20000
    buffer_load_dwordx4 v2, s[8:11], s91 offen lds
    v_xor_b32 v246, 32, v244
    v_xor_b32 v247, 0x2000, v246
    v_xor_b32 v248, 64, v244
    v_xor_b32 v249, 0x2000, v248
    v_xor_b32 v250, 0x60, v244
    v_xor_b32 v251, 0x2000, v250
    s_lshl_b32 s62, s59, 5
    s_lshl_b32 s63, s60, 1
    s_add_u32 s62, s62, s63
    s_add_u32 m0, m0, 0x400
    s_add_u32 s91, s70, 0x28000
    buffer_load_dwordx4 v2, s[8:11], s91 offen lds
    s_add_u32 s62, s62, s57
    s_lshl_b32 s77, s62, 17
    s_lshl_b32 s63, s58, 13
    s_add_u32 s77, s77, s63
    s_add_u32 s55, s77, 0x20000
    s_lshl_b32 s62, s62, 2
    s_add_u32 s63, s62, s58
    s_mul_i32 s87, s63, 0x2400
    s_xor_b32 s63, s63, 1
    s_add_u32 m0, m0, 0xc00
    s_add_u32 s91, s70, 0x40000
    buffer_load_dwordx4 v2, s[8:11], s91 offen lds
    s_mul_i32 s88, s63, 0x2400
    s_and_b32 s62, s2, 7
    s_lshr_b32 s63, s2, 3
    s_and_b32 s3, s62, 3
    s_lshl_b32 s3, s3, 2
    s_and_b32 s64, s63, 3
    s_add_u32 s3, s3, s64
    s_lshr_b32 s94, s62, 2
    s_lshl_b32 s94, s94, 3
    s_add_u32 m0, m0, 0x400
    s_add_u32 s91, s70, 0x48000
    buffer_load_dwordx4 v2, s[8:11], s91 offen lds
    s_lshr_b32 s64, s63, 2
    s_add_u32 s94, s94, s64
    s_lshr_b32 s54, s60, 1
    s_lshl_b32 s54, s54, 4
    s_add_u32 s54, s54, s59
    s_lshl_b32 s54, s54, 2
    s_add_u32 s54, s54, s56
    s_lshl_b32 s54, s54, 14
    s_and_b32 s64, s60, 1
    s_add_u32 m0, m0, 0xc00
    s_add_u32 s91, s70, 0x60000
    buffer_load_dwordx4 v2, s[8:11], s91 offen lds
    s_xor_b32 s64, s64, 1
    s_lshl_b32 s64, s64, 28
    s_or_b32 s54, s54, s64
    v_add_u32 v254, s78, v4
    v_bfe_u32 v10, v0, 3, 2
    v_and_b32 v11, 2, v10
    v_and_b32 v13, 7, v0
    v_xor_b32 v11, v11, v13
    v_lshlrev_b32 v11, 4, v11
    s_add_u32 m0, m0, 0x400
    s_add_u32 s91, s70, 0x68000
    buffer_load_dwordx4 v2, s[8:11], s91 offen lds
    s_cmp_gt_u32 s79, 1
    s_cselect_b32 s83, 1, 2
    s_lshl_b32 s84, s83, 7
    s_add_u32 s68, s80, s84
    s_add_u32 s69, s81, s84
    s_lshl_b32 s84, s83, 19
    s_add_u32 s70, s82, s84
    v_lshl_add_u32 v11, v10, 8, v11
    v_lshrrev_b32 v10, 5, v0
    v_lshl_add_u32 v3, v10, 7, v11
    v_xor_b32 v15, 64, v3
    s_add_u32 s47, s63, s2
    s_and_b32 s47, s47, 7
    s_lshl_b32 s47, s47, 14
    s_mov_b32 s89, 0x3e0293ee
    s_mov_b32 s74, 0
    s_mov_b32 s75, 0x19000
    s_mov_b32 s96, 0xc800
    v_mov_b32 v203, 0
    s_mov_b32 s44, 0x3e0293ee
    s_mov_b32 s45, 0x3e0293ee
    s_lshl_b32 s62, s3, 4
    s_add_u32 s62, s62, s94
    s_lshl_b32 s62, s62, 8
    s_add_u32 s46, s62, 0x1800000
    s_cmp_eq_u32 s56, 0
    s_cselect_b32 s62, s46, 0x10000000
    s_mov_b64 exec, 1
    buffer_store_dword v203, v203, s[20:23], s62 offen sc0 sc1
    s_mov_b64 exec, -1
    s_waitcnt vmcnt(15)
    s_barrier
    ds_read_b128 a[0:3], v5
    ds_read_b64_tr_b16 a[80:81], v9
    ds_read_b64_tr_b16 a[82:83], v9 offset:1024
    ds_read_b128 a[4:7], v6
    ds_read_b64_tr_b16 a[84:85], v9 offset:8192
    ds_read_b64_tr_b16 a[86:87], v9 offset:9216
    ds_read_b128 a[12:15], v6 offset:2048
    ds_read_b128 a[8:11], v5 offset:2048
    ds_read_b128 a[16:19], v5 offset:4096
    ds_read_b128 a[20:23], v6 offset:4096
    ds_read_b128 a[28:31], v6 offset:6144
    ds_read_b128 a[24:27], v5 offset:6144
    ds_read_b128 a[32:35], v7
    ds_read_b128 a[36:39], v8
    s_add_u32 m0, s75, s71
    s_add_u32 s91, s68, 0
    ds_read_b64_tr_b16 a[88:89], v9 offset:8
    s_waitcnt lgkmcnt(12)
    v_mfma_f32_16x16x32_bf16 v[16:19], a[80:83], a[0:3], 0
    s_waitcnt lgkmcnt(9)
    ds_read_b64_tr_b16 a[90:91], v9 offset:1032
    buffer_load_dwordx4 v1, s[4:7], s91 offen lds
    v_mfma_f32_16x16x32_bf16 v[16:19], a[84:87], a[4:7], v[16:19]
    s_waitcnt lgkmcnt(9)
    s_add_u32 m0, m0, 0x400
    ds_read_b64_tr_b16 a[92:93], v9 offset:8200
    v_mfma_f32_16x16x32_bf16 v[20:23], a[84:87], a[12:15], 0
    s_waitcnt lgkmcnt(9)
    s_add_u32 s91, s68, 0x4000
    ds_read_b64_tr_b16 a[94:95], v9 offset:9224
    v_mfma_f32_16x16x32_bf16 v[20:23], a[80:83], a[8:11], v[20:23]
    s_waitcnt lgkmcnt(9)
    buffer_load_dwordx4 v1, s[4:7], s91 offen lds
    v_mfma_f32_16x16x32_bf16 v[24:27], a[80:83], a[16:19], 0
    s_waitcnt lgkmcnt(8)
    v_xor_b32 v11, 64, v9
    v_mfma_f32_16x16x32_bf16 v[24:27], a[84:87], a[20:23], v[24:27]
    s_waitcnt lgkmcnt(7)
    s_add_u32 m0, m0, 0x400
    ds_read_b64_tr_b16 a[96:97], v11
    v_mfma_f32_16x16x32_bf16 v[28:31], a[84:87], a[28:31], 0
    s_waitcnt lgkmcnt(7)
    s_add_u32 s91, s68, 0x8000
    ds_read_b64_tr_b16 a[98:99], v11 offset:1024
    v_mfma_f32_16x16x32_bf16 v[28:31], a[80:83], a[24:27], v[28:31]
    s_waitcnt lgkmcnt(7)
    ds_read_b64_tr_b16 a[100:101], v11 offset:8192
    buffer_load_dwordx4 v1, s[4:7], s91 offen lds
    v_mfma_f32_16x16x32_bf16 v[144:147], a[80:83], a[32:35], 0
    s_waitcnt lgkmcnt(7)
    s_add_u32 m0, m0, 0x400
    ds_read_b64_tr_b16 a[102:103], v11 offset:9216
    v_mfma_f32_16x16x32_bf16 v[144:147], a[84:87], a[36:39], v[144:147]
    s_waitcnt lgkmcnt(4)
    s_add_u32 s91, s68, 0xc000
    v_mfma_f32_16x16x32_bf16 v[148:151], a[92:95], a[36:39], 0
    ds_read_b64_tr_b16 a[104:105], v11 offset:8
    buffer_load_dwordx4 v1, s[4:7], s91 offen lds
    v_mfma_f32_16x16x32_bf16 v[148:151], a[88:91], a[32:35], v[148:151]
    ds_read_b64_tr_b16 a[106:107], v11 offset:1032
    v_mfma_f32_16x16x32_bf16 v[44:47], a[88:91], a[24:27], 0
    v_mfma_f32_16x16x32_bf16 v[44:47], a[92:95], a[28:31], v[44:47]
    s_add_u32 m0, s75, s72
    ds_read_b64_tr_b16 a[108:109], v11 offset:8200
    v_mfma_f32_16x16x32_bf16 v[40:43], a[92:95], a[20:23], 0
    ds_read_b64_tr_b16 a[110:111], v11 offset:9224
    v_mfma_f32_16x16x32_bf16 v[40:43], a[88:91], a[16:19], v[40:43]
    s_mov_b64 exec, s[66:67]
    buffer_load_dwordx4 v1, s[4:7], s69 offen lds
    s_mov_b64 exec, -1
    v_mfma_f32_16x16x32_bf16 v[36:39], a[88:91], a[8:11], 0
    s_add_u32 m0, s75, s73
    v_xor_b32 v10, 0x80, v9
    v_mfma_f32_16x16x32_bf16 v[36:39], a[92:95], a[12:15], v[36:39]
    s_add_u32 s91, s70, 0
    ds_read_b64_tr_b16 a[80:81], v10
    buffer_load_dwordx4 v2, s[8:11], s91 offen lds
    v_mfma_f32_16x16x32_bf16 v[32:35], a[92:95], a[4:7], 0
    ds_read_b64_tr_b16 a[82:83], v10 offset:1024
    v_mfma_f32_16x16x32_bf16 v[32:35], a[88:91], a[0:3], v[32:35]
    s_waitcnt lgkmcnt(8)
    s_add_u32 m0, m0, 0x400
    ds_read_b64_tr_b16 a[84:85], v10 offset:8192
    v_mfma_f32_16x16x32_bf16 v[48:51], a[96:99], a[0:3], 0
    s_waitcnt lgkmcnt(7)
    s_add_u32 s91, s70, 0x8000
    ds_read_b64_tr_b16 a[86:87], v10 offset:9216
    v_mfma_f32_16x16x32_bf16 v[48:51], a[100:103], a[4:7], v[48:51]
    buffer_load_dwordx4 v2, s[8:11], s91 offen lds
    v_mfma_f32_16x16x32_bf16 v[52:55], a[100:103], a[12:15], 0
    s_add_u32 m0, m0, 0xc00
    ds_read_b64_tr_b16 a[88:89], v10 offset:8
    v_mfma_f32_16x16x32_bf16 v[52:55], a[96:99], a[8:11], v[52:55]
    s_add_u32 s91, s70, 0x20000
    ds_read_b64_tr_b16 a[90:91], v10 offset:1032
    v_mfma_f32_16x16x32_bf16 v[56:59], a[96:99], a[16:19], 0
    buffer_load_dwordx4 v2, s[8:11], s91 offen lds
    v_mfma_f32_16x16x32_bf16 v[56:59], a[100:103], a[20:23], v[56:59]
    ds_read_b64_tr_b16 a[92:93], v10 offset:8200
    v_mfma_f32_16x16x32_bf16 v[60:63], a[100:103], a[28:31], 0
    s_add_u32 m0, m0, 0x400
    ds_read_b64_tr_b16 a[94:95], v10 offset:9224
    v_mfma_f32_16x16x32_bf16 v[60:63], a[96:99], a[24:27], v[60:63]
    s_waitcnt lgkmcnt(10)
    s_add_u32 s91, s70, 0x28000
    v_mfma_f32_16x16x32_bf16 v[76:79], a[104:107], a[24:27], 0
    s_waitcnt lgkmcnt(8)
    v_xor_b32 v11, 0xc0, v9
    buffer_load_dwordx4 v2, s[8:11], s91 offen lds
    v_mfma_f32_16x16x32_bf16 v[76:79], a[108:111], a[28:31], v[76:79]
    s_add_u32 m0, m0, 0xc00
    ds_read_b64_tr_b16 a[96:97], v11
    v_mfma_f32_16x16x32_bf16 v[72:75], a[108:111], a[20:23], 0
    s_add_u32 s91, s70, 0x40000
    ds_read_b64_tr_b16 a[98:99], v11 offset:1024
    v_mfma_f32_16x16x32_bf16 v[72:75], a[104:107], a[16:19], v[72:75]
    ds_read_b64_tr_b16 a[100:101], v11 offset:8192
    buffer_load_dwordx4 v2, s[8:11], s91 offen lds
    v_mfma_f32_16x16x32_bf16 v[68:71], a[104:107], a[8:11], 0
    ds_read_b64_tr_b16 a[102:103], v11 offset:9216
    v_mfma_f32_16x16x32_bf16 v[68:71], a[108:111], a[12:15], v[68:71]
    s_add_u32 m0, m0, 0x400
    v_mfma_f32_16x16x32_bf16 v[64:67], a[108:111], a[4:7], 0
    s_add_u32 s91, s70, 0x48000
    v_mfma_f32_16x16x32_bf16 v[64:67], a[104:107], a[0:3], v[64:67]
    s_waitcnt lgkmcnt(10)
    ds_read_b64_tr_b16 a[104:105], v11 offset:8
    buffer_load_dwordx4 v2, s[8:11], s91 offen lds
    v_mfma_f32_16x16x32_bf16 v[80:83], a[80:83], a[0:3], 0
    s_waitcnt lgkmcnt(9)
    s_add_u32 m0, m0, 0xc00
    ds_read_b64_tr_b16 a[106:107], v11 offset:1032
    v_mfma_f32_16x16x32_bf16 v[80:83], a[84:87], a[4:7], v[80:83]
    s_add_u32 s91, s70, 0x60000
    v_mfma_f32_16x16x32_bf16 v[84:87], a[84:87], a[12:15], 0
    ds_read_b64_tr_b16 a[108:109], v11 offset:8200
    buffer_load_dwordx4 v2, s[8:11], s91 offen lds
    v_mfma_f32_16x16x32_bf16 v[84:87], a[80:83], a[8:11], v[84:87]
    ds_read_b64_tr_b16 a[110:111], v11 offset:9224
    v_mfma_f32_16x16x32_bf16 v[88:91], a[80:83], a[16:19], 0
    s_add_u32 m0, m0, 0x400
    v_mfma_f32_16x16x32_bf16 v[88:91], a[84:87], a[20:23], v[88:91]
    s_add_u32 s91, s70, 0x68000
    v_mfma_f32_16x16x32_bf16 v[92:95], a[84:87], a[28:31], 0
    buffer_load_dwordx4 v2, s[8:11], s91 offen lds
    v_mfma_f32_16x16x32_bf16 v[92:95], a[80:83], a[24:27], v[92:95]
    v_mfma_f32_16x16x32_bf16 v[152:155], a[80:83], a[32:35], 0
    v_mfma_f32_16x16x32_bf16 v[152:155], a[84:87], a[36:39], v[152:155]
    s_waitcnt lgkmcnt(8)
    v_mfma_f32_16x16x32_bf16 v[156:159], a[92:95], a[36:39], 0
    s_cmp_gt_u32 s79, 2
    s_cselect_b32 s83, 2, 3
    v_mfma_f32_16x16x32_bf16 v[156:159], a[88:91], a[32:35], v[156:159]
    s_lshl_b32 s84, s83, 7
    v_mfma_f32_16x16x32_bf16 v[108:111], a[88:91], a[24:27], 0
    s_add_u32 s68, s80, s84
    v_mfma_f32_16x16x32_bf16 v[108:111], a[92:95], a[28:31], v[108:111]
    s_add_u32 s69, s81, s84
    s_lshl_b32 s84, s83, 19
    s_add_u32 s70, s82, s84
    v_mfma_f32_16x16x32_bf16 v[104:107], a[92:95], a[20:23], 0
    s_mov_b32 s75, s74
    s_cmp_eq_u32 s74, 0x19000
    s_cselect_b32 s76, 0xfffe7000, s96
    v_mfma_f32_16x16x32_bf16 v[104:107], a[88:91], a[16:19], v[104:107]
    s_add_u32 s74, s74, s76
    v_add_u32 v9, s76, v9
    v_add_u32 v5, s76, v5
    v_mfma_f32_16x16x32_bf16 v[100:103], a[88:91], a[8:11], 0
    v_add_u32 v6, s76, v6
    v_add_u32 v7, s76, v7
    v_mfma_f32_16x16x32_bf16 v[100:103], a[92:95], a[12:15], v[100:103]
    s_waitcnt vmcnt(14) lgkmcnt(0)
    v_add_u32 v8, s76, v8
    v_mfma_f32_16x16x32_bf16 v[96:99], a[92:95], a[4:7], 0
    s_barrier
    v_mfma_f32_16x16x32_bf16 v[96:99], a[88:91], a[0:3], v[96:99]
    v_mfma_f32_16x16x32_bf16 v[112:115], a[96:99], a[0:3], 0
    s_add_u32 m0, s75, s71
    ds_read_b128 a[40:43], v5
    ds_read_b64_tr_b16 a[80:81], v9
    v_mfma_f32_16x16x32_bf16 v[112:115], a[100:103], a[4:7], v[112:115]
    s_add_u32 s91, s68, 0
    ds_read_b64_tr_b16 a[82:83], v9 offset:1024
    v_mfma_f32_16x16x32_bf16 v[116:119], a[100:103], a[12:15], 0
    ds_read_b128 a[44:47], v6
    buffer_load_dwordx4 v1, s[4:7], s91 offen lds
    v_mfma_f32_16x16x32_bf16 v[116:119], a[96:99], a[8:11], v[116:119]
    ds_read_b64_tr_b16 a[84:85], v9 offset:8192
    v_mfma_f32_16x16x32_bf16 v[120:123], a[96:99], a[16:19], 0
    s_add_u32 m0, m0, 0x400
    ds_read_b64_tr_b16 a[86:87], v9 offset:9216
    v_mfma_f32_16x16x32_bf16 v[120:123], a[100:103], a[20:23], v[120:123]
    s_add_u32 s91, s68, 0x4000
    ds_read_b128 a[52:55], v6 offset:2048
    v_mfma_f32_16x16x32_bf16 v[124:127], a[100:103], a[28:31], 0
    buffer_load_dwordx4 v1, s[4:7], s91 offen lds
    v_mfma_f32_16x16x32_bf16 v[124:127], a[96:99], a[24:27], v[124:127]
    s_add_u32 s90, s77, 0x14000
    ds_read_b128 a[48:51], v5 offset:2048
    v_mfma_f32_16x16x32_bf16 v[140:143], a[104:107], a[24:27], 0
    s_xor_b32 s90, s90, s47
    ds_read_b128 a[56:59], v5 offset:4096
    v_mfma_f32_16x16x32_bf16 v[140:143], a[108:111], a[28:31], v[140:143]
    s_add_u32 m0, m0, 0x400
    ds_read_b128 a[60:63], v6 offset:4096
    buffer_load_dwordx4 a[224:227], v3, s[16:19], s90 offen nt
    v_mfma_f32_16x16x32_bf16 v[136:139], a[108:111], a[20:23], 0
    s_add_u32 s91, s68, 0x8000
    ds_read_b128 a[68:71], v6 offset:6144
    v_mfma_f32_16x16x32_bf16 v[136:139], a[104:107], a[16:19], v[136:139]
    ds_read_b128 a[64:67], v5 offset:6144
    buffer_load_dwordx4 v1, s[4:7], s91 offen lds
    v_mfma_f32_16x16x32_bf16 v[132:135], a[104:107], a[8:11], 0
    ds_read_b128 a[72:75], v7
    v_mfma_f32_16x16x32_bf16 v[132:135], a[108:111], a[12:15], v[132:135]
    s_add_u32 m0, m0, 0x400
    ds_read_b128 a[76:79], v8
    v_mfma_f32_16x16x32_bf16 v[128:131], a[108:111], a[4:7], 0
    s_add_u32 s91, s68, 0xc000
    v_mfma_f32_16x16x32_bf16 v[128:131], a[104:107], a[0:3], v[128:131]
    s_waitcnt lgkmcnt(11)
    ds_read_b64_tr_b16 a[88:89], v9 offset:8
    buffer_load_dwordx4 v1, s[4:7], s91 offen lds
    v_mfma_f32_16x16x32_bf16 v[16:19], a[80:83], a[40:43], v[16:19]
    s_waitcnt lgkmcnt(9)
    ds_read_b64_tr_b16 a[90:91], v9 offset:1032
    v_mfma_f32_16x16x32_bf16 v[16:19], a[84:87], a[44:47], v[16:19]
    s_waitcnt lgkmcnt(9)
    ds_read_b64_tr_b16 a[92:93], v9 offset:8200
    v_mfma_f32_16x16x32_bf16 v[20:23], a[84:87], a[52:55], v[20:23]
    s_waitcnt lgkmcnt(9)
    ds_read_b64_tr_b16 a[94:95], v9 offset:9224
    v_mfma_f32_16x16x32_bf16 v[20:23], a[80:83], a[48:51], v[20:23]
    s_waitcnt lgkmcnt(9)
    s_add_u32 m0, s75, s72
    v_mfma_f32_16x16x32_bf16 v[24:27], a[80:83], a[56:59], v[24:27]
    s_waitcnt lgkmcnt(8)
    v_xor_b32 v11, 64, v9
    v_mfma_f32_16x16x32_bf16 v[24:27], a[84:87], a[60:63], v[24:27]
    s_waitcnt lgkmcnt(7)
    ds_read_b64_tr_b16 a[96:97], v11
    v_mfma_f32_16x16x32_bf16 v[28:31], a[84:87], a[68:71], v[28:31]
    s_waitcnt lgkmcnt(7)
    s_mov_b64 exec, s[66:67]
    buffer_load_dwordx4 v1, s[4:7], s69 offen lds
    s_mov_b64 exec, -1
    v_mfma_f32_16x16x32_bf16 v[28:31], a[80:83], a[64:67], v[28:31]
    s_waitcnt lgkmcnt(6)
    s_add_u32 m0, s75, s73
    ds_read_b64_tr_b16 a[98:99], v11 offset:1024
    ds_read_b64_tr_b16 a[100:101], v11 offset:8192
    v_mfma_f32_16x16x32_bf16 v[144:147], a[80:83], a[72:75], v[144:147]
    s_waitcnt lgkmcnt(7)
    s_add_u32 s91, s70, 0
    ds_read_b64_tr_b16 a[102:103], v11 offset:9216
    v_mfma_f32_16x16x32_bf16 v[144:147], a[84:87], a[76:79], v[144:147]
    s_waitcnt lgkmcnt(4)
    buffer_load_dwordx4 v2, s[8:11], s91 offen lds
    v_mfma_f32_16x16x32_bf16 v[148:151], a[92:95], a[76:79], v[148:151]
    ds_read_b64_tr_b16 a[104:105], v11 offset:8
    v_mfma_f32_16x16x32_bf16 v[148:151], a[88:91], a[72:75], v[148:151]
    s_add_u32 s90, s77, 0x14000
    ds_read_b64_tr_b16 a[106:107], v11 offset:1032
    v_mfma_f32_16x16x32_bf16 v[44:47], a[88:91], a[64:67], v[44:47]
    s_xor_b32 s90, s90, s47
    v_mfma_f32_16x16x32_bf16 v[44:47], a[92:95], a[68:71], v[44:47]
    s_add_u32 m0, m0, 0x400
    ds_read_b64_tr_b16 a[108:109], v11 offset:8200
    buffer_load_dwordx4 a[228:231], v15, s[16:19], s90 offen offset:1024 nt
    v_mfma_f32_16x16x32_bf16 v[40:43], a[92:95], a[60:63], v[40:43]
    s_add_u32 s91, s70, 0x8000
    ds_read_b64_tr_b16 a[110:111], v11 offset:9224
    buffer_load_dwordx4 v2, s[8:11], s91 offen lds
    v_mfma_f32_16x16x32_bf16 v[40:43], a[88:91], a[56:59], v[40:43]
    v_mfma_f32_16x16x32_bf16 v[36:39], a[88:91], a[48:51], v[36:39]
    s_add_u32 m0, m0, 0xc00
    v_xor_b32 v10, 0x80, v9
    v_mfma_f32_16x16x32_bf16 v[36:39], a[92:95], a[52:55], v[36:39]
    s_add_u32 s91, s70, 0x20000
    ds_read_b64_tr_b16 a[80:81], v10
    v_mfma_f32_16x16x32_bf16 v[32:35], a[92:95], a[44:47], v[32:35]
    ds_read_b64_tr_b16 a[82:83], v10 offset:1024
    buffer_load_dwordx4 v2, s[8:11], s91 offen lds
    v_mfma_f32_16x16x32_bf16 v[32:35], a[88:91], a[40:43], v[32:35]
    s_waitcnt lgkmcnt(8)
    ds_read_b64_tr_b16 a[84:85], v10 offset:8192
    v_mfma_f32_16x16x32_bf16 v[48:51], a[96:99], a[40:43], v[48:51]
    s_waitcnt lgkmcnt(7)
    s_add_u32 m0, m0, 0x400
    ds_read_b64_tr_b16 a[86:87], v10 offset:9216
    v_mfma_f32_16x16x32_bf16 v[48:51], a[100:103], a[44:47], v[48:51]
    s_add_u32 s91, s70, 0x28000
    v_mfma_f32_16x16x32_bf16 v[52:55], a[100:103], a[52:55], v[52:55]
    ds_read_b64_tr_b16 a[88:89], v10 offset:8
    buffer_load_dwordx4 v2, s[8:11], s91 offen lds
    v_mfma_f32_16x16x32_bf16 v[52:55], a[96:99], a[48:51], v[52:55]
    ds_read_b64_tr_b16 a[90:91], v10 offset:1032
    v_mfma_f32_16x16x32_bf16 v[56:59], a[96:99], a[56:59], v[56:59]
    v_mfma_f32_16x16x32_bf16 v[56:59], a[100:103], a[60:63], v[56:59]
    s_add_u32 m0, m0, 0xc00
    ds_read_b64_tr_b16 a[92:93], v10 offset:8200
    v_mfma_f32_16x16x32_bf16 v[60:63], a[100:103], a[68:71], v[60:63]
    s_add_u32 s91, s70, 0x40000
    ds_read_b64_tr_b16 a[94:95], v10 offset:9224
    v_mfma_f32_16x16x32_bf16 v[60:63], a[96:99], a[64:67], v[60:63]
    s_waitcnt lgkmcnt(10)
    buffer_load_dwordx4 v2, s[8:11], s91 offen lds
    v_mfma_f32_16x16x32_bf16 v[76:79], a[104:107], a[64:67], v[76:79]
    s_waitcnt lgkmcnt(8)
    v_xor_b32 v11, 0xc0, v9
    v_mfma_f32_16x16x32_bf16 v[76:79], a[108:111], a[68:71], v[76:79]
    ds_read_b64_tr_b16 a[96:97], v11
    v_mfma_f32_16x16x32_bf16 v[72:75], a[108:111], a[60:63], v[72:75]
    s_add_u32 m0, m0, 0x400
    ds_read_b64_tr_b16 a[98:99], v11 offset:1024
    v_mfma_f32_16x16x32_bf16 v[72:75], a[104:107], a[56:59], v[72:75]
    s_add_u32 s90, s54, 0
    ds_read_b64_tr_b16 a[100:101], v11 offset:8192
    v_mfma_f32_16x16x32_bf16 v[68:71], a[104:107], a[48:51], v[68:71]
    s_add_u32 s91, s70, 0x48000
    ds_read_b64_tr_b16 a[102:103], v11 offset:9216
    buffer_load_dwordx4 v[160:163], v4, s[24:27], s90 offen
    v_mfma_f32_16x16x32_bf16 v[68:71], a[108:111], a[52:55], v[68:71]
    buffer_load_dwordx4 v2, s[8:11], s91 offen lds
    v_mfma_f32_16x16x32_bf16 v[64:67], a[108:111], a[44:47], v[64:67]
    s_add_u32 m0, m0, 0xc00
    v_mfma_f32_16x16x32_bf16 v[64:67], a[104:107], a[40:43], v[64:67]
    s_waitcnt lgkmcnt(10)
    s_add_u32 s91, s70, 0x60000
    ds_read_b64_tr_b16 a[104:105], v11 offset:8
    v_mfma_f32_16x16x32_bf16 v[80:83], a[80:83], a[40:43], v[80:83]
    s_waitcnt lgkmcnt(9)
    ds_read_b64_tr_b16 a[106:107], v11 offset:1032
    buffer_load_dwordx4 v2, s[8:11], s91 offen lds
    v_mfma_f32_16x16x32_bf16 v[80:83], a[84:87], a[44:47], v[80:83]
    v_mfma_f32_16x16x32_bf16 v[84:87], a[84:87], a[52:55], v[84:87]
    ds_read_b64_tr_b16 a[108:109], v11 offset:8200
    v_mfma_f32_16x16x32_bf16 v[84:87], a[80:83], a[48:51], v[84:87]
    s_add_u32 m0, m0, 0x400
    ds_read_b64_tr_b16 a[110:111], v11 offset:9224
    v_mfma_f32_16x16x32_bf16 v[88:91], a[80:83], a[56:59], v[88:91]
    s_add_u32 s91, s70, 0x68000
    v_mfma_f32_16x16x32_bf16 v[88:91], a[84:87], a[60:63], v[88:91]
    buffer_load_dwordx4 v2, s[8:11], s91 offen lds
    v_mfma_f32_16x16x32_bf16 v[92:95], a[84:87], a[68:71], v[92:95]
    v_mfma_f32_16x16x32_bf16 v[92:95], a[80:83], a[64:67], v[92:95]
    v_mfma_f32_16x16x32_bf16 v[152:155], a[80:83], a[72:75], v[152:155]
    v_mfma_f32_16x16x32_bf16 v[152:155], a[84:87], a[76:79], v[152:155]
    s_waitcnt lgkmcnt(8)
    v_mfma_f32_16x16x32_bf16 v[156:159], a[92:95], a[76:79], v[156:159]
    s_cmp_gt_u32 s79, 3
    s_cselect_b32 s83, 3, 4
    v_mfma_f32_16x16x32_bf16 v[156:159], a[88:91], a[72:75], v[156:159]
    s_lshl_b32 s84, s83, 7
    v_mfma_f32_16x16x32_bf16 v[108:111], a[88:91], a[64:67], v[108:111]
    s_add_u32 s68, s80, s84
    v_mfma_f32_16x16x32_bf16 v[108:111], a[92:95], a[68:71], v[108:111]
    s_add_u32 s69, s81, s84
    s_lshl_b32 s84, s83, 19
    s_add_u32 s70, s82, s84
    v_mfma_f32_16x16x32_bf16 v[104:107], a[92:95], a[60:63], v[104:107]
    s_mov_b32 s75, s74
    s_cmp_eq_u32 s74, 0x19000
    s_cselect_b32 s76, 0xfffe7000, s96
    v_mfma_f32_16x16x32_bf16 v[104:107], a[88:91], a[56:59], v[104:107]
    s_add_u32 s74, s74, s76
    s_add_u32 s90, s77, 0x14000
    s_xor_b32 s90, s90, s47
    v_mfma_f32_16x16x32_bf16 v[100:103], a[88:91], a[48:51], v[100:103]
    buffer_load_dwordx4 a[232:235], v3, s[16:19], s90 offen offset:2048 nt
    v_add_u32 v9, s76, v9
    v_mfma_f32_16x16x32_bf16 v[100:103], a[92:95], a[52:55], v[100:103]
    s_waitcnt vmcnt(17) lgkmcnt(0)
    v_add_u32 v5, s76, v5
    v_add_u32 v6, s76, v6
    v_mfma_f32_16x16x32_bf16 v[96:99], a[92:95], a[44:47], v[96:99]
    s_barrier
    v_add_u32 v7, s76, v7
    v_add_u32 v8, s76, v8
    v_mfma_f32_16x16x32_bf16 v[96:99], a[88:91], a[40:43], v[96:99]
    v_mfma_f32_16x16x32_bf16 v[112:115], a[96:99], a[40:43], v[112:115]
    s_add_u32 m0, s75, s71
    ds_read_b128 a[0:3], v5
    ds_read_b64_tr_b16 a[80:81], v9
    v_mfma_f32_16x16x32_bf16 v[112:115], a[100:103], a[44:47], v[112:115]
    s_add_u32 s91, s68, 0
    ds_read_b64_tr_b16 a[82:83], v9 offset:1024
    v_mfma_f32_16x16x32_bf16 v[116:119], a[100:103], a[52:55], v[116:119]
    ds_read_b128 a[4:7], v6
    buffer_load_dwordx4 v1, s[4:7], s91 offen lds
    v_mfma_f32_16x16x32_bf16 v[116:119], a[96:99], a[48:51], v[116:119]
    ds_read_b64_tr_b16 a[84:85], v9 offset:8192
    v_mfma_f32_16x16x32_bf16 v[120:123], a[96:99], a[56:59], v[120:123]
    s_add_u32 m0, m0, 0x400
    ds_read_b64_tr_b16 a[86:87], v9 offset:9216
    v_mfma_f32_16x16x32_bf16 v[120:123], a[100:103], a[60:63], v[120:123]
    s_add_u32 s91, s68, 0x4000
    ds_read_b128 a[12:15], v6 offset:2048
    v_mfma_f32_16x16x32_bf16 v[124:127], a[100:103], a[68:71], v[124:127]
    buffer_load_dwordx4 v1, s[4:7], s91 offen lds
    v_mfma_f32_16x16x32_bf16 v[124:127], a[96:99], a[64:67], v[124:127]
    ds_read_b128 a[8:11], v5 offset:2048
    v_mfma_f32_16x16x32_bf16 v[140:143], a[104:107], a[64:67], v[140:143]
    ds_read_b128 a[16:19], v5 offset:4096
    v_mfma_f32_16x16x32_bf16 v[140:143], a[108:111], a[68:71], v[140:143]
    s_add_u32 m0, m0, 0x400
    ds_read_b128 a[20:23], v6 offset:4096
    v_mfma_f32_16x16x32_bf16 v[136:139], a[108:111], a[60:63], v[136:139]
    s_add_u32 s91, s68, 0x8000
    ds_read_b128 a[28:31], v6 offset:6144
    v_mfma_f32_16x16x32_bf16 v[136:139], a[104:107], a[56:59], v[136:139]
    ds_read_b128 a[24:27], v5 offset:6144
    buffer_load_dwordx4 v1, s[4:7], s91 offen lds
    v_mfma_f32_16x16x32_bf16 v[132:135], a[104:107], a[48:51], v[132:135]
    ds_read_b128 a[32:35], v7
    v_mfma_f32_16x16x32_bf16 v[132:135], a[108:111], a[52:55], v[132:135]
    s_add_u32 s90, s77, 0x14000
    ds_read_b128 a[36:39], v8
    v_mfma_f32_16x16x32_bf16 v[128:131], a[108:111], a[44:47], v[128:131]
    s_xor_b32 s90, s90, s47
    v_mfma_f32_16x16x32_bf16 v[128:131], a[104:107], a[40:43], v[128:131]
    s_waitcnt lgkmcnt(11)
    s_add_u32 m0, m0, 0x400
    ds_read_b64_tr_b16 a[88:89], v9 offset:8
    buffer_load_dwordx4 a[236:239], v15, s[16:19], s90 offen offset:3072 nt
    v_mfma_f32_16x16x32_bf16 v[16:19], a[80:83], a[0:3], v[16:19]
    s_waitcnt lgkmcnt(9)
    s_add_u32 s91, s68, 0xc000
    ds_read_b64_tr_b16 a[90:91], v9 offset:1032
    buffer_load_dwordx4 v1, s[4:7], s91 offen lds
    v_mfma_f32_16x16x32_bf16 v[16:19], a[84:87], a[4:7], v[16:19]
    s_waitcnt lgkmcnt(9)
    ds_read_b64_tr_b16 a[92:93], v9 offset:8200
    v_mfma_f32_16x16x32_bf16 v[20:23], a[84:87], a[12:15], v[20:23]
    s_waitcnt lgkmcnt(9)
    ds_read_b64_tr_b16 a[94:95], v9 offset:9224
    v_mfma_f32_16x16x32_bf16 v[20:23], a[80:83], a[8:11], v[20:23]
    s_waitcnt lgkmcnt(9)
    s_add_u32 m0, s75, s72
    v_mfma_f32_16x16x32_bf16 v[24:27], a[80:83], a[16:19], v[24:27]
    s_waitcnt lgkmcnt(8)
    v_xor_b32 v11, 64, v9
    v_mfma_f32_16x16x32_bf16 v[24:27], a[84:87], a[20:23], v[24:27]
    s_waitcnt lgkmcnt(7)
    ds_read_b64_tr_b16 a[96:97], v11
    v_mfma_f32_16x16x32_bf16 v[28:31], a[84:87], a[28:31], v[28:31]
    s_waitcnt lgkmcnt(7)
    s_mov_b64 exec, s[66:67]
    buffer_load_dwordx4 v1, s[4:7], s69 offen lds
    s_mov_b64 exec, -1
    v_mfma_f32_16x16x32_bf16 v[28:31], a[80:83], a[24:27], v[28:31]
    s_waitcnt lgkmcnt(6)
    s_add_u32 m0, s75, s73
    ds_read_b64_tr_b16 a[98:99], v11 offset:1024
    ds_read_b64_tr_b16 a[100:101], v11 offset:8192
    v_mfma_f32_16x16x32_bf16 v[144:147], a[80:83], a[32:35], v[144:147]
    s_waitcnt lgkmcnt(7)
    s_add_u32 s91, s70, 0
    ds_read_b64_tr_b16 a[102:103], v11 offset:9216
    v_mfma_f32_16x16x32_bf16 v[144:147], a[84:87], a[36:39], v[144:147]
    s_waitcnt lgkmcnt(4)
    buffer_load_dwordx4 v2, s[8:11], s91 offen lds
    v_mfma_f32_16x16x32_bf16 v[148:151], a[92:95], a[36:39], v[148:151]
    ds_read_b64_tr_b16 a[104:105], v11 offset:8
    v_mfma_f32_16x16x32_bf16 v[148:151], a[88:91], a[32:35], v[148:151]
    s_add_u32 m0, m0, 0x400
    ds_read_b64_tr_b16 a[106:107], v11 offset:1032
    v_mfma_f32_16x16x32_bf16 v[44:47], a[88:91], a[24:27], v[44:47]
    s_add_u32 s91, s70, 0x8000
    v_mfma_f32_16x16x32_bf16 v[44:47], a[92:95], a[28:31], v[44:47]
    ds_read_b64_tr_b16 a[108:109], v11 offset:8200
    buffer_load_dwordx4 v2, s[8:11], s91 offen lds
    v_mfma_f32_16x16x32_bf16 v[40:43], a[92:95], a[20:23], v[40:43]
    ds_read_b64_tr_b16 a[110:111], v11 offset:9224
    v_mfma_f32_16x16x32_bf16 v[40:43], a[88:91], a[16:19], v[40:43]
    v_mfma_f32_16x16x32_bf16 v[36:39], a[88:91], a[8:11], v[36:39]
    s_add_u32 m0, m0, 0xc00
    v_xor_b32 v10, 0x80, v9
    v_mfma_f32_16x16x32_bf16 v[36:39], a[92:95], a[12:15], v[36:39]
    s_add_u32 s91, s70, 0x20000
    ds_read_b64_tr_b16 a[80:81], v10
    v_mfma_f32_16x16x32_bf16 v[32:35], a[92:95], a[4:7], v[32:35]
    s_add_u32 s90, s54, 0
    ds_read_b64_tr_b16 a[82:83], v10 offset:1024
    buffer_load_dwordx4 v2, s[8:11], s91 offen lds
    v_mfma_f32_16x16x32_bf16 v[32:35], a[88:91], a[0:3], v[32:35]
    s_waitcnt lgkmcnt(8)
    ds_read_b64_tr_b16 a[84:85], v10 offset:8192
    buffer_load_dwordx4 v[164:167], v4, s[24:27], s90 offen offset:1024
    v_mfma_f32_16x16x32_bf16 v[48:51], a[96:99], a[0:3], v[48:51]
    s_waitcnt lgkmcnt(7)
    s_add_u32 m0, m0, 0x400
    ds_read_b64_tr_b16 a[86:87], v10 offset:9216
    v_mfma_f32_16x16x32_bf16 v[48:51], a[100:103], a[4:7], v[48:51]
    s_add_u32 s91, s70, 0x28000
    v_mfma_f32_16x16x32_bf16 v[52:55], a[100:103], a[12:15], v[52:55]
    ds_read_b64_tr_b16 a[88:89], v10 offset:8
    buffer_load_dwordx4 v2, s[8:11], s91 offen lds
    v_mfma_f32_16x16x32_bf16 v[52:55], a[96:99], a[8:11], v[52:55]
    ds_read_b64_tr_b16 a[90:91], v10 offset:1032
    v_mfma_f32_16x16x32_bf16 v[56:59], a[96:99], a[16:19], v[56:59]
    s_lshl_b32 s62, s3, 4
    s_cmp_eq_u32 s56, 0
    s_cselect_b32 s62, s62, 0x10000000
    v_mov_b32 v204, 0
    v_mov_b32 v205, 1
    s_mov_b64 exec, 1
    buffer_atomic_add v205, v204, s[32:35], s62 offen sc1
    s_mov_b64 exec, -1
    v_mfma_f32_16x16x32_bf16 v[56:59], a[100:103], a[20:23], v[56:59]
    s_add_u32 m0, m0, 0xc00
    ds_read_b64_tr_b16 a[92:93], v10 offset:8200
    v_mfma_f32_16x16x32_bf16 v[60:63], a[100:103], a[28:31], v[60:63]
    s_add_u32 s91, s70, 0x40000
    ds_read_b64_tr_b16 a[94:95], v10 offset:9224
    v_mfma_f32_16x16x32_bf16 v[60:63], a[96:99], a[24:27], v[60:63]
    s_waitcnt lgkmcnt(10)
    buffer_load_dwordx4 v2, s[8:11], s91 offen lds
    v_mfma_f32_16x16x32_bf16 v[76:79], a[104:107], a[24:27], v[76:79]
    s_waitcnt lgkmcnt(8)
    v_xor_b32 v11, 0xc0, v9
    v_mfma_f32_16x16x32_bf16 v[76:79], a[108:111], a[28:31], v[76:79]
    ds_read_b64_tr_b16 a[96:97], v11
    v_mfma_f32_16x16x32_bf16 v[72:75], a[108:111], a[20:23], v[72:75]
    s_add_u32 m0, m0, 0x400
    ds_read_b64_tr_b16 a[98:99], v11 offset:1024
    v_mfma_f32_16x16x32_bf16 v[72:75], a[104:107], a[16:19], v[72:75]
    s_add_u32 s91, s70, 0x48000
    ds_read_b64_tr_b16 a[100:101], v11 offset:8192
    v_mfma_f32_16x16x32_bf16 v[68:71], a[104:107], a[8:11], v[68:71]
    ds_read_b64_tr_b16 a[102:103], v11 offset:9216
    buffer_load_dwordx4 v2, s[8:11], s91 offen lds
    v_mfma_f32_16x16x32_bf16 v[68:71], a[108:111], a[12:15], v[68:71]
    v_mfma_f32_16x16x32_bf16 v[64:67], a[108:111], a[4:7], v[64:67]
    s_add_u32 m0, m0, 0xc00
    v_mfma_f32_16x16x32_bf16 v[64:67], a[104:107], a[0:3], v[64:67]
    s_waitcnt lgkmcnt(10)
    s_add_u32 s91, s70, 0x60000
    ds_read_b64_tr_b16 a[104:105], v11 offset:8
    v_mfma_f32_16x16x32_bf16 v[80:83], a[80:83], a[0:3], v[80:83]
    s_waitcnt lgkmcnt(9)
    s_add_u32 s90, s77, 0x15000
    ds_read_b64_tr_b16 a[106:107], v11 offset:1032
    buffer_load_dwordx4 v2, s[8:11], s91 offen lds
    v_mfma_f32_16x16x32_bf16 v[80:83], a[84:87], a[4:7], v[80:83]
    s_xor_b32 s90, s90, s47
    v_mfma_f32_16x16x32_bf16 v[84:87], a[84:87], a[12:15], v[84:87]
    ds_read_b64_tr_b16 a[108:109], v11 offset:8200
    buffer_load_dwordx4 a[240:243], v3, s[16:19], s90 offen nt
    v_mfma_f32_16x16x32_bf16 v[84:87], a[80:83], a[8:11], v[84:87]
    s_add_u32 m0, m0, 0x400
    ds_read_b64_tr_b16 a[110:111], v11 offset:9224
    v_mfma_f32_16x16x32_bf16 v[88:91], a[80:83], a[16:19], v[88:91]
    s_add_u32 s91, s70, 0x68000
    v_mfma_f32_16x16x32_bf16 v[88:91], a[84:87], a[20:23], v[88:91]
    buffer_load_dwordx4 v2, s[8:11], s91 offen lds
    v_mfma_f32_16x16x32_bf16 v[92:95], a[84:87], a[28:31], v[92:95]
    v_mfma_f32_16x16x32_bf16 v[92:95], a[80:83], a[24:27], v[92:95]
    v_mfma_f32_16x16x32_bf16 v[152:155], a[80:83], a[32:35], v[152:155]
    v_mfma_f32_16x16x32_bf16 v[152:155], a[84:87], a[36:39], v[152:155]
    s_waitcnt lgkmcnt(8)
    v_mfma_f32_16x16x32_bf16 v[156:159], a[92:95], a[36:39], v[156:159]
    s_cmp_gt_u32 s79, 4
    s_cselect_b32 s83, 4, 5
    v_mfma_f32_16x16x32_bf16 v[156:159], a[88:91], a[32:35], v[156:159]
    s_lshl_b32 s84, s83, 7
    v_mfma_f32_16x16x32_bf16 v[108:111], a[88:91], a[24:27], v[108:111]
    s_add_u32 s68, s80, s84
    v_mfma_f32_16x16x32_bf16 v[108:111], a[92:95], a[28:31], v[108:111]
    s_add_u32 s69, s81, s84
    s_lshl_b32 s84, s83, 19
    s_add_u32 s70, s82, s84
    v_mfma_f32_16x16x32_bf16 v[104:107], a[92:95], a[20:23], v[104:107]
    s_mov_b32 s75, s74
    s_cmp_eq_u32 s74, 0x19000
    s_cselect_b32 s76, 0xfffe7000, s96
    v_mfma_f32_16x16x32_bf16 v[104:107], a[88:91], a[16:19], v[104:107]
    s_add_u32 s74, s74, s76
    v_add_u32 v9, s76, v9
    v_add_u32 v5, s76, v5
    v_mfma_f32_16x16x32_bf16 v[100:103], a[88:91], a[8:11], v[100:103]
    v_add_u32 v6, s76, v6
    v_add_u32 v7, s76, v7
    v_mfma_f32_16x16x32_bf16 v[100:103], a[92:95], a[12:15], v[100:103]
    s_waitcnt vmcnt(18) lgkmcnt(0)
    v_add_u32 v8, s76, v8
    v_mfma_f32_16x16x32_bf16 v[96:99], a[92:95], a[4:7], v[96:99]
    s_barrier
    v_mfma_f32_16x16x32_bf16 v[96:99], a[88:91], a[0:3], v[96:99]
    v_mfma_f32_16x16x32_bf16 v[112:115], a[96:99], a[0:3], v[112:115]
    s_add_u32 m0, s75, s71
    ds_read_b128 a[40:43], v5
    ds_read_b64_tr_b16 a[80:81], v9
    v_mfma_f32_16x16x32_bf16 v[112:115], a[100:103], a[4:7], v[112:115]
    s_add_u32 s91, s68, 0
    ds_read_b64_tr_b16 a[82:83], v9 offset:1024
    v_mfma_f32_16x16x32_bf16 v[116:119], a[100:103], a[12:15], v[116:119]
    s_add_u32 s90, s77, 0x15000
    ds_read_b128 a[44:47], v6
    buffer_load_dwordx4 v1, s[4:7], s91 offen lds
    v_mfma_f32_16x16x32_bf16 v[116:119], a[96:99], a[8:11], v[116:119]
    s_xor_b32 s90, s90, s47
    ds_read_b64_tr_b16 a[84:85], v9 offset:8192
    buffer_load_dwordx4 a[244:247], v15, s[16:19], s90 offen offset:1024 nt
    v_mfma_f32_16x16x32_bf16 v[120:123], a[96:99], a[16:19], v[120:123]
    s_add_u32 m0, m0, 0x400
    ds_read_b64_tr_b16 a[86:87], v9 offset:9216
    v_mfma_f32_16x16x32_bf16 v[120:123], a[100:103], a[20:23], v[120:123]
    s_add_u32 s91, s68, 0x4000
    ds_read_b128 a[52:55], v6 offset:2048
    v_mfma_f32_16x16x32_bf16 v[124:127], a[100:103], a[28:31], v[124:127]
    buffer_load_dwordx4 v1, s[4:7], s91 offen lds
    v_mfma_f32_16x16x32_bf16 v[124:127], a[96:99], a[24:27], v[124:127]
    ds_read_b128 a[48:51], v5 offset:2048
    v_mfma_f32_16x16x32_bf16 v[140:143], a[104:107], a[24:27], v[140:143]
    ds_read_b128 a[56:59], v5 offset:4096
    v_mfma_f32_16x16x32_bf16 v[140:143], a[108:111], a[28:31], v[140:143]
    s_add_u32 m0, m0, 0x400
    ds_read_b128 a[60:63], v6 offset:4096
    v_mfma_f32_16x16x32_bf16 v[136:139], a[108:111], a[20:23], v[136:139]
    s_add_u32 s91, s68, 0x8000
    ds_read_b128 a[68:71], v6 offset:6144
    v_mfma_f32_16x16x32_bf16 v[136:139], a[104:107], a[16:19], v[136:139]
    ds_read_b128 a[64:67], v5 offset:6144
    buffer_load_dwordx4 v1, s[4:7], s91 offen lds
    v_mfma_f32_16x16x32_bf16 v[132:135], a[104:107], a[8:11], v[132:135]
    ds_read_b128 a[72:75], v7
    v_mfma_f32_16x16x32_bf16 v[132:135], a[108:111], a[12:15], v[132:135]
    s_add_u32 m0, m0, 0x400
    ds_read_b128 a[76:79], v8
    v_mfma_f32_16x16x32_bf16 v[128:131], a[108:111], a[4:7], v[128:131]
    s_add_u32 s91, s68, 0xc000
    v_mfma_f32_16x16x32_bf16 v[128:131], a[104:107], a[0:3], v[128:131]
    s_waitcnt lgkmcnt(11)
    ds_read_b64_tr_b16 a[88:89], v9 offset:8
    buffer_load_dwordx4 v1, s[4:7], s91 offen lds
    v_mfma_f32_16x16x32_bf16 v[16:19], a[80:83], a[40:43], v[16:19]
    s_waitcnt lgkmcnt(9)
    ds_read_b64_tr_b16 a[90:91], v9 offset:1032
    v_mfma_f32_16x16x32_bf16 v[16:19], a[84:87], a[44:47], v[16:19]
    s_waitcnt lgkmcnt(9)
    ds_read_b64_tr_b16 a[92:93], v9 offset:8200
    v_mfma_f32_16x16x32_bf16 v[20:23], a[84:87], a[52:55], v[20:23]
    s_waitcnt lgkmcnt(9)
    ds_read_b64_tr_b16 a[94:95], v9 offset:9224
    v_mfma_f32_16x16x32_bf16 v[20:23], a[80:83], a[48:51], v[20:23]
    s_waitcnt lgkmcnt(9)
    s_add_u32 m0, s75, s72
    v_mfma_f32_16x16x32_bf16 v[24:27], a[80:83], a[56:59], v[24:27]
    s_waitcnt lgkmcnt(8)
    s_add_u32 s90, s54, 0
    v_xor_b32 v11, 64, v9
    v_mfma_f32_16x16x32_bf16 v[24:27], a[84:87], a[60:63], v[24:27]
    s_waitcnt lgkmcnt(7)
    ds_read_b64_tr_b16 a[96:97], v11
    buffer_load_dwordx4 v[168:171], v4, s[24:27], s90 offen offset:2048
    v_mfma_f32_16x16x32_bf16 v[28:31], a[84:87], a[68:71], v[28:31]
    s_waitcnt lgkmcnt(7)
    s_mov_b64 exec, s[66:67]
    buffer_load_dwordx4 v1, s[4:7], s69 offen lds
    s_mov_b64 exec, -1
    v_mfma_f32_16x16x32_bf16 v[28:31], a[80:83], a[64:67], v[28:31]
    s_waitcnt lgkmcnt(6)
    s_add_u32 m0, s75, s73
    ds_read_b64_tr_b16 a[98:99], v11 offset:1024
    ds_read_b64_tr_b16 a[100:101], v11 offset:8192
    v_mfma_f32_16x16x32_bf16 v[144:147], a[80:83], a[72:75], v[144:147]
    s_waitcnt lgkmcnt(7)
    s_add_u32 s91, s70, 0
    ds_read_b64_tr_b16 a[102:103], v11 offset:9216
    v_mfma_f32_16x16x32_bf16 v[144:147], a[84:87], a[76:79], v[144:147]
    s_waitcnt lgkmcnt(4)
    buffer_load_dwordx4 v2, s[8:11], s91 offen lds
    v_mfma_f32_16x16x32_bf16 v[148:151], a[92:95], a[76:79], v[148:151]
    ds_read_b64_tr_b16 a[104:105], v11 offset:8
    v_mfma_f32_16x16x32_bf16 v[148:151], a[88:91], a[72:75], v[148:151]
    s_add_u32 m0, m0, 0x400
    ds_read_b64_tr_b16 a[106:107], v11 offset:1032
    v_mfma_f32_16x16x32_bf16 v[44:47], a[88:91], a[64:67], v[44:47]
    s_add_u32 s91, s70, 0x8000
    v_mfma_f32_16x16x32_bf16 v[44:47], a[92:95], a[68:71], v[44:47]
    ds_read_b64_tr_b16 a[108:109], v11 offset:8200
    buffer_load_dwordx4 v2, s[8:11], s91 offen lds
    v_mfma_f32_16x16x32_bf16 v[40:43], a[92:95], a[60:63], v[40:43]
    ds_read_b64_tr_b16 a[110:111], v11 offset:9224
    v_mfma_f32_16x16x32_bf16 v[40:43], a[88:91], a[56:59], v[40:43]
    v_mfma_f32_16x16x32_bf16 v[36:39], a[88:91], a[48:51], v[36:39]
    s_add_u32 m0, m0, 0xc00
    v_xor_b32 v10, 0x80, v9
    v_mfma_f32_16x16x32_bf16 v[36:39], a[92:95], a[52:55], v[36:39]
    s_add_u32 s91, s70, 0x20000
    ds_read_b64_tr_b16 a[80:81], v10
    v_mfma_f32_16x16x32_bf16 v[32:35], a[92:95], a[44:47], v[32:35]
    ds_read_b64_tr_b16 a[82:83], v10 offset:1024
    buffer_load_dwordx4 v2, s[8:11], s91 offen lds
    v_mfma_f32_16x16x32_bf16 v[32:35], a[88:91], a[40:43], v[32:35]
    s_waitcnt lgkmcnt(8)
    ds_read_b64_tr_b16 a[84:85], v10 offset:8192
    v_mfma_f32_16x16x32_bf16 v[48:51], a[96:99], a[40:43], v[48:51]
    s_waitcnt lgkmcnt(7)
    s_add_u32 m0, m0, 0x400
    ds_read_b64_tr_b16 a[86:87], v10 offset:9216
    v_mfma_f32_16x16x32_bf16 v[48:51], a[100:103], a[44:47], v[48:51]
    s_add_u32 s91, s70, 0x28000
    v_mfma_f32_16x16x32_bf16 v[52:55], a[100:103], a[52:55], v[52:55]
    ds_read_b64_tr_b16 a[88:89], v10 offset:8
    buffer_load_dwordx4 v2, s[8:11], s91 offen lds
    v_mfma_f32_16x16x32_bf16 v[52:55], a[96:99], a[48:51], v[52:55]
    s_add_u32 s90, s77, 0x15000
    ds_read_b64_tr_b16 a[90:91], v10 offset:1032
    v_mfma_f32_16x16x32_bf16 v[56:59], a[96:99], a[56:59], v[56:59]
    s_xor_b32 s90, s90, s47
    v_mfma_f32_16x16x32_bf16 v[56:59], a[100:103], a[60:63], v[56:59]
    s_add_u32 m0, m0, 0xc00
    ds_read_b64_tr_b16 a[92:93], v10 offset:8200
    buffer_load_dwordx4 a[248:251], v3, s[16:19], s90 offen offset:2048 nt
    v_mfma_f32_16x16x32_bf16 v[60:63], a[100:103], a[68:71], v[60:63]
    s_add_u32 s91, s70, 0x40000
    ds_read_b64_tr_b16 a[94:95], v10 offset:9224
    v_mfma_f32_16x16x32_bf16 v[60:63], a[96:99], a[64:67], v[60:63]
    s_waitcnt lgkmcnt(10)
    buffer_load_dwordx4 v2, s[8:11], s91 offen lds
    v_mfma_f32_16x16x32_bf16 v[76:79], a[104:107], a[64:67], v[76:79]
    s_waitcnt lgkmcnt(8)
    v_xor_b32 v11, 0xc0, v9
    v_mfma_f32_16x16x32_bf16 v[76:79], a[108:111], a[68:71], v[76:79]
    ds_read_b64_tr_b16 a[96:97], v11
    v_mfma_f32_16x16x32_bf16 v[72:75], a[108:111], a[60:63], v[72:75]
    s_add_u32 m0, m0, 0x400
    ds_read_b64_tr_b16 a[98:99], v11 offset:1024
    v_mfma_f32_16x16x32_bf16 v[72:75], a[104:107], a[56:59], v[72:75]
    s_add_u32 s91, s70, 0x48000
    ds_read_b64_tr_b16 a[100:101], v11 offset:8192
    v_mfma_f32_16x16x32_bf16 v[68:71], a[104:107], a[48:51], v[68:71]
    ds_read_b64_tr_b16 a[102:103], v11 offset:9216
    buffer_load_dwordx4 v2, s[8:11], s91 offen lds
    v_mfma_f32_16x16x32_bf16 v[68:71], a[108:111], a[52:55], v[68:71]
    v_mfma_f32_16x16x32_bf16 v[64:67], a[108:111], a[44:47], v[64:67]
    s_add_u32 m0, m0, 0xc00
    v_mfma_f32_16x16x32_bf16 v[64:67], a[104:107], a[40:43], v[64:67]
    s_waitcnt lgkmcnt(10)
    s_add_u32 s91, s70, 0x60000
    ds_read_b64_tr_b16 a[104:105], v11 offset:8
    v_mfma_f32_16x16x32_bf16 v[80:83], a[80:83], a[40:43], v[80:83]
    s_waitcnt lgkmcnt(9)
    ds_read_b64_tr_b16 a[106:107], v11 offset:1032
    buffer_load_dwordx4 v2, s[8:11], s91 offen lds
    v_mfma_f32_16x16x32_bf16 v[80:83], a[84:87], a[44:47], v[80:83]
    v_mfma_f32_16x16x32_bf16 v[84:87], a[84:87], a[52:55], v[84:87]
    ds_read_b64_tr_b16 a[108:109], v11 offset:8200
    v_mfma_f32_16x16x32_bf16 v[84:87], a[80:83], a[48:51], v[84:87]
    s_add_u32 m0, m0, 0x400
    ds_read_b64_tr_b16 a[110:111], v11 offset:9224
    v_mfma_f32_16x16x32_bf16 v[88:91], a[80:83], a[56:59], v[88:91]
    s_add_u32 s91, s70, 0x68000
    v_mfma_f32_16x16x32_bf16 v[88:91], a[84:87], a[60:63], v[88:91]
    buffer_load_dwordx4 v2, s[8:11], s91 offen lds
    v_mfma_f32_16x16x32_bf16 v[92:95], a[84:87], a[68:71], v[92:95]
    s_add_u32 s90, s77, 0x15000
    v_mfma_f32_16x16x32_bf16 v[92:95], a[80:83], a[64:67], v[92:95]
    s_xor_b32 s90, s90, s47
    v_mfma_f32_16x16x32_bf16 v[152:155], a[80:83], a[72:75], v[152:155]
    buffer_load_dwordx4 a[252:255], v15, s[16:19], s90 offen offset:3072 nt
    v_mfma_f32_16x16x32_bf16 v[152:155], a[84:87], a[76:79], v[152:155]
    s_waitcnt lgkmcnt(8)
    v_mfma_f32_16x16x32_bf16 v[156:159], a[92:95], a[76:79], v[156:159]
    s_cmp_gt_u32 s79, 5
    s_cselect_b32 s83, 5, 6
    v_mfma_f32_16x16x32_bf16 v[156:159], a[88:91], a[72:75], v[156:159]
    s_lshl_b32 s84, s83, 7
    v_mfma_f32_16x16x32_bf16 v[108:111], a[88:91], a[64:67], v[108:111]
    s_add_u32 s68, s80, s84
    v_mfma_f32_16x16x32_bf16 v[108:111], a[92:95], a[68:71], v[108:111]
    s_add_u32 s69, s81, s84
    s_lshl_b32 s84, s83, 19
    s_add_u32 s70, s82, s84
    v_mfma_f32_16x16x32_bf16 v[104:107], a[92:95], a[60:63], v[104:107]
    s_mov_b32 s75, s74
    s_cmp_eq_u32 s74, 0x19000
    s_cselect_b32 s76, 0xfffe7000, s96
    v_mfma_f32_16x16x32_bf16 v[104:107], a[88:91], a[56:59], v[104:107]
    s_add_u32 s74, s74, s76
    v_add_u32 v9, s76, v9
    v_add_u32 v5, s76, v5
    v_mfma_f32_16x16x32_bf16 v[100:103], a[88:91], a[48:51], v[100:103]
    v_add_u32 v6, s76, v6
    v_add_u32 v7, s76, v7
    v_mfma_f32_16x16x32_bf16 v[100:103], a[92:95], a[52:55], v[100:103]
    s_waitcnt vmcnt(17) lgkmcnt(0)
    v_add_u32 v8, s76, v8
    v_mfma_f32_16x16x32_bf16 v[96:99], a[92:95], a[44:47], v[96:99]
    s_barrier
    v_mfma_f32_16x16x32_bf16 v[96:99], a[88:91], a[40:43], v[96:99]
    v_mfma_f32_16x16x32_bf16 v[112:115], a[96:99], a[40:43], v[112:115]
    s_add_u32 m0, s75, s71
    ds_read_b128 a[0:3], v5
    ds_read_b64_tr_b16 a[80:81], v9
    v_mfma_f32_16x16x32_bf16 v[112:115], a[100:103], a[44:47], v[112:115]
    s_add_u32 s91, s68, 0
    ds_read_b64_tr_b16 a[82:83], v9 offset:1024
    v_mfma_f32_16x16x32_bf16 v[116:119], a[100:103], a[52:55], v[116:119]
    ds_read_b128 a[4:7], v6
    buffer_load_dwordx4 v1, s[4:7], s91 offen lds
    v_mfma_f32_16x16x32_bf16 v[116:119], a[96:99], a[48:51], v[116:119]
    ds_read_b64_tr_b16 a[84:85], v9 offset:8192
    v_mfma_f32_16x16x32_bf16 v[120:123], a[96:99], a[56:59], v[120:123]
    s_add_u32 m0, m0, 0x400
    ds_read_b64_tr_b16 a[86:87], v9 offset:9216
    v_mfma_f32_16x16x32_bf16 v[120:123], a[100:103], a[60:63], v[120:123]
    s_add_u32 s91, s68, 0x4000
    ds_read_b128 a[12:15], v6 offset:2048
    v_mfma_f32_16x16x32_bf16 v[124:127], a[100:103], a[68:71], v[124:127]
    buffer_load_dwordx4 v1, s[4:7], s91 offen lds
    v_mfma_f32_16x16x32_bf16 v[124:127], a[96:99], a[64:67], v[124:127]
    s_add_u32 s90, s54, 0
    ds_read_b128 a[8:11], v5 offset:2048
    v_mfma_f32_16x16x32_bf16 v[140:143], a[104:107], a[64:67], v[140:143]
    ds_read_b128 a[16:19], v5 offset:4096
    buffer_load_dwordx4 v[172:175], v4, s[24:27], s90 offen offset:3072
    v_mfma_f32_16x16x32_bf16 v[140:143], a[108:111], a[68:71], v[140:143]
    s_add_u32 m0, m0, 0x400
    ds_read_b128 a[20:23], v6 offset:4096
    v_mfma_f32_16x16x32_bf16 v[136:139], a[108:111], a[60:63], v[136:139]
    s_add_u32 s91, s68, 0x8000
    ds_read_b128 a[28:31], v6 offset:6144
    v_mfma_f32_16x16x32_bf16 v[136:139], a[104:107], a[56:59], v[136:139]
    ds_read_b128 a[24:27], v5 offset:6144
    buffer_load_dwordx4 v1, s[4:7], s91 offen lds
    v_mfma_f32_16x16x32_bf16 v[132:135], a[104:107], a[48:51], v[132:135]
    ds_read_b128 a[32:35], v7
    v_mfma_f32_16x16x32_bf16 v[132:135], a[108:111], a[52:55], v[132:135]
    s_add_u32 m0, m0, 0x400
    ds_read_b128 a[36:39], v8
    v_mfma_f32_16x16x32_bf16 v[128:131], a[108:111], a[44:47], v[128:131]
    s_add_u32 s91, s68, 0xc000
    v_mfma_f32_16x16x32_bf16 v[128:131], a[104:107], a[40:43], v[128:131]
    s_waitcnt lgkmcnt(11)
    ds_read_b64_tr_b16 a[88:89], v9 offset:8
    buffer_load_dwordx4 v1, s[4:7], s91 offen lds
    v_mfma_f32_16x16x32_bf16 v[16:19], a[80:83], a[0:3], v[16:19]
    s_waitcnt lgkmcnt(9)
    ds_read_b64_tr_b16 a[90:91], v9 offset:1032
    v_mfma_f32_16x16x32_bf16 v[16:19], a[84:87], a[4:7], v[16:19]
    s_waitcnt lgkmcnt(9)
    ds_read_b64_tr_b16 a[92:93], v9 offset:8200
    v_mfma_f32_16x16x32_bf16 v[20:23], a[84:87], a[12:15], v[20:23]
    s_waitcnt lgkmcnt(9)
    ds_read_b64_tr_b16 a[94:95], v9 offset:9224
    v_mfma_f32_16x16x32_bf16 v[20:23], a[80:83], a[8:11], v[20:23]
    s_waitcnt lgkmcnt(9)
    s_add_u32 m0, s75, s72
    v_mfma_f32_16x16x32_bf16 v[24:27], a[80:83], a[16:19], v[24:27]
    s_waitcnt lgkmcnt(8)
    v_xor_b32 v11, 64, v9
    v_mfma_f32_16x16x32_bf16 v[24:27], a[84:87], a[20:23], v[24:27]
    s_waitcnt lgkmcnt(7)
    ds_read_b64_tr_b16 a[96:97], v11
    v_mfma_f32_16x16x32_bf16 v[28:31], a[84:87], a[28:31], v[28:31]
    s_waitcnt lgkmcnt(7)
    s_mov_b64 exec, s[66:67]
    buffer_load_dwordx4 v1, s[4:7], s69 offen lds
    s_mov_b64 exec, -1
    v_mfma_f32_16x16x32_bf16 v[28:31], a[80:83], a[24:27], v[28:31]
    s_waitcnt lgkmcnt(6)
    s_add_u32 m0, s75, s73
    ds_read_b64_tr_b16 a[98:99], v11 offset:1024
    ds_read_b64_tr_b16 a[100:101], v11 offset:8192
    v_mfma_f32_16x16x32_bf16 v[144:147], a[80:83], a[32:35], v[144:147]
    s_waitcnt lgkmcnt(7)
    s_add_u32 s91, s70, 0
    ds_read_b64_tr_b16 a[102:103], v11 offset:9216
    v_mfma_f32_16x16x32_bf16 v[144:147], a[84:87], a[36:39], v[144:147]
    s_waitcnt lgkmcnt(4)
    s_add_u32 s90, s77, 0xc000
    buffer_load_dwordx4 v2, s[8:11], s91 offen lds
    v_mfma_f32_16x16x32_bf16 v[148:151], a[92:95], a[36:39], v[148:151]
    s_xor_b32 s90, s90, s47
    ds_read_b64_tr_b16 a[104:105], v11 offset:8
    v_mfma_f32_16x16x32_bf16 v[148:151], a[88:91], a[32:35], v[148:151]
    s_add_u32 m0, m0, 0x400
    ds_read_b64_tr_b16 a[106:107], v11 offset:1032
    buffer_load_dwordx4 a[192:195], v3, s[16:19], s90 offen nt
    v_mfma_f32_16x16x32_bf16 v[44:47], a[88:91], a[24:27], v[44:47]
    s_add_u32 s91, s70, 0x8000
    v_mfma_f32_16x16x32_bf16 v[44:47], a[92:95], a[28:31], v[44:47]
    ds_read_b64_tr_b16 a[108:109], v11 offset:8200
    buffer_load_dwordx4 v2, s[8:11], s91 offen lds
    v_mfma_f32_16x16x32_bf16 v[40:43], a[92:95], a[20:23], v[40:43]
    ds_read_b64_tr_b16 a[110:111], v11 offset:9224
    v_mfma_f32_16x16x32_bf16 v[40:43], a[88:91], a[16:19], v[40:43]
    v_mfma_f32_16x16x32_bf16 v[36:39], a[88:91], a[8:11], v[36:39]
    s_add_u32 m0, m0, 0xc00
    v_xor_b32 v10, 0x80, v9
    v_mfma_f32_16x16x32_bf16 v[36:39], a[92:95], a[12:15], v[36:39]
    s_add_u32 s91, s70, 0x20000
    ds_read_b64_tr_b16 a[80:81], v10
    v_mfma_f32_16x16x32_bf16 v[32:35], a[92:95], a[4:7], v[32:35]
    ds_read_b64_tr_b16 a[82:83], v10 offset:1024
    buffer_load_dwordx4 v2, s[8:11], s91 offen lds
    v_mfma_f32_16x16x32_bf16 v[32:35], a[88:91], a[0:3], v[32:35]
    s_waitcnt lgkmcnt(8)
    ds_read_b64_tr_b16 a[84:85], v10 offset:8192
    v_mfma_f32_16x16x32_bf16 v[48:51], a[96:99], a[0:3], v[48:51]
    s_waitcnt lgkmcnt(7)
    s_add_u32 m0, m0, 0x400
    ds_read_b64_tr_b16 a[86:87], v10 offset:9216
    v_mfma_f32_16x16x32_bf16 v[48:51], a[100:103], a[4:7], v[48:51]
    s_add_u32 s91, s70, 0x28000
    v_mfma_f32_16x16x32_bf16 v[52:55], a[100:103], a[12:15], v[52:55]
    ds_read_b64_tr_b16 a[88:89], v10 offset:8
    buffer_load_dwordx4 v2, s[8:11], s91 offen lds
    v_mfma_f32_16x16x32_bf16 v[52:55], a[96:99], a[8:11], v[52:55]
    ds_read_b64_tr_b16 a[90:91], v10 offset:1032
    v_mfma_f32_16x16x32_bf16 v[56:59], a[96:99], a[16:19], v[56:59]
    v_mfma_f32_16x16x32_bf16 v[56:59], a[100:103], a[20:23], v[56:59]
    s_add_u32 m0, m0, 0xc00
    ds_read_b64_tr_b16 a[92:93], v10 offset:8200
    v_mfma_f32_16x16x32_bf16 v[60:63], a[100:103], a[28:31], v[60:63]
    s_add_u32 s91, s70, 0x40000
    ds_read_b64_tr_b16 a[94:95], v10 offset:9224
    v_mfma_f32_16x16x32_bf16 v[60:63], a[96:99], a[24:27], v[60:63]
    s_waitcnt lgkmcnt(10)
    buffer_load_dwordx4 v2, s[8:11], s91 offen lds
    v_mfma_f32_16x16x32_bf16 v[76:79], a[104:107], a[24:27], v[76:79]
    s_waitcnt lgkmcnt(8)
    v_xor_b32 v11, 0xc0, v9
    v_mfma_f32_16x16x32_bf16 v[76:79], a[108:111], a[28:31], v[76:79]
    s_add_u32 s90, s77, 0xc000
    ds_read_b64_tr_b16 a[96:97], v11
    v_mfma_f32_16x16x32_bf16 v[72:75], a[108:111], a[20:23], v[72:75]
    s_xor_b32 s90, s90, s47
    ds_read_b64_tr_b16 a[98:99], v11 offset:1024
    v_mfma_f32_16x16x32_bf16 v[72:75], a[104:107], a[16:19], v[72:75]
    s_add_u32 m0, m0, 0x400
    ds_read_b64_tr_b16 a[100:101], v11 offset:8192
    buffer_load_dwordx4 a[196:199], v15, s[16:19], s90 offen offset:1024 nt
    v_mfma_f32_16x16x32_bf16 v[68:71], a[104:107], a[8:11], v[68:71]
    s_add_u32 s91, s70, 0x48000
    ds_read_b64_tr_b16 a[102:103], v11 offset:9216
    buffer_load_dwordx4 v2, s[8:11], s91 offen lds
    v_mfma_f32_16x16x32_bf16 v[68:71], a[108:111], a[12:15], v[68:71]
    v_mfma_f32_16x16x32_bf16 v[64:67], a[108:111], a[4:7], v[64:67]
    s_add_u32 m0, m0, 0xc00
    v_mfma_f32_16x16x32_bf16 v[64:67], a[104:107], a[0:3], v[64:67]
    s_waitcnt lgkmcnt(10)
    s_add_u32 s91, s70, 0x60000
    ds_read_b64_tr_b16 a[104:105], v11 offset:8
    v_mfma_f32_16x16x32_bf16 v[80:83], a[80:83], a[0:3], v[80:83]
    s_waitcnt lgkmcnt(9)
    ds_read_b64_tr_b16 a[106:107], v11 offset:1032
    buffer_load_dwordx4 v2, s[8:11], s91 offen lds
    v_mfma_f32_16x16x32_bf16 v[80:83], a[84:87], a[4:7], v[80:83]
    v_mfma_f32_16x16x32_bf16 v[84:87], a[84:87], a[12:15], v[84:87]
    ds_read_b64_tr_b16 a[108:109], v11 offset:8200
    v_mfma_f32_16x16x32_bf16 v[84:87], a[80:83], a[8:11], v[84:87]
    s_add_u32 m0, m0, 0x400
    ds_read_b64_tr_b16 a[110:111], v11 offset:9224
    v_mfma_f32_16x16x32_bf16 v[88:91], a[80:83], a[16:19], v[88:91]
    s_add_u32 s91, s70, 0x68000
    v_mfma_f32_16x16x32_bf16 v[88:91], a[84:87], a[20:23], v[88:91]
    buffer_load_dwordx4 v2, s[8:11], s91 offen lds
    v_mfma_f32_16x16x32_bf16 v[92:95], a[84:87], a[28:31], v[92:95]
    v_mfma_f32_16x16x32_bf16 v[92:95], a[80:83], a[24:27], v[92:95]
    v_mfma_f32_16x16x32_bf16 v[152:155], a[80:83], a[32:35], v[152:155]
    v_mfma_f32_16x16x32_bf16 v[152:155], a[84:87], a[36:39], v[152:155]
    s_waitcnt lgkmcnt(8)
    v_mfma_f32_16x16x32_bf16 v[156:159], a[92:95], a[36:39], v[156:159]
    s_cmp_gt_u32 s79, 6
    s_cselect_b32 s83, 6, 7
    v_mfma_f32_16x16x32_bf16 v[156:159], a[88:91], a[32:35], v[156:159]
    s_lshl_b32 s84, s83, 7
    v_mfma_f32_16x16x32_bf16 v[108:111], a[88:91], a[24:27], v[108:111]
    s_add_u32 s68, s80, s84
    v_mfma_f32_16x16x32_bf16 v[108:111], a[92:95], a[28:31], v[108:111]
    s_add_u32 s69, s81, s84
    s_lshl_b32 s84, s83, 19
    s_add_u32 s70, s82, s84
    v_mfma_f32_16x16x32_bf16 v[104:107], a[92:95], a[20:23], v[104:107]
    s_mov_b32 s75, s74
    s_cmp_eq_u32 s74, 0x19000
    s_cselect_b32 s76, 0xfffe7000, s96
    v_mfma_f32_16x16x32_bf16 v[104:107], a[88:91], a[16:19], v[104:107]
    s_add_u32 s74, s74, s76
    s_add_u32 s90, s54, 0x1000
    buffer_load_dwordx4 v[176:179], v4, s[24:27], s90 offen
    v_mfma_f32_16x16x32_bf16 v[100:103], a[88:91], a[8:11], v[100:103]
    v_add_u32 v9, s76, v9
    v_add_u32 v5, s76, v5
    v_mfma_f32_16x16x32_bf16 v[100:103], a[92:95], a[12:15], v[100:103]
    s_waitcnt vmcnt(18) lgkmcnt(0)
    v_add_u32 v6, s76, v6
    v_add_u32 v7, s76, v7
    v_mfma_f32_16x16x32_bf16 v[96:99], a[92:95], a[4:7], v[96:99]
    s_barrier
    v_add_u32 v8, s76, v8
    v_mfma_f32_16x16x32_bf16 v[96:99], a[88:91], a[0:3], v[96:99]
    v_mfma_f32_16x16x32_bf16 v[112:115], a[96:99], a[0:3], v[112:115]
    s_add_u32 m0, s75, s71
    ds_read_b128 a[40:43], v5
    ds_read_b64_tr_b16 a[80:81], v9
    v_mfma_f32_16x16x32_bf16 v[112:115], a[100:103], a[4:7], v[112:115]
    s_add_u32 s91, s68, 0
    ds_read_b64_tr_b16 a[82:83], v9 offset:1024
    v_mfma_f32_16x16x32_bf16 v[116:119], a[100:103], a[12:15], v[116:119]
    ds_read_b128 a[44:47], v6
    buffer_load_dwordx4 v1, s[4:7], s91 offen lds
    v_mfma_f32_16x16x32_bf16 v[116:119], a[96:99], a[8:11], v[116:119]
    ds_read_b64_tr_b16 a[84:85], v9 offset:8192
    v_mfma_f32_16x16x32_bf16 v[120:123], a[96:99], a[16:19], v[120:123]
    s_add_u32 m0, m0, 0x400
    ds_read_b64_tr_b16 a[86:87], v9 offset:9216
    v_mfma_f32_16x16x32_bf16 v[120:123], a[100:103], a[20:23], v[120:123]
    s_add_u32 s91, s68, 0x4000
    ds_read_b128 a[52:55], v6 offset:2048
    v_mfma_f32_16x16x32_bf16 v[124:127], a[100:103], a[28:31], v[124:127]
    buffer_load_dwordx4 v1, s[4:7], s91 offen lds
    v_mfma_f32_16x16x32_bf16 v[124:127], a[96:99], a[24:27], v[124:127]
    ds_read_b128 a[48:51], v5 offset:2048
    v_mfma_f32_16x16x32_bf16 v[140:143], a[104:107], a[24:27], v[140:143]
    ds_read_b128 a[56:59], v5 offset:4096
    v_mfma_f32_16x16x32_bf16 v[140:143], a[108:111], a[28:31], v[140:143]
    s_add_u32 m0, m0, 0x400
    ds_read_b128 a[60:63], v6 offset:4096
    v_mfma_f32_16x16x32_bf16 v[136:139], a[108:111], a[20:23], v[136:139]
    s_add_u32 s91, s68, 0x8000
    ds_read_b128 a[68:71], v6 offset:6144
    v_mfma_f32_16x16x32_bf16 v[136:139], a[104:107], a[16:19], v[136:139]
    ds_read_b128 a[64:67], v5 offset:6144
    buffer_load_dwordx4 v1, s[4:7], s91 offen lds
    v_mfma_f32_16x16x32_bf16 v[132:135], a[104:107], a[8:11], v[132:135]
    s_add_u32 s90, s77, 0xc000
    ds_read_b128 a[72:75], v7
    v_mfma_f32_16x16x32_bf16 v[132:135], a[108:111], a[12:15], v[132:135]
    s_xor_b32 s90, s90, s47
    ds_read_b128 a[76:79], v8
    v_mfma_f32_16x16x32_bf16 v[128:131], a[108:111], a[4:7], v[128:131]
    s_add_u32 m0, m0, 0x400
    buffer_load_dwordx4 a[200:203], v3, s[16:19], s90 offen offset:2048 nt
    v_mfma_f32_16x16x32_bf16 v[128:131], a[104:107], a[0:3], v[128:131]
    s_waitcnt lgkmcnt(11)
    s_add_u32 s91, s68, 0xc000
    ds_read_b64_tr_b16 a[88:89], v9 offset:8
    buffer_load_dwordx4 v1, s[4:7], s91 offen lds
    v_mfma_f32_16x16x32_bf16 v[16:19], a[80:83], a[40:43], v[16:19]
    s_waitcnt lgkmcnt(9)
    ds_read_b64_tr_b16 a[90:91], v9 offset:1032
    v_mfma_f32_16x16x32_bf16 v[16:19], a[84:87], a[44:47], v[16:19]
    s_waitcnt lgkmcnt(9)
    ds_read_b64_tr_b16 a[92:93], v9 offset:8200
    v_mfma_f32_16x16x32_bf16 v[20:23], a[84:87], a[52:55], v[20:23]
    s_waitcnt lgkmcnt(9)
    ds_read_b64_tr_b16 a[94:95], v9 offset:9224
    v_mfma_f32_16x16x32_bf16 v[20:23], a[80:83], a[48:51], v[20:23]
    s_waitcnt lgkmcnt(9)
    s_add_u32 m0, s75, s72
    v_mfma_f32_16x16x32_bf16 v[24:27], a[80:83], a[56:59], v[24:27]
    s_waitcnt lgkmcnt(8)
    v_xor_b32 v11, 64, v9
    v_mfma_f32_16x16x32_bf16 v[24:27], a[84:87], a[60:63], v[24:27]
    s_waitcnt lgkmcnt(7)
    ds_read_b64_tr_b16 a[96:97], v11
    v_mfma_f32_16x16x32_bf16 v[28:31], a[84:87], a[68:71], v[28:31]
    s_waitcnt lgkmcnt(7)
    s_mov_b64 exec, s[66:67]
    buffer_load_dwordx4 v1, s[4:7], s69 offen lds
    s_mov_b64 exec, -1
    v_mfma_f32_16x16x32_bf16 v[28:31], a[80:83], a[64:67], v[28:31]
    s_waitcnt lgkmcnt(6)
    s_add_u32 m0, s75, s73
    ds_read_b64_tr_b16 a[98:99], v11 offset:1024
    ds_read_b64_tr_b16 a[100:101], v11 offset:8192
    v_mfma_f32_16x16x32_bf16 v[144:147], a[80:83], a[72:75], v[144:147]
    s_waitcnt lgkmcnt(7)
    s_add_u32 s91, s70, 0
    ds_read_b64_tr_b16 a[102:103], v11 offset:9216
    v_mfma_f32_16x16x32_bf16 v[144:147], a[84:87], a[76:79], v[144:147]
    s_waitcnt lgkmcnt(4)
    buffer_load_dwordx4 v2, s[8:11], s91 offen lds
    v_mfma_f32_16x16x32_bf16 v[148:151], a[92:95], a[76:79], v[148:151]
    ds_read_b64_tr_b16 a[104:105], v11 offset:8
    v_mfma_f32_16x16x32_bf16 v[148:151], a[88:91], a[72:75], v[148:151]
    s_add_u32 m0, m0, 0x400
    ds_read_b64_tr_b16 a[106:107], v11 offset:1032
    v_mfma_f32_16x16x32_bf16 v[44:47], a[88:91], a[64:67], v[44:47]
    s_add_u32 s91, s70, 0x8000
    v_mfma_f32_16x16x32_bf16 v[44:47], a[92:95], a[68:71], v[44:47]
    ds_read_b64_tr_b16 a[108:109], v11 offset:8200
    buffer_load_dwordx4 v2, s[8:11], s91 offen lds
    v_mfma_f32_16x16x32_bf16 v[40:43], a[92:95], a[60:63], v[40:43]
    ds_read_b64_tr_b16 a[110:111], v11 offset:9224
    v_mfma_f32_16x16x32_bf16 v[40:43], a[88:91], a[56:59], v[40:43]
    s_add_u32 s90, s77, 0xc000
    v_mfma_f32_16x16x32_bf16 v[36:39], a[88:91], a[48:51], v[36:39]
    s_xor_b32 s90, s90, s47
    v_xor_b32 v10, 0x80, v9
    v_mfma_f32_16x16x32_bf16 v[36:39], a[92:95], a[52:55], v[36:39]
    s_add_u32 m0, m0, 0xc00
    ds_read_b64_tr_b16 a[80:81], v10
    buffer_load_dwordx4 a[204:207], v15, s[16:19], s90 offen offset:3072 nt
    v_mfma_f32_16x16x32_bf16 v[32:35], a[92:95], a[44:47], v[32:35]
    s_add_u32 s91, s70, 0x20000
    ds_read_b64_tr_b16 a[82:83], v10 offset:1024
    buffer_load_dwordx4 v2, s[8:11], s91 offen lds
    v_mfma_f32_16x16x32_bf16 v[32:35], a[88:91], a[40:43], v[32:35]
    s_waitcnt lgkmcnt(8)
    ds_read_b64_tr_b16 a[84:85], v10 offset:8192
    v_mfma_f32_16x16x32_bf16 v[48:51], a[96:99], a[40:43], v[48:51]
    s_waitcnt lgkmcnt(7)
    s_add_u32 m0, m0, 0x400
    ds_read_b64_tr_b16 a[86:87], v10 offset:9216
    v_mfma_f32_16x16x32_bf16 v[48:51], a[100:103], a[44:47], v[48:51]
    s_add_u32 s91, s70, 0x28000
    v_mfma_f32_16x16x32_bf16 v[52:55], a[100:103], a[52:55], v[52:55]
    ds_read_b64_tr_b16 a[88:89], v10 offset:8
    buffer_load_dwordx4 v2, s[8:11], s91 offen lds
    v_mfma_f32_16x16x32_bf16 v[52:55], a[96:99], a[48:51], v[52:55]
    ds_read_b64_tr_b16 a[90:91], v10 offset:1032
    v_mfma_f32_16x16x32_bf16 v[56:59], a[96:99], a[56:59], v[56:59]
    v_mfma_f32_16x16x32_bf16 v[56:59], a[100:103], a[60:63], v[56:59]
    s_add_u32 m0, m0, 0xc00
    ds_read_b64_tr_b16 a[92:93], v10 offset:8200
    v_mfma_f32_16x16x32_bf16 v[60:63], a[100:103], a[68:71], v[60:63]
    s_add_u32 s91, s70, 0x40000
    ds_read_b64_tr_b16 a[94:95], v10 offset:9224
    v_mfma_f32_16x16x32_bf16 v[60:63], a[96:99], a[64:67], v[60:63]
    s_waitcnt lgkmcnt(10)
    buffer_load_dwordx4 v2, s[8:11], s91 offen lds
    v_mfma_f32_16x16x32_bf16 v[76:79], a[104:107], a[64:67], v[76:79]
    s_waitcnt lgkmcnt(8)
    v_xor_b32 v11, 0xc0, v9
    v_mfma_f32_16x16x32_bf16 v[76:79], a[108:111], a[68:71], v[76:79]
    ds_read_b64_tr_b16 a[96:97], v11
    v_mfma_f32_16x16x32_bf16 v[72:75], a[108:111], a[60:63], v[72:75]
    s_add_u32 m0, m0, 0x400
    ds_read_b64_tr_b16 a[98:99], v11 offset:1024
    v_mfma_f32_16x16x32_bf16 v[72:75], a[104:107], a[56:59], v[72:75]
    s_add_u32 s91, s70, 0x48000
    ds_read_b64_tr_b16 a[100:101], v11 offset:8192
    v_mfma_f32_16x16x32_bf16 v[68:71], a[104:107], a[48:51], v[68:71]
    ds_read_b64_tr_b16 a[102:103], v11 offset:9216
    buffer_load_dwordx4 v2, s[8:11], s91 offen lds
    v_mfma_f32_16x16x32_bf16 v[68:71], a[108:111], a[52:55], v[68:71]
    v_mfma_f32_16x16x32_bf16 v[64:67], a[108:111], a[44:47], v[64:67]
    s_add_u32 m0, m0, 0xc00
    v_mfma_f32_16x16x32_bf16 v[64:67], a[104:107], a[40:43], v[64:67]
    s_waitcnt lgkmcnt(10)
    s_add_u32 s91, s70, 0x60000
    ds_read_b64_tr_b16 a[104:105], v11 offset:8
    v_mfma_f32_16x16x32_bf16 v[80:83], a[80:83], a[40:43], v[80:83]
    s_waitcnt lgkmcnt(9)
    s_add_u32 s90, s54, 0x1000
    ds_read_b64_tr_b16 a[106:107], v11 offset:1032
    buffer_load_dwordx4 v2, s[8:11], s91 offen lds
    v_mfma_f32_16x16x32_bf16 v[80:83], a[84:87], a[44:47], v[80:83]
    buffer_load_dwordx4 v[180:183], v4, s[24:27], s90 offen offset:1024
    v_mfma_f32_16x16x32_bf16 v[84:87], a[84:87], a[52:55], v[84:87]
    ds_read_b64_tr_b16 a[108:109], v11 offset:8200
    v_mfma_f32_16x16x32_bf16 v[84:87], a[80:83], a[48:51], v[84:87]
    s_add_u32 m0, m0, 0x400
    ds_read_b64_tr_b16 a[110:111], v11 offset:9224
    v_mfma_f32_16x16x32_bf16 v[88:91], a[80:83], a[56:59], v[88:91]
    s_add_u32 s91, s70, 0x68000
    v_mfma_f32_16x16x32_bf16 v[88:91], a[84:87], a[60:63], v[88:91]
    buffer_load_dwordx4 v2, s[8:11], s91 offen lds
    v_mfma_f32_16x16x32_bf16 v[92:95], a[84:87], a[68:71], v[92:95]
    v_mfma_f32_16x16x32_bf16 v[92:95], a[80:83], a[64:67], v[92:95]
    v_mfma_f32_16x16x32_bf16 v[152:155], a[80:83], a[72:75], v[152:155]
    v_mfma_f32_16x16x32_bf16 v[152:155], a[84:87], a[76:79], v[152:155]
    s_waitcnt lgkmcnt(8)
    v_mfma_f32_16x16x32_bf16 v[156:159], a[92:95], a[76:79], v[156:159]
    s_cmp_gt_u32 s79, 7
    s_cselect_b32 s83, 7, 8
    v_mfma_f32_16x16x32_bf16 v[156:159], a[88:91], a[72:75], v[156:159]
    s_lshl_b32 s84, s83, 7
    v_mfma_f32_16x16x32_bf16 v[108:111], a[88:91], a[64:67], v[108:111]
    s_add_u32 s68, s80, s84
    v_mfma_f32_16x16x32_bf16 v[108:111], a[92:95], a[68:71], v[108:111]
    s_add_u32 s69, s81, s84
    s_lshl_b32 s84, s83, 19
    s_add_u32 s70, s82, s84
    v_mfma_f32_16x16x32_bf16 v[104:107], a[92:95], a[60:63], v[104:107]
    s_mov_b32 s75, s74
    s_cmp_eq_u32 s74, 0x19000
    s_cselect_b32 s76, 0xfffe7000, s96
    v_mfma_f32_16x16x32_bf16 v[104:107], a[88:91], a[56:59], v[104:107]
    s_add_u32 s74, s74, s76
    v_add_u32 v9, s76, v9
    v_add_u32 v5, s76, v5
    v_mfma_f32_16x16x32_bf16 v[100:103], a[88:91], a[48:51], v[100:103]
    v_add_u32 v6, s76, v6
    v_add_u32 v7, s76, v7
    v_mfma_f32_16x16x32_bf16 v[100:103], a[92:95], a[52:55], v[100:103]
    s_waitcnt vmcnt(17) lgkmcnt(0)
    v_add_u32 v8, s76, v8
    v_mfma_f32_16x16x32_bf16 v[96:99], a[92:95], a[44:47], v[96:99]
    s_barrier
    v_mfma_f32_16x16x32_bf16 v[96:99], a[88:91], a[40:43], v[96:99]
    v_mfma_f32_16x16x32_bf16 v[112:115], a[96:99], a[40:43], v[112:115]
    s_add_u32 m0, s75, s71
    ds_read_b128 a[0:3], v5
    ds_read_b64_tr_b16 a[80:81], v9
    v_mfma_f32_16x16x32_bf16 v[112:115], a[100:103], a[44:47], v[112:115]
    s_add_u32 s91, s68, 0
    ds_read_b64_tr_b16 a[82:83], v9 offset:1024
    v_mfma_f32_16x16x32_bf16 v[116:119], a[100:103], a[52:55], v[116:119]
    s_add_u32 s90, s77, 0xd000
    ds_read_b128 a[4:7], v6
    buffer_load_dwordx4 v1, s[4:7], s91 offen lds
    v_mfma_f32_16x16x32_bf16 v[116:119], a[96:99], a[48:51], v[116:119]
    s_xor_b32 s90, s90, s47
    ds_read_b64_tr_b16 a[84:85], v9 offset:8192
    buffer_load_dwordx4 a[208:211], v3, s[16:19], s90 offen nt
    v_mfma_f32_16x16x32_bf16 v[120:123], a[96:99], a[56:59], v[120:123]
    s_add_u32 m0, m0, 0x400
    ds_read_b64_tr_b16 a[86:87], v9 offset:9216
    v_mfma_f32_16x16x32_bf16 v[120:123], a[100:103], a[60:63], v[120:123]
    s_add_u32 s91, s68, 0x4000
    ds_read_b128 a[12:15], v6 offset:2048
    v_mfma_f32_16x16x32_bf16 v[124:127], a[100:103], a[68:71], v[124:127]
    buffer_load_dwordx4 v1, s[4:7], s91 offen lds
    v_mfma_f32_16x16x32_bf16 v[124:127], a[96:99], a[64:67], v[124:127]
    ds_read_b128 a[8:11], v5 offset:2048
    v_mfma_f32_16x16x32_bf16 v[140:143], a[104:107], a[64:67], v[140:143]
    ds_read_b128 a[16:19], v5 offset:4096
    v_mfma_f32_16x16x32_bf16 v[140:143], a[108:111], a[68:71], v[140:143]
    s_add_u32 m0, m0, 0x400
    ds_read_b128 a[20:23], v6 offset:4096
    v_mfma_f32_16x16x32_bf16 v[136:139], a[108:111], a[60:63], v[136:139]
    s_add_u32 s91, s68, 0x8000
    ds_read_b128 a[28:31], v6 offset:6144
    v_mfma_f32_16x16x32_bf16 v[136:139], a[104:107], a[56:59], v[136:139]
    ds_read_b128 a[24:27], v5 offset:6144
    buffer_load_dwordx4 v1, s[4:7], s91 offen lds
    v_mfma_f32_16x16x32_bf16 v[132:135], a[104:107], a[48:51], v[132:135]
    ds_read_b128 a[32:35], v7
    v_mfma_f32_16x16x32_bf16 v[132:135], a[108:111], a[52:55], v[132:135]
    s_add_u32 m0, m0, 0x400
    ds_read_b128 a[36:39], v8
    v_mfma_f32_16x16x32_bf16 v[128:131], a[108:111], a[44:47], v[128:131]
    s_add_u32 s91, s68, 0xc000
    v_mfma_f32_16x16x32_bf16 v[128:131], a[104:107], a[40:43], v[128:131]
    s_waitcnt lgkmcnt(11)
    ds_read_b64_tr_b16 a[88:89], v9 offset:8
    buffer_load_dwordx4 v1, s[4:7], s91 offen lds
    v_mfma_f32_16x16x32_bf16 v[16:19], a[80:83], a[0:3], v[16:19]
    s_waitcnt lgkmcnt(9)
    ds_read_b64_tr_b16 a[90:91], v9 offset:1032
    v_mfma_f32_16x16x32_bf16 v[16:19], a[84:87], a[4:7], v[16:19]
    s_waitcnt lgkmcnt(9)
    ds_read_b64_tr_b16 a[92:93], v9 offset:8200
    v_mfma_f32_16x16x32_bf16 v[20:23], a[84:87], a[12:15], v[20:23]
    s_waitcnt lgkmcnt(9)
    s_add_u32 s90, s77, 0xd000
    ds_read_b64_tr_b16 a[94:95], v9 offset:9224
    v_mfma_f32_16x16x32_bf16 v[20:23], a[80:83], a[8:11], v[20:23]
    s_waitcnt lgkmcnt(9)
    s_xor_b32 s90, s90, s47
    v_mfma_f32_16x16x32_bf16 v[24:27], a[80:83], a[16:19], v[24:27]
    s_waitcnt lgkmcnt(8)
    s_add_u32 m0, s75, s72
    v_xor_b32 v11, 64, v9
    buffer_load_dwordx4 a[212:215], v15, s[16:19], s90 offen offset:1024 nt
    v_mfma_f32_16x16x32_bf16 v[24:27], a[84:87], a[20:23], v[24:27]
    s_waitcnt lgkmcnt(7)
    ds_read_b64_tr_b16 a[96:97], v11
    v_mfma_f32_16x16x32_bf16 v[28:31], a[84:87], a[28:31], v[28:31]
    s_waitcnt lgkmcnt(7)
    s_mov_b64 exec, s[66:67]
    buffer_load_dwordx4 v1, s[4:7], s69 offen lds
    s_mov_b64 exec, -1
    v_mfma_f32_16x16x32_bf16 v[28:31], a[80:83], a[24:27], v[28:31]
    s_waitcnt lgkmcnt(6)
    s_add_u32 m0, s75, s73
    ds_read_b64_tr_b16 a[98:99], v11 offset:1024
    ds_read_b64_tr_b16 a[100:101], v11 offset:8192
    v_mfma_f32_16x16x32_bf16 v[144:147], a[80:83], a[32:35], v[144:147]
    s_waitcnt lgkmcnt(7)
    s_add_u32 s91, s70, 0
    ds_read_b64_tr_b16 a[102:103], v11 offset:9216
    v_mfma_f32_16x16x32_bf16 v[144:147], a[84:87], a[36:39], v[144:147]
    s_waitcnt lgkmcnt(4)
    buffer_load_dwordx4 v2, s[8:11], s91 offen lds
    v_mfma_f32_16x16x32_bf16 v[148:151], a[92:95], a[36:39], v[148:151]
    ds_read_b64_tr_b16 a[104:105], v11 offset:8
    v_mfma_f32_16x16x32_bf16 v[148:151], a[88:91], a[32:35], v[148:151]
    s_add_u32 m0, m0, 0x400
    ds_read_b64_tr_b16 a[106:107], v11 offset:1032
    v_mfma_f32_16x16x32_bf16 v[44:47], a[88:91], a[24:27], v[44:47]
    s_add_u32 s91, s70, 0x8000
    v_mfma_f32_16x16x32_bf16 v[44:47], a[92:95], a[28:31], v[44:47]
    ds_read_b64_tr_b16 a[108:109], v11 offset:8200
    buffer_load_dwordx4 v2, s[8:11], s91 offen lds
    v_mfma_f32_16x16x32_bf16 v[40:43], a[92:95], a[20:23], v[40:43]
    ds_read_b64_tr_b16 a[110:111], v11 offset:9224
    v_mfma_f32_16x16x32_bf16 v[40:43], a[88:91], a[16:19], v[40:43]
    v_mfma_f32_16x16x32_bf16 v[36:39], a[88:91], a[8:11], v[36:39]
    s_add_u32 m0, m0, 0xc00
    v_xor_b32 v10, 0x80, v9
    v_mfma_f32_16x16x32_bf16 v[36:39], a[92:95], a[12:15], v[36:39]
    s_add_u32 s91, s70, 0x20000
    ds_read_b64_tr_b16 a[80:81], v10
    v_mfma_f32_16x16x32_bf16 v[32:35], a[92:95], a[4:7], v[32:35]
    ds_read_b64_tr_b16 a[82:83], v10 offset:1024
    buffer_load_dwordx4 v2, s[8:11], s91 offen lds
    v_mfma_f32_16x16x32_bf16 v[32:35], a[88:91], a[0:3], v[32:35]
    s_waitcnt lgkmcnt(8)
    ds_read_b64_tr_b16 a[84:85], v10 offset:8192
    v_mfma_f32_16x16x32_bf16 v[48:51], a[96:99], a[0:3], v[48:51]
    s_waitcnt lgkmcnt(7)
    s_add_u32 m0, m0, 0x400
    ds_read_b64_tr_b16 a[86:87], v10 offset:9216
    v_mfma_f32_16x16x32_bf16 v[48:51], a[100:103], a[4:7], v[48:51]
    s_add_u32 s91, s70, 0x28000
    v_mfma_f32_16x16x32_bf16 v[52:55], a[100:103], a[12:15], v[52:55]
    s_add_u32 s90, s54, 0x1000
    ds_read_b64_tr_b16 a[88:89], v10 offset:8
    buffer_load_dwordx4 v2, s[8:11], s91 offen lds
    v_mfma_f32_16x16x32_bf16 v[52:55], a[96:99], a[8:11], v[52:55]
    ds_read_b64_tr_b16 a[90:91], v10 offset:1032
    buffer_load_dwordx4 v[184:187], v4, s[24:27], s90 offen offset:2048
    v_mfma_f32_16x16x32_bf16 v[56:59], a[96:99], a[16:19], v[56:59]
    v_mfma_f32_16x16x32_bf16 v[56:59], a[100:103], a[20:23], v[56:59]
    s_add_u32 m0, m0, 0xc00
    ds_read_b64_tr_b16 a[92:93], v10 offset:8200
    v_mfma_f32_16x16x32_bf16 v[60:63], a[100:103], a[28:31], v[60:63]
    s_add_u32 s91, s70, 0x40000
    ds_read_b64_tr_b16 a[94:95], v10 offset:9224
    v_mfma_f32_16x16x32_bf16 v[60:63], a[96:99], a[24:27], v[60:63]
    s_waitcnt lgkmcnt(10)
    buffer_load_dwordx4 v2, s[8:11], s91 offen lds
    v_mfma_f32_16x16x32_bf16 v[76:79], a[104:107], a[24:27], v[76:79]
    s_waitcnt lgkmcnt(8)
    v_xor_b32 v11, 0xc0, v9
    v_mfma_f32_16x16x32_bf16 v[76:79], a[108:111], a[28:31], v[76:79]
    ds_read_b64_tr_b16 a[96:97], v11
    v_mfma_f32_16x16x32_bf16 v[72:75], a[108:111], a[20:23], v[72:75]
    s_add_u32 m0, m0, 0x400
    ds_read_b64_tr_b16 a[98:99], v11 offset:1024
    v_mfma_f32_16x16x32_bf16 v[72:75], a[104:107], a[16:19], v[72:75]
    s_add_u32 s91, s70, 0x48000
    ds_read_b64_tr_b16 a[100:101], v11 offset:8192
    v_mfma_f32_16x16x32_bf16 v[68:71], a[104:107], a[8:11], v[68:71]
    ds_read_b64_tr_b16 a[102:103], v11 offset:9216
    buffer_load_dwordx4 v2, s[8:11], s91 offen lds
    v_mfma_f32_16x16x32_bf16 v[68:71], a[108:111], a[12:15], v[68:71]
    v_mfma_f32_16x16x32_bf16 v[64:67], a[108:111], a[4:7], v[64:67]
    s_add_u32 m0, m0, 0xc00
    v_mfma_f32_16x16x32_bf16 v[64:67], a[104:107], a[0:3], v[64:67]
    s_waitcnt lgkmcnt(10)
    s_add_u32 s91, s70, 0x60000
    ds_read_b64_tr_b16 a[104:105], v11 offset:8
    v_mfma_f32_16x16x32_bf16 v[80:83], a[80:83], a[0:3], v[80:83]
    s_waitcnt lgkmcnt(9)
    ds_read_b64_tr_b16 a[106:107], v11 offset:1032
    buffer_load_dwordx4 v2, s[8:11], s91 offen lds
    v_mfma_f32_16x16x32_bf16 v[80:83], a[84:87], a[4:7], v[80:83]
    v_mfma_f32_16x16x32_bf16 v[84:87], a[84:87], a[12:15], v[84:87]
    ds_read_b64_tr_b16 a[108:109], v11 offset:8200
    v_mfma_f32_16x16x32_bf16 v[84:87], a[80:83], a[8:11], v[84:87]
    s_add_u32 m0, m0, 0x400
    ds_read_b64_tr_b16 a[110:111], v11 offset:9224
    v_mfma_f32_16x16x32_bf16 v[88:91], a[80:83], a[16:19], v[88:91]
    s_add_u32 s91, s70, 0x68000
    v_mfma_f32_16x16x32_bf16 v[88:91], a[84:87], a[20:23], v[88:91]
    s_add_u32 s90, s77, 0xd000
    buffer_load_dwordx4 v2, s[8:11], s91 offen lds
    v_mfma_f32_16x16x32_bf16 v[92:95], a[84:87], a[28:31], v[92:95]
    s_xor_b32 s90, s90, s47
    v_mfma_f32_16x16x32_bf16 v[92:95], a[80:83], a[24:27], v[92:95]
    buffer_load_dwordx4 a[216:219], v3, s[16:19], s90 offen offset:2048 nt
    v_mfma_f32_16x16x32_bf16 v[152:155], a[80:83], a[32:35], v[152:155]
    v_mfma_f32_16x16x32_bf16 v[152:155], a[84:87], a[36:39], v[152:155]
    s_waitcnt lgkmcnt(8)
    v_mfma_f32_16x16x32_bf16 v[156:159], a[92:95], a[36:39], v[156:159]
    s_cmp_gt_u32 s79, 8
    s_cselect_b32 s83, 8, 9
    v_mfma_f32_16x16x32_bf16 v[156:159], a[88:91], a[32:35], v[156:159]
    s_lshl_b32 s84, s83, 7
    v_mfma_f32_16x16x32_bf16 v[108:111], a[88:91], a[24:27], v[108:111]
    s_add_u32 s68, s80, s84
    v_mfma_f32_16x16x32_bf16 v[108:111], a[92:95], a[28:31], v[108:111]
    s_add_u32 s69, s81, s84
    s_lshl_b32 s84, s83, 19
    s_add_u32 s70, s82, s84
    v_mfma_f32_16x16x32_bf16 v[104:107], a[92:95], a[20:23], v[104:107]
    s_mov_b32 s75, s74
    s_cmp_eq_u32 s74, 0x19000
    s_cselect_b32 s76, 0xfffe7000, s96
    v_mfma_f32_16x16x32_bf16 v[104:107], a[88:91], a[16:19], v[104:107]
    s_add_u32 s74, s74, s76
    v_add_u32 v9, s76, v9
    v_add_u32 v5, s76, v5
    v_mfma_f32_16x16x32_bf16 v[100:103], a[88:91], a[8:11], v[100:103]
    v_add_u32 v6, s76, v6
    v_add_u32 v7, s76, v7
    v_mfma_f32_16x16x32_bf16 v[100:103], a[92:95], a[12:15], v[100:103]
    s_waitcnt vmcnt(17) lgkmcnt(0)
    v_add_u32 v8, s76, v8
    v_mfma_f32_16x16x32_bf16 v[96:99], a[92:95], a[4:7], v[96:99]
    s_barrier
    v_mfma_f32_16x16x32_bf16 v[96:99], a[88:91], a[0:3], v[96:99]
    v_mfma_f32_16x16x32_bf16 v[112:115], a[96:99], a[0:3], v[112:115]
    s_add_u32 m0, s75, s71
    ds_read_b128 a[40:43], v5
    ds_read_b64_tr_b16 a[80:81], v9
    v_mfma_f32_16x16x32_bf16 v[112:115], a[100:103], a[4:7], v[112:115]
    s_add_u32 s91, s68, 0
    ds_read_b64_tr_b16 a[82:83], v9 offset:1024
    v_mfma_f32_16x16x32_bf16 v[116:119], a[100:103], a[12:15], v[116:119]
    ds_read_b128 a[44:47], v6
    buffer_load_dwordx4 v1, s[4:7], s91 offen lds
    v_mfma_f32_16x16x32_bf16 v[116:119], a[96:99], a[8:11], v[116:119]
    ds_read_b64_tr_b16 a[84:85], v9 offset:8192
    v_mfma_f32_16x16x32_bf16 v[120:123], a[96:99], a[16:19], v[120:123]
    s_add_u32 s90, s77, 0xd000
    ds_read_b64_tr_b16 a[86:87], v9 offset:9216
    v_mfma_f32_16x16x32_bf16 v[120:123], a[100:103], a[20:23], v[120:123]
    s_xor_b32 s90, s90, s47
    ds_read_b128 a[52:55], v6 offset:2048
    v_mfma_f32_16x16x32_bf16 v[124:127], a[100:103], a[28:31], v[124:127]
    s_add_u32 m0, m0, 0x400
    buffer_load_dwordx4 a[220:223], v15, s[16:19], s90 offen offset:3072 nt
    v_mfma_f32_16x16x32_bf16 v[124:127], a[96:99], a[24:27], v[124:127]
    s_add_u32 s91, s68, 0x4000
    ds_read_b128 a[48:51], v5 offset:2048
    buffer_load_dwordx4 v1, s[4:7], s91 offen lds
    v_mfma_f32_16x16x32_bf16 v[140:143], a[104:107], a[24:27], v[140:143]
    ds_read_b128 a[56:59], v5 offset:4096
    v_mfma_f32_16x16x32_bf16 v[140:143], a[108:111], a[28:31], v[140:143]
    s_add_u32 m0, m0, 0x400
    ds_read_b128 a[60:63], v6 offset:4096
    v_mfma_f32_16x16x32_bf16 v[136:139], a[108:111], a[20:23], v[136:139]
    s_add_u32 s91, s68, 0x8000
    ds_read_b128 a[68:71], v6 offset:6144
    v_mfma_f32_16x16x32_bf16 v[136:139], a[104:107], a[16:19], v[136:139]
    ds_read_b128 a[64:67], v5 offset:6144
    buffer_load_dwordx4 v1, s[4:7], s91 offen lds
    v_mfma_f32_16x16x32_bf16 v[132:135], a[104:107], a[8:11], v[132:135]
    ds_read_b128 a[72:75], v7
    v_mfma_f32_16x16x32_bf16 v[132:135], a[108:111], a[12:15], v[132:135]
    s_add_u32 m0, m0, 0x400
    ds_read_b128 a[76:79], v8
    v_mfma_f32_16x16x32_bf16 v[128:131], a[108:111], a[4:7], v[128:131]
    s_add_u32 s91, s68, 0xc000
    v_mfma_f32_16x16x32_bf16 v[128:131], a[104:107], a[0:3], v[128:131]
    s_waitcnt lgkmcnt(11)
    ds_read_b64_tr_b16 a[88:89], v9 offset:8
    buffer_load_dwordx4 v1, s[4:7], s91 offen lds
    v_mfma_f32_16x16x32_bf16 v[16:19], a[80:83], a[40:43], v[16:19]
    s_waitcnt lgkmcnt(9)
    ds_read_b64_tr_b16 a[90:91], v9 offset:1032
    v_mfma_f32_16x16x32_bf16 v[16:19], a[84:87], a[44:47], v[16:19]
    s_waitcnt lgkmcnt(9)
    ds_read_b64_tr_b16 a[92:93], v9 offset:8200
    v_mfma_f32_16x16x32_bf16 v[20:23], a[84:87], a[52:55], v[20:23]
    s_waitcnt lgkmcnt(9)
    ds_read_b64_tr_b16 a[94:95], v9 offset:9224
    v_mfma_f32_16x16x32_bf16 v[20:23], a[80:83], a[48:51], v[20:23]
    s_waitcnt lgkmcnt(9)
    s_add_u32 m0, s75, s72
    v_mfma_f32_16x16x32_bf16 v[24:27], a[80:83], a[56:59], v[24:27]
    s_waitcnt lgkmcnt(8)
    v_xor_b32 v11, 64, v9
    v_mfma_f32_16x16x32_bf16 v[24:27], a[84:87], a[60:63], v[24:27]
    s_waitcnt lgkmcnt(7)
    ds_read_b64_tr_b16 a[96:97], v11
    v_mfma_f32_16x16x32_bf16 v[28:31], a[84:87], a[68:71], v[28:31]
    s_waitcnt lgkmcnt(7)
    s_mov_b64 exec, s[66:67]
    buffer_load_dwordx4 v1, s[4:7], s69 offen lds
    s_mov_b64 exec, -1
    v_mfma_f32_16x16x32_bf16 v[28:31], a[80:83], a[64:67], v[28:31]
    s_waitcnt lgkmcnt(6)
    s_add_u32 m0, s75, s73
    ds_read_b64_tr_b16 a[98:99], v11 offset:1024
    ds_read_b64_tr_b16 a[100:101], v11 offset:8192
    v_mfma_f32_16x16x32_bf16 v[144:147], a[80:83], a[72:75], v[144:147]
    s_waitcnt lgkmcnt(7)
    s_add_u32 s91, s70, 0
    ds_read_b64_tr_b16 a[102:103], v11 offset:9216
    v_mfma_f32_16x16x32_bf16 v[144:147], a[84:87], a[76:79], v[144:147]
    s_waitcnt lgkmcnt(4)
    s_add_u32 s90, s54, 0x1000
    buffer_load_dwordx4 v2, s[8:11], s91 offen lds
    v_mfma_f32_16x16x32_bf16 v[148:151], a[92:95], a[76:79], v[148:151]
    ds_read_b64_tr_b16 a[104:105], v11 offset:8
    buffer_load_dwordx4 v[188:191], v4, s[24:27], s90 offen offset:3072
    v_mfma_f32_16x16x32_bf16 v[148:151], a[88:91], a[72:75], v[148:151]
    s_add_u32 m0, m0, 0x400
    ds_read_b64_tr_b16 a[106:107], v11 offset:1032
    v_mfma_f32_16x16x32_bf16 v[44:47], a[88:91], a[64:67], v[44:47]
    s_add_u32 s91, s70, 0x8000
    v_mfma_f32_16x16x32_bf16 v[44:47], a[92:95], a[68:71], v[44:47]
    ds_read_b64_tr_b16 a[108:109], v11 offset:8200
    buffer_load_dwordx4 v2, s[8:11], s91 offen lds
    v_mfma_f32_16x16x32_bf16 v[40:43], a[92:95], a[60:63], v[40:43]
    ds_read_b64_tr_b16 a[110:111], v11 offset:9224
    v_mfma_f32_16x16x32_bf16 v[40:43], a[88:91], a[56:59], v[40:43]
    v_mfma_f32_16x16x32_bf16 v[36:39], a[88:91], a[48:51], v[36:39]
    s_add_u32 m0, m0, 0xc00
    v_xor_b32 v10, 0x80, v9
    v_mfma_f32_16x16x32_bf16 v[36:39], a[92:95], a[52:55], v[36:39]
    s_add_u32 s91, s70, 0x20000
    ds_read_b64_tr_b16 a[80:81], v10
    v_mfma_f32_16x16x32_bf16 v[32:35], a[92:95], a[44:47], v[32:35]
    ds_read_b64_tr_b16 a[82:83], v10 offset:1024
    buffer_load_dwordx4 v2, s[8:11], s91 offen lds
    v_mfma_f32_16x16x32_bf16 v[32:35], a[88:91], a[40:43], v[32:35]
    s_waitcnt lgkmcnt(8)
    ds_read_b64_tr_b16 a[84:85], v10 offset:8192
    v_mfma_f32_16x16x32_bf16 v[48:51], a[96:99], a[40:43], v[48:51]
    s_waitcnt lgkmcnt(7)
    s_add_u32 m0, m0, 0x400
    ds_read_b64_tr_b16 a[86:87], v10 offset:9216
    v_mfma_f32_16x16x32_bf16 v[48:51], a[100:103], a[44:47], v[48:51]
    s_add_u32 s91, s70, 0x28000
    v_mfma_f32_16x16x32_bf16 v[52:55], a[100:103], a[52:55], v[52:55]
    ds_read_b64_tr_b16 a[88:89], v10 offset:8
    buffer_load_dwordx4 v2, s[8:11], s91 offen lds
    v_mfma_f32_16x16x32_bf16 v[52:55], a[96:99], a[48:51], v[52:55]
    ds_read_b64_tr_b16 a[90:91], v10 offset:1032
    v_mfma_f32_16x16x32_bf16 v[56:59], a[96:99], a[56:59], v[56:59]
    v_mfma_f32_16x16x32_bf16 v[56:59], a[100:103], a[60:63], v[56:59]
    s_add_u32 m0, m0, 0xc00
    ds_read_b64_tr_b16 a[92:93], v10 offset:8200
    v_mfma_f32_16x16x32_bf16 v[60:63], a[100:103], a[68:71], v[60:63]
    s_add_u32 s91, s70, 0x40000
    ds_read_b64_tr_b16 a[94:95], v10 offset:9224
    v_mfma_f32_16x16x32_bf16 v[60:63], a[96:99], a[64:67], v[60:63]
    s_waitcnt lgkmcnt(10)
    s_add_u32 s90, s77, 0x4000
    buffer_load_dwordx4 v2, s[8:11], s91 offen lds
    v_mfma_f32_16x16x32_bf16 v[76:79], a[104:107], a[64:67], v[76:79]
    s_waitcnt lgkmcnt(8)
    s_xor_b32 s90, s90, s47
    v_xor_b32 v11, 0xc0, v9
    v_mfma_f32_16x16x32_bf16 v[76:79], a[108:111], a[68:71], v[76:79]
    ds_read_b64_tr_b16 a[96:97], v11
    buffer_load_dwordx4 a[120:123], v3, s[12:15], s90 offen nt
    v_mfma_f32_16x16x32_bf16 v[72:75], a[108:111], a[60:63], v[72:75]
    s_add_u32 m0, m0, 0x400
    ds_read_b64_tr_b16 a[98:99], v11 offset:1024
    v_mfma_f32_16x16x32_bf16 v[72:75], a[104:107], a[56:59], v[72:75]
    s_add_u32 s91, s70, 0x48000
    ds_read_b64_tr_b16 a[100:101], v11 offset:8192
    v_mfma_f32_16x16x32_bf16 v[68:71], a[104:107], a[48:51], v[68:71]
    ds_read_b64_tr_b16 a[102:103], v11 offset:9216
    buffer_load_dwordx4 v2, s[8:11], s91 offen lds
    v_mfma_f32_16x16x32_bf16 v[68:71], a[108:111], a[52:55], v[68:71]
    v_mfma_f32_16x16x32_bf16 v[64:67], a[108:111], a[44:47], v[64:67]
    s_add_u32 m0, m0, 0xc00
    v_mfma_f32_16x16x32_bf16 v[64:67], a[104:107], a[40:43], v[64:67]
    s_waitcnt lgkmcnt(10)
    s_add_u32 s91, s70, 0x60000
    ds_read_b64_tr_b16 a[104:105], v11 offset:8
    v_mfma_f32_16x16x32_bf16 v[80:83], a[80:83], a[40:43], v[80:83]
    s_waitcnt lgkmcnt(9)
    ds_read_b64_tr_b16 a[106:107], v11 offset:1032
    buffer_load_dwordx4 v2, s[8:11], s91 offen lds
    v_mfma_f32_16x16x32_bf16 v[80:83], a[84:87], a[44:47], v[80:83]
    v_mfma_f32_16x16x32_bf16 v[84:87], a[84:87], a[52:55], v[84:87]
    ds_read_b64_tr_b16 a[108:109], v11 offset:8200
    v_mfma_f32_16x16x32_bf16 v[84:87], a[80:83], a[48:51], v[84:87]
    s_add_u32 m0, m0, 0x400
    ds_read_b64_tr_b16 a[110:111], v11 offset:9224
    v_mfma_f32_16x16x32_bf16 v[88:91], a[80:83], a[56:59], v[88:91]
    s_add_u32 s91, s70, 0x68000
    v_mfma_f32_16x16x32_bf16 v[88:91], a[84:87], a[60:63], v[88:91]
    buffer_load_dwordx4 v2, s[8:11], s91 offen lds
    v_mfma_f32_16x16x32_bf16 v[92:95], a[84:87], a[68:71], v[92:95]
    v_mfma_f32_16x16x32_bf16 v[92:95], a[80:83], a[64:67], v[92:95]
    v_mfma_f32_16x16x32_bf16 v[152:155], a[80:83], a[72:75], v[152:155]
    v_mfma_f32_16x16x32_bf16 v[152:155], a[84:87], a[76:79], v[152:155]
    s_waitcnt lgkmcnt(8)
    v_mfma_f32_16x16x32_bf16 v[156:159], a[92:95], a[76:79], v[156:159]
    s_cmp_gt_u32 s79, 9
    s_cselect_b32 s83, 9, 10
    v_mfma_f32_16x16x32_bf16 v[156:159], a[88:91], a[72:75], v[156:159]
    s_lshl_b32 s84, s83, 7
    v_mfma_f32_16x16x32_bf16 v[108:111], a[88:91], a[64:67], v[108:111]
    s_add_u32 s68, s80, s84
    v_mfma_f32_16x16x32_bf16 v[108:111], a[92:95], a[68:71], v[108:111]
    s_add_u32 s69, s81, s84
    s_lshl_b32 s84, s83, 19
    s_add_u32 s70, s82, s84
    v_mfma_f32_16x16x32_bf16 v[104:107], a[92:95], a[60:63], v[104:107]
    s_mov_b32 s75, s74
    s_cmp_eq_u32 s74, 0x19000
    s_cselect_b32 s76, 0xfffe7000, s96
    v_mfma_f32_16x16x32_bf16 v[104:107], a[88:91], a[56:59], v[104:107]
    s_add_u32 s90, s77, 0x4000
    s_xor_b32 s90, s90, s47
    buffer_load_dwordx4 a[124:127], v15, s[12:15], s90 offen offset:1024 nt
    s_add_u32 s74, s74, s76
    v_mfma_f32_16x16x32_bf16 v[100:103], a[88:91], a[48:51], v[100:103]
    v_add_u32 v9, s76, v9
    v_add_u32 v5, s76, v5
    v_mfma_f32_16x16x32_bf16 v[100:103], a[92:95], a[52:55], v[100:103]
    s_waitcnt vmcnt(18) lgkmcnt(0)
    v_add_u32 v6, s76, v6
    v_add_u32 v7, s76, v7
    v_mfma_f32_16x16x32_bf16 v[96:99], a[92:95], a[44:47], v[96:99]
    s_barrier
    v_add_u32 v8, s76, v8
    v_mfma_f32_16x16x32_bf16 v[96:99], a[88:91], a[40:43], v[96:99]
    v_mfma_f32_16x16x32_bf16 v[112:115], a[96:99], a[40:43], v[112:115]
    s_add_u32 m0, s75, s71
    ds_read_b128 a[0:3], v5
    ds_read_b64_tr_b16 a[80:81], v9
    v_mfma_f32_16x16x32_bf16 v[112:115], a[100:103], a[44:47], v[112:115]
    s_add_u32 s91, s68, 0
    ds_read_b64_tr_b16 a[82:83], v9 offset:1024
    v_mfma_f32_16x16x32_bf16 v[116:119], a[100:103], a[52:55], v[116:119]
    ds_read_b128 a[4:7], v6
    buffer_load_dwordx4 v1, s[4:7], s91 offen lds
    v_mfma_f32_16x16x32_bf16 v[116:119], a[96:99], a[48:51], v[116:119]
    ds_read_b64_tr_b16 a[84:85], v9 offset:8192
    v_mfma_f32_16x16x32_bf16 v[120:123], a[96:99], a[56:59], v[120:123]
    s_add_u32 m0, m0, 0x400
    ds_read_b64_tr_b16 a[86:87], v9 offset:9216
    v_mfma_f32_16x16x32_bf16 v[120:123], a[100:103], a[60:63], v[120:123]
    s_add_u32 s91, s68, 0x4000
    ds_read_b128 a[12:15], v6 offset:2048
    v_mfma_f32_16x16x32_bf16 v[124:127], a[100:103], a[68:71], v[124:127]
    buffer_load_dwordx4 v1, s[4:7], s91 offen lds
    v_mfma_f32_16x16x32_bf16 v[124:127], a[96:99], a[64:67], v[124:127]
    ds_read_b128 a[8:11], v5 offset:2048
    v_mfma_f32_16x16x32_bf16 v[140:143], a[104:107], a[64:67], v[140:143]
    ds_read_b128 a[16:19], v5 offset:4096
    v_mfma_f32_16x16x32_bf16 v[140:143], a[108:111], a[68:71], v[140:143]
    s_add_u32 m0, m0, 0x400
    ds_read_b128 a[20:23], v6 offset:4096
    v_mfma_f32_16x16x32_bf16 v[136:139], a[108:111], a[60:63], v[136:139]
    s_add_u32 s91, s68, 0x8000
    ds_read_b128 a[28:31], v6 offset:6144
    v_mfma_f32_16x16x32_bf16 v[136:139], a[104:107], a[56:59], v[136:139]
    s_add_u32 s90, s54, 0x2000
    ds_read_b128 a[24:27], v5 offset:6144
    buffer_load_dwordx4 v1, s[4:7], s91 offen lds
    v_mfma_f32_16x16x32_bf16 v[132:135], a[104:107], a[48:51], v[132:135]
    ds_read_b128 a[32:35], v7
    buffer_load_dwordx4 v[160:163], v4, s[24:27], s90 offen
    v_mfma_f32_16x16x32_bf16 v[132:135], a[108:111], a[52:55], v[132:135]
    s_add_u32 m0, m0, 0x400
    ds_read_b128 a[36:39], v8
    v_mfma_f32_16x16x32_bf16 v[128:131], a[108:111], a[44:47], v[128:131]
    s_add_u32 s91, s68, 0xc000
    v_mfma_f32_16x16x32_bf16 v[128:131], a[104:107], a[40:43], v[128:131]
    s_waitcnt lgkmcnt(11)
    ds_read_b64_tr_b16 a[88:89], v9 offset:8
    buffer_load_dwordx4 v1, s[4:7], s91 offen lds
    v_mfma_f32_16x16x32_bf16 v[16:19], a[80:83], a[0:3], v[16:19]
    s_waitcnt lgkmcnt(9)
    ds_read_b64_tr_b16 a[90:91], v9 offset:1032
    v_mfma_f32_16x16x32_bf16 v[16:19], a[84:87], a[4:7], v[16:19]
    s_waitcnt lgkmcnt(9)
    ds_read_b64_tr_b16 a[92:93], v9 offset:8200
    v_mfma_f32_16x16x32_bf16 v[20:23], a[84:87], a[12:15], v[20:23]
    s_waitcnt lgkmcnt(9)
    ds_read_b64_tr_b16 a[94:95], v9 offset:9224
    v_mfma_f32_16x16x32_bf16 v[20:23], a[80:83], a[8:11], v[20:23]
    s_waitcnt lgkmcnt(9)
    s_add_u32 m0, s75, s72
    v_mfma_f32_16x16x32_bf16 v[24:27], a[80:83], a[16:19], v[24:27]
    s_waitcnt lgkmcnt(8)
    v_xor_b32 v11, 64, v9
    v_mfma_f32_16x16x32_bf16 v[24:27], a[84:87], a[20:23], v[24:27]
    s_waitcnt lgkmcnt(7)
    ds_read_b64_tr_b16 a[96:97], v11
    v_mfma_f32_16x16x32_bf16 v[28:31], a[84:87], a[28:31], v[28:31]
    s_waitcnt lgkmcnt(7)
    s_mov_b64 exec, s[66:67]
    buffer_load_dwordx4 v1, s[4:7], s69 offen lds
    s_mov_b64 exec, -1
    v_mfma_f32_16x16x32_bf16 v[28:31], a[80:83], a[24:27], v[28:31]
    s_waitcnt lgkmcnt(6)
    s_add_u32 m0, s75, s73
    ds_read_b64_tr_b16 a[98:99], v11 offset:1024
    ds_read_b64_tr_b16 a[100:101], v11 offset:8192
    v_mfma_f32_16x16x32_bf16 v[144:147], a[80:83], a[32:35], v[144:147]
    s_waitcnt lgkmcnt(7)
    s_add_u32 s91, s70, 0
    ds_read_b64_tr_b16 a[102:103], v11 offset:9216
    v_mfma_f32_16x16x32_bf16 v[144:147], a[84:87], a[36:39], v[144:147]
    s_waitcnt lgkmcnt(4)
    buffer_load_dwordx4 v2, s[8:11], s91 offen lds
    v_mfma_f32_16x16x32_bf16 v[148:151], a[92:95], a[36:39], v[148:151]
    ds_read_b64_tr_b16 a[104:105], v11 offset:8
    v_mfma_f32_16x16x32_bf16 v[148:151], a[88:91], a[32:35], v[148:151]
    s_add_u32 m0, m0, 0x400
    ds_read_b64_tr_b16 a[106:107], v11 offset:1032
    v_mfma_f32_16x16x32_bf16 v[44:47], a[88:91], a[24:27], v[44:47]
    s_add_u32 s91, s70, 0x8000
    v_mfma_f32_16x16x32_bf16 v[44:47], a[92:95], a[28:31], v[44:47]
    ds_read_b64_tr_b16 a[108:109], v11 offset:8200
    buffer_load_dwordx4 v2, s[8:11], s91 offen lds
    v_mfma_f32_16x16x32_bf16 v[40:43], a[92:95], a[20:23], v[40:43]
    s_add_u32 s90, s77, 0x4000
    ds_read_b64_tr_b16 a[110:111], v11 offset:9224
    v_mfma_f32_16x16x32_bf16 v[40:43], a[88:91], a[16:19], v[40:43]
    s_xor_b32 s90, s90, s47
    v_mfma_f32_16x16x32_bf16 v[36:39], a[88:91], a[8:11], v[36:39]
    s_add_u32 m0, m0, 0xc00
    v_xor_b32 v10, 0x80, v9
    buffer_load_dwordx4 a[128:131], v3, s[12:15], s90 offen offset:2048 nt
    v_mfma_f32_16x16x32_bf16 v[36:39], a[92:95], a[12:15], v[36:39]
    s_add_u32 s91, s70, 0x20000
    ds_read_b64_tr_b16 a[80:81], v10
    v_mfma_f32_16x16x32_bf16 v[32:35], a[92:95], a[4:7], v[32:35]
    ds_read_b64_tr_b16 a[82:83], v10 offset:1024
    buffer_load_dwordx4 v2, s[8:11], s91 offen lds
    v_mfma_f32_16x16x32_bf16 v[32:35], a[88:91], a[0:3], v[32:35]
    s_waitcnt lgkmcnt(8)
    ds_read_b64_tr_b16 a[84:85], v10 offset:8192
    v_mfma_f32_16x16x32_bf16 v[48:51], a[96:99], a[0:3], v[48:51]
    s_waitcnt lgkmcnt(7)
    s_add_u32 m0, m0, 0x400
    ds_read_b64_tr_b16 a[86:87], v10 offset:9216
    v_mfma_f32_16x16x32_bf16 v[48:51], a[100:103], a[4:7], v[48:51]
    s_add_u32 s91, s70, 0x28000
    v_mfma_f32_16x16x32_bf16 v[52:55], a[100:103], a[12:15], v[52:55]
    ds_read_b64_tr_b16 a[88:89], v10 offset:8
    buffer_load_dwordx4 v2, s[8:11], s91 offen lds
    v_mfma_f32_16x16x32_bf16 v[52:55], a[96:99], a[8:11], v[52:55]
    ds_read_b64_tr_b16 a[90:91], v10 offset:1032
    v_mfma_f32_16x16x32_bf16 v[56:59], a[96:99], a[16:19], v[56:59]
    v_mfma_f32_16x16x32_bf16 v[56:59], a[100:103], a[20:23], v[56:59]
    s_add_u32 m0, m0, 0xc00
    ds_read_b64_tr_b16 a[92:93], v10 offset:8200
    v_mfma_f32_16x16x32_bf16 v[60:63], a[100:103], a[28:31], v[60:63]
    s_add_u32 s91, s70, 0x40000
    ds_read_b64_tr_b16 a[94:95], v10 offset:9224
    v_mfma_f32_16x16x32_bf16 v[60:63], a[96:99], a[24:27], v[60:63]
    s_waitcnt lgkmcnt(10)
    buffer_load_dwordx4 v2, s[8:11], s91 offen lds
    v_mfma_f32_16x16x32_bf16 v[76:79], a[104:107], a[24:27], v[76:79]
    s_waitcnt lgkmcnt(8)
    v_xor_b32 v11, 0xc0, v9
    v_mfma_f32_16x16x32_bf16 v[76:79], a[108:111], a[28:31], v[76:79]
    ds_read_b64_tr_b16 a[96:97], v11
    v_mfma_f32_16x16x32_bf16 v[72:75], a[108:111], a[20:23], v[72:75]
    s_add_u32 m0, m0, 0x400
    ds_read_b64_tr_b16 a[98:99], v11 offset:1024
    v_mfma_f32_16x16x32_bf16 v[72:75], a[104:107], a[16:19], v[72:75]
    s_add_u32 s91, s70, 0x48000
    ds_read_b64_tr_b16 a[100:101], v11 offset:8192
    v_mfma_f32_16x16x32_bf16 v[68:71], a[104:107], a[8:11], v[68:71]
    ds_read_b64_tr_b16 a[102:103], v11 offset:9216
    buffer_load_dwordx4 v2, s[8:11], s91 offen lds
    v_mfma_f32_16x16x32_bf16 v[68:71], a[108:111], a[12:15], v[68:71]
    s_add_u32 s90, s77, 0x4000
    v_mfma_f32_16x16x32_bf16 v[64:67], a[108:111], a[4:7], v[64:67]
    s_xor_b32 s90, s90, s47
    v_mfma_f32_16x16x32_bf16 v[64:67], a[104:107], a[0:3], v[64:67]
    s_waitcnt lgkmcnt(10)
    s_add_u32 m0, m0, 0xc00
    ds_read_b64_tr_b16 a[104:105], v11 offset:8
    buffer_load_dwordx4 a[132:135], v15, s[12:15], s90 offen offset:3072 nt
    v_mfma_f32_16x16x32_bf16 v[80:83], a[80:83], a[0:3], v[80:83]
    s_waitcnt lgkmcnt(9)
    s_add_u32 s91, s70, 0x60000
    ds_read_b64_tr_b16 a[106:107], v11 offset:1032
    buffer_load_dwordx4 v2, s[8:11], s91 offen lds
    v_mfma_f32_16x16x32_bf16 v[80:83], a[84:87], a[4:7], v[80:83]
    v_mfma_f32_16x16x32_bf16 v[84:87], a[84:87], a[12:15], v[84:87]
    ds_read_b64_tr_b16 a[108:109], v11 offset:8200
    v_mfma_f32_16x16x32_bf16 v[84:87], a[80:83], a[8:11], v[84:87]
    s_add_u32 m0, m0, 0x400
    ds_read_b64_tr_b16 a[110:111], v11 offset:9224
    v_mfma_f32_16x16x32_bf16 v[88:91], a[80:83], a[16:19], v[88:91]
    s_add_u32 s91, s70, 0x68000
    v_mfma_f32_16x16x32_bf16 v[88:91], a[84:87], a[20:23], v[88:91]
    buffer_load_dwordx4 v2, s[8:11], s91 offen lds
    v_mfma_f32_16x16x32_bf16 v[92:95], a[84:87], a[28:31], v[92:95]
    v_mfma_f32_16x16x32_bf16 v[92:95], a[80:83], a[24:27], v[92:95]
    v_mfma_f32_16x16x32_bf16 v[152:155], a[80:83], a[32:35], v[152:155]
    v_mfma_f32_16x16x32_bf16 v[152:155], a[84:87], a[36:39], v[152:155]
    s_waitcnt lgkmcnt(8)
    v_mfma_f32_16x16x32_bf16 v[156:159], a[92:95], a[36:39], v[156:159]
    s_cmp_gt_u32 s79, 10
    s_cselect_b32 s83, 10, 11
    v_mfma_f32_16x16x32_bf16 v[156:159], a[88:91], a[32:35], v[156:159]
    s_lshl_b32 s84, s83, 7
    v_mfma_f32_16x16x32_bf16 v[108:111], a[88:91], a[24:27], v[108:111]
    s_add_u32 s68, s80, s84
    v_mfma_f32_16x16x32_bf16 v[108:111], a[92:95], a[28:31], v[108:111]
    s_add_u32 s69, s81, s84
    s_lshl_b32 s84, s83, 19
    s_add_u32 s70, s82, s84
    v_mfma_f32_16x16x32_bf16 v[104:107], a[92:95], a[20:23], v[104:107]
    s_mov_b32 s75, s74
    s_cmp_eq_u32 s74, 0x19000
    s_cselect_b32 s76, 0xfffe7000, s96
    v_mfma_f32_16x16x32_bf16 v[104:107], a[88:91], a[16:19], v[104:107]
    s_add_u32 s74, s74, s76
    s_add_u32 s90, s54, 0x2000
    buffer_load_dwordx4 v[164:167], v4, s[24:27], s90 offen offset:1024
    v_mfma_f32_16x16x32_bf16 v[100:103], a[88:91], a[8:11], v[100:103]
    v_add_u32 v9, s76, v9
    v_add_u32 v5, s76, v5
    v_mfma_f32_16x16x32_bf16 v[100:103], a[92:95], a[12:15], v[100:103]
    s_waitcnt vmcnt(18) lgkmcnt(0)
    v_add_u32 v6, s76, v6
    v_add_u32 v7, s76, v7
    v_mfma_f32_16x16x32_bf16 v[96:99], a[92:95], a[4:7], v[96:99]
    s_barrier
    v_add_u32 v8, s76, v8
    v_mfma_f32_16x16x32_bf16 v[96:99], a[88:91], a[0:3], v[96:99]
    v_mfma_f32_16x16x32_bf16 v[112:115], a[96:99], a[0:3], v[112:115]
    s_add_u32 m0, s75, s71
    ds_read_b128 a[40:43], v5
    ds_read_b64_tr_b16 a[80:81], v9
    v_mfma_f32_16x16x32_bf16 v[112:115], a[100:103], a[4:7], v[112:115]
    s_add_u32 s91, s68, 0
    ds_read_b64_tr_b16 a[82:83], v9 offset:1024
    v_mfma_f32_16x16x32_bf16 v[116:119], a[100:103], a[12:15], v[116:119]
    ds_read_b128 a[44:47], v6
    buffer_load_dwordx4 v1, s[4:7], s91 offen lds
    v_mfma_f32_16x16x32_bf16 v[116:119], a[96:99], a[8:11], v[116:119]
    ds_read_b64_tr_b16 a[84:85], v9 offset:8192
    v_mfma_f32_16x16x32_bf16 v[120:123], a[96:99], a[16:19], v[120:123]
    s_add_u32 m0, m0, 0x400
    ds_read_b64_tr_b16 a[86:87], v9 offset:9216
    v_mfma_f32_16x16x32_bf16 v[120:123], a[100:103], a[20:23], v[120:123]
    s_add_u32 s91, s68, 0x4000
    ds_read_b128 a[52:55], v6 offset:2048
    v_mfma_f32_16x16x32_bf16 v[124:127], a[100:103], a[28:31], v[124:127]
    buffer_load_dwordx4 v1, s[4:7], s91 offen lds
    v_mfma_f32_16x16x32_bf16 v[124:127], a[96:99], a[24:27], v[124:127]
    ds_read_b128 a[48:51], v5 offset:2048
    v_mfma_f32_16x16x32_bf16 v[140:143], a[104:107], a[24:27], v[140:143]
    ds_read_b128 a[56:59], v5 offset:4096
    v_mfma_f32_16x16x32_bf16 v[140:143], a[108:111], a[28:31], v[140:143]
    s_add_u32 m0, m0, 0x400
    ds_read_b128 a[60:63], v6 offset:4096
    v_mfma_f32_16x16x32_bf16 v[136:139], a[108:111], a[20:23], v[136:139]
    s_add_u32 s91, s68, 0x8000
    ds_read_b128 a[68:71], v6 offset:6144
    v_mfma_f32_16x16x32_bf16 v[136:139], a[104:107], a[16:19], v[136:139]
    ds_read_b128 a[64:67], v5 offset:6144
    buffer_load_dwordx4 v1, s[4:7], s91 offen lds
    v_mfma_f32_16x16x32_bf16 v[132:135], a[104:107], a[8:11], v[132:135]
    ds_read_b128 a[72:75], v7
    v_mfma_f32_16x16x32_bf16 v[132:135], a[108:111], a[12:15], v[132:135]
    s_add_u32 m0, m0, 0x400
    ds_read_b128 a[76:79], v8
    v_mfma_f32_16x16x32_bf16 v[128:131], a[108:111], a[4:7], v[128:131]
    s_add_u32 s91, s68, 0xc000
    v_mfma_f32_16x16x32_bf16 v[128:131], a[104:107], a[0:3], v[128:131]
    s_waitcnt lgkmcnt(11)
    ds_read_b64_tr_b16 a[88:89], v9 offset:8
    buffer_load_dwordx4 v1, s[4:7], s91 offen lds
    v_mfma_f32_16x16x32_bf16 v[16:19], a[80:83], a[40:43], v[16:19]
    s_waitcnt lgkmcnt(9)
    s_add_u32 s90, s77, 0x5000
    ds_read_b64_tr_b16 a[90:91], v9 offset:1032
    v_mfma_f32_16x16x32_bf16 v[16:19], a[84:87], a[44:47], v[16:19]
    s_waitcnt lgkmcnt(9)
    s_xor_b32 s90, s90, s47
    ds_read_b64_tr_b16 a[92:93], v9 offset:8200
    v_mfma_f32_16x16x32_bf16 v[20:23], a[84:87], a[52:55], v[20:23]
    s_waitcnt lgkmcnt(9)
    ds_read_b64_tr_b16 a[94:95], v9 offset:9224
    buffer_load_dwordx4 a[136:139], v3, s[12:15], s90 offen nt
    v_mfma_f32_16x16x32_bf16 v[20:23], a[80:83], a[48:51], v[20:23]
    s_waitcnt lgkmcnt(9)
    s_add_u32 m0, s75, s72
    v_mfma_f32_16x16x32_bf16 v[24:27], a[80:83], a[56:59], v[24:27]
    s_waitcnt lgkmcnt(8)
    v_xor_b32 v11, 64, v9
    v_mfma_f32_16x16x32_bf16 v[24:27], a[84:87], a[60:63], v[24:27]
    s_waitcnt lgkmcnt(7)
    ds_read_b64_tr_b16 a[96:97], v11
    v_mfma_f32_16x16x32_bf16 v[28:31], a[84:87], a[68:71], v[28:31]
    s_waitcnt lgkmcnt(7)
    s_mov_b64 exec, s[66:67]
    buffer_load_dwordx4 v1, s[4:7], s69 offen lds
    s_mov_b64 exec, -1
    v_mfma_f32_16x16x32_bf16 v[28:31], a[80:83], a[64:67], v[28:31]
    s_waitcnt lgkmcnt(6)
    s_add_u32 m0, s75, s73
    ds_read_b64_tr_b16 a[98:99], v11 offset:1024
    ds_read_b64_tr_b16 a[100:101], v11 offset:8192
    v_mfma_f32_16x16x32_bf16 v[144:147], a[80:83], a[72:75], v[144:147]
    s_waitcnt lgkmcnt(7)
    s_add_u32 s91, s70, 0
    ds_read_b64_tr_b16 a[102:103], v11 offset:9216
    v_mfma_f32_16x16x32_bf16 v[144:147], a[84:87], a[76:79], v[144:147]
    s_waitcnt lgkmcnt(4)
    buffer_load_dwordx4 v2, s[8:11], s91 offen lds
    v_mfma_f32_16x16x32_bf16 v[148:151], a[92:95], a[76:79], v[148:151]
    ds_read_b64_tr_b16 a[104:105], v11 offset:8
    v_mfma_f32_16x16x32_bf16 v[148:151], a[88:91], a[72:75], v[148:151]
    s_add_u32 m0, m0, 0x400
    ds_read_b64_tr_b16 a[106:107], v11 offset:1032
    v_mfma_f32_16x16x32_bf16 v[44:47], a[88:91], a[64:67], v[44:47]
    s_add_u32 s91, s70, 0x8000
    v_mfma_f32_16x16x32_bf16 v[44:47], a[92:95], a[68:71], v[44:47]
    ds_read_b64_tr_b16 a[108:109], v11 offset:8200
    buffer_load_dwordx4 v2, s[8:11], s91 offen lds
    v_mfma_f32_16x16x32_bf16 v[40:43], a[92:95], a[60:63], v[40:43]
    ds_read_b64_tr_b16 a[110:111], v11 offset:9224
    v_mfma_f32_16x16x32_bf16 v[40:43], a[88:91], a[56:59], v[40:43]
    v_mfma_f32_16x16x32_bf16 v[36:39], a[88:91], a[48:51], v[36:39]
    s_add_u32 m0, m0, 0xc00
    v_xor_b32 v10, 0x80, v9
    v_mfma_f32_16x16x32_bf16 v[36:39], a[92:95], a[52:55], v[36:39]
    s_add_u32 s91, s70, 0x20000
    ds_read_b64_tr_b16 a[80:81], v10
    v_mfma_f32_16x16x32_bf16 v[32:35], a[92:95], a[44:47], v[32:35]
    ds_read_b64_tr_b16 a[82:83], v10 offset:1024
    buffer_load_dwordx4 v2, s[8:11], s91 offen lds
    v_mfma_f32_16x16x32_bf16 v[32:35], a[88:91], a[40:43], v[32:35]
    s_waitcnt lgkmcnt(8)
    ds_read_b64_tr_b16 a[84:85], v10 offset:8192
    v_mfma_f32_16x16x32_bf16 v[48:51], a[96:99], a[40:43], v[48:51]
    s_waitcnt lgkmcnt(7)
    s_add_u32 s90, s77, 0x5000
    ds_read_b64_tr_b16 a[86:87], v10 offset:9216
    v_mfma_f32_16x16x32_bf16 v[48:51], a[100:103], a[44:47], v[48:51]
    s_xor_b32 s90, s90, s47
    v_mfma_f32_16x16x32_bf16 v[52:55], a[100:103], a[52:55], v[52:55]
    s_add_u32 m0, m0, 0x400
    ds_read_b64_tr_b16 a[88:89], v10 offset:8
    buffer_load_dwordx4 a[140:143], v15, s[12:15], s90 offen offset:1024 nt
    v_mfma_f32_16x16x32_bf16 v[52:55], a[96:99], a[48:51], v[52:55]
    s_add_u32 s91, s70, 0x28000
    ds_read_b64_tr_b16 a[90:91], v10 offset:1032
    buffer_load_dwordx4 v2, s[8:11], s91 offen lds
    v_mfma_f32_16x16x32_bf16 v[56:59], a[96:99], a[56:59], v[56:59]
    v_mfma_f32_16x16x32_bf16 v[56:59], a[100:103], a[60:63], v[56:59]
    s_add_u32 m0, m0, 0xc00
    ds_read_b64_tr_b16 a[92:93], v10 offset:8200
    v_mfma_f32_16x16x32_bf16 v[60:63], a[100:103], a[68:71], v[60:63]
    s_add_u32 s91, s70, 0x40000
    ds_read_b64_tr_b16 a[94:95], v10 offset:9224
    v_mfma_f32_16x16x32_bf16 v[60:63], a[96:99], a[64:67], v[60:63]
    s_waitcnt lgkmcnt(10)
    buffer_load_dwordx4 v2, s[8:11], s91 offen lds
    v_mfma_f32_16x16x32_bf16 v[76:79], a[104:107], a[64:67], v[76:79]
    s_waitcnt lgkmcnt(8)
    v_xor_b32 v11, 0xc0, v9
    v_mfma_f32_16x16x32_bf16 v[76:79], a[108:111], a[68:71], v[76:79]
    ds_read_b64_tr_b16 a[96:97], v11
    v_mfma_f32_16x16x32_bf16 v[72:75], a[108:111], a[60:63], v[72:75]
    s_add_u32 m0, m0, 0x400
    ds_read_b64_tr_b16 a[98:99], v11 offset:1024
    v_mfma_f32_16x16x32_bf16 v[72:75], a[104:107], a[56:59], v[72:75]
    s_add_u32 s91, s70, 0x48000
    ds_read_b64_tr_b16 a[100:101], v11 offset:8192
    v_mfma_f32_16x16x32_bf16 v[68:71], a[104:107], a[48:51], v[68:71]
    ds_read_b64_tr_b16 a[102:103], v11 offset:9216
    buffer_load_dwordx4 v2, s[8:11], s91 offen lds
    v_mfma_f32_16x16x32_bf16 v[68:71], a[108:111], a[52:55], v[68:71]
    v_mfma_f32_16x16x32_bf16 v[64:67], a[108:111], a[44:47], v[64:67]
    s_add_u32 m0, m0, 0xc00
    v_mfma_f32_16x16x32_bf16 v[64:67], a[104:107], a[40:43], v[64:67]
    s_waitcnt lgkmcnt(10)
    s_add_u32 s91, s70, 0x60000
    ds_read_b64_tr_b16 a[104:105], v11 offset:8
    v_mfma_f32_16x16x32_bf16 v[80:83], a[80:83], a[40:43], v[80:83]
    s_waitcnt lgkmcnt(9)
    ds_read_b64_tr_b16 a[106:107], v11 offset:1032
    buffer_load_dwordx4 v2, s[8:11], s91 offen lds
    v_mfma_f32_16x16x32_bf16 v[80:83], a[84:87], a[44:47], v[80:83]
    v_mfma_f32_16x16x32_bf16 v[84:87], a[84:87], a[52:55], v[84:87]
    ds_read_b64_tr_b16 a[108:109], v11 offset:8200
    v_mfma_f32_16x16x32_bf16 v[84:87], a[80:83], a[48:51], v[84:87]
    s_add_u32 m0, m0, 0x400
    ds_read_b64_tr_b16 a[110:111], v11 offset:9224
    v_mfma_f32_16x16x32_bf16 v[88:91], a[80:83], a[56:59], v[88:91]
    s_add_u32 s90, s54, 0x2000
    v_mfma_f32_16x16x32_bf16 v[88:91], a[84:87], a[60:63], v[88:91]
    s_add_u32 s91, s70, 0x68000
    buffer_load_dwordx4 v[168:171], v4, s[24:27], s90 offen offset:2048
    buffer_load_dwordx4 v2, s[8:11], s91 offen lds
    v_mfma_f32_16x16x32_bf16 v[92:95], a[84:87], a[68:71], v[92:95]
    v_mfma_f32_16x16x32_bf16 v[92:95], a[80:83], a[64:67], v[92:95]
    v_mfma_f32_16x16x32_bf16 v[152:155], a[80:83], a[72:75], v[152:155]
    v_mfma_f32_16x16x32_bf16 v[152:155], a[84:87], a[76:79], v[152:155]
    s_waitcnt lgkmcnt(8)
    v_mfma_f32_16x16x32_bf16 v[156:159], a[92:95], a[76:79], v[156:159]
    s_cmp_gt_u32 s79, 11
    s_cselect_b32 s83, 11, 12
    v_mfma_f32_16x16x32_bf16 v[156:159], a[88:91], a[72:75], v[156:159]
    s_lshl_b32 s84, s83, 7
    v_mfma_f32_16x16x32_bf16 v[108:111], a[88:91], a[64:67], v[108:111]
    s_add_u32 s68, s80, s84
    v_mfma_f32_16x16x32_bf16 v[108:111], a[92:95], a[68:71], v[108:111]
    s_add_u32 s69, s81, s84
    s_lshl_b32 s84, s83, 19
    s_add_u32 s70, s82, s84
    v_mfma_f32_16x16x32_bf16 v[104:107], a[92:95], a[60:63], v[104:107]
    s_mov_b32 s75, s74
    s_cmp_eq_u32 s74, 0x19000
    s_cselect_b32 s76, 0xfffe7000, s96
    v_mfma_f32_16x16x32_bf16 v[104:107], a[88:91], a[56:59], v[104:107]
    s_add_u32 s74, s74, s76
    v_add_u32 v9, s76, v9
    v_add_u32 v5, s76, v5
    v_mfma_f32_16x16x32_bf16 v[100:103], a[88:91], a[48:51], v[100:103]
    v_add_u32 v6, s76, v6
    v_add_u32 v7, s76, v7
    v_mfma_f32_16x16x32_bf16 v[100:103], a[92:95], a[52:55], v[100:103]
    s_waitcnt vmcnt(17) lgkmcnt(0)
    v_add_u32 v8, s76, v8
    v_mfma_f32_16x16x32_bf16 v[96:99], a[92:95], a[44:47], v[96:99]
    s_barrier
    v_mfma_f32_16x16x32_bf16 v[96:99], a[88:91], a[40:43], v[96:99]
    v_mfma_f32_16x16x32_bf16 v[112:115], a[96:99], a[40:43], v[112:115]
    s_add_u32 m0, s75, s71
    ds_read_b128 a[0:3], v5
    ds_read_b64_tr_b16 a[80:81], v9
    v_mfma_f32_16x16x32_bf16 v[112:115], a[100:103], a[44:47], v[112:115]
    s_add_u32 s91, s68, 0
    ds_read_b64_tr_b16 a[82:83], v9 offset:1024
    v_mfma_f32_16x16x32_bf16 v[116:119], a[100:103], a[52:55], v[116:119]
    ds_read_b128 a[4:7], v6
    buffer_load_dwordx4 v1, s[4:7], s91 offen lds
    v_mfma_f32_16x16x32_bf16 v[116:119], a[96:99], a[48:51], v[116:119]
    s_add_u32 s90, s77, 0x5000
    ds_read_b64_tr_b16 a[84:85], v9 offset:8192
    v_mfma_f32_16x16x32_bf16 v[120:123], a[96:99], a[56:59], v[120:123]
    s_xor_b32 s90, s90, s47
    ds_read_b64_tr_b16 a[86:87], v9 offset:9216
    v_mfma_f32_16x16x32_bf16 v[120:123], a[100:103], a[60:63], v[120:123]
    s_add_u32 m0, m0, 0x400
    ds_read_b128 a[12:15], v6 offset:2048
    buffer_load_dwordx4 a[144:147], v3, s[12:15], s90 offen offset:2048 nt
    v_mfma_f32_16x16x32_bf16 v[124:127], a[100:103], a[68:71], v[124:127]
    s_add_u32 s91, s68, 0x4000
    buffer_load_dwordx4 v1, s[4:7], s91 offen lds
    v_mfma_f32_16x16x32_bf16 v[124:127], a[96:99], a[64:67], v[124:127]
    ds_read_b128 a[8:11], v5 offset:2048
    v_mfma_f32_16x16x32_bf16 v[140:143], a[104:107], a[64:67], v[140:143]
    ds_read_b128 a[16:19], v5 offset:4096
    v_mfma_f32_16x16x32_bf16 v[140:143], a[108:111], a[68:71], v[140:143]
    s_add_u32 m0, m0, 0x400
    ds_read_b128 a[20:23], v6 offset:4096
    v_mfma_f32_16x16x32_bf16 v[136:139], a[108:111], a[60:63], v[136:139]
    s_add_u32 s91, s68, 0x8000
    ds_read_b128 a[28:31], v6 offset:6144
    v_mfma_f32_16x16x32_bf16 v[136:139], a[104:107], a[56:59], v[136:139]
    ds_read_b128 a[24:27], v5 offset:6144
    buffer_load_dwordx4 v1, s[4:7], s91 offen lds
    v_mfma_f32_16x16x32_bf16 v[132:135], a[104:107], a[48:51], v[132:135]
    ds_read_b128 a[32:35], v7
    v_mfma_f32_16x16x32_bf16 v[132:135], a[108:111], a[52:55], v[132:135]
    s_add_u32 m0, m0, 0x400
    ds_read_b128 a[36:39], v8
    v_mfma_f32_16x16x32_bf16 v[128:131], a[108:111], a[44:47], v[128:131]
    s_add_u32 s91, s68, 0xc000
    v_mfma_f32_16x16x32_bf16 v[128:131], a[104:107], a[40:43], v[128:131]
    s_waitcnt lgkmcnt(11)
    ds_read_b64_tr_b16 a[88:89], v9 offset:8
    buffer_load_dwordx4 v1, s[4:7], s91 offen lds
    v_mfma_f32_16x16x32_bf16 v[16:19], a[80:83], a[0:3], v[16:19]
    s_waitcnt lgkmcnt(9)
    ds_read_b64_tr_b16 a[90:91], v9 offset:1032
    v_mfma_f32_16x16x32_bf16 v[16:19], a[84:87], a[4:7], v[16:19]
    s_waitcnt lgkmcnt(9)
    ds_read_b64_tr_b16 a[92:93], v9 offset:8200
    v_mfma_f32_16x16x32_bf16 v[20:23], a[84:87], a[12:15], v[20:23]
    s_waitcnt lgkmcnt(9)
    ds_read_b64_tr_b16 a[94:95], v9 offset:9224
    v_mfma_f32_16x16x32_bf16 v[20:23], a[80:83], a[8:11], v[20:23]
    s_waitcnt lgkmcnt(9)
    s_add_u32 m0, s75, s72
    v_mfma_f32_16x16x32_bf16 v[24:27], a[80:83], a[16:19], v[24:27]
    s_waitcnt lgkmcnt(8)
    v_xor_b32 v11, 64, v9
    v_mfma_f32_16x16x32_bf16 v[24:27], a[84:87], a[20:23], v[24:27]
    s_waitcnt lgkmcnt(7)
    ds_read_b64_tr_b16 a[96:97], v11
    v_mfma_f32_16x16x32_bf16 v[28:31], a[84:87], a[28:31], v[28:31]
    s_waitcnt lgkmcnt(7)
    s_add_u32 s90, s77, 0x5000
    s_mov_b64 exec, s[66:67]
    buffer_load_dwordx4 v1, s[4:7], s69 offen lds
    s_mov_b64 exec, -1
    v_mfma_f32_16x16x32_bf16 v[28:31], a[80:83], a[24:27], v[28:31]
    s_waitcnt lgkmcnt(6)
    s_xor_b32 s90, s90, s47
    ds_read_b64_tr_b16 a[98:99], v11 offset:1024
    ds_read_b64_tr_b16 a[100:101], v11 offset:8192
    v_mfma_f32_16x16x32_bf16 v[144:147], a[80:83], a[32:35], v[144:147]
    s_waitcnt lgkmcnt(7)
    s_add_u32 m0, s75, s73
    ds_read_b64_tr_b16 a[102:103], v11 offset:9216
    buffer_load_dwordx4 a[148:151], v15, s[12:15], s90 offen offset:3072 nt
    v_mfma_f32_16x16x32_bf16 v[144:147], a[84:87], a[36:39], v[144:147]
    s_waitcnt lgkmcnt(4)
    s_add_u32 s91, s70, 0
    buffer_load_dwordx4 v2, s[8:11], s91 offen lds
    v_mfma_f32_16x16x32_bf16 v[148:151], a[92:95], a[36:39], v[148:151]
    ds_read_b64_tr_b16 a[104:105], v11 offset:8
    v_mfma_f32_16x16x32_bf16 v[148:151], a[88:91], a[32:35], v[148:151]
    s_add_u32 m0, m0, 0x400
    ds_read_b64_tr_b16 a[106:107], v11 offset:1032
    v_mfma_f32_16x16x32_bf16 v[44:47], a[88:91], a[24:27], v[44:47]
    s_add_u32 s91, s70, 0x8000
    v_mfma_f32_16x16x32_bf16 v[44:47], a[92:95], a[28:31], v[44:47]
    ds_read_b64_tr_b16 a[108:109], v11 offset:8200
    buffer_load_dwordx4 v2, s[8:11], s91 offen lds
    v_mfma_f32_16x16x32_bf16 v[40:43], a[92:95], a[20:23], v[40:43]
    ds_read_b64_tr_b16 a[110:111], v11 offset:9224
    v_mfma_f32_16x16x32_bf16 v[40:43], a[88:91], a[16:19], v[40:43]
    v_mfma_f32_16x16x32_bf16 v[36:39], a[88:91], a[8:11], v[36:39]
    s_add_u32 m0, m0, 0xc00
    v_xor_b32 v10, 0x80, v9
    v_mfma_f32_16x16x32_bf16 v[36:39], a[92:95], a[12:15], v[36:39]
    s_add_u32 s91, s70, 0x20000
    ds_read_b64_tr_b16 a[80:81], v10
    v_mfma_f32_16x16x32_bf16 v[32:35], a[92:95], a[4:7], v[32:35]
    ds_read_b64_tr_b16 a[82:83], v10 offset:1024
    buffer_load_dwordx4 v2, s[8:11], s91 offen lds
    v_mfma_f32_16x16x32_bf16 v[32:35], a[88:91], a[0:3], v[32:35]
    s_waitcnt lgkmcnt(8)
    ds_read_b64_tr_b16 a[84:85], v10 offset:8192
    v_mfma_f32_16x16x32_bf16 v[48:51], a[96:99], a[0:3], v[48:51]
    s_waitcnt lgkmcnt(7)
    s_add_u32 m0, m0, 0x400
    ds_read_b64_tr_b16 a[86:87], v10 offset:9216
    v_mfma_f32_16x16x32_bf16 v[48:51], a[100:103], a[4:7], v[48:51]
    s_add_u32 s91, s70, 0x28000
    v_mfma_f32_16x16x32_bf16 v[52:55], a[100:103], a[12:15], v[52:55]
    ds_read_b64_tr_b16 a[88:89], v10 offset:8
    buffer_load_dwordx4 v2, s[8:11], s91 offen lds
    v_mfma_f32_16x16x32_bf16 v[52:55], a[96:99], a[8:11], v[52:55]
    ds_read_b64_tr_b16 a[90:91], v10 offset:1032
    v_mfma_f32_16x16x32_bf16 v[56:59], a[96:99], a[16:19], v[56:59]
    v_mfma_f32_16x16x32_bf16 v[56:59], a[100:103], a[20:23], v[56:59]
    s_add_u32 m0, m0, 0xc00
    ds_read_b64_tr_b16 a[92:93], v10 offset:8200
    v_mfma_f32_16x16x32_bf16 v[60:63], a[100:103], a[28:31], v[60:63]
    s_add_u32 s91, s70, 0x40000
    ds_read_b64_tr_b16 a[94:95], v10 offset:9224
    v_mfma_f32_16x16x32_bf16 v[60:63], a[96:99], a[24:27], v[60:63]
    s_waitcnt lgkmcnt(10)
    s_add_u32 s90, s54, 0x2000
    buffer_load_dwordx4 v2, s[8:11], s91 offen lds
    v_mfma_f32_16x16x32_bf16 v[76:79], a[104:107], a[24:27], v[76:79]
    s_waitcnt lgkmcnt(8)
    v_xor_b32 v11, 0xc0, v9
    buffer_load_dwordx4 v[172:175], v4, s[24:27], s90 offen offset:3072
    v_mfma_f32_16x16x32_bf16 v[76:79], a[108:111], a[28:31], v[76:79]
    ds_read_b64_tr_b16 a[96:97], v11
    v_mfma_f32_16x16x32_bf16 v[72:75], a[108:111], a[20:23], v[72:75]
    s_add_u32 m0, m0, 0x400
    ds_read_b64_tr_b16 a[98:99], v11 offset:1024
    v_mfma_f32_16x16x32_bf16 v[72:75], a[104:107], a[16:19], v[72:75]
    s_add_u32 s91, s70, 0x48000
    ds_read_b64_tr_b16 a[100:101], v11 offset:8192
    v_mfma_f32_16x16x32_bf16 v[68:71], a[104:107], a[8:11], v[68:71]
    ds_read_b64_tr_b16 a[102:103], v11 offset:9216
    buffer_load_dwordx4 v2, s[8:11], s91 offen lds
    v_mfma_f32_16x16x32_bf16 v[68:71], a[108:111], a[12:15], v[68:71]
    v_mfma_f32_16x16x32_bf16 v[64:67], a[108:111], a[4:7], v[64:67]
    s_add_u32 m0, m0, 0xc00
    v_mfma_f32_16x16x32_bf16 v[64:67], a[104:107], a[0:3], v[64:67]
    s_waitcnt lgkmcnt(10)
    s_add_u32 s91, s70, 0x60000
    ds_read_b64_tr_b16 a[104:105], v11 offset:8
    v_mfma_f32_16x16x32_bf16 v[80:83], a[80:83], a[0:3], v[80:83]
    s_waitcnt lgkmcnt(9)
    ds_read_b64_tr_b16 a[106:107], v11 offset:1032
    buffer_load_dwordx4 v2, s[8:11], s91 offen lds
    v_mfma_f32_16x16x32_bf16 v[80:83], a[84:87], a[4:7], v[80:83]
    v_mfma_f32_16x16x32_bf16 v[84:87], a[84:87], a[12:15], v[84:87]
    ds_read_b64_tr_b16 a[108:109], v11 offset:8200
    v_mfma_f32_16x16x32_bf16 v[84:87], a[80:83], a[8:11], v[84:87]
    s_add_u32 m0, m0, 0x400
    ds_read_b64_tr_b16 a[110:111], v11 offset:9224
    v_mfma_f32_16x16x32_bf16 v[88:91], a[80:83], a[16:19], v[88:91]
    s_add_u32 s91, s70, 0x68000
    v_mfma_f32_16x16x32_bf16 v[88:91], a[84:87], a[20:23], v[88:91]
    buffer_load_dwordx4 v2, s[8:11], s91 offen lds
    v_mfma_f32_16x16x32_bf16 v[92:95], a[84:87], a[28:31], v[92:95]
    v_mfma_f32_16x16x32_bf16 v[92:95], a[80:83], a[24:27], v[92:95]
    v_mfma_f32_16x16x32_bf16 v[152:155], a[80:83], a[32:35], v[152:155]
    v_mfma_f32_16x16x32_bf16 v[152:155], a[84:87], a[36:39], v[152:155]
    s_waitcnt lgkmcnt(8)
    s_add_u32 s90, s77, 0
    v_mfma_f32_16x16x32_bf16 v[156:159], a[92:95], a[36:39], v[156:159]
    s_xor_b32 s90, s90, s47
    s_cmp_gt_u32 s79, 12
    s_cselect_b32 s83, 12, 13
    v_mfma_f32_16x16x32_bf16 v[156:159], a[88:91], a[32:35], v[156:159]
    s_lshl_b32 s84, s83, 7
    buffer_load_dwordx4 a[152:155], v3, s[16:19], s90 offen nt
    v_mfma_f32_16x16x32_bf16 v[108:111], a[88:91], a[24:27], v[108:111]
    s_add_u32 s68, s80, s84
    v_mfma_f32_16x16x32_bf16 v[108:111], a[92:95], a[28:31], v[108:111]
    s_add_u32 s69, s81, s84
    s_lshl_b32 s84, s83, 19
    s_add_u32 s70, s82, s84
    v_mfma_f32_16x16x32_bf16 v[104:107], a[92:95], a[20:23], v[104:107]
    s_mov_b32 s75, s74
    s_cmp_eq_u32 s74, 0x19000
    s_cselect_b32 s76, 0xfffe7000, s96
    v_mfma_f32_16x16x32_bf16 v[104:107], a[88:91], a[16:19], v[104:107]
    s_add_u32 s74, s74, s76
    v_add_u32 v9, s76, v9
    v_add_u32 v5, s76, v5
    v_mfma_f32_16x16x32_bf16 v[100:103], a[88:91], a[8:11], v[100:103]
    v_add_u32 v6, s76, v6
    v_add_u32 v7, s76, v7
    v_mfma_f32_16x16x32_bf16 v[100:103], a[92:95], a[12:15], v[100:103]
    s_waitcnt vmcnt(17) lgkmcnt(0)
    v_add_u32 v8, s76, v8
    v_mfma_f32_16x16x32_bf16 v[96:99], a[92:95], a[4:7], v[96:99]
    s_barrier
    v_mfma_f32_16x16x32_bf16 v[96:99], a[88:91], a[0:3], v[96:99]
    v_mfma_f32_16x16x32_bf16 v[112:115], a[96:99], a[0:3], v[112:115]
    s_add_u32 m0, s75, s71
    ds_read_b128 a[40:43], v5
    ds_read_b64_tr_b16 a[80:81], v9
    v_mfma_f32_16x16x32_bf16 v[112:115], a[100:103], a[4:7], v[112:115]
    s_add_u32 s91, s68, 0
    ds_read_b64_tr_b16 a[82:83], v9 offset:1024
    v_mfma_f32_16x16x32_bf16 v[116:119], a[100:103], a[12:15], v[116:119]
    ds_read_b128 a[44:47], v6
    buffer_load_dwordx4 v1, s[4:7], s91 offen lds
    v_mfma_f32_16x16x32_bf16 v[116:119], a[96:99], a[8:11], v[116:119]
    ds_read_b64_tr_b16 a[84:85], v9 offset:8192
    v_mfma_f32_16x16x32_bf16 v[120:123], a[96:99], a[16:19], v[120:123]
    s_add_u32 m0, m0, 0x400
    ds_read_b64_tr_b16 a[86:87], v9 offset:9216
    v_mfma_f32_16x16x32_bf16 v[120:123], a[100:103], a[20:23], v[120:123]
    s_add_u32 s91, s68, 0x4000
    ds_read_b128 a[52:55], v6 offset:2048
    v_mfma_f32_16x16x32_bf16 v[124:127], a[100:103], a[28:31], v[124:127]
    buffer_load_dwordx4 v1, s[4:7], s91 offen lds
    v_mfma_f32_16x16x32_bf16 v[124:127], a[96:99], a[24:27], v[124:127]
    ds_read_b128 a[48:51], v5 offset:2048
    v_mfma_f32_16x16x32_bf16 v[140:143], a[104:107], a[24:27], v[140:143]
    ds_read_b128 a[56:59], v5 offset:4096
    v_mfma_f32_16x16x32_bf16 v[140:143], a[108:111], a[28:31], v[140:143]
    s_add_u32 s90, s77, 0
    ds_read_b128 a[60:63], v6 offset:4096
    v_mfma_f32_16x16x32_bf16 v[136:139], a[108:111], a[20:23], v[136:139]
    s_xor_b32 s90, s90, s47
    ds_read_b128 a[68:71], v6 offset:6144
    v_mfma_f32_16x16x32_bf16 v[136:139], a[104:107], a[16:19], v[136:139]
    s_add_u32 m0, m0, 0x400
    ds_read_b128 a[64:67], v5 offset:6144
    buffer_load_dwordx4 a[156:159], v15, s[16:19], s90 offen offset:1024 nt
    v_mfma_f32_16x16x32_bf16 v[132:135], a[104:107], a[8:11], v[132:135]
    s_add_u32 s91, s68, 0x8000
    ds_read_b128 a[72:75], v7
    buffer_load_dwordx4 v1, s[4:7], s91 offen lds
    v_mfma_f32_16x16x32_bf16 v[132:135], a[108:111], a[12:15], v[132:135]
    s_add_u32 m0, m0, 0x400
    ds_read_b128 a[76:79], v8
    v_mfma_f32_16x16x32_bf16 v[128:131], a[108:111], a[4:7], v[128:131]
    s_add_u32 s91, s68, 0xc000
    v_mfma_f32_16x16x32_bf16 v[128:131], a[104:107], a[0:3], v[128:131]
    s_waitcnt lgkmcnt(11)
    ds_read_b64_tr_b16 a[88:89], v9 offset:8
    buffer_load_dwordx4 v1, s[4:7], s91 offen lds
    v_mfma_f32_16x16x32_bf16 v[16:19], a[80:83], a[40:43], v[16:19]
    s_waitcnt lgkmcnt(9)
    ds_read_b64_tr_b16 a[90:91], v9 offset:1032
    v_mfma_f32_16x16x32_bf16 v[16:19], a[84:87], a[44:47], v[16:19]
    s_waitcnt lgkmcnt(9)
    ds_read_b64_tr_b16 a[92:93], v9 offset:8200
    v_mfma_f32_16x16x32_bf16 v[20:23], a[84:87], a[52:55], v[20:23]
    s_waitcnt lgkmcnt(9)
    ds_read_b64_tr_b16 a[94:95], v9 offset:9224
    v_mfma_f32_16x16x32_bf16 v[20:23], a[80:83], a[48:51], v[20:23]
    s_waitcnt lgkmcnt(9)
    s_add_u32 m0, s75, s72
    v_mfma_f32_16x16x32_bf16 v[24:27], a[80:83], a[56:59], v[24:27]
    s_waitcnt lgkmcnt(8)
    v_xor_b32 v11, 64, v9
    v_mfma_f32_16x16x32_bf16 v[24:27], a[84:87], a[60:63], v[24:27]
    s_waitcnt lgkmcnt(7)
    ds_read_b64_tr_b16 a[96:97], v11
    v_mfma_f32_16x16x32_bf16 v[28:31], a[84:87], a[68:71], v[28:31]
    s_waitcnt lgkmcnt(7)
    s_mov_b64 exec, s[66:67]
    buffer_load_dwordx4 v1, s[4:7], s69 offen lds
    s_mov_b64 exec, -1
    v_mfma_f32_16x16x32_bf16 v[28:31], a[80:83], a[64:67], v[28:31]
    s_waitcnt lgkmcnt(6)
    s_add_u32 m0, s75, s73
    ds_read_b64_tr_b16 a[98:99], v11 offset:1024
    ds_read_b64_tr_b16 a[100:101], v11 offset:8192
    v_mfma_f32_16x16x32_bf16 v[144:147], a[80:83], a[72:75], v[144:147]
    s_waitcnt lgkmcnt(7)
    s_add_u32 s91, s70, 0
    ds_read_b64_tr_b16 a[102:103], v11 offset:9216
    v_mfma_f32_16x16x32_bf16 v[144:147], a[84:87], a[76:79], v[144:147]
    s_waitcnt lgkmcnt(4)
    buffer_load_dwordx4 v2, s[8:11], s91 offen lds
    v_mfma_f32_16x16x32_bf16 v[148:151], a[92:95], a[76:79], v[148:151]
    ds_read_b64_tr_b16 a[104:105], v11 offset:8
    v_mfma_f32_16x16x32_bf16 v[148:151], a[88:91], a[72:75], v[148:151]
    s_add_u32 m0, m0, 0x400
    ds_read_b64_tr_b16 a[106:107], v11 offset:1032
    v_mfma_f32_16x16x32_bf16 v[44:47], a[88:91], a[64:67], v[44:47]
    s_add_u32 s91, s70, 0x8000
    v_mfma_f32_16x16x32_bf16 v[44:47], a[92:95], a[68:71], v[44:47]
    s_add_u32 s90, s54, 0x3000
    ds_read_b64_tr_b16 a[108:109], v11 offset:8200
    buffer_load_dwordx4 v2, s[8:11], s91 offen lds
    v_mfma_f32_16x16x32_bf16 v[40:43], a[92:95], a[60:63], v[40:43]
    ds_read_b64_tr_b16 a[110:111], v11 offset:9224
    buffer_load_dwordx4 v[176:179], v4, s[24:27], s90 offen
    v_mfma_f32_16x16x32_bf16 v[40:43], a[88:91], a[56:59], v[40:43]
    v_mfma_f32_16x16x32_bf16 v[36:39], a[88:91], a[48:51], v[36:39]
    s_add_u32 m0, m0, 0xc00
    v_xor_b32 v10, 0x80, v9
    v_mfma_f32_16x16x32_bf16 v[36:39], a[92:95], a[52:55], v[36:39]
    s_add_u32 s91, s70, 0x20000
    ds_read_b64_tr_b16 a[80:81], v10
    v_mfma_f32_16x16x32_bf16 v[32:35], a[92:95], a[44:47], v[32:35]
    ds_read_b64_tr_b16 a[82:83], v10 offset:1024
    buffer_load_dwordx4 v2, s[8:11], s91 offen lds
    v_mfma_f32_16x16x32_bf16 v[32:35], a[88:91], a[40:43], v[32:35]
    s_waitcnt lgkmcnt(8)
    ds_read_b64_tr_b16 a[84:85], v10 offset:8192
    v_mfma_f32_16x16x32_bf16 v[48:51], a[96:99], a[40:43], v[48:51]
    s_waitcnt lgkmcnt(7)
    s_add_u32 m0, m0, 0x400
    ds_read_b64_tr_b16 a[86:87], v10 offset:9216
    v_mfma_f32_16x16x32_bf16 v[48:51], a[100:103], a[44:47], v[48:51]
    s_add_u32 s91, s70, 0x28000
    v_mfma_f32_16x16x32_bf16 v[52:55], a[100:103], a[52:55], v[52:55]
    ds_read_b64_tr_b16 a[88:89], v10 offset:8
    buffer_load_dwordx4 v2, s[8:11], s91 offen lds
    v_mfma_f32_16x16x32_bf16 v[52:55], a[96:99], a[48:51], v[52:55]
    ds_read_b64_tr_b16 a[90:91], v10 offset:1032
    v_mfma_f32_16x16x32_bf16 v[56:59], a[96:99], a[56:59], v[56:59]
    v_mfma_f32_16x16x32_bf16 v[56:59], a[100:103], a[60:63], v[56:59]
    s_add_u32 m0, m0, 0xc00
    ds_read_b64_tr_b16 a[92:93], v10 offset:8200
    v_mfma_f32_16x16x32_bf16 v[60:63], a[100:103], a[68:71], v[60:63]
    s_add_u32 s91, s70, 0x40000
    ds_read_b64_tr_b16 a[94:95], v10 offset:9224
    v_mfma_f32_16x16x32_bf16 v[60:63], a[96:99], a[64:67], v[60:63]
    s_waitcnt lgkmcnt(10)
    buffer_load_dwordx4 v2, s[8:11], s91 offen lds
    v_mfma_f32_16x16x32_bf16 v[76:79], a[104:107], a[64:67], v[76:79]
    s_waitcnt lgkmcnt(8)
    v_xor_b32 v11, 0xc0, v9
    v_mfma_f32_16x16x32_bf16 v[76:79], a[108:111], a[68:71], v[76:79]
    ds_read_b64_tr_b16 a[96:97], v11
    v_mfma_f32_16x16x32_bf16 v[72:75], a[108:111], a[60:63], v[72:75]
    s_add_u32 m0, m0, 0x400
    ds_read_b64_tr_b16 a[98:99], v11 offset:1024
    v_mfma_f32_16x16x32_bf16 v[72:75], a[104:107], a[56:59], v[72:75]
    s_add_u32 s91, s70, 0x48000
    ds_read_b64_tr_b16 a[100:101], v11 offset:8192
    v_mfma_f32_16x16x32_bf16 v[68:71], a[104:107], a[48:51], v[68:71]
    s_add_u32 s90, s77, 0
    ds_read_b64_tr_b16 a[102:103], v11 offset:9216
    buffer_load_dwordx4 v2, s[8:11], s91 offen lds
    v_mfma_f32_16x16x32_bf16 v[68:71], a[108:111], a[52:55], v[68:71]
    s_xor_b32 s90, s90, s47
    v_mfma_f32_16x16x32_bf16 v[64:67], a[108:111], a[44:47], v[64:67]
    s_add_u32 m0, m0, 0xc00
    buffer_load_dwordx4 a[160:163], v3, s[16:19], s90 offen offset:2048 nt
    v_mfma_f32_16x16x32_bf16 v[64:67], a[104:107], a[40:43], v[64:67]
    s_waitcnt lgkmcnt(10)
    s_add_u32 s91, s70, 0x60000
    ds_read_b64_tr_b16 a[104:105], v11 offset:8
    v_mfma_f32_16x16x32_bf16 v[80:83], a[80:83], a[40:43], v[80:83]
    s_waitcnt lgkmcnt(9)
    ds_read_b64_tr_b16 a[106:107], v11 offset:1032
    buffer_load_dwordx4 v2, s[8:11], s91 offen lds
    v_mfma_f32_16x16x32_bf16 v[80:83], a[84:87], a[44:47], v[80:83]
    v_mfma_f32_16x16x32_bf16 v[84:87], a[84:87], a[52:55], v[84:87]
    ds_read_b64_tr_b16 a[108:109], v11 offset:8200
    v_mfma_f32_16x16x32_bf16 v[84:87], a[80:83], a[48:51], v[84:87]
    s_add_u32 m0, m0, 0x400
    ds_read_b64_tr_b16 a[110:111], v11 offset:9224
    v_mfma_f32_16x16x32_bf16 v[88:91], a[80:83], a[56:59], v[88:91]
    s_add_u32 s91, s70, 0x68000
    v_mfma_f32_16x16x32_bf16 v[88:91], a[84:87], a[60:63], v[88:91]
    buffer_load_dwordx4 v2, s[8:11], s91 offen lds
    v_mfma_f32_16x16x32_bf16 v[92:95], a[84:87], a[68:71], v[92:95]
    v_mfma_f32_16x16x32_bf16 v[92:95], a[80:83], a[64:67], v[92:95]
    v_mfma_f32_16x16x32_bf16 v[152:155], a[80:83], a[72:75], v[152:155]
    v_mfma_f32_16x16x32_bf16 v[152:155], a[84:87], a[76:79], v[152:155]
    s_waitcnt lgkmcnt(8)
    v_mfma_f32_16x16x32_bf16 v[156:159], a[92:95], a[76:79], v[156:159]
    s_cmp_gt_u32 s79, 13
    s_cselect_b32 s83, 13, 14
    v_mfma_f32_16x16x32_bf16 v[156:159], a[88:91], a[72:75], v[156:159]
    s_lshl_b32 s84, s83, 7
    v_mfma_f32_16x16x32_bf16 v[108:111], a[88:91], a[64:67], v[108:111]
    s_add_u32 s68, s80, s84
    v_mfma_f32_16x16x32_bf16 v[108:111], a[92:95], a[68:71], v[108:111]
    s_add_u32 s69, s81, s84
    s_lshl_b32 s84, s83, 19
    s_add_u32 s70, s82, s84
    v_mfma_f32_16x16x32_bf16 v[104:107], a[92:95], a[60:63], v[104:107]
    s_mov_b32 s75, s74
    s_cmp_eq_u32 s74, 0x19000
    s_cselect_b32 s76, 0xfffe7000, s96
    v_mfma_f32_16x16x32_bf16 v[104:107], a[88:91], a[56:59], v[104:107]
    s_add_u32 s74, s74, s76
    s_add_u32 s90, s77, 0
    s_xor_b32 s90, s90, s47
    v_mfma_f32_16x16x32_bf16 v[100:103], a[88:91], a[48:51], v[100:103]
    buffer_load_dwordx4 a[164:167], v15, s[16:19], s90 offen offset:3072 nt
    v_add_u32 v9, s76, v9
    v_mfma_f32_16x16x32_bf16 v[100:103], a[92:95], a[52:55], v[100:103]
    s_waitcnt vmcnt(18) lgkmcnt(0)
    v_add_u32 v5, s76, v5
    v_add_u32 v6, s76, v6
    v_mfma_f32_16x16x32_bf16 v[96:99], a[92:95], a[44:47], v[96:99]
    s_barrier
    v_add_u32 v7, s76, v7
    v_add_u32 v8, s76, v8
    v_mfma_f32_16x16x32_bf16 v[96:99], a[88:91], a[40:43], v[96:99]
    v_mfma_f32_16x16x32_bf16 v[112:115], a[96:99], a[40:43], v[112:115]
    s_add_u32 m0, s75, s71
    ds_read_b128 a[0:3], v5
    ds_read_b64_tr_b16 a[80:81], v9
    v_mfma_f32_16x16x32_bf16 v[112:115], a[100:103], a[44:47], v[112:115]
    s_add_u32 s91, s68, 0
    ds_read_b64_tr_b16 a[82:83], v9 offset:1024
    v_mfma_f32_16x16x32_bf16 v[116:119], a[100:103], a[52:55], v[116:119]
    ds_read_b128 a[4:7], v6
    buffer_load_dwordx4 v1, s[4:7], s91 offen lds
    v_mfma_f32_16x16x32_bf16 v[116:119], a[96:99], a[48:51], v[116:119]
    ds_read_b64_tr_b16 a[84:85], v9 offset:8192
    v_mfma_f32_16x16x32_bf16 v[120:123], a[96:99], a[56:59], v[120:123]
    s_add_u32 m0, m0, 0x400
    ds_read_b64_tr_b16 a[86:87], v9 offset:9216
    v_mfma_f32_16x16x32_bf16 v[120:123], a[100:103], a[60:63], v[120:123]
    s_add_u32 s91, s68, 0x4000
    ds_read_b128 a[12:15], v6 offset:2048
    v_mfma_f32_16x16x32_bf16 v[124:127], a[100:103], a[68:71], v[124:127]
    buffer_load_dwordx4 v1, s[4:7], s91 offen lds
    v_mfma_f32_16x16x32_bf16 v[124:127], a[96:99], a[64:67], v[124:127]
    ds_read_b128 a[8:11], v5 offset:2048
    v_mfma_f32_16x16x32_bf16 v[140:143], a[104:107], a[64:67], v[140:143]
    ds_read_b128 a[16:19], v5 offset:4096
    v_mfma_f32_16x16x32_bf16 v[140:143], a[108:111], a[68:71], v[140:143]
    s_add_u32 m0, m0, 0x400
    ds_read_b128 a[20:23], v6 offset:4096
    v_mfma_f32_16x16x32_bf16 v[136:139], a[108:111], a[60:63], v[136:139]
    s_add_u32 s91, s68, 0x8000
    ds_read_b128 a[28:31], v6 offset:6144
    v_mfma_f32_16x16x32_bf16 v[136:139], a[104:107], a[56:59], v[136:139]
    ds_read_b128 a[24:27], v5 offset:6144
    buffer_load_dwordx4 v1, s[4:7], s91 offen lds
    v_mfma_f32_16x16x32_bf16 v[132:135], a[104:107], a[48:51], v[132:135]
    ds_read_b128 a[32:35], v7
    v_mfma_f32_16x16x32_bf16 v[132:135], a[108:111], a[52:55], v[132:135]
    s_add_u32 m0, m0, 0x400
    ds_read_b128 a[36:39], v8
    v_mfma_f32_16x16x32_bf16 v[128:131], a[108:111], a[44:47], v[128:131]
    s_add_u32 s91, s68, 0xc000
    v_mfma_f32_16x16x32_bf16 v[128:131], a[104:107], a[40:43], v[128:131]
    s_waitcnt lgkmcnt(11)
    ds_read_b64_tr_b16 a[88:89], v9 offset:8
    buffer_load_dwordx4 v1, s[4:7], s91 offen lds
    v_mfma_f32_16x16x32_bf16 v[16:19], a[80:83], a[0:3], v[16:19]
    s_waitcnt lgkmcnt(9)
    s_add_u32 s90, s54, 0x3000
    ds_read_b64_tr_b16 a[90:91], v9 offset:1032
    v_mfma_f32_16x16x32_bf16 v[16:19], a[84:87], a[4:7], v[16:19]
    s_waitcnt lgkmcnt(9)
    ds_read_b64_tr_b16 a[92:93], v9 offset:8200
    buffer_load_dwordx4 v[180:183], v4, s[24:27], s90 offen offset:1024
    v_mfma_f32_16x16x32_bf16 v[20:23], a[84:87], a[12:15], v[20:23]
    s_waitcnt lgkmcnt(9)
    ds_read_b64_tr_b16 a[94:95], v9 offset:9224
    v_mfma_f32_16x16x32_bf16 v[20:23], a[80:83], a[8:11], v[20:23]
    s_waitcnt lgkmcnt(9)
    s_add_u32 m0, s75, s72
    v_mfma_f32_16x16x32_bf16 v[24:27], a[80:83], a[16:19], v[24:27]
    s_waitcnt lgkmcnt(8)
    v_xor_b32 v11, 64, v9
    v_mfma_f32_16x16x32_bf16 v[24:27], a[84:87], a[20:23], v[24:27]
    s_waitcnt lgkmcnt(7)
    ds_read_b64_tr_b16 a[96:97], v11
    v_mfma_f32_16x16x32_bf16 v[28:31], a[84:87], a[28:31], v[28:31]
    s_waitcnt lgkmcnt(7)
    s_mov_b64 exec, s[66:67]
    buffer_load_dwordx4 v1, s[4:7], s69 offen lds
    s_mov_b64 exec, -1
    v_mfma_f32_16x16x32_bf16 v[28:31], a[80:83], a[24:27], v[28:31]
    s_waitcnt lgkmcnt(6)
    s_add_u32 m0, s75, s73
    ds_read_b64_tr_b16 a[98:99], v11 offset:1024
    ds_read_b64_tr_b16 a[100:101], v11 offset:8192
    v_mfma_f32_16x16x32_bf16 v[144:147], a[80:83], a[32:35], v[144:147]
    s_waitcnt lgkmcnt(7)
    s_add_u32 s91, s70, 0
    ds_read_b64_tr_b16 a[102:103], v11 offset:9216
    v_mfma_f32_16x16x32_bf16 v[144:147], a[84:87], a[36:39], v[144:147]
    s_waitcnt lgkmcnt(4)
    buffer_load_dwordx4 v2, s[8:11], s91 offen lds
    v_mfma_f32_16x16x32_bf16 v[148:151], a[92:95], a[36:39], v[148:151]
    ds_read_b64_tr_b16 a[104:105], v11 offset:8
    v_mfma_f32_16x16x32_bf16 v[148:151], a[88:91], a[32:35], v[148:151]
    s_add_u32 m0, m0, 0x400
    ds_read_b64_tr_b16 a[106:107], v11 offset:1032
    v_mfma_f32_16x16x32_bf16 v[44:47], a[88:91], a[24:27], v[44:47]
    s_add_u32 s91, s70, 0x8000
    v_mfma_f32_16x16x32_bf16 v[44:47], a[92:95], a[28:31], v[44:47]
    ds_read_b64_tr_b16 a[108:109], v11 offset:8200
    buffer_load_dwordx4 v2, s[8:11], s91 offen lds
    v_mfma_f32_16x16x32_bf16 v[40:43], a[92:95], a[20:23], v[40:43]
    ds_read_b64_tr_b16 a[110:111], v11 offset:9224
    v_mfma_f32_16x16x32_bf16 v[40:43], a[88:91], a[16:19], v[40:43]
    v_mfma_f32_16x16x32_bf16 v[36:39], a[88:91], a[8:11], v[36:39]
    s_add_u32 m0, m0, 0xc00
    v_xor_b32 v10, 0x80, v9
    v_mfma_f32_16x16x32_bf16 v[36:39], a[92:95], a[12:15], v[36:39]
    s_add_u32 s91, s70, 0x20000
    ds_read_b64_tr_b16 a[80:81], v10
    v_mfma_f32_16x16x32_bf16 v[32:35], a[92:95], a[4:7], v[32:35]
    s_add_u32 s90, s77, 0x1000
    ds_read_b64_tr_b16 a[82:83], v10 offset:1024
    buffer_load_dwordx4 v2, s[8:11], s91 offen lds
    v_mfma_f32_16x16x32_bf16 v[32:35], a[88:91], a[0:3], v[32:35]
    s_waitcnt lgkmcnt(8)
    s_xor_b32 s90, s90, s47
    ds_read_b64_tr_b16 a[84:85], v10 offset:8192
    v_mfma_f32_16x16x32_bf16 v[48:51], a[96:99], a[0:3], v[48:51]
    s_waitcnt lgkmcnt(7)
    s_add_u32 m0, m0, 0x400
    ds_read_b64_tr_b16 a[86:87], v10 offset:9216
    buffer_load_dwordx4 a[168:171], v3, s[16:19], s90 offen nt
    v_mfma_f32_16x16x32_bf16 v[48:51], a[100:103], a[4:7], v[48:51]
    s_add_u32 s91, s70, 0x28000
    v_mfma_f32_16x16x32_bf16 v[52:55], a[100:103], a[12:15], v[52:55]
    ds_read_b64_tr_b16 a[88:89], v10 offset:8
    buffer_load_dwordx4 v2, s[8:11], s91 offen lds
    v_mfma_f32_16x16x32_bf16 v[52:55], a[96:99], a[8:11], v[52:55]
    ds_read_b64_tr_b16 a[90:91], v10 offset:1032
    v_mfma_f32_16x16x32_bf16 v[56:59], a[96:99], a[16:19], v[56:59]
    v_mfma_f32_16x16x32_bf16 v[56:59], a[100:103], a[20:23], v[56:59]
    s_add_u32 m0, m0, 0xc00
    ds_read_b64_tr_b16 a[92:93], v10 offset:8200
    v_mfma_f32_16x16x32_bf16 v[60:63], a[100:103], a[28:31], v[60:63]
    s_add_u32 s91, s70, 0x40000
    ds_read_b64_tr_b16 a[94:95], v10 offset:9224
    v_mfma_f32_16x16x32_bf16 v[60:63], a[96:99], a[24:27], v[60:63]
    s_waitcnt lgkmcnt(10)
    buffer_load_dwordx4 v2, s[8:11], s91 offen lds
    v_mfma_f32_16x16x32_bf16 v[76:79], a[104:107], a[24:27], v[76:79]
    s_waitcnt lgkmcnt(8)
    v_xor_b32 v11, 0xc0, v9
    v_mfma_f32_16x16x32_bf16 v[76:79], a[108:111], a[28:31], v[76:79]
    ds_read_b64_tr_b16 a[96:97], v11
    v_mfma_f32_16x16x32_bf16 v[72:75], a[108:111], a[20:23], v[72:75]
    s_add_u32 m0, m0, 0x400
    ds_read_b64_tr_b16 a[98:99], v11 offset:1024
    v_mfma_f32_16x16x32_bf16 v[72:75], a[104:107], a[16:19], v[72:75]
    s_add_u32 s91, s70, 0x48000
    ds_read_b64_tr_b16 a[100:101], v11 offset:8192
    v_mfma_f32_16x16x32_bf16 v[68:71], a[104:107], a[8:11], v[68:71]
    ds_read_b64_tr_b16 a[102:103], v11 offset:9216
    buffer_load_dwordx4 v2, s[8:11], s91 offen lds
    v_mfma_f32_16x16x32_bf16 v[68:71], a[108:111], a[12:15], v[68:71]
    v_mfma_f32_16x16x32_bf16 v[64:67], a[108:111], a[4:7], v[64:67]
    s_add_u32 m0, m0, 0xc00
    v_mfma_f32_16x16x32_bf16 v[64:67], a[104:107], a[0:3], v[64:67]
    s_waitcnt lgkmcnt(10)
    s_add_u32 s91, s70, 0x60000
    ds_read_b64_tr_b16 a[104:105], v11 offset:8
    v_mfma_f32_16x16x32_bf16 v[80:83], a[80:83], a[0:3], v[80:83]
    s_waitcnt lgkmcnt(9)
    ds_read_b64_tr_b16 a[106:107], v11 offset:1032
    buffer_load_dwordx4 v2, s[8:11], s91 offen lds
    v_mfma_f32_16x16x32_bf16 v[80:83], a[84:87], a[4:7], v[80:83]
    v_mfma_f32_16x16x32_bf16 v[84:87], a[84:87], a[12:15], v[84:87]
    s_add_u32 s90, s77, 0x1000
    ds_read_b64_tr_b16 a[108:109], v11 offset:8200
    v_mfma_f32_16x16x32_bf16 v[84:87], a[80:83], a[8:11], v[84:87]
    s_xor_b32 s90, s90, s47
    ds_read_b64_tr_b16 a[110:111], v11 offset:9224
    v_mfma_f32_16x16x32_bf16 v[88:91], a[80:83], a[16:19], v[88:91]
    s_add_u32 m0, m0, 0x400
    buffer_load_dwordx4 a[172:175], v15, s[16:19], s90 offen offset:1024 nt
    v_mfma_f32_16x16x32_bf16 v[88:91], a[84:87], a[20:23], v[88:91]
    s_add_u32 s91, s70, 0x68000
    buffer_load_dwordx4 v2, s[8:11], s91 offen lds
    v_mfma_f32_16x16x32_bf16 v[92:95], a[84:87], a[28:31], v[92:95]
    v_mfma_f32_16x16x32_bf16 v[92:95], a[80:83], a[24:27], v[92:95]
    v_mfma_f32_16x16x32_bf16 v[152:155], a[80:83], a[32:35], v[152:155]
    v_mfma_f32_16x16x32_bf16 v[152:155], a[84:87], a[36:39], v[152:155]
    s_waitcnt lgkmcnt(8)
    v_mfma_f32_16x16x32_bf16 v[156:159], a[92:95], a[36:39], v[156:159]
    s_cmp_gt_u32 s79, 14
    s_cselect_b32 s83, 14, 15
    v_mfma_f32_16x16x32_bf16 v[156:159], a[88:91], a[32:35], v[156:159]
    s_lshl_b32 s84, s83, 7
    v_mfma_f32_16x16x32_bf16 v[108:111], a[88:91], a[24:27], v[108:111]
    s_add_u32 s68, s80, s84
    v_mfma_f32_16x16x32_bf16 v[108:111], a[92:95], a[28:31], v[108:111]
    s_add_u32 s69, s81, s84
    s_lshl_b32 s84, s83, 19
    s_add_u32 s70, s82, s84
    v_mfma_f32_16x16x32_bf16 v[104:107], a[92:95], a[20:23], v[104:107]
    s_mov_b32 s75, s74
    s_cmp_eq_u32 s74, 0x19000
    s_cselect_b32 s76, 0xfffe7000, s96
    v_mfma_f32_16x16x32_bf16 v[104:107], a[88:91], a[16:19], v[104:107]
    s_add_u32 s74, s74, s76
    v_add_u32 v9, s76, v9
    v_add_u32 v5, s76, v5
    v_mfma_f32_16x16x32_bf16 v[100:103], a[88:91], a[8:11], v[100:103]
    v_add_u32 v6, s76, v6
    v_add_u32 v7, s76, v7
    v_mfma_f32_16x16x32_bf16 v[100:103], a[92:95], a[12:15], v[100:103]
    s_waitcnt vmcnt(17) lgkmcnt(0)
    v_add_u32 v8, s76, v8
    v_mfma_f32_16x16x32_bf16 v[96:99], a[92:95], a[4:7], v[96:99]
    s_barrier
    v_mfma_f32_16x16x32_bf16 v[96:99], a[88:91], a[0:3], v[96:99]
    v_mfma_f32_16x16x32_bf16 v[112:115], a[96:99], a[0:3], v[112:115]
    s_add_u32 m0, s75, s71
    ds_read_b128 a[40:43], v5
    ds_read_b64_tr_b16 a[80:81], v9
    v_mfma_f32_16x16x32_bf16 v[112:115], a[100:103], a[4:7], v[112:115]
    s_add_u32 s91, s68, 0
    ds_read_b64_tr_b16 a[82:83], v9 offset:1024
    v_mfma_f32_16x16x32_bf16 v[116:119], a[100:103], a[12:15], v[116:119]
    s_add_u32 s90, s54, 0x3000
    ds_read_b128 a[44:47], v6
    buffer_load_dwordx4 v1, s[4:7], s91 offen lds
    v_mfma_f32_16x16x32_bf16 v[116:119], a[96:99], a[8:11], v[116:119]
    ds_read_b64_tr_b16 a[84:85], v9 offset:8192
    buffer_load_dwordx4 v[184:187], v4, s[24:27], s90 offen offset:2048
    v_mfma_f32_16x16x32_bf16 v[120:123], a[96:99], a[16:19], v[120:123]
    s_add_u32 m0, m0, 0x400
    ds_read_b64_tr_b16 a[86:87], v9 offset:9216
    v_mfma_f32_16x16x32_bf16 v[120:123], a[100:103], a[20:23], v[120:123]
    s_add_u32 s91, s68, 0x4000
    ds_read_b128 a[52:55], v6 offset:2048
    v_mfma_f32_16x16x32_bf16 v[124:127], a[100:103], a[28:31], v[124:127]
    buffer_load_dwordx4 v1, s[4:7], s91 offen lds
    v_mfma_f32_16x16x32_bf16 v[124:127], a[96:99], a[24:27], v[124:127]
    ds_read_b128 a[48:51], v5 offset:2048
    v_mfma_f32_16x16x32_bf16 v[140:143], a[104:107], a[24:27], v[140:143]
    ds_read_b128 a[56:59], v5 offset:4096
    v_mfma_f32_16x16x32_bf16 v[140:143], a[108:111], a[28:31], v[140:143]
    s_add_u32 m0, m0, 0x400
    ds_read_b128 a[60:63], v6 offset:4096
    v_mfma_f32_16x16x32_bf16 v[136:139], a[108:111], a[20:23], v[136:139]
    s_add_u32 s91, s68, 0x8000
    ds_read_b128 a[68:71], v6 offset:6144
    v_mfma_f32_16x16x32_bf16 v[136:139], a[104:107], a[16:19], v[136:139]
    ds_read_b128 a[64:67], v5 offset:6144
    buffer_load_dwordx4 v1, s[4:7], s91 offen lds
    v_mfma_f32_16x16x32_bf16 v[132:135], a[104:107], a[8:11], v[132:135]
    ds_read_b128 a[72:75], v7
    v_mfma_f32_16x16x32_bf16 v[132:135], a[108:111], a[12:15], v[132:135]
    s_add_u32 m0, m0, 0x400
    ds_read_b128 a[76:79], v8
    v_mfma_f32_16x16x32_bf16 v[128:131], a[108:111], a[4:7], v[128:131]
    s_add_u32 s91, s68, 0xc000
    v_mfma_f32_16x16x32_bf16 v[128:131], a[104:107], a[0:3], v[128:131]
    s_waitcnt lgkmcnt(11)
    ds_read_b64_tr_b16 a[88:89], v9 offset:8
    buffer_load_dwordx4 v1, s[4:7], s91 offen lds
    v_mfma_f32_16x16x32_bf16 v[16:19], a[80:83], a[40:43], v[16:19]
    s_waitcnt lgkmcnt(9)
    ds_read_b64_tr_b16 a[90:91], v9 offset:1032
    v_mfma_f32_16x16x32_bf16 v[16:19], a[84:87], a[44:47], v[16:19]
    s_waitcnt lgkmcnt(9)
    ds_read_b64_tr_b16 a[92:93], v9 offset:8200
    v_mfma_f32_16x16x32_bf16 v[20:23], a[84:87], a[52:55], v[20:23]
    s_waitcnt lgkmcnt(9)
    ds_read_b64_tr_b16 a[94:95], v9 offset:9224
    v_mfma_f32_16x16x32_bf16 v[20:23], a[80:83], a[48:51], v[20:23]
    s_waitcnt lgkmcnt(9)
    s_add_u32 m0, s75, s72
    v_mfma_f32_16x16x32_bf16 v[24:27], a[80:83], a[56:59], v[24:27]
    s_waitcnt lgkmcnt(8)
    v_xor_b32 v11, 64, v9
    v_mfma_f32_16x16x32_bf16 v[24:27], a[84:87], a[60:63], v[24:27]
    s_waitcnt lgkmcnt(7)
    s_add_u32 s90, s77, 0x1000
    ds_read_b64_tr_b16 a[96:97], v11
    v_mfma_f32_16x16x32_bf16 v[28:31], a[84:87], a[68:71], v[28:31]
    s_waitcnt lgkmcnt(7)
    s_xor_b32 s90, s90, s47
    s_mov_b64 exec, s[66:67]
    buffer_load_dwordx4 v1, s[4:7], s69 offen lds
    s_mov_b64 exec, -1
    v_mfma_f32_16x16x32_bf16 v[28:31], a[80:83], a[64:67], v[28:31]
    s_waitcnt lgkmcnt(6)
    s_add_u32 m0, s75, s73
    ds_read_b64_tr_b16 a[98:99], v11 offset:1024
    ds_read_b64_tr_b16 a[100:101], v11 offset:8192
    v_mfma_f32_16x16x32_bf16 v[144:147], a[80:83], a[72:75], v[144:147]
    s_waitcnt lgkmcnt(7)
    s_add_u32 s91, s70, 0
    ds_read_b64_tr_b16 a[102:103], v11 offset:9216
    buffer_load_dwordx4 a[176:179], v3, s[16:19], s90 offen offset:2048 nt
    v_mfma_f32_16x16x32_bf16 v[144:147], a[84:87], a[76:79], v[144:147]
    s_waitcnt lgkmcnt(4)
    buffer_load_dwordx4 v2, s[8:11], s91 offen lds
    v_mfma_f32_16x16x32_bf16 v[148:151], a[92:95], a[76:79], v[148:151]
    ds_read_b64_tr_b16 a[104:105], v11 offset:8
    v_mfma_f32_16x16x32_bf16 v[148:151], a[88:91], a[72:75], v[148:151]
    s_add_u32 m0, m0, 0x400
    ds_read_b64_tr_b16 a[106:107], v11 offset:1032
    v_mfma_f32_16x16x32_bf16 v[44:47], a[88:91], a[64:67], v[44:47]
    s_add_u32 s91, s70, 0x8000
    v_mfma_f32_16x16x32_bf16 v[44:47], a[92:95], a[68:71], v[44:47]
    ds_read_b64_tr_b16 a[108:109], v11 offset:8200
    buffer_load_dwordx4 v2, s[8:11], s91 offen lds
    v_mfma_f32_16x16x32_bf16 v[40:43], a[92:95], a[60:63], v[40:43]
    ds_read_b64_tr_b16 a[110:111], v11 offset:9224
    v_mfma_f32_16x16x32_bf16 v[40:43], a[88:91], a[56:59], v[40:43]
    v_mfma_f32_16x16x32_bf16 v[36:39], a[88:91], a[48:51], v[36:39]
    s_add_u32 m0, m0, 0xc00
    v_xor_b32 v10, 0x80, v9
    v_mfma_f32_16x16x32_bf16 v[36:39], a[92:95], a[52:55], v[36:39]
    s_add_u32 s91, s70, 0x20000
    ds_read_b64_tr_b16 a[80:81], v10
    v_mfma_f32_16x16x32_bf16 v[32:35], a[92:95], a[44:47], v[32:35]
    ds_read_b64_tr_b16 a[82:83], v10 offset:1024
    buffer_load_dwordx4 v2, s[8:11], s91 offen lds
    v_mfma_f32_16x16x32_bf16 v[32:35], a[88:91], a[40:43], v[32:35]
    s_waitcnt lgkmcnt(8)
    ds_read_b64_tr_b16 a[84:85], v10 offset:8192
    v_mfma_f32_16x16x32_bf16 v[48:51], a[96:99], a[40:43], v[48:51]
    s_waitcnt lgkmcnt(7)
    s_add_u32 m0, m0, 0x400
    ds_read_b64_tr_b16 a[86:87], v10 offset:9216
    v_mfma_f32_16x16x32_bf16 v[48:51], a[100:103], a[44:47], v[48:51]
    s_add_u32 s91, s70, 0x28000
    v_mfma_f32_16x16x32_bf16 v[52:55], a[100:103], a[52:55], v[52:55]
    ds_read_b64_tr_b16 a[88:89], v10 offset:8
    buffer_load_dwordx4 v2, s[8:11], s91 offen lds
    v_mfma_f32_16x16x32_bf16 v[52:55], a[96:99], a[48:51], v[52:55]
    ds_read_b64_tr_b16 a[90:91], v10 offset:1032
    v_mfma_f32_16x16x32_bf16 v[56:59], a[96:99], a[56:59], v[56:59]
    s_add_u32 s90, s77, 0x1000
    v_mfma_f32_16x16x32_bf16 v[56:59], a[100:103], a[60:63], v[56:59]
    s_xor_b32 s90, s90, s47
    ds_read_b64_tr_b16 a[92:93], v10 offset:8200
    v_mfma_f32_16x16x32_bf16 v[60:63], a[100:103], a[68:71], v[60:63]
    s_add_u32 m0, m0, 0xc00
    ds_read_b64_tr_b16 a[94:95], v10 offset:9224
    buffer_load_dwordx4 a[180:183], v15, s[16:19], s90 offen offset:3072 nt
    v_mfma_f32_16x16x32_bf16 v[60:63], a[96:99], a[64:67], v[60:63]
    s_waitcnt lgkmcnt(10)
    s_add_u32 s91, s70, 0x40000
    buffer_load_dwordx4 v2, s[8:11], s91 offen lds
    v_mfma_f32_16x16x32_bf16 v[76:79], a[104:107], a[64:67], v[76:79]
    s_waitcnt lgkmcnt(8)
    v_xor_b32 v11, 0xc0, v9
    v_mfma_f32_16x16x32_bf16 v[76:79], a[108:111], a[68:71], v[76:79]
    ds_read_b64_tr_b16 a[96:97], v11
    v_mfma_f32_16x16x32_bf16 v[72:75], a[108:111], a[60:63], v[72:75]
    s_add_u32 m0, m0, 0x400
    ds_read_b64_tr_b16 a[98:99], v11 offset:1024
    v_mfma_f32_16x16x32_bf16 v[72:75], a[104:107], a[56:59], v[72:75]
    s_add_u32 s91, s70, 0x48000
    ds_read_b64_tr_b16 a[100:101], v11 offset:8192
    v_mfma_f32_16x16x32_bf16 v[68:71], a[104:107], a[48:51], v[68:71]
    ds_read_b64_tr_b16 a[102:103], v11 offset:9216
    buffer_load_dwordx4 v2, s[8:11], s91 offen lds
    v_mfma_f32_16x16x32_bf16 v[68:71], a[108:111], a[52:55], v[68:71]
    v_mfma_f32_16x16x32_bf16 v[64:67], a[108:111], a[44:47], v[64:67]
    s_add_u32 m0, m0, 0xc00
    v_mfma_f32_16x16x32_bf16 v[64:67], a[104:107], a[40:43], v[64:67]
    s_waitcnt lgkmcnt(10)
    s_add_u32 s91, s70, 0x60000
    ds_read_b64_tr_b16 a[104:105], v11 offset:8
    v_mfma_f32_16x16x32_bf16 v[80:83], a[80:83], a[40:43], v[80:83]
    s_waitcnt lgkmcnt(9)
    ds_read_b64_tr_b16 a[106:107], v11 offset:1032
    buffer_load_dwordx4 v2, s[8:11], s91 offen lds
    v_mfma_f32_16x16x32_bf16 v[80:83], a[84:87], a[44:47], v[80:83]
    v_mfma_f32_16x16x32_bf16 v[84:87], a[84:87], a[52:55], v[84:87]
    ds_read_b64_tr_b16 a[108:109], v11 offset:8200
    v_mfma_f32_16x16x32_bf16 v[84:87], a[80:83], a[48:51], v[84:87]
    s_add_u32 m0, m0, 0x400
    ds_read_b64_tr_b16 a[110:111], v11 offset:9224
    v_mfma_f32_16x16x32_bf16 v[88:91], a[80:83], a[56:59], v[88:91]
    s_add_u32 s91, s70, 0x68000
    v_mfma_f32_16x16x32_bf16 v[88:91], a[84:87], a[60:63], v[88:91]
    buffer_load_dwordx4 v2, s[8:11], s91 offen lds
    v_mfma_f32_16x16x32_bf16 v[92:95], a[84:87], a[68:71], v[92:95]
    v_mfma_f32_16x16x32_bf16 v[92:95], a[80:83], a[64:67], v[92:95]
    v_mfma_f32_16x16x32_bf16 v[152:155], a[80:83], a[72:75], v[152:155]
    v_mfma_f32_16x16x32_bf16 v[152:155], a[84:87], a[76:79], v[152:155]
    s_waitcnt lgkmcnt(8)
    s_add_u32 s90, s54, 0x3000
    v_mfma_f32_16x16x32_bf16 v[156:159], a[92:95], a[76:79], v[156:159]
    buffer_load_dwordx4 v[188:191], v4, s[24:27], s90 offen offset:3072
    v_mfma_f32_16x16x32_bf16 v[156:159], a[88:91], a[72:75], v[156:159]
    s_cmp_gt_u32 s79, 15
    s_cselect_b32 s83, 15, 16
    v_mfma_f32_16x16x32_bf16 v[108:111], a[88:91], a[64:67], v[108:111]
    s_lshl_b32 s84, s83, 7
    v_mfma_f32_16x16x32_bf16 v[108:111], a[92:95], a[68:71], v[108:111]
    s_add_u32 s68, s80, s84
    s_add_u32 s69, s81, s84
    s_lshl_b32 s84, s83, 19
    v_mfma_f32_16x16x32_bf16 v[104:107], a[92:95], a[60:63], v[104:107]
    s_add_u32 s70, s82, s84
    s_mov_b32 s75, s74
    s_cmp_eq_u32 s74, 0x19000
    s_cselect_b32 s76, 0xfffe7000, s96
    v_mfma_f32_16x16x32_bf16 v[104:107], a[88:91], a[56:59], v[104:107]
    s_add_u32 s74, s74, s76
    v_add_u32 v9, s76, v9
    v_add_u32 v5, s76, v5
    v_mfma_f32_16x16x32_bf16 v[100:103], a[88:91], a[48:51], v[100:103]
    v_add_u32 v6, s76, v6
    v_add_u32 v7, s76, v7
    v_mfma_f32_16x16x32_bf16 v[100:103], a[92:95], a[52:55], v[100:103]
    s_waitcnt vmcnt(17) lgkmcnt(0)
    v_add_u32 v8, s76, v8
    v_mfma_f32_16x16x32_bf16 v[96:99], a[92:95], a[44:47], v[96:99]
    s_barrier
    v_mfma_f32_16x16x32_bf16 v[96:99], a[88:91], a[40:43], v[96:99]
    v_mfma_f32_16x16x32_bf16 v[112:115], a[96:99], a[40:43], v[112:115]
    ds_read_b128 a[0:3], v5
    ds_read_b64_tr_b16 a[80:81], v9
    v_mfma_f32_16x16x32_bf16 v[112:115], a[100:103], a[44:47], v[112:115]
    s_add_u32 m0, s78, 0x10000
    ds_read_b64_tr_b16 a[82:83], v9 offset:1024
    v_mfma_f32_16x16x32_bf16 v[116:119], a[100:103], a[52:55], v[116:119]
    s_add_u32 s91, s77, 0
    ds_read_b128 a[4:7], v6
    v_mfma_f32_16x16x32_bf16 v[116:119], a[96:99], a[48:51], v[116:119]
    s_xor_b32 s91, s91, s47
    ds_read_b64_tr_b16 a[84:85], v9 offset:8192
    v_mfma_f32_16x16x32_bf16 v[120:123], a[96:99], a[56:59], v[120:123]
    ds_read_b64_tr_b16 a[86:87], v9 offset:9216
    buffer_load_dwordx4 v3, s[12:15], s91 offen nt lds
    v_mfma_f32_16x16x32_bf16 v[120:123], a[100:103], a[60:63], v[120:123]
    ds_read_b128 a[12:15], v6 offset:2048
    v_mfma_f32_16x16x32_bf16 v[124:127], a[100:103], a[68:71], v[124:127]
    v_mfma_f32_16x16x32_bf16 v[124:127], a[96:99], a[64:67], v[124:127]
    ds_read_b128 a[8:11], v5 offset:2048
    v_mfma_f32_16x16x32_bf16 v[140:143], a[104:107], a[64:67], v[140:143]
    ds_read_b128 a[16:19], v5 offset:4096
    v_mfma_f32_16x16x32_bf16 v[140:143], a[108:111], a[68:71], v[140:143]
    ds_read_b128 a[20:23], v6 offset:4096
    v_mfma_f32_16x16x32_bf16 v[136:139], a[108:111], a[60:63], v[136:139]
    ds_read_b128 a[28:31], v6 offset:6144
    v_mfma_f32_16x16x32_bf16 v[136:139], a[104:107], a[56:59], v[136:139]
    ds_read_b128 a[24:27], v5 offset:6144
    buffer_load_dwordx4 v15, s[12:15], s91 offen offset:1024 nt lds
    v_mfma_f32_16x16x32_bf16 v[132:135], a[104:107], a[48:51], v[132:135]
    ds_read_b128 a[32:35], v7
    v_mfma_f32_16x16x32_bf16 v[132:135], a[108:111], a[52:55], v[132:135]
    ds_read_b128 a[36:39], v8
    v_mfma_f32_16x16x32_bf16 v[128:131], a[108:111], a[44:47], v[128:131]
    v_mfma_f32_16x16x32_bf16 v[128:131], a[104:107], a[40:43], v[128:131]
    s_waitcnt lgkmcnt(11)
    ds_read_b64_tr_b16 a[88:89], v9 offset:8
    v_mfma_f32_16x16x32_bf16 v[16:19], a[80:83], a[0:3], v[16:19]
    s_waitcnt lgkmcnt(9)
    ds_read_b64_tr_b16 a[90:91], v9 offset:1032
    v_mfma_f32_16x16x32_bf16 v[16:19], a[84:87], a[4:7], v[16:19]
    s_waitcnt lgkmcnt(9)
    ds_read_b64_tr_b16 a[92:93], v9 offset:8200
    v_mfma_f32_16x16x32_bf16 v[20:23], a[84:87], a[12:15], v[20:23]
    s_waitcnt lgkmcnt(9)
    ds_read_b64_tr_b16 a[94:95], v9 offset:9224
    buffer_load_dwordx4 v3, s[12:15], s91 offen offset:2048 nt lds
    v_mfma_f32_16x16x32_bf16 v[20:23], a[80:83], a[8:11], v[20:23]
    s_waitcnt lgkmcnt(9)
    v_mfma_f32_16x16x32_bf16 v[24:27], a[80:83], a[16:19], v[24:27]
    s_waitcnt lgkmcnt(8)
    v_xor_b32 v11, 64, v9
    v_mfma_f32_16x16x32_bf16 v[24:27], a[84:87], a[20:23], v[24:27]
    s_waitcnt lgkmcnt(7)
    ds_read_b64_tr_b16 a[96:97], v11
    v_mfma_f32_16x16x32_bf16 v[28:31], a[84:87], a[28:31], v[28:31]
    s_waitcnt lgkmcnt(7)
    ds_read_b64_tr_b16 a[98:99], v11 offset:1024
    v_mfma_f32_16x16x32_bf16 v[28:31], a[80:83], a[24:27], v[28:31]
    s_waitcnt lgkmcnt(7)
    ds_read_b64_tr_b16 a[100:101], v11 offset:8192
    v_mfma_f32_16x16x32_bf16 v[144:147], a[80:83], a[32:35], v[144:147]
    s_waitcnt lgkmcnt(7)
    ds_read_b64_tr_b16 a[102:103], v11 offset:9216
    v_mfma_f32_16x16x32_bf16 v[144:147], a[84:87], a[36:39], v[144:147]
    s_waitcnt lgkmcnt(4)
    buffer_load_dwordx4 v15, s[12:15], s91 offen offset:3072 nt lds
    v_mfma_f32_16x16x32_bf16 v[148:151], a[92:95], a[36:39], v[148:151]
    ds_read_b64_tr_b16 a[104:105], v11 offset:8
    v_mfma_f32_16x16x32_bf16 v[148:151], a[88:91], a[32:35], v[148:151]
    ds_read_b64_tr_b16 a[106:107], v11 offset:1032
    v_mfma_f32_16x16x32_bf16 v[44:47], a[88:91], a[24:27], v[44:47]
    v_mfma_f32_16x16x32_bf16 v[44:47], a[92:95], a[28:31], v[44:47]
    s_add_u32 m0, m0, 0x1000
    ds_read_b64_tr_b16 a[108:109], v11 offset:8200
    v_mfma_f32_16x16x32_bf16 v[40:43], a[92:95], a[20:23], v[40:43]
    s_add_u32 s91, s77, 0x1000
    ds_read_b64_tr_b16 a[110:111], v11 offset:9224
    v_mfma_f32_16x16x32_bf16 v[40:43], a[88:91], a[16:19], v[40:43]
    s_xor_b32 s91, s91, s47
    v_mfma_f32_16x16x32_bf16 v[36:39], a[88:91], a[8:11], v[36:39]
    v_xor_b32 v10, 0x80, v9
    buffer_load_dwordx4 v3, s[12:15], s91 offen nt lds
    v_mfma_f32_16x16x32_bf16 v[36:39], a[92:95], a[12:15], v[36:39]
    ds_read_b64_tr_b16 a[80:81], v10
    v_mfma_f32_16x16x32_bf16 v[32:35], a[92:95], a[4:7], v[32:35]
    ds_read_b64_tr_b16 a[82:83], v10 offset:1024
    v_mfma_f32_16x16x32_bf16 v[32:35], a[88:91], a[0:3], v[32:35]
    s_waitcnt lgkmcnt(8)
    ds_read_b64_tr_b16 a[84:85], v10 offset:8192
    v_mfma_f32_16x16x32_bf16 v[48:51], a[96:99], a[0:3], v[48:51]
    s_waitcnt lgkmcnt(7)
    ds_read_b64_tr_b16 a[86:87], v10 offset:9216
    v_mfma_f32_16x16x32_bf16 v[48:51], a[100:103], a[4:7], v[48:51]
    v_mfma_f32_16x16x32_bf16 v[52:55], a[100:103], a[12:15], v[52:55]
    ds_read_b64_tr_b16 a[88:89], v10 offset:8
    v_mfma_f32_16x16x32_bf16 v[52:55], a[96:99], a[8:11], v[52:55]
    ds_read_b64_tr_b16 a[90:91], v10 offset:1032
    buffer_load_dwordx4 v15, s[12:15], s91 offen offset:1024 nt lds
    v_mfma_f32_16x16x32_bf16 v[56:59], a[96:99], a[16:19], v[56:59]
    v_mfma_f32_16x16x32_bf16 v[56:59], a[100:103], a[20:23], v[56:59]
    ds_read_b64_tr_b16 a[92:93], v10 offset:8200
    v_mfma_f32_16x16x32_bf16 v[60:63], a[100:103], a[28:31], v[60:63]
    ds_read_b64_tr_b16 a[94:95], v10 offset:9224
    v_mfma_f32_16x16x32_bf16 v[60:63], a[96:99], a[24:27], v[60:63]
    s_waitcnt lgkmcnt(10)
    v_mfma_f32_16x16x32_bf16 v[76:79], a[104:107], a[24:27], v[76:79]
    s_waitcnt lgkmcnt(8)
    v_xor_b32 v11, 0xc0, v9
    v_mfma_f32_16x16x32_bf16 v[76:79], a[108:111], a[28:31], v[76:79]
    ds_read_b64_tr_b16 a[96:97], v11
    v_mfma_f32_16x16x32_bf16 v[72:75], a[108:111], a[20:23], v[72:75]
    ds_read_b64_tr_b16 a[98:99], v11 offset:1024
    buffer_load_dwordx4 v3, s[12:15], s91 offen offset:2048 nt lds
    v_mfma_f32_16x16x32_bf16 v[72:75], a[104:107], a[16:19], v[72:75]
    ds_read_b64_tr_b16 a[100:101], v11 offset:8192
    v_mfma_f32_16x16x32_bf16 v[68:71], a[104:107], a[8:11], v[68:71]
    ds_read_b64_tr_b16 a[102:103], v11 offset:9216
    v_mfma_f32_16x16x32_bf16 v[68:71], a[108:111], a[12:15], v[68:71]
    v_mfma_f32_16x16x32_bf16 v[64:67], a[108:111], a[4:7], v[64:67]
    v_mfma_f32_16x16x32_bf16 v[64:67], a[104:107], a[0:3], v[64:67]
    s_waitcnt lgkmcnt(10)
    ds_read_b64_tr_b16 a[104:105], v11 offset:8
    v_mfma_f32_16x16x32_bf16 v[80:83], a[80:83], a[0:3], v[80:83]
    s_waitcnt lgkmcnt(9)
    ds_read_b64_tr_b16 a[106:107], v11 offset:1032
    v_mfma_f32_16x16x32_bf16 v[80:83], a[84:87], a[4:7], v[80:83]
    buffer_load_dwordx4 v15, s[12:15], s91 offen offset:3072 nt lds
    v_mfma_f32_16x16x32_bf16 v[84:87], a[84:87], a[12:15], v[84:87]
    ds_read_b64_tr_b16 a[108:109], v11 offset:8200
    v_mfma_f32_16x16x32_bf16 v[84:87], a[80:83], a[8:11], v[84:87]
    ds_read_b64_tr_b16 a[110:111], v11 offset:9224
    v_mfma_f32_16x16x32_bf16 v[88:91], a[80:83], a[16:19], v[88:91]
    v_mfma_f32_16x16x32_bf16 v[88:91], a[84:87], a[20:23], v[88:91]
    v_mfma_f32_16x16x32_bf16 v[92:95], a[84:87], a[28:31], v[92:95]
    v_mfma_f32_16x16x32_bf16 v[92:95], a[80:83], a[24:27], v[92:95]
    v_mfma_f32_16x16x32_bf16 v[152:155], a[80:83], a[32:35], v[152:155]
    s_mov_b32 s75, s74
    s_cmp_eq_u32 s74, 0x19000
    s_cselect_b32 s76, 0xfffe7000, s96
    v_mfma_f32_16x16x32_bf16 v[152:155], a[84:87], a[36:39], v[152:155]
    s_waitcnt lgkmcnt(8)
    s_add_u32 s74, s74, s76
    v_add_u32 v9, s76, v9
    v_add_u32 v5, s76, v5
    v_mfma_f32_16x16x32_bf16 v[156:159], a[92:95], a[36:39], v[156:159]
    v_add_u32 v6, s76, v6
    v_add_u32 v7, s76, v7
    v_mfma_f32_16x16x32_bf16 v[156:159], a[88:91], a[32:35], v[156:159]
    v_add_u32 v8, s76, v8
    v_mfma_f32_16x16x32_bf16 v[108:111], a[88:91], a[24:27], v[108:111]
    v_mfma_f32_16x16x32_bf16 v[108:111], a[92:95], a[28:31], v[108:111]
    v_mfma_f32_16x16x32_bf16 v[104:107], a[92:95], a[20:23], v[104:107]
    v_mfma_f32_16x16x32_bf16 v[104:107], a[88:91], a[16:19], v[104:107]
    v_mfma_f32_16x16x32_bf16 v[100:103], a[88:91], a[8:11], v[100:103]
    v_mfma_f32_16x16x32_bf16 v[100:103], a[92:95], a[12:15], v[100:103]
    s_waitcnt vmcnt(9) lgkmcnt(0)
    v_mfma_f32_16x16x32_bf16 v[96:99], a[92:95], a[4:7], v[96:99]
    s_barrier
    v_mfma_f32_16x16x32_bf16 v[96:99], a[88:91], a[0:3], v[96:99]
    v_mfma_f32_16x16x32_bf16 v[112:115], a[96:99], a[0:3], v[112:115]
    ds_read_b128 a[40:43], v5
    ds_read_b64_tr_b16 a[80:81], v9
    v_mfma_f32_16x16x32_bf16 v[112:115], a[100:103], a[4:7], v[112:115]
    ds_read_b64_tr_b16 a[82:83], v9 offset:1024
    v_mfma_f32_16x16x32_bf16 v[116:119], a[100:103], a[12:15], v[116:119]
    ds_read_b128 a[44:47], v6
    v_add_u32 v13, 0x18000, v254
    v_mfma_f32_16x16x32_bf16 v[116:119], a[96:99], a[8:11], v[116:119]
    ds_read_b64_tr_b16 a[84:85], v9 offset:8192
    v_mfma_f32_16x16x32_bf16 v[120:123], a[96:99], a[16:19], v[120:123]
    ds_read_b64_tr_b16 a[86:87], v9 offset:9216
    v_mfma_f32_16x16x32_bf16 v[120:123], a[100:103], a[20:23], v[120:123]
    ds_read_b128 a[52:55], v6 offset:2048
    ds_write_b128 v13, a[120:123]
    v_mfma_f32_16x16x32_bf16 v[124:127], a[100:103], a[28:31], v[124:127]
    v_mfma_f32_16x16x32_bf16 v[124:127], a[96:99], a[24:27], v[124:127]
    ds_read_b128 a[48:51], v5 offset:2048
    v_mfma_f32_16x16x32_bf16 v[140:143], a[104:107], a[24:27], v[140:143]
    ds_read_b128 a[56:59], v5 offset:4096
    v_mfma_f32_16x16x32_bf16 v[140:143], a[108:111], a[28:31], v[140:143]
    ds_read_b128 a[60:63], v6 offset:4096
    v_mfma_f32_16x16x32_bf16 v[136:139], a[108:111], a[20:23], v[136:139]
    ds_read_b128 a[68:71], v6 offset:6144
    ds_write_b128 v13, a[124:127] offset:1024
    v_mfma_f32_16x16x32_bf16 v[136:139], a[104:107], a[16:19], v[136:139]
    ds_read_b128 a[64:67], v5 offset:6144
    v_mfma_f32_16x16x32_bf16 v[132:135], a[104:107], a[8:11], v[132:135]
    ds_read_b128 a[72:75], v7
    v_mfma_f32_16x16x32_bf16 v[132:135], a[108:111], a[12:15], v[132:135]
    ds_read_b128 a[76:79], v8
    ds_write_b128 v13, a[128:131] offset:2048
    v_mfma_f32_16x16x32_bf16 v[128:131], a[108:111], a[4:7], v[128:131]
    v_mfma_f32_16x16x32_bf16 v[128:131], a[104:107], a[0:3], v[128:131]
    s_waitcnt lgkmcnt(14)
    ds_read_b64_tr_b16 a[88:89], v9 offset:8
    v_mfma_f32_16x16x32_bf16 v[16:19], a[80:83], a[40:43], v[16:19]
    s_waitcnt lgkmcnt(12)
    ds_read_b64_tr_b16 a[90:91], v9 offset:1032
    ds_write_b128 v13, a[132:135] offset:3072
    v_mfma_f32_16x16x32_bf16 v[16:19], a[84:87], a[44:47], v[16:19]
    s_waitcnt lgkmcnt(13)
    ds_read_b64_tr_b16 a[92:93], v9 offset:8200
    v_mfma_f32_16x16x32_bf16 v[20:23], a[84:87], a[52:55], v[20:23]
    s_waitcnt lgkmcnt(12)
    ds_read_b64_tr_b16 a[94:95], v9 offset:9224
    v_mfma_f32_16x16x32_bf16 v[20:23], a[80:83], a[48:51], v[20:23]
    s_waitcnt lgkmcnt(12)
    ds_write_b128 v13, a[136:139] offset:4096
    v_mfma_f32_16x16x32_bf16 v[24:27], a[80:83], a[56:59], v[24:27]
    s_waitcnt lgkmcnt(12)
    v_xor_b32 v11, 64, v9
    v_mfma_f32_16x16x32_bf16 v[24:27], a[84:87], a[60:63], v[24:27]
    s_waitcnt lgkmcnt(11)
    ds_read_b64_tr_b16 a[96:97], v11
    v_mfma_f32_16x16x32_bf16 v[28:31], a[84:87], a[68:71], v[28:31]
    s_waitcnt lgkmcnt(10)
    ds_read_b64_tr_b16 a[98:99], v11 offset:1024
    v_mfma_f32_16x16x32_bf16 v[28:31], a[80:83], a[64:67], v[28:31]
    s_waitcnt lgkmcnt(10)
    ds_read_b64_tr_b16 a[100:101], v11 offset:8192
    ds_write_b128 v13, a[140:143] offset:5120
    v_mfma_f32_16x16x32_bf16 v[144:147], a[80:83], a[72:75], v[144:147]
    s_waitcnt lgkmcnt(11)
    ds_read_b64_tr_b16 a[102:103], v11 offset:9216
    v_mfma_f32_16x16x32_bf16 v[144:147], a[84:87], a[76:79], v[144:147]
    s_waitcnt lgkmcnt(6)
    v_mfma_f32_16x16x32_bf16 v[148:151], a[92:95], a[76:79], v[148:151]
    ds_read_b64_tr_b16 a[104:105], v11 offset:8
    ds_write_b128 v13, a[144:147] offset:6144
    v_mfma_f32_16x16x32_bf16 v[148:151], a[88:91], a[72:75], v[148:151]
    ds_read_b64_tr_b16 a[106:107], v11 offset:1032
    v_mfma_f32_16x16x32_bf16 v[44:47], a[88:91], a[64:67], v[44:47]
    v_mfma_f32_16x16x32_bf16 v[44:47], a[92:95], a[68:71], v[44:47]
    ds_read_b64_tr_b16 a[108:109], v11 offset:8200
    v_mfma_f32_16x16x32_bf16 v[40:43], a[92:95], a[60:63], v[40:43]
    ds_read_b64_tr_b16 a[110:111], v11 offset:9224
    ds_write_b128 v13, a[148:151] offset:7168
    v_mfma_f32_16x16x32_bf16 v[40:43], a[88:91], a[56:59], v[40:43]
    v_mfma_f32_16x16x32_bf16 v[36:39], a[88:91], a[48:51], v[36:39]
    v_xor_b32 v10, 0x80, v9
    v_mfma_f32_16x16x32_bf16 v[36:39], a[92:95], a[52:55], v[36:39]
    ds_read_b64_tr_b16 a[80:81], v10
    v_mfma_f32_16x16x32_bf16 v[32:35], a[92:95], a[44:47], v[32:35]
    ds_read_b64_tr_b16 a[82:83], v10 offset:1024
    v_add_u32 v14, 0x20000, v254
    v_mfma_f32_16x16x32_bf16 v[32:35], a[88:91], a[40:43], v[32:35]
    s_waitcnt lgkmcnt(11)
    ds_read_b64_tr_b16 a[84:85], v10 offset:8192
    v_mfma_f32_16x16x32_bf16 v[48:51], a[96:99], a[40:43], v[48:51]
    s_waitcnt lgkmcnt(9)
    ds_read_b64_tr_b16 a[86:87], v10 offset:9216
    v_mfma_f32_16x16x32_bf16 v[48:51], a[100:103], a[44:47], v[48:51]
    ds_write_b128 v14, a[152:155]
    v_mfma_f32_16x16x32_bf16 v[52:55], a[100:103], a[52:55], v[52:55]
    ds_read_b64_tr_b16 a[88:89], v10 offset:8
    v_mfma_f32_16x16x32_bf16 v[52:55], a[96:99], a[48:51], v[52:55]
    ds_read_b64_tr_b16 a[90:91], v10 offset:1032
    v_mul_f32 v144, s89, v144
    v_mfma_f32_16x16x32_bf16 v[56:59], a[96:99], a[56:59], v[56:59]
    v_mul_f32 v145, s89, v145
    v_mul_f32 v146, s89, v146
    v_mul_f32 v147, s89, v147
    v_mfma_f32_16x16x32_bf16 v[56:59], a[100:103], a[60:63], v[56:59]
    ds_read_b64_tr_b16 a[92:93], v10 offset:8200
    ds_write_b128 v14, a[156:159] offset:1024
    v_mfma_f32_16x16x32_bf16 v[60:63], a[100:103], a[68:71], v[60:63]
    ds_read_b64_tr_b16 a[94:95], v10 offset:9224
    v_mul_f32 v148, s89, v148
    v_mfma_f32_16x16x32_bf16 v[60:63], a[96:99], a[64:67], v[60:63]
    s_waitcnt lgkmcnt(13)
    v_mul_f32 v149, s89, v149
    v_mul_f32 v150, s89, v150
    v_mul_f32 v151, s89, v151
    v_mfma_f32_16x16x32_bf16 v[76:79], a[104:107], a[64:67], v[76:79]
    s_waitcnt lgkmcnt(11)
    v_xor_b32 v11, 0xc0, v9
    v_cvt_pk_bf16_f32 v224, v144, v145
    v_mfma_f32_16x16x32_bf16 v[76:79], a[108:111], a[68:71], v[76:79]
    ds_read_b64_tr_b16 a[96:97], v11
    ds_write_b128 v14, a[160:163] offset:2048
    v_mfma_f32_16x16x32_bf16 v[72:75], a[108:111], a[60:63], v[72:75]
    ds_read_b64_tr_b16 a[98:99], v11 offset:1024
    v_cvt_pk_bf16_f32 v226, v148, v149
    v_cvt_pk_bf16_f32 v225, v146, v147
    v_mfma_f32_16x16x32_bf16 v[72:75], a[104:107], a[56:59], v[72:75]
    ds_read_b64_tr_b16 a[100:101], v11 offset:8192
    v_cvt_pk_bf16_f32 v227, v150, v151
    v_mfma_f32_16x16x32_bf16 v[68:71], a[104:107], a[48:51], v[68:71]
    ds_read_b64_tr_b16 a[102:103], v11 offset:9216
    ds_write_b128 v14, a[164:167] offset:3072
    v_mfma_f32_16x16x32_bf16 v[68:71], a[108:111], a[52:55], v[68:71]
    v_mul_f32 v16, s89, v16
    v_mul_f32 v17, s89, v17
    v_mfma_f32_16x16x32_bf16 v[64:67], a[108:111], a[44:47], v[64:67]
    v_mul_f32 v18, s89, v18
    v_mul_f32 v19, s89, v19
    v_mul_f32 v32, s89, v32
    v_mfma_f32_16x16x32_bf16 v[64:67], a[104:107], a[40:43], v[64:67]
    s_waitcnt lgkmcnt(14)
    ds_read_b64_tr_b16 a[104:105], v11 offset:8
    ds_write_b128 v14, a[168:171] offset:4096
    v_mfma_f32_16x16x32_bf16 v[80:83], a[80:83], a[40:43], v[80:83]
    s_waitcnt lgkmcnt(14)
    ds_read_b64_tr_b16 a[106:107], v11 offset:1032
    v_mul_f32 v33, s89, v33
    v_mfma_f32_16x16x32_bf16 v[80:83], a[84:87], a[44:47], v[80:83]
    v_mul_f32 v34, s89, v34
    v_mul_f32 v35, s89, v35
    v_cvt_pk_bf16_f32 v160, v16, v17
    v_mfma_f32_16x16x32_bf16 v[84:87], a[84:87], a[52:55], v[84:87]
    ds_read_b64_tr_b16 a[108:109], v11 offset:8200
    v_cvt_pk_bf16_f32 v162, v32, v33
    v_mfma_f32_16x16x32_bf16 v[84:87], a[80:83], a[48:51], v[84:87]
    ds_read_b64_tr_b16 a[110:111], v11 offset:9224
    ds_write_b128 v14, a[172:175] offset:5120
    v_mfma_f32_16x16x32_bf16 v[88:91], a[80:83], a[56:59], v[88:91]
    v_cvt_pk_bf16_f32 v161, v18, v19
    v_cvt_pk_bf16_f32 v163, v34, v35
    v_mul_f32 v20, s89, v20
    v_mfma_f32_16x16x32_bf16 v[88:91], a[84:87], a[60:63], v[88:91]
    v_mul_f32 v21, s89, v21
    v_mul_f32 v22, s89, v22
    v_mfma_f32_16x16x32_bf16 v[92:95], a[84:87], a[68:71], v[92:95]
    ds_write_b128 v14, a[176:179] offset:6144
    v_mfma_f32_16x16x32_bf16 v[92:95], a[80:83], a[64:67], v[92:95]
    v_mul_f32 v23, s89, v23
    v_mul_f32 v36, s89, v36
    v_mfma_f32_16x16x32_bf16 v[152:155], a[80:83], a[72:75], v[152:155]
    v_mul_f32 v37, s89, v37
    v_mul_f32 v38, s89, v38
    v_mul_f32 v39, s89, v39
    v_mfma_f32_16x16x32_bf16 v[152:155], a[84:87], a[76:79], v[152:155]
    s_waitcnt lgkmcnt(13)
    v_cvt_pk_bf16_f32 v176, v20, v21
    v_cvt_pk_bf16_f32 v178, v36, v37
    v_cvt_pk_bf16_f32 v177, v22, v23
    v_mfma_f32_16x16x32_bf16 v[156:159], a[92:95], a[76:79], v[156:159]
    ds_write_b128 v14, a[180:183] offset:7168
    v_mfma_f32_16x16x32_bf16 v[156:159], a[88:91], a[72:75], v[156:159]
    v_cvt_pk_bf16_f32 v179, v38, v39
    v_mul_f32 v24, s89, v24
    v_mul_f32 v25, s89, v25
    v_mfma_f32_16x16x32_bf16 v[108:111], a[88:91], a[64:67], v[108:111]
    v_mul_f32 v26, s89, v26
    v_mul_f32 v27, s89, v27
    v_mfma_f32_16x16x32_bf16 v[108:111], a[92:95], a[68:71], v[108:111]
    v_mul_f32 v40, s89, v40
    v_mul_f32 v41, s89, v41
    v_mul_f32 v42, s89, v42
    v_mfma_f32_16x16x32_bf16 v[104:107], a[92:95], a[60:63], v[104:107]
    v_mul_f32 v43, s89, v43
    v_cvt_pk_bf16_f32 v192, v24, v25
    v_cvt_pk_bf16_f32 v194, v40, v41
    v_mfma_f32_16x16x32_bf16 v[104:107], a[88:91], a[56:59], v[104:107]
    v_cvt_pk_bf16_f32 v193, v26, v27
    v_cvt_pk_bf16_f32 v195, v42, v43
    v_mfma_f32_16x16x32_bf16 v[100:103], a[88:91], a[48:51], v[100:103]
    v_mul_f32 v28, s89, v28
    v_mul_f32 v29, s89, v29
    v_mul_f32 v30, s89, v30
    v_mfma_f32_16x16x32_bf16 v[100:103], a[92:95], a[52:55], v[100:103]
    s_waitcnt lgkmcnt(0)
    v_mul_f32 v31, s89, v31
    v_mul_f32 v44, s89, v44
    v_mfma_f32_16x16x32_bf16 v[96:99], a[92:95], a[44:47], v[96:99]
    s_barrier
    v_mul_f32 v45, s89, v45
    v_mul_f32 v46, s89, v46
    v_mul_f32 v47, s89, v47
    v_mfma_f32_16x16x32_bf16 v[96:99], a[88:91], a[40:43], v[96:99]
    v_cvt_pk_bf16_f32 v208, v28, v29
    v_cvt_pk_bf16_f32 v210, v44, v45
    v_cvt_pk_bf16_f32 v209, v30, v31
    v_cvt_pk_bf16_f32 v211, v46, v47
    s_lshl_b32 s62, s59, 4
    v_mov_b32 v8, 0
    s_mov_b64 exec, 1
    buffer_load_dword v9, v8, s[32:35], s62 offen sc1
    s_mov_b64 exec, -1
    v_mfma_f32_16x16x32_bf16 v[112:115], a[96:99], a[40:43], v[112:115]
    s_add_u32 m0, s78, 0
    v_mfma_f32_16x16x32_bf16 v[112:115], a[100:103], a[44:47], v[112:115]
    s_add_u32 s91, s77, 0x8000
    s_xor_b32 s91, s91, s47
    v_mfma_f32_16x16x32_bf16 v[116:119], a[100:103], a[52:55], v[116:119]
    buffer_load_dwordx4 v3, s[12:15], s91 offen nt lds
    v_mul_f32 v152, s89, v152
    v_mul_f32 v153, s89, v153
    v_mul_f32 v154, s89, v154
    v_mfma_f32_16x16x32_bf16 v[116:119], a[96:99], a[48:51], v[116:119]
    buffer_load_dwordx4 v15, s[12:15], s91 offen offset:1024 nt lds
    v_mul_f32 v155, s89, v155
    v_mul_f32 v156, s89, v156
    v_mul_f32 v157, s89, v157
    v_mul_f32 v158, s89, v158
    v_mfma_f32_16x16x32_bf16 v[120:123], a[96:99], a[56:59], v[120:123]
    v_mul_f32 v159, s89, v159
    v_cvt_pk_bf16_f32 v232, v152, v153
    v_cvt_pk_bf16_f32 v234, v156, v157
    v_cvt_pk_bf16_f32 v233, v154, v155
    v_mfma_f32_16x16x32_bf16 v[120:123], a[100:103], a[60:63], v[120:123]
    buffer_load_dwordx4 v3, s[12:15], s91 offen offset:2048 nt lds
    v_cvt_pk_bf16_f32 v235, v158, v159
    v_mul_f32 v48, s89, v48
    v_mul_f32 v49, s89, v49
    v_mfma_f32_16x16x32_bf16 v[124:127], a[100:103], a[68:71], v[124:127]
    buffer_load_dwordx4 v15, s[12:15], s91 offen offset:3072 nt lds
    v_mul_f32 v50, s89, v50
    v_mul_f32 v51, s89, v51
    v_mul_f32 v64, s89, v64
    v_mfma_f32_16x16x32_bf16 v[124:127], a[96:99], a[64:67], v[124:127]
    s_add_u32 m0, m0, 0x1000
    s_add_u32 s91, s77, 0x9000
    s_xor_b32 s91, s91, s47
    v_mul_f32 v65, s89, v65
    v_mul_f32 v66, s89, v66
    v_mul_f32 v67, s89, v67
    v_mfma_f32_16x16x32_bf16 v[140:143], a[104:107], a[64:67], v[140:143]
    buffer_load_dwordx4 v3, s[12:15], s91 offen nt lds
    v_cvt_pk_bf16_f32 v164, v48, v49
    v_cvt_pk_bf16_f32 v166, v64, v65
    v_cvt_pk_bf16_f32 v165, v50, v51
    v_mfma_f32_16x16x32_bf16 v[140:143], a[108:111], a[68:71], v[140:143]
    buffer_load_dwordx4 v15, s[12:15], s91 offen offset:1024 nt lds
    v_cvt_pk_bf16_f32 v167, v66, v67
    v_mul_f32 v52, s89, v52
    v_mul_f32 v53, s89, v53
    v_mfma_f32_16x16x32_bf16 v[136:139], a[108:111], a[60:63], v[136:139]
    v_mul_f32 v54, s89, v54
    v_mul_f32 v55, s89, v55
    v_mul_f32 v68, s89, v68
    v_mul_f32 v69, s89, v69
    v_mfma_f32_16x16x32_bf16 v[136:139], a[104:107], a[56:59], v[136:139]
    buffer_load_dwordx4 v3, s[12:15], s91 offen offset:2048 nt lds
    v_mul_f32 v70, s89, v70
    v_mul_f32 v71, s89, v71
    v_cvt_pk_bf16_f32 v180, v52, v53
    v_cvt_pk_bf16_f32 v182, v68, v69
    v_mfma_f32_16x16x32_bf16 v[132:135], a[104:107], a[48:51], v[132:135]
    buffer_load_dwordx4 v15, s[12:15], s91 offen offset:3072 nt lds
    v_cvt_pk_bf16_f32 v181, v54, v55
    v_cvt_pk_bf16_f32 v183, v70, v71
    v_mul_f32 v56, s89, v56
    v_mfma_f32_16x16x32_bf16 v[132:135], a[108:111], a[52:55], v[132:135]
    v_mul_f32 v57, s89, v57
    v_mul_f32 v58, s89, v58
    v_mul_f32 v59, s89, v59
    v_mul_f32 v72, s89, v72
    v_mfma_f32_16x16x32_bf16 v[128:131], a[108:111], a[44:47], v[128:131]
    v_mul_f32 v73, s89, v73
    v_mul_f32 v74, s89, v74
    v_mul_f32 v75, s89, v75
    v_cvt_pk_bf16_f32 v196, v56, v57
    v_mfma_f32_16x16x32_bf16 v[128:131], a[104:107], a[40:43], v[128:131]
    v_cvt_pk_bf16_f32 v198, v72, v73
    v_cvt_pk_bf16_f32 v197, v58, v59
    v_cvt_pk_bf16_f32 v199, v74, v75
    v_mul_f32 v60, s89, v60
    v_mul_f32 v61, s89, v61
    v_mul_f32 v62, s89, v62
    v_mul_f32 v63, s89, v63
    v_mul_f32 v76, s89, v76
    v_mul_f32 v77, s89, v77
    v_mul_f32 v78, s89, v78
    v_mul_f32 v79, s89, v79
    v_cvt_pk_bf16_f32 v212, v60, v61
    v_cvt_pk_bf16_f32 v214, v76, v77
    v_cvt_pk_bf16_f32 v213, v62, v63
    v_cvt_pk_bf16_f32 v215, v78, v79
    v_xor_b32 v10, 0xa000, v254
    ds_write_b128 v10, v[224:227]
    ds_write_b128 v10, v[232:235] offset:1024
    v_pk_mul_f32 v[80:81], v[80:81], s[44:45]
    v_pk_mul_f32 v[82:83], v[82:83], s[44:45]
    v_pk_mul_f32 v[96:97], v[96:97], s[44:45]
    v_pk_mul_f32 v[98:99], v[98:99], s[44:45]
    v_cvt_pk_bf16_f32 v168, v80, v81
    v_cvt_pk_bf16_f32 v170, v96, v97
    v_cvt_pk_bf16_f32 v169, v82, v83
    v_cvt_pk_bf16_f32 v171, v98, v99
    v_pk_mul_f32 v[112:113], v[112:113], s[44:45]
    v_pk_mul_f32 v[114:115], v[114:115], s[44:45]
    v_pk_mul_f32 v[128:129], v[128:129], s[44:45]
    v_pk_mul_f32 v[130:131], v[130:131], s[44:45]
    v_cvt_pk_bf16_f32 v172, v112, v113
    v_cvt_pk_bf16_f32 v174, v128, v129
    v_cvt_pk_bf16_f32 v173, v114, v115
    v_cvt_pk_bf16_f32 v175, v130, v131
    v_pk_mul_f32 v[84:85], v[84:85], s[44:45]
    v_pk_mul_f32 v[86:87], v[86:87], s[44:45]
    v_pk_mul_f32 v[100:101], v[100:101], s[44:45]
    v_pk_mul_f32 v[102:103], v[102:103], s[44:45]
    v_cvt_pk_bf16_f32 v184, v84, v85
    v_cvt_pk_bf16_f32 v186, v100, v101
    v_cvt_pk_bf16_f32 v185, v86, v87
    v_cvt_pk_bf16_f32 v187, v102, v103
    v_pk_mul_f32 v[116:117], v[116:117], s[44:45]
    v_pk_mul_f32 v[118:119], v[118:119], s[44:45]
    v_pk_mul_f32 v[132:133], v[132:133], s[44:45]
    v_pk_mul_f32 v[134:135], v[134:135], s[44:45]
    s_waitcnt vmcnt(17)
    v_cvt_pk_bf16_f32 v188, v116, v117
    v_cvt_pk_bf16_f32 v190, v132, v133
    v_cvt_pk_bf16_f32 v189, v118, v119
    v_cvt_pk_bf16_f32 v191, v134, v135
    v_pk_mul_f32 v[88:89], v[88:89], s[44:45]
    v_pk_mul_f32 v[90:91], v[90:91], s[44:45]
    v_pk_mul_f32 v[104:105], v[104:105], s[44:45]
    v_pk_mul_f32 v[106:107], v[106:107], s[44:45]
    v_cvt_pk_bf16_f32 v200, v88, v89
    v_cvt_pk_bf16_f32 v202, v104, v105
    v_cvt_pk_bf16_f32 v201, v90, v91
    v_cvt_pk_bf16_f32 v203, v106, v107
    v_pk_mul_f32 v[120:121], v[120:121], s[44:45]
    v_pk_mul_f32 v[122:123], v[122:123], s[44:45]
    v_pk_mul_f32 v[136:137], v[136:137], s[44:45]
    v_pk_mul_f32 v[138:139], v[138:139], s[44:45]
    v_cvt_pk_bf16_f32 v204, v120, v121
    v_cvt_pk_bf16_f32 v206, v136, v137
    v_cvt_pk_bf16_f32 v205, v122, v123
    v_cvt_pk_bf16_f32 v207, v138, v139
    v_pk_mul_f32 v[92:93], v[92:93], s[44:45]
    v_pk_mul_f32 v[94:95], v[94:95], s[44:45]
    v_pk_mul_f32 v[108:109], v[108:109], s[44:45]
    v_pk_mul_f32 v[110:111], v[110:111], s[44:45]
    v_cvt_pk_bf16_f32 v216, v92, v93
    v_cvt_pk_bf16_f32 v218, v108, v109
    v_cvt_pk_bf16_f32 v217, v94, v95
    v_cvt_pk_bf16_f32 v219, v110, v111
    v_pk_mul_f32 v[124:125], v[124:125], s[44:45]
    v_pk_mul_f32 v[126:127], v[126:127], s[44:45]
    v_pk_mul_f32 v[140:141], v[140:141], s[44:45]
    v_pk_mul_f32 v[142:143], v[142:143], s[44:45]
    v_cvt_pk_bf16_f32 v220, v124, v125
    v_cvt_pk_bf16_f32 v222, v140, v141
    v_cvt_pk_bf16_f32 v221, v126, v127
    v_cvt_pk_bf16_f32 v223, v142, v143
    s_waitcnt vmcnt(8)
    v_readfirstlane_b32 s63, v9
    s_nop 0
    s_cmp_lt_u32 s63, 16
    s_cbranch_scc1 mha_gate
mha_gate_ok:
    s_waitcnt lgkmcnt(0)
    s_barrier
    ds_read_b128 v[228:231], v254 offset:32768
    ds_read_b128 v[236:239], v254 offset:33792
    v_mov_b32 v153, 0xff800000
    v_mov_b32 v154, 0xff800000
    v_mov_b32 v155, 0xff800000
    v_mov_b32 v156, 0xff800000
    v_mov_b32 v157, 0xff800000
    s_mov_b32 s66, 0
mha_attn_entry:
    ds_read_b128 a[160:163], v240
    ds_read_b128 a[164:167], v242
    ds_read_b128 a[168:171], v240 offset:512
    ds_read_b128 a[172:175], v242 offset:512
    ds_read_b128 a[176:179], v240 offset:4096
    ds_read_b128 a[180:183], v242 offset:4096
    ds_read_b128 a[184:187], v240 offset:4608
    ds_read_b128 a[188:191], v242 offset:4608
    v_mov_b32 v148, 0
    v_mov_b32 v149, 0
    v_mov_b32 v150, 0
    v_mov_b32 v151, 0
    v_mov_b32 v152, 0
    s_waitcnt lgkmcnt(7)
    v_mfma_f32_16x16x32_bf16 v[16:19], a[160:163], v[160:163], 0
    s_waitcnt lgkmcnt(6)
    v_mfma_f32_16x16x32_bf16 v[16:19], a[164:167], v[164:167], v[16:19]
    s_waitcnt lgkmcnt(5)
    v_mfma_f32_16x16x32_bf16 v[16:19], a[168:171], v[168:171], v[16:19]
    s_waitcnt lgkmcnt(4)
    v_mfma_f32_16x16x32_bf16 v[16:19], a[172:175], v[172:175], v[16:19]
    v_mfma_f32_16x16x32_bf16 v[20:23], a[172:175], v[188:191], 0
    v_mfma_f32_16x16x32_bf16 v[20:23], a[168:171], v[184:187], v[20:23]
    v_mfma_f32_16x16x32_bf16 v[20:23], a[164:167], v[180:183], v[20:23]
    s_nop 4
    v_max3_f32 v10, v16, v17, v18
    v_max3_f32 v10, v10, v19, v153
    v_mov_b32 v11, v10
    v_mfma_f32_16x16x32_bf16 v[20:23], a[160:163], v[176:179], v[20:23]
    s_nop 0
    v_permlane32_swap_b32 v10, v11
    v_max_f32 v10, v10, v11
    v_mov_b32 v11, v10
    v_mfma_f32_16x16x32_bf16 v[24:27], a[160:163], v[192:195], 0
    s_nop 0
    v_permlane16_swap_b32 v10, v11
    v_max_f32 v10, v10, v11
    v_sub_f32 v128, 0, v10
    v_mfma_f32_16x16x32_bf16 v[24:27], a[164:167], v[196:199], v[24:27]
    v_sub_f32 v129, 0, v10
    v_sub_f32 v130, 0, v10
    v_sub_f32 v131, 0, v10
    v_mfma_f32_16x16x32_bf16 v[24:27], a[168:171], v[200:203], v[24:27]
    v_max3_f32 v12, v20, v21, v22
    v_max3_f32 v12, v12, v23, v154
    v_mov_b32 v13, v12
    v_mfma_f32_16x16x32_bf16 v[24:27], a[172:175], v[204:207], v[24:27]
    s_nop 0
    v_permlane32_swap_b32 v12, v13
    v_max_f32 v12, v12, v13
    v_mov_b32 v13, v12
    v_mfma_f32_16x16x32_bf16 v[28:31], a[172:175], v[220:223], 0
    s_nop 0
    v_permlane16_swap_b32 v12, v13
    v_max_f32 v12, v12, v13
    v_sub_f32 v132, 0, v12
    v_mfma_f32_16x16x32_bf16 v[28:31], a[168:171], v[216:219], v[28:31]
    v_sub_f32 v133, 0, v12
    v_sub_f32 v134, 0, v12
    v_sub_f32 v135, 0, v12
    v_mfma_f32_16x16x32_bf16 v[28:31], a[164:167], v[212:215], v[28:31]
    v_max3_f32 v10, v24, v25, v26
    v_max3_f32 v10, v10, v27, v155
    v_mov_b32 v11, v10
    v_mfma_f32_16x16x32_bf16 v[28:31], a[160:163], v[208:211], v[28:31]
    s_nop 0
    v_permlane32_swap_b32 v10, v11
    v_max_f32 v10, v10, v11
    v_mov_b32 v11, v10
    v_mfma_f32_16x16x32_bf16 v[32:35], a[160:163], v[224:227], 0
    s_nop 0
    v_permlane16_swap_b32 v10, v11
    v_max_f32 v10, v10, v11
    v_sub_f32 v136, 0, v10
    v_mfma_f32_16x16x32_bf16 v[32:35], a[164:167], v[228:231], v[32:35]
    v_sub_f32 v137, 0, v10
    v_sub_f32 v138, 0, v10
    v_sub_f32 v139, 0, v10
    v_mfma_f32_16x16x32_bf16 v[32:35], a[168:171], v[232:235], v[32:35]
    v_max3_f32 v12, v28, v29, v30
    v_max3_f32 v12, v12, v31, v156
    v_mov_b32 v13, v12
    v_mfma_f32_16x16x32_bf16 v[32:35], a[172:175], v[236:239], v[32:35]
    s_waitcnt lgkmcnt(3)
    ds_read_b128 a[160:163], v241
    v_permlane32_swap_b32 v12, v13
    v_max_f32 v12, v12, v13
    v_mov_b32 v13, v12
    v_mfma_f32_16x16x32_bf16 v[36:39], a[176:179], v[160:163], v[128:131]
    s_waitcnt lgkmcnt(3)
    v_permlane16_swap_b32 v12, v13
    v_max_f32 v12, v12, v13
    v_sub_f32 v140, 0, v12
    v_mfma_f32_16x16x32_bf16 v[36:39], a[180:183], v[164:167], v[36:39]
    s_waitcnt lgkmcnt(0)
    ds_read_b128 a[164:167], v243
    v_sub_f32 v141, 0, v12
    v_sub_f32 v142, 0, v12
    v_sub_f32 v143, 0, v12
    v_mfma_f32_16x16x32_bf16 v[36:39], a[184:187], v[168:171], v[36:39]
    s_add_u32 m0, s78, 0x8000
    v_max3_f32 v10, v32, v33, v34
    v_max3_f32 v10, v10, v35, v157
    v_mov_b32 v11, v10
    v_mfma_f32_16x16x32_bf16 v[36:39], a[188:191], v[172:175], v[36:39]
    s_add_u32 s91, s77, 0x4000
    ds_read_b128 a[168:171], v241 offset:512
    v_permlane32_swap_b32 v10, v11
    v_max_f32 v10, v10, v11
    v_mov_b32 v11, v10
    v_mfma_f32_16x16x32_bf16 v[40:43], a[188:191], v[188:191], v[132:135]
    s_xor_b32 s91, s91, s47
    buffer_load_dwordx4 v3, s[16:19], s91 offen nt lds
    v_permlane16_swap_b32 v10, v11
    v_max_f32 v10, v10, v11
    v_mfma_f32_16x16x32_bf16 v[40:43], a[184:187], v[184:187], v[40:43]
    ds_read_b128 a[172:175], v243 offset:512
    v_sub_f32 v144, 0, v10
    v_sub_f32 v145, 0, v10
    v_sub_f32 v146, 0, v10
    v_mfma_f32_16x16x32_bf16 v[40:43], a[180:183], v[180:183], v[40:43]
    v_sub_f32 v147, 0, v10
    v_add_f32 v16, v16, v128
    v_exp_f32 v16, v16
    v_mfma_f32_16x16x32_bf16 v[40:43], a[176:179], v[176:179], v[40:43]
    v_add_f32 v17, v17, v128
    v_exp_f32 v17, v17
    v_add_f32 v18, v18, v128
    v_exp_f32 v18, v18
    v_mfma_f32_16x16x32_bf16 v[44:47], a[176:179], v[192:195], v[136:139]
    v_add_f32 v19, v19, v128
    v_exp_f32 v19, v19
    v_add_f32 v148, v148, v16
    v_mfma_f32_16x16x32_bf16 v[44:47], a[180:183], v[196:199], v[44:47]
    buffer_load_dwordx4 v15, s[16:19], s91 offen offset:1024 nt lds
    v_cvt_pk_bf16_f32 v56, v16, v17
    v_add_f32 v148, v148, v17
    v_add_f32 v148, v148, v18
    v_mfma_f32_16x16x32_bf16 v[44:47], a[184:187], v[200:203], v[44:47]
    v_cvt_pk_bf16_f32 v57, v18, v19
    v_add_f32 v148, v148, v19
    v_add_f32 v20, v20, v132
    v_exp_f32 v20, v20
    v_mfma_f32_16x16x32_bf16 v[44:47], a[188:191], v[204:207], v[44:47]
    v_add_f32 v21, v21, v132
    v_exp_f32 v21, v21
    v_add_f32 v22, v22, v132
    v_exp_f32 v22, v22
    v_mfma_f32_16x16x32_bf16 v[48:51], a[188:191], v[220:223], v[140:143]
    v_add_f32 v23, v23, v132
    v_exp_f32 v23, v23
    v_add_f32 v149, v149, v20
    v_mfma_f32_16x16x32_bf16 v[48:51], a[184:187], v[216:219], v[48:51]
    v_cvt_pk_bf16_f32 v60, v20, v21
    v_add_f32 v149, v149, v21
    v_add_f32 v149, v149, v22
    v_cvt_pk_bf16_f32 v61, v22, v23
    v_mfma_f32_16x16x32_bf16 v[48:51], a[180:183], v[212:215], v[48:51]
    buffer_load_dwordx4 v3, s[16:19], s91 offen offset:2048 nt lds
    v_add_f32 v149, v149, v23
    v_add_f32 v24, v24, v136
    v_exp_f32 v24, v24
    v_mfma_f32_16x16x32_bf16 v[48:51], a[176:179], v[208:211], v[48:51]
    v_add_f32 v25, v25, v136
    v_exp_f32 v25, v25
    v_add_f32 v26, v26, v136
    v_exp_f32 v26, v26
    v_mfma_f32_16x16x32_bf16 v[52:55], a[176:179], v[224:227], v[144:147]
    v_add_f32 v27, v27, v136
    v_exp_f32 v27, v27
    v_add_f32 v150, v150, v24
    v_mfma_f32_16x16x32_bf16 v[52:55], a[180:183], v[228:231], v[52:55]
    v_cvt_pk_bf16_f32 v64, v24, v25
    v_add_f32 v150, v150, v25
    v_add_f32 v150, v150, v26
    v_cvt_pk_bf16_f32 v65, v26, v27
    v_mfma_f32_16x16x32_bf16 v[52:55], a[184:187], v[232:235], v[52:55]
    v_add_f32 v150, v150, v27
    v_add_f32 v28, v28, v140
    v_exp_f32 v28, v28
    v_mfma_f32_16x16x32_bf16 v[52:55], a[188:191], v[236:239], v[52:55]
    ds_read_b128 a[176:179], v241 offset:4096
    buffer_load_dwordx4 v15, s[16:19], s91 offen offset:3072 nt lds
    v_add_f32 v29, v29, v140
    v_exp_f32 v29, v29
    v_mfma_f32_16x16x32_bf16 v[16:19], a[160:163], v[160:163], v[128:131]
    s_waitcnt lgkmcnt(3)
    ds_read_b128 a[180:183], v243 offset:4096
    v_add_f32 v30, v30, v140
    v_exp_f32 v30, v30
    v_mfma_f32_16x16x32_bf16 v[16:19], a[164:167], v[164:167], v[16:19]
    s_waitcnt lgkmcnt(3)
    s_add_u32 m0, m0, 0x1000
    v_add_f32 v31, v31, v140
    v_exp_f32 v31, v31
    v_add_f32 v151, v151, v28
    v_mfma_f32_16x16x32_bf16 v[16:19], a[168:171], v[168:171], v[16:19]
    s_waitcnt lgkmcnt(2)
    s_add_u32 s91, s77, 0x5000
    ds_read_b128 a[184:187], v241 offset:4608
    v_cvt_pk_bf16_f32 v68, v28, v29
    v_add_f32 v151, v151, v29
    v_add_f32 v151, v151, v30
    v_mfma_f32_16x16x32_bf16 v[16:19], a[172:175], v[172:175], v[16:19]
    s_xor_b32 s91, s91, s47
    v_cvt_pk_bf16_f32 v69, v30, v31
    v_add_f32 v151, v151, v31
    v_add_f32 v32, v32, v144
    v_exp_f32 v32, v32
    v_mfma_f32_16x16x32_bf16 v[20:23], a[172:175], v[188:191], v[132:135]
    ds_read_b128 a[188:191], v243 offset:4608
    buffer_load_dwordx4 v3, s[16:19], s91 offen nt lds
    v_add_f32 v33, v33, v144
    v_exp_f32 v33, v33
    v_mfma_f32_16x16x32_bf16 v[20:23], a[168:171], v[184:187], v[20:23]
    v_add_f32 v34, v34, v144
    v_exp_f32 v34, v34
    v_add_f32 v152, v152, v32
    v_mfma_f32_16x16x32_bf16 v[20:23], a[164:167], v[180:183], v[20:23]
    v_add_f32 v35, v35, v144
    v_exp_f32 v35, v35
    v_cvt_pk_bf16_f32 v72, v32, v33
    v_mfma_f32_16x16x32_bf16 v[20:23], a[160:163], v[176:179], v[20:23]
    v_exp_f32 v36, v36
    v_exp_f32 v37, v37
    v_add_f32 v152, v152, v33
    v_mfma_f32_16x16x32_bf16 v[24:27], a[160:163], v[192:195], v[136:139]
    v_exp_f32 v38, v38
    v_exp_f32 v39, v39
    v_mfma_f32_16x16x32_bf16 v[24:27], a[164:167], v[196:199], v[24:27]
    buffer_load_dwordx4 v15, s[16:19], s91 offen offset:1024 nt lds
    v_add_f32 v152, v152, v34
    v_cvt_pk_bf16_f32 v73, v34, v35
    v_add_f32 v152, v152, v35
    v_mfma_f32_16x16x32_bf16 v[24:27], a[168:171], v[200:203], v[24:27]
    v_add_f32 v148, v148, v36
    v_cvt_pk_bf16_f32 v58, v36, v37
    v_add_f32 v148, v148, v37
    v_add_f32 v148, v148, v38
    v_mfma_f32_16x16x32_bf16 v[24:27], a[172:175], v[204:207], v[24:27]
    v_cvt_pk_bf16_f32 v59, v38, v39
    v_add_f32 v148, v148, v39
    v_exp_f32 v40, v40
    v_add_u32 v240, 0x8000, v240
    v_mfma_f32_16x16x32_bf16 v[28:31], a[172:175], v[220:223], v[140:143]
    v_exp_f32 v41, v41
    v_exp_f32 v42, v42
    v_mfma_f32_16x16x32_bf16 v[28:31], a[168:171], v[216:219], v[28:31]
    v_exp_f32 v43, v43
    v_add_f32 v149, v149, v40
    v_cvt_pk_bf16_f32 v62, v40, v41
    v_mfma_f32_16x16x32_bf16 v[28:31], a[164:167], v[212:215], v[28:31]
    buffer_load_dwordx4 v3, s[16:19], s91 offen offset:2048 nt lds
    v_add_f32 v149, v149, v41
    v_add_f32 v149, v149, v42
    v_cvt_pk_bf16_f32 v63, v42, v43
    v_mfma_f32_16x16x32_bf16 v[28:31], a[160:163], v[208:211], v[28:31]
    s_waitcnt lgkmcnt(3)
    v_add_f32 v149, v149, v43
    v_exp_f32 v44, v44
    v_exp_f32 v45, v45
    v_mfma_f32_16x16x32_bf16 v[36:39], a[176:179], v[160:163], v[128:131]
    s_waitcnt lgkmcnt(2)
    v_exp_f32 v46, v46
    v_exp_f32 v47, v47
    v_mfma_f32_16x16x32_bf16 v[36:39], a[180:183], v[164:167], v[36:39]
    s_waitcnt lgkmcnt(1)
    v_add_f32 v150, v150, v44
    v_cvt_pk_bf16_f32 v66, v44, v45
    v_add_f32 v150, v150, v45
    v_add_f32 v150, v150, v46
    v_mfma_f32_16x16x32_bf16 v[36:39], a[184:187], v[168:171], v[36:39]
    s_waitcnt lgkmcnt(0)
    v_cvt_pk_bf16_f32 v67, v46, v47
    v_add_f32 v150, v150, v47
    v_exp_f32 v48, v48
    v_mfma_f32_16x16x32_bf16 v[36:39], a[188:191], v[172:175], v[36:39]
    buffer_load_dwordx4 v15, s[16:19], s91 offen offset:3072 nt lds
    v_exp_f32 v49, v49
    v_exp_f32 v50, v50
    v_mfma_f32_16x16x32_bf16 v[40:43], a[188:191], v[188:191], v[132:135]
    v_exp_f32 v51, v51
    v_add_f32 v151, v151, v48
    v_cvt_pk_bf16_f32 v70, v48, v49
    v_mfma_f32_16x16x32_bf16 v[40:43], a[184:187], v[184:187], v[40:43]
    v_add_f32 v151, v151, v49
    v_add_f32 v151, v151, v50
    v_cvt_pk_bf16_f32 v71, v50, v51
    v_add_f32 v151, v151, v51
    v_mfma_f32_16x16x32_bf16 v[40:43], a[180:183], v[180:183], v[40:43]
    v_exp_f32 v52, v52
    v_exp_f32 v53, v53
    v_mfma_f32_16x16x32_bf16 v[40:43], a[176:179], v[176:179], v[40:43]
    v_exp_f32 v54, v54
    v_exp_f32 v55, v55
    v_add_u32 v242, 0x8000, v242
    v_mfma_f32_16x16x32_bf16 v[44:47], a[176:179], v[192:195], v[136:139]
    v_exp_f32 v16, v16
    v_exp_f32 v17, v17
    v_mfma_f32_16x16x32_bf16 v[44:47], a[180:183], v[196:199], v[44:47]
    v_exp_f32 v18, v18
    v_exp_f32 v19, v19
    v_mfma_f32_16x16x32_bf16 v[44:47], a[184:187], v[200:203], v[44:47]
    v_exp_f32 v20, v20
    v_exp_f32 v21, v21
    v_mfma_f32_16x16x32_bf16 v[44:47], a[188:191], v[204:207], v[44:47]
    v_exp_f32 v22, v22
    v_exp_f32 v23, v23
    v_add_u32 v241, 0x8000, v241
    v_mfma_f32_16x16x32_bf16 v[48:51], a[188:191], v[220:223], v[140:143]
    v_exp_f32 v24, v24
    v_exp_f32 v25, v25
    v_mfma_f32_16x16x32_bf16 v[48:51], a[184:187], v[216:219], v[48:51]
    v_exp_f32 v26, v26
    v_exp_f32 v27, v27
    v_mfma_f32_16x16x32_bf16 v[48:51], a[180:183], v[212:215], v[48:51]
    v_exp_f32 v28, v28
    v_exp_f32 v29, v29
    v_mfma_f32_16x16x32_bf16 v[48:51], a[176:179], v[208:211], v[48:51]
    v_exp_f32 v30, v30
    v_exp_f32 v31, v31
    v_add_u32 v243, 0x8000, v243
    v_add_f32 v152, v152, v52
    v_cvt_pk_bf16_f32 v74, v52, v53
    v_add_f32 v152, v152, v53
    v_add_f32 v152, v152, v54
    v_cvt_pk_bf16_f32 v75, v54, v55
    v_add_f32 v152, v152, v55
    v_add_f32 v148, v148, v16
    v_cvt_pk_bf16_f32 v76, v16, v17
    v_add_f32 v148, v148, v17
    v_add_f32 v148, v148, v18
    v_cvt_pk_bf16_f32 v77, v18, v19
    v_add_f32 v148, v148, v19
    v_add_f32 v149, v149, v20
    v_cvt_pk_bf16_f32 v80, v20, v21
    v_add_f32 v149, v149, v21
    v_add_f32 v149, v149, v22
    v_cvt_pk_bf16_f32 v81, v22, v23
    v_add_f32 v149, v149, v23
    v_add_f32 v150, v150, v24
    v_cvt_pk_bf16_f32 v84, v24, v25
    v_add_f32 v150, v150, v25
    v_add_f32 v150, v150, v26
    v_cvt_pk_bf16_f32 v85, v26, v27
    v_add_f32 v150, v150, v27
    v_add_f32 v151, v151, v28
    v_cvt_pk_bf16_f32 v88, v28, v29
    v_add_f32 v151, v151, v29
    v_add_f32 v151, v151, v30
    v_cvt_pk_bf16_f32 v89, v30, v31
    v_add_f32 v151, v151, v31
    s_waitcnt lgkmcnt(0)
    s_barrier
    ds_read_b128 a[160:163], v240
    ds_read_b128 a[164:167], v242
    ds_read_b128 a[168:171], v240 offset:512
    ds_read_b128 a[172:175], v242 offset:512
    s_waitcnt lgkmcnt(3)
    v_mfma_f32_16x16x32_bf16 v[16:19], a[160:163], v[160:163], v[128:131]
    s_waitcnt lgkmcnt(2)
    s_add_u32 m0, s78, 0x10000
    ds_read_b64_tr_b16 a[176:177], v244
    v_mfma_f32_16x16x32_bf16 v[16:19], a[164:167], v[164:167], v[16:19]
    s_waitcnt lgkmcnt(2)
    s_add_u32 s91, s77, 0xc000
    ds_read_b64_tr_b16 a[178:179], v244 offset:4096
    v_exp_f32 v36, v36
    v_mfma_f32_16x16x32_bf16 v[16:19], a[168:171], v[168:171], v[16:19]
    s_waitcnt lgkmcnt(2)
    s_xor_b32 s91, s91, s47
    ds_read_b64_tr_b16 a[180:181], v245
    v_mfma_f32_16x16x32_bf16 v[16:19], a[172:175], v[172:175], v[16:19]
    s_waitcnt vmcnt(4)
    ds_read_b64_tr_b16 a[182:183], v245 offset:4096
    buffer_load_dwordx4 v3, s[12:15], s91 offen nt lds
    v_mfma_f32_16x16x32_bf16 v[20:23], a[172:175], v[188:191], v[132:135]
    ds_read_b64_tr_b16 a[184:185], v246
    v_mfma_f32_16x16x32_bf16 v[20:23], a[168:171], v[184:187], v[20:23]
    ds_read_b64_tr_b16 a[186:187], v246 offset:4096
    v_exp_f32 v37, v37
    v_mfma_f32_16x16x32_bf16 v[20:23], a[164:167], v[180:183], v[20:23]
    v_exp_f32 v38, v38
    v_mfma_f32_16x16x32_bf16 v[20:23], a[160:163], v[176:179], v[20:23]
    ds_read_b64_tr_b16 a[188:189], v247
    v_exp_f32 v39, v39
    v_mfma_f32_16x16x32_bf16 v[24:27], a[160:163], v[192:195], v[136:139]
    v_exp_f32 v40, v40
    v_add_f32 v148, v148, v36
    v_mfma_f32_16x16x32_bf16 v[24:27], a[164:167], v[196:199], v[24:27]
    ds_read_b64_tr_b16 a[190:191], v247 offset:4096
    v_cvt_pk_bf16_f32 v78, v36, v37
    v_mfma_f32_16x16x32_bf16 v[24:27], a[168:171], v[200:203], v[24:27]
    v_exp_f32 v41, v41
    v_add_f32 v148, v148, v37
    v_mfma_f32_16x16x32_bf16 v[24:27], a[172:175], v[204:207], v[24:27]
    v_exp_f32 v42, v42
    v_mfma_f32_16x16x32_bf16 v[28:31], a[172:175], v[220:223], v[140:143]
    v_exp_f32 v43, v43
    v_add_f32 v148, v148, v38
    v_mfma_f32_16x16x32_bf16 v[28:31], a[168:171], v[216:219], v[28:31]
    v_exp_f32 v44, v44
    v_mfma_f32_16x16x32_bf16 v[28:31], a[164:167], v[212:215], v[28:31]
    v_exp_f32 v45, v45
    v_cvt_pk_bf16_f32 v79, v38, v39
    v_mfma_f32_16x16x32_bf16 v[28:31], a[160:163], v[208:211], v[28:31]
    s_waitcnt vmcnt(4)
    v_exp_f32 v46, v46
    v_add_f32 v148, v148, v39
    v_mfma_f32_16x16x32_bf16 v[32:35], a[160:163], v[224:227], v[144:147]
    v_exp_f32 v47, v47
    v_mfma_f32_16x16x32_bf16 v[32:35], a[164:167], v[228:231], v[32:35]
    v_exp_f32 v48, v48
    v_add_f32 v149, v149, v40
    v_mfma_f32_16x16x32_bf16 v[32:35], a[168:171], v[232:235], v[32:35]
    v_exp_f32 v49, v49
    v_exp_f32 v50, v50
    v_exp_f32 v51, v51
    v_cvt_pk_bf16_f32 v82, v40, v41
    v_add_f32 v149, v149, v41
    v_add_f32 v149, v149, v42
    v_cvt_pk_bf16_f32 v83, v42, v43
    v_add_f32 v149, v149, v43
    v_add_f32 v150, v150, v44
    v_cvt_pk_bf16_f32 v86, v44, v45
    v_add_f32 v150, v150, v45
    v_add_f32 v150, v150, v46
    v_cvt_pk_bf16_f32 v87, v46, v47
    v_add_f32 v150, v150, v47
    v_add_f32 v151, v151, v48
    v_cvt_pk_bf16_f32 v90, v48, v49
    v_add_f32 v151, v151, v49
    v_add_f32 v151, v151, v50
    v_cvt_pk_bf16_f32 v91, v50, v51
    v_add_f32 v151, v151, v51
    buffer_load_dwordx4 v15, s[12:15], s91 offen offset:1024 nt lds
    v_mfma_f32_16x16x32_bf16 v[32:35], a[172:175], v[236:239], v[32:35]
    s_waitcnt lgkmcnt(6)
    ds_read_b128 a[160:163], v240 offset:4096
    v_exp_f32 v16, v16
    v_mfma_f32_16x16x32_bf16 a[0:3], a[176:179], v[56:59], 0
    s_waitcnt lgkmcnt(5)
    v_exp_f32 v17, v17
    v_mfma_f32_16x16x32_bf16 a[0:3], a[180:183], v[76:79], a[0:3]
    ds_read_b128 a[164:167], v242 offset:4096
    v_exp_f32 v18, v18
    v_mfma_f32_16x16x32_bf16 a[4:7], a[180:183], v[80:83], 0
    v_exp_f32 v19, v19
    v_add_f32 v148, v148, v16
    v_mfma_f32_16x16x32_bf16 a[4:7], a[176:179], v[60:63], a[4:7]
    ds_read_b128 a[168:171], v240 offset:4608
    v_cvt_pk_bf16_f32 v92, v16, v17
    v_mfma_f32_16x16x32_bf16 a[8:11], a[176:179], v[64:67], 0
    v_add_f32 v148, v148, v17
    v_add_f32 v148, v148, v18
    v_cvt_pk_bf16_f32 v93, v18, v19
    v_mfma_f32_16x16x32_bf16 a[8:11], a[180:183], v[84:87], a[8:11]
    ds_read_b128 a[172:175], v242 offset:4608
    v_add_f32 v148, v148, v19
    v_mfma_f32_16x16x32_bf16 a[12:15], a[180:183], v[88:91], 0
    v_exp_f32 v20, v20
    v_add_u32 v240, 0xfffe8000, v240
    v_mfma_f32_16x16x32_bf16 a[12:15], a[176:179], v[68:71], a[12:15]
    v_exp_f32 v21, v21
    v_mfma_f32_16x16x32_bf16 a[16:19], a[176:179], v[72:75], 0
    s_waitcnt lgkmcnt(6)
    ds_read_b64_tr_b16 a[176:177], v248
    v_exp_f32 v22, v22
    v_mfma_f32_16x16x32_bf16 a[36:39], a[184:187], v[72:75], 0
    s_waitcnt vmcnt(4)
    v_exp_f32 v23, v23
    v_add_f32 v149, v149, v20
    v_mfma_f32_16x16x32_bf16 a[32:35], a[184:187], v[68:71], 0
    s_waitcnt lgkmcnt(5)
    ds_read_b64_tr_b16 a[178:179], v248 offset:4096
    buffer_load_dwordx4 v3, s[12:15], s91 offen offset:2048 nt lds
    v_mfma_f32_16x16x32_bf16 a[32:35], a[188:191], v[88:91], a[32:35]
    v_cvt_pk_bf16_f32 v96, v20, v21
    v_add_f32 v149, v149, v21
    v_add_f32 v149, v149, v22
    v_mfma_f32_16x16x32_bf16 a[28:31], a[188:191], v[84:87], 0
    ds_read_b64_tr_b16 a[180:181], v249
    v_cvt_pk_bf16_f32 v97, v22, v23
    v_mfma_f32_16x16x32_bf16 a[28:31], a[184:187], v[64:67], a[28:31]
    v_add_f32 v149, v149, v23
    v_exp_f32 v24, v24
    v_mfma_f32_16x16x32_bf16 a[24:27], a[184:187], v[60:63], 0
    ds_read_b64_tr_b16 a[182:183], v249 offset:4096
    v_add_u32 v242, 0xfffe8000, v242
    v_mfma_f32_16x16x32_bf16 a[24:27], a[188:191], v[80:83], a[24:27]
    v_exp_f32 v25, v25
    v_add_f32 v150, v150, v24
    v_mfma_f32_16x16x32_bf16 a[20:23], a[188:191], v[76:79], 0
    v_exp_f32 v26, v26
    v_cvt_pk_bf16_f32 v100, v24, v25
    v_mfma_f32_16x16x32_bf16 a[20:23], a[184:187], v[56:59], a[20:23]
    s_waitcnt lgkmcnt(7)
    ds_read_b64_tr_b16 a[184:185], v250
    v_add_f32 v150, v150, v25
    v_mfma_f32_16x16x32_bf16 v[36:39], a[160:163], v[160:163], v[128:131]
    s_waitcnt lgkmcnt(7)
    ds_read_b64_tr_b16 a[186:187], v250 offset:4096
    v_exp_f32 v27, v27
    v_mfma_f32_16x16x32_bf16 v[36:39], a[164:167], v[164:167], v[36:39]
    s_waitcnt lgkmcnt(7)
    v_add_f32 v150, v150, v26
    v_cvt_pk_bf16_f32 v101, v26, v27
    v_mfma_f32_16x16x32_bf16 v[36:39], a[168:171], v[168:171], v[36:39]
    s_waitcnt lgkmcnt(6)
    ds_read_b64_tr_b16 a[188:189], v251
    v_add_f32 v150, v150, v27
    v_mfma_f32_16x16x32_bf16 v[36:39], a[172:175], v[172:175], v[36:39]
    v_exp_f32 v28, v28
    v_mfma_f32_16x16x32_bf16 v[40:43], a[172:175], v[188:191], v[132:135]
    ds_read_b64_tr_b16 a[190:191], v251 offset:4096
    v_exp_f32 v29, v29
    v_mfma_f32_16x16x32_bf16 v[40:43], a[168:171], v[184:187], v[40:43]
    s_waitcnt vmcnt(4)
    v_exp_f32 v30, v30
    v_add_f32 v151, v151, v28
    v_mfma_f32_16x16x32_bf16 v[40:43], a[164:167], v[180:183], v[40:43]
    buffer_load_dwordx4 v15, s[12:15], s91 offen offset:3072 nt lds
    v_cvt_pk_bf16_f32 v104, v28, v29
    v_mfma_f32_16x16x32_bf16 v[40:43], a[160:163], v[176:179], v[40:43]
    v_exp_f32 v31, v31
    v_add_f32 v151, v151, v29
    v_mfma_f32_16x16x32_bf16 v[44:47], a[160:163], v[192:195], v[136:139]
    v_add_f32 v151, v151, v30
    v_cvt_pk_bf16_f32 v105, v30, v31
    v_mfma_f32_16x16x32_bf16 v[44:47], a[164:167], v[196:199], v[44:47]
    v_add_f32 v151, v151, v31
    v_exp_f32 v32, v32
    v_mfma_f32_16x16x32_bf16 v[44:47], a[168:171], v[200:203], v[44:47]
    v_exp_f32 v33, v33
    v_mfma_f32_16x16x32_bf16 v[44:47], a[172:175], v[204:207], v[44:47]
    v_exp_f32 v34, v34
    v_add_f32 v152, v152, v32
    v_mfma_f32_16x16x32_bf16 v[48:51], a[172:175], v[220:223], v[140:143]
    v_exp_f32 v35, v35
    v_cvt_pk_bf16_f32 v108, v32, v33
    v_mfma_f32_16x16x32_bf16 v[48:51], a[168:171], v[216:219], v[48:51]
    v_exp_f32 v36, v36
    v_mfma_f32_16x16x32_bf16 v[48:51], a[164:167], v[212:215], v[48:51]
    v_exp_f32 v37, v37
    v_add_f32 v152, v152, v33
    v_mfma_f32_16x16x32_bf16 v[48:51], a[160:163], v[208:211], v[48:51]
    s_add_u32 m0, m0, 0x1000
    v_exp_f32 v38, v38
    v_mfma_f32_16x16x32_bf16 v[52:55], a[160:163], v[224:227], v[144:147]
    s_add_u32 s91, s77, 0xd000
    v_exp_f32 v39, v39
    v_add_f32 v152, v152, v34
    v_mfma_f32_16x16x32_bf16 v[52:55], a[164:167], v[228:231], v[52:55]
    s_xor_b32 s91, s91, s47
    v_cvt_pk_bf16_f32 v109, v34, v35
    v_add_f32 v152, v152, v35
    v_mfma_f32_16x16x32_bf16 v[52:55], a[168:171], v[232:235], v[52:55]
    s_waitcnt vmcnt(4)
    v_add_f32 v148, v148, v36
    v_cvt_pk_bf16_f32 v94, v36, v37
    v_add_f32 v148, v148, v37
    v_mfma_f32_16x16x32_bf16 v[52:55], a[172:175], v[236:239], v[52:55]
    s_waitcnt lgkmcnt(6)
    ds_read_b128 a[160:163], v241
    buffer_load_dwordx4 v3, s[12:15], s91 offen nt lds
    v_add_f32 v148, v148, v38
    v_mfma_f32_16x16x32_bf16 a[40:43], a[176:179], v[56:59], 0
    s_waitcnt lgkmcnt(5)
    v_cvt_pk_bf16_f32 v95, v38, v39
    v_add_f32 v148, v148, v39
    v_mfma_f32_16x16x32_bf16 a[40:43], a[180:183], v[76:79], a[40:43]
    ds_read_b128 a[164:167], v243
    v_exp_f32 v40, v40
    v_mfma_f32_16x16x32_bf16 a[44:47], a[180:183], v[80:83], 0
    v_exp_f32 v41, v41
    v_mfma_f32_16x16x32_bf16 a[44:47], a[176:179], v[60:63], a[44:47]
    ds_read_b128 a[168:171], v241 offset:512
    v_exp_f32 v42, v42
    v_mfma_f32_16x16x32_bf16 a[48:51], a[176:179], v[64:67], 0
    v_exp_f32 v43, v43
    v_mfma_f32_16x16x32_bf16 a[48:51], a[180:183], v[84:87], a[48:51]
    ds_read_b128 a[172:175], v243 offset:512
    v_add_f32 v149, v149, v40
    v_cvt_pk_bf16_f32 v98, v40, v41
    v_mfma_f32_16x16x32_bf16 a[52:55], a[180:183], v[88:91], 0
    v_add_f32 v149, v149, v41
    v_add_f32 v149, v149, v42
    v_cvt_pk_bf16_f32 v99, v42, v43
    v_mfma_f32_16x16x32_bf16 a[52:55], a[176:179], v[68:71], a[52:55]
    v_add_f32 v149, v149, v43
    v_mfma_f32_16x16x32_bf16 a[56:59], a[176:179], v[72:75], 0
    s_waitcnt lgkmcnt(6)
    ds_read_b64_tr_b16 a[176:177], v244 offset:512
    v_exp_f32 v44, v44
    v_mfma_f32_16x16x32_bf16 a[76:79], a[184:187], v[72:75], 0
    v_exp_f32 v45, v45
    v_mfma_f32_16x16x32_bf16 a[72:75], a[184:187], v[68:71], 0
    s_waitcnt lgkmcnt(5)
    ds_read_b64_tr_b16 a[178:179], v244 offset:4608
    v_exp_f32 v46, v46
    v_mfma_f32_16x16x32_bf16 a[72:75], a[188:191], v[88:91], a[72:75]
    v_exp_f32 v47, v47
    v_mfma_f32_16x16x32_bf16 a[68:71], a[188:191], v[84:87], 0
    s_waitcnt vmcnt(4)
    ds_read_b64_tr_b16 a[180:181], v245 offset:512
    v_add_f32 v150, v150, v44
    v_cvt_pk_bf16_f32 v102, v44, v45
    v_mfma_f32_16x16x32_bf16 a[68:71], a[184:187], v[64:67], a[68:71]
    buffer_load_dwordx4 v15, s[12:15], s91 offen offset:1024 nt lds
    v_add_f32 v150, v150, v45
    v_add_f32 v150, v150, v46
    v_mfma_f32_16x16x32_bf16 a[64:67], a[184:187], v[60:63], 0
    ds_read_b64_tr_b16 a[182:183], v245 offset:4608
    v_cvt_pk_bf16_f32 v103, v46, v47
    v_mfma_f32_16x16x32_bf16 a[64:67], a[188:191], v[80:83], a[64:67]
    v_add_f32 v150, v150, v47
    v_exp_f32 v48, v48
    v_mfma_f32_16x16x32_bf16 a[60:63], a[188:191], v[76:79], 0
    v_exp_f32 v49, v49
    v_mfma_f32_16x16x32_bf16 a[60:63], a[184:187], v[56:59], a[60:63]
    s_waitcnt lgkmcnt(7)
    ds_read_b64_tr_b16 a[184:185], v246 offset:512
    v_exp_f32 v50, v50
    v_mfma_f32_16x16x32_bf16 v[16:19], a[160:163], v[160:163], v[128:131]
    s_waitcnt lgkmcnt(7)
    ds_read_b64_tr_b16 a[186:187], v246 offset:4608
    v_add_f32 v151, v151, v48
    v_mfma_f32_16x16x32_bf16 v[16:19], a[164:167], v[164:167], v[16:19]
    s_waitcnt lgkmcnt(7)
    v_exp_f32 v51, v51
    v_cvt_pk_bf16_f32 v106, v48, v49
    v_mfma_f32_16x16x32_bf16 v[16:19], a[168:171], v[168:171], v[16:19]
    s_waitcnt lgkmcnt(6)
    ds_read_b64_tr_b16 a[188:189], v247 offset:512
    v_add_f32 v151, v151, v49
    v_add_f32 v151, v151, v50
    v_mfma_f32_16x16x32_bf16 v[16:19], a[172:175], v[172:175], v[16:19]
    v_cvt_pk_bf16_f32 v107, v50, v51
    v_add_f32 v151, v151, v51
    v_mfma_f32_16x16x32_bf16 v[20:23], a[172:175], v[188:191], v[132:135]
    ds_read_b64_tr_b16 a[190:191], v247 offset:4608
    v_add_u32 v244, 0xfffe8000, v244
    v_add_u32 v245, 0xfffe8000, v245
    v_mfma_f32_16x16x32_bf16 v[20:23], a[168:171], v[184:187], v[20:23]
    v_add_u32 v246, 0xfffe8000, v246
    v_add_u32 v247, 0xfffe8000, v247
    v_mfma_f32_16x16x32_bf16 v[20:23], a[164:167], v[180:183], v[20:23]
    v_exp_f32 v52, v52
    v_mfma_f32_16x16x32_bf16 v[20:23], a[160:163], v[176:179], v[20:23]
    v_exp_f32 v53, v53
    v_mfma_f32_16x16x32_bf16 v[24:27], a[160:163], v[192:195], v[136:139]
    s_waitcnt vmcnt(4)
    v_exp_f32 v54, v54
    v_add_f32 v152, v152, v52
    v_mfma_f32_16x16x32_bf16 v[24:27], a[164:167], v[196:199], v[24:27]
    buffer_load_dwordx4 v3, s[12:15], s91 offen offset:2048 nt lds
    v_exp_f32 v55, v55
    v_mfma_f32_16x16x32_bf16 v[24:27], a[168:171], v[200:203], v[24:27]
    v_exp_f32 v16, v16
    v_mfma_f32_16x16x32_bf16 v[24:27], a[172:175], v[204:207], v[24:27]
    v_exp_f32 v17, v17
    v_cvt_pk_bf16_f32 v110, v52, v53
    v_mfma_f32_16x16x32_bf16 v[28:31], a[172:175], v[220:223], v[140:143]
    v_exp_f32 v18, v18
    v_mfma_f32_16x16x32_bf16 v[28:31], a[168:171], v[216:219], v[28:31]
    v_exp_f32 v19, v19
    v_add_f32 v152, v152, v53
    v_mfma_f32_16x16x32_bf16 v[28:31], a[164:167], v[212:215], v[28:31]
    v_exp_f32 v20, v20
    v_mfma_f32_16x16x32_bf16 v[28:31], a[160:163], v[208:211], v[28:31]
    s_waitcnt lgkmcnt(6)
    ds_read_b128 a[160:163], v241 offset:4096
    v_exp_f32 v21, v21
    v_mfma_f32_16x16x32_bf16 a[80:83], a[176:179], v[56:59], 0
    s_waitcnt lgkmcnt(5)
    v_exp_f32 v22, v22
    v_add_f32 v152, v152, v54
    v_mfma_f32_16x16x32_bf16 a[80:83], a[180:183], v[76:79], a[80:83]
    ds_read_b128 a[164:167], v243 offset:4096
    v_cvt_pk_bf16_f32 v111, v54, v55
    v_mfma_f32_16x16x32_bf16 a[84:87], a[180:183], v[80:83], 0
    v_exp_f32 v23, v23
    v_add_f32 v152, v152, v55
    v_mfma_f32_16x16x32_bf16 a[84:87], a[176:179], v[60:63], a[84:87]
    ds_read_b128 a[168:171], v241 offset:4608
    v_add_f32 v148, v148, v16
    v_mfma_f32_16x16x32_bf16 a[88:91], a[176:179], v[64:67], 0
    v_exp_f32 v24, v24
    v_cvt_pk_bf16_f32 v112, v16, v17
    v_mfma_f32_16x16x32_bf16 a[88:91], a[180:183], v[84:87], a[88:91]
    ds_read_b128 a[172:175], v243 offset:4608
    v_add_u32 v241, 0xfffe8000, v241
    v_mfma_f32_16x16x32_bf16 a[92:95], a[180:183], v[88:91], 0
    s_waitcnt vmcnt(4)
    v_add_u32 v243, 0xfffe8000, v243
    v_exp_f32 v25, v25
    v_mfma_f32_16x16x32_bf16 a[92:95], a[176:179], v[68:71], a[92:95]
    buffer_load_dwordx4 v15, s[12:15], s91 offen offset:3072 nt lds
    v_exp_f32 v26, v26
    v_mfma_f32_16x16x32_bf16 a[96:99], a[176:179], v[72:75], 0
    s_waitcnt lgkmcnt(6)
    ds_read_b64_tr_b16 a[176:177], v248 offset:512
    v_add_f32 v148, v148, v17
    v_mfma_f32_16x16x32_bf16 a[116:119], a[184:187], v[72:75], 0
    v_exp_f32 v27, v27
    v_add_f32 v148, v148, v18
    v_mfma_f32_16x16x32_bf16 a[112:115], a[184:187], v[68:71], 0
    s_waitcnt lgkmcnt(5)
    ds_read_b64_tr_b16 a[178:179], v248 offset:4608
    v_cvt_pk_bf16_f32 v113, v18, v19
    v_mfma_f32_16x16x32_bf16 a[112:115], a[188:191], v[88:91], a[112:115]
    v_exp_f32 v28, v28
    v_add_f32 v148, v148, v19
    v_mfma_f32_16x16x32_bf16 a[108:111], a[188:191], v[84:87], 0
    ds_read_b64_tr_b16 a[180:181], v249 offset:512
    v_add_f32 v149, v149, v20
    v_mfma_f32_16x16x32_bf16 a[108:111], a[184:187], v[64:67], a[108:111]
    v_exp_f32 v29, v29
    v_cvt_pk_bf16_f32 v116, v20, v21
    v_mfma_f32_16x16x32_bf16 a[104:107], a[184:187], v[60:63], 0
    ds_read_b64_tr_b16 a[182:183], v249 offset:4608
    v_add_u32 v248, 0xfffe8000, v248
    v_add_u32 v249, 0xfffe8000, v249
    v_mfma_f32_16x16x32_bf16 a[104:107], a[188:191], v[80:83], a[104:107]
    v_exp_f32 v30, v30
    v_mfma_f32_16x16x32_bf16 a[100:103], a[188:191], v[76:79], 0
    v_exp_f32 v31, v31
    v_add_f32 v149, v149, v21
    v_mfma_f32_16x16x32_bf16 a[100:103], a[184:187], v[56:59], a[100:103]
    s_waitcnt lgkmcnt(7)
    ds_read_b64_tr_b16 a[184:185], v250 offset:512
    v_add_f32 v149, v149, v22
    v_mfma_f32_16x16x32_bf16 v[36:39], a[160:163], v[160:163], v[128:131]
    s_waitcnt lgkmcnt(7)
    ds_read_b64_tr_b16 a[186:187], v250 offset:4608
    v_cvt_pk_bf16_f32 v117, v22, v23
    v_add_f32 v149, v149, v23
    v_mfma_f32_16x16x32_bf16 v[36:39], a[164:167], v[164:167], v[36:39]
    s_waitcnt lgkmcnt(7)
    v_add_f32 v150, v150, v24
    v_cvt_pk_bf16_f32 v120, v24, v25
    v_mfma_f32_16x16x32_bf16 v[36:39], a[168:171], v[168:171], v[36:39]
    s_waitcnt lgkmcnt(6)
    ds_read_b64_tr_b16 a[188:189], v251 offset:512
    v_add_f32 v150, v150, v25
    v_add_f32 v150, v150, v26
    v_mfma_f32_16x16x32_bf16 v[36:39], a[172:175], v[172:175], v[36:39]
    v_cvt_pk_bf16_f32 v121, v26, v27
    v_add_f32 v150, v150, v27
    v_add_f32 v151, v151, v28
    v_mfma_f32_16x16x32_bf16 v[40:43], a[172:175], v[188:191], v[132:135]
    ds_read_b64_tr_b16 a[190:191], v251 offset:4608
    v_add_u32 v250, 0xfffe8000, v250
    v_mfma_f32_16x16x32_bf16 v[40:43], a[168:171], v[184:187], v[40:43]
    v_add_u32 v251, 0xfffe8000, v251
    v_cvt_pk_bf16_f32 v124, v28, v29
    v_add_f32 v151, v151, v29
    v_mfma_f32_16x16x32_bf16 v[40:43], a[164:167], v[180:183], v[40:43]
    v_add_f32 v151, v151, v30
    v_cvt_pk_bf16_f32 v125, v30, v31
    v_mfma_f32_16x16x32_bf16 v[40:43], a[160:163], v[176:179], v[40:43]
    v_add_f32 v151, v151, v31
    v_mfma_f32_16x16x32_bf16 v[44:47], a[160:163], v[192:195], v[136:139]
    v_mfma_f32_16x16x32_bf16 v[44:47], a[164:167], v[196:199], v[44:47]
    v_mfma_f32_16x16x32_bf16 v[44:47], a[168:171], v[200:203], v[44:47]
    v_mfma_f32_16x16x32_bf16 v[44:47], a[172:175], v[204:207], v[44:47]
    v_mfma_f32_16x16x32_bf16 v[48:51], a[172:175], v[220:223], v[140:143]
    v_mfma_f32_16x16x32_bf16 v[48:51], a[168:171], v[216:219], v[48:51]
    s_waitcnt vmcnt(8) lgkmcnt(0)
    v_mfma_f32_16x16x32_bf16 v[48:51], a[164:167], v[212:215], v[48:51]
    s_barrier
    v_mfma_f32_16x16x32_bf16 v[48:51], a[160:163], v[208:211], v[48:51]
    v_mfma_f32_16x16x32_bf16 a[120:123], a[176:179], v[56:59], 0
    s_add_u32 m0, s78, 0x18000
    ds_read_b128 a[160:163], v240
    v_mfma_f32_16x16x32_bf16 a[120:123], a[180:183], v[76:79], a[120:123]
    s_add_u32 s91, s77, 0x8000
    ds_read_b128 a[164:167], v242
    v_mfma_f32_16x16x32_bf16 a[124:127], a[180:183], v[80:83], 0
    s_xor_b32 s91, s91, s47
    v_exp_f32 v36, v36
    v_mfma_f32_16x16x32_bf16 a[124:127], a[176:179], v[60:63], a[124:127]
    s_waitcnt vmcnt(4)
    ds_read_b128 a[168:171], v240 offset:512
    buffer_load_dwordx4 v3, s[16:19], s91 offen nt lds
    v_mfma_f32_16x16x32_bf16 a[128:131], a[176:179], v[64:67], 0
    v_exp_f32 v37, v37
    v_mfma_f32_16x16x32_bf16 a[128:131], a[180:183], v[84:87], a[128:131]
    ds_read_b128 a[172:175], v242 offset:512
    v_add_f32 v148, v148, v36
    v_mfma_f32_16x16x32_bf16 a[132:135], a[180:183], v[88:91], 0
    v_exp_f32 v38, v38
    v_mfma_f32_16x16x32_bf16 a[132:135], a[176:179], v[68:71], a[132:135]
    v_exp_f32 v39, v39
    v_cvt_pk_bf16_f32 v114, v36, v37
    v_mfma_f32_16x16x32_bf16 a[136:139], a[176:179], v[72:75], 0
    ds_read_b64_tr_b16 a[176:177], v244
    v_add_f32 v148, v148, v37
    v_mfma_f32_16x16x32_bf16 a[156:159], a[184:187], v[72:75], 0
    v_exp_f32 v40, v40
    v_mfma_f32_16x16x32_bf16 a[152:155], a[184:187], v[68:71], 0
    s_waitcnt vmcnt(4)
    ds_read_b64_tr_b16 a[178:179], v244 offset:4096
    v_exp_f32 v41, v41
    v_mfma_f32_16x16x32_bf16 a[152:155], a[188:191], v[88:91], a[152:155]
    buffer_load_dwordx4 v15, s[16:19], s91 offen offset:1024 nt lds
    v_add_f32 v148, v148, v38
    v_mfma_f32_16x16x32_bf16 a[148:151], a[188:191], v[84:87], 0
    ds_read_b64_tr_b16 a[180:181], v245
    v_cvt_pk_bf16_f32 v115, v38, v39
    v_mfma_f32_16x16x32_bf16 a[148:151], a[184:187], v[64:67], a[148:151]
    v_exp_f32 v42, v42
    v_mfma_f32_16x16x32_bf16 a[144:147], a[184:187], v[60:63], 0
    ds_read_b64_tr_b16 a[182:183], v245 offset:4096
    v_exp_f32 v43, v43
    v_mfma_f32_16x16x32_bf16 a[144:147], a[188:191], v[80:83], a[144:147]
    v_exp_f32 v44, v44
    v_mfma_f32_16x16x32_bf16 a[140:143], a[188:191], v[76:79], 0
    v_exp_f32 v45, v45
    v_mfma_f32_16x16x32_bf16 a[140:143], a[184:187], v[56:59], a[140:143]
    s_waitcnt lgkmcnt(7)
    ds_read_b64_tr_b16 a[184:185], v246
    v_exp_f32 v46, v46
    v_mfma_f32_16x16x32_bf16 v[16:19], a[160:163], v[160:163], v[128:131]
    s_waitcnt lgkmcnt(7)
    ds_read_b64_tr_b16 a[186:187], v246 offset:4096
    v_add_f32 v148, v148, v39
    v_mfma_f32_16x16x32_bf16 v[16:19], a[164:167], v[164:167], v[16:19]
    s_waitcnt lgkmcnt(7)
    v_exp_f32 v47, v47
    v_mfma_f32_16x16x32_bf16 v[16:19], a[168:171], v[168:171], v[16:19]
    s_waitcnt lgkmcnt(6)
    ds_read_b64_tr_b16 a[188:189], v247
    v_add_f32 v149, v149, v40
    v_mfma_f32_16x16x32_bf16 v[16:19], a[172:175], v[172:175], v[16:19]
    s_waitcnt vmcnt(4)
    v_exp_f32 v48, v48
    v_cvt_pk_bf16_f32 v118, v40, v41
    v_mfma_f32_16x16x32_bf16 v[20:23], a[172:175], v[188:191], v[132:135]
    ds_read_b64_tr_b16 a[190:191], v247 offset:4096
    buffer_load_dwordx4 v3, s[16:19], s91 offen offset:2048 nt lds
    v_mfma_f32_16x16x32_bf16 v[20:23], a[168:171], v[184:187], v[20:23]
    v_exp_f32 v49, v49
    v_mfma_f32_16x16x32_bf16 v[20:23], a[164:167], v[180:183], v[20:23]
    v_exp_f32 v50, v50
    v_mfma_f32_16x16x32_bf16 v[20:23], a[160:163], v[176:179], v[20:23]
    v_exp_f32 v51, v51
    v_add_f32 v149, v149, v41
    v_mfma_f32_16x16x32_bf16 v[24:27], a[160:163], v[192:195], v[136:139]
    v_add_f32 v149, v149, v42
    v_cvt_pk_bf16_f32 v119, v42, v43
    v_mfma_f32_16x16x32_bf16 v[24:27], a[164:167], v[196:199], v[24:27]
    v_add_f32 v149, v149, v43
    v_add_f32 v150, v150, v44
    v_mfma_f32_16x16x32_bf16 v[24:27], a[168:171], v[200:203], v[24:27]
    v_cvt_pk_bf16_f32 v122, v44, v45
    v_add_f32 v150, v150, v45
    v_add_f32 v150, v150, v46
    v_mfma_f32_16x16x32_bf16 v[24:27], a[172:175], v[204:207], v[24:27]
    v_cvt_pk_bf16_f32 v123, v46, v47
    v_add_f32 v150, v150, v47
    v_mfma_f32_16x16x32_bf16 v[28:31], a[172:175], v[220:223], v[140:143]
    v_add_f32 v151, v151, v48
    v_cvt_pk_bf16_f32 v126, v48, v49
    v_mfma_f32_16x16x32_bf16 v[28:31], a[168:171], v[216:219], v[28:31]
    v_add_f32 v151, v151, v49
    v_add_f32 v151, v151, v50
    v_mfma_f32_16x16x32_bf16 v[28:31], a[164:167], v[212:215], v[28:31]
    v_cvt_pk_bf16_f32 v127, v50, v51
    v_add_f32 v151, v151, v51
    v_mfma_f32_16x16x32_bf16 v[28:31], a[160:163], v[208:211], v[28:31]
    s_waitcnt vmcnt(4)
    v_exp_f32 v16, v16
    v_mfma_f32_16x16x32_bf16 v[32:35], a[160:163], v[224:227], v[144:147]
    buffer_load_dwordx4 v15, s[16:19], s91 offen offset:3072 nt lds
    v_mfma_f32_16x16x32_bf16 v[32:35], a[164:167], v[228:231], v[32:35]
    v_exp_f32 v17, v17
    v_add_f32 v148, v148, v16
    v_mfma_f32_16x16x32_bf16 v[32:35], a[168:171], v[232:235], v[32:35]
    v_exp_f32 v18, v18
    v_mfma_f32_16x16x32_bf16 v[32:35], a[172:175], v[236:239], v[32:35]
    s_waitcnt lgkmcnt(6)
    ds_read_b128 a[160:163], v240 offset:4096
    v_cvt_pk_bf16_f32 v56, v16, v17
    v_mfma_f32_16x16x32_bf16 a[0:3], a[176:179], v[92:95], a[0:3]
    s_waitcnt lgkmcnt(5)
    v_exp_f32 v19, v19
    v_mfma_f32_16x16x32_bf16 a[0:3], a[180:183], v[112:115], a[0:3]
    ds_read_b128 a[164:167], v242 offset:4096
    v_add_f32 v148, v148, v17
    v_add_f32 v148, v148, v18
    v_mfma_f32_16x16x32_bf16 a[4:7], a[180:183], v[116:119], a[4:7]
    v_cvt_pk_bf16_f32 v57, v18, v19
    v_add_f32 v148, v148, v19
    v_mfma_f32_16x16x32_bf16 a[4:7], a[176:179], v[96:99], a[4:7]
    s_add_u32 m0, m0, 0x1000
    ds_read_b128 a[168:171], v240 offset:4608
    v_mfma_f32_16x16x32_bf16 a[8:11], a[176:179], v[100:103], a[8:11]
    s_add_u32 s91, s77, 0x9000
    v_exp_f32 v20, v20
    v_mfma_f32_16x16x32_bf16 a[8:11], a[180:183], v[120:123], a[8:11]
    s_xor_b32 s91, s91, s47
    ds_read_b128 a[172:175], v242 offset:4608
    v_exp_f32 v21, v21
    v_mfma_f32_16x16x32_bf16 a[12:15], a[180:183], v[124:127], a[12:15]
    s_waitcnt vmcnt(4)
    v_exp_f32 v22, v22
    v_mfma_f32_16x16x32_bf16 a[12:15], a[176:179], v[104:107], a[12:15]
    buffer_load_dwordx4 v3, s[16:19], s91 offen nt lds
    v_add_f32 v149, v149, v20
    v_mfma_f32_16x16x32_bf16 a[16:19], a[176:179], v[108:111], a[16:19]
    s_waitcnt lgkmcnt(6)
    ds_read_b64_tr_b16 a[176:177], v248
    v_exp_f32 v23, v23
    v_mfma_f32_16x16x32_bf16 a[36:39], a[184:187], v[108:111], a[36:39]
    v_cvt_pk_bf16_f32 v60, v20, v21
    v_add_f32 v149, v149, v21
    v_mfma_f32_16x16x32_bf16 a[32:35], a[184:187], v[104:107], a[32:35]
    s_waitcnt lgkmcnt(5)
    ds_read_b64_tr_b16 a[178:179], v248 offset:4096
    v_add_f32 v149, v149, v22
    v_mfma_f32_16x16x32_bf16 a[32:35], a[188:191], v[124:127], a[32:35]
    v_cvt_pk_bf16_f32 v61, v22, v23
    v_add_f32 v149, v149, v23
    v_mfma_f32_16x16x32_bf16 a[28:31], a[188:191], v[120:123], a[28:31]
    ds_read_b64_tr_b16 a[180:181], v249
    v_exp_f32 v24, v24
    v_mfma_f32_16x16x32_bf16 a[28:31], a[184:187], v[100:103], a[28:31]
    v_exp_f32 v25, v25
    v_mfma_f32_16x16x32_bf16 a[24:27], a[184:187], v[96:99], a[24:27]
    ds_read_b64_tr_b16 a[182:183], v249 offset:4096
    v_add_f32 v150, v150, v24
    v_mfma_f32_16x16x32_bf16 a[24:27], a[188:191], v[116:119], a[24:27]
    v_exp_f32 v26, v26
    v_cvt_pk_bf16_f32 v64, v24, v25
    v_mfma_f32_16x16x32_bf16 a[20:23], a[188:191], v[112:115], a[20:23]
    v_exp_f32 v27, v27
    v_mfma_f32_16x16x32_bf16 a[20:23], a[184:187], v[92:95], a[20:23]
    s_waitcnt lgkmcnt(7)
    ds_read_b64_tr_b16 a[184:185], v250
    v_add_f32 v150, v150, v25
    v_mfma_f32_16x16x32_bf16 v[36:39], a[160:163], v[160:163], v[128:131]
    s_waitcnt lgkmcnt(7)
    s_waitcnt vmcnt(4)
    ds_read_b64_tr_b16 a[186:187], v250 offset:4096
    v_add_f32 v150, v150, v26
    v_mfma_f32_16x16x32_bf16 v[36:39], a[164:167], v[164:167], v[36:39]
    s_waitcnt lgkmcnt(7)
    buffer_load_dwordx4 v15, s[16:19], s91 offen offset:1024 nt lds
    v_cvt_pk_bf16_f32 v65, v26, v27
    v_add_f32 v150, v150, v27
    v_mfma_f32_16x16x32_bf16 v[36:39], a[168:171], v[168:171], v[36:39]
    s_waitcnt lgkmcnt(6)
    ds_read_b64_tr_b16 a[188:189], v251
    v_add_u32 v240, 0x10000, v240
    v_mfma_f32_16x16x32_bf16 v[36:39], a[172:175], v[172:175], v[36:39]
    v_exp_f32 v28, v28
    v_mfma_f32_16x16x32_bf16 v[40:43], a[172:175], v[188:191], v[132:135]
    ds_read_b64_tr_b16 a[190:191], v251 offset:4096
    v_add_u32 v242, 0x10000, v242
    v_mfma_f32_16x16x32_bf16 v[40:43], a[168:171], v[184:187], v[40:43]
    v_exp_f32 v29, v29
    v_add_f32 v151, v151, v28
    v_mfma_f32_16x16x32_bf16 v[40:43], a[164:167], v[180:183], v[40:43]
    v_exp_f32 v30, v30
    v_mfma_f32_16x16x32_bf16 v[40:43], a[160:163], v[176:179], v[40:43]
    v_exp_f32 v31, v31
    v_mfma_f32_16x16x32_bf16 v[44:47], a[160:163], v[192:195], v[136:139]
    v_cvt_pk_bf16_f32 v68, v28, v29
    v_add_f32 v151, v151, v29
    v_add_f32 v151, v151, v30
    v_mfma_f32_16x16x32_bf16 v[44:47], a[164:167], v[196:199], v[44:47]
    v_cvt_pk_bf16_f32 v69, v30, v31
    v_add_f32 v151, v151, v31
    v_mfma_f32_16x16x32_bf16 v[44:47], a[168:171], v[200:203], v[44:47]
    v_exp_f32 v32, v32
    v_mfma_f32_16x16x32_bf16 v[44:47], a[172:175], v[204:207], v[44:47]
    s_waitcnt vmcnt(4)
    v_exp_f32 v33, v33
    v_mfma_f32_16x16x32_bf16 v[48:51], a[172:175], v[220:223], v[140:143]
    buffer_load_dwordx4 v3, s[16:19], s91 offen offset:2048 nt lds
    v_exp_f32 v34, v34
    v_mfma_f32_16x16x32_bf16 v[48:51], a[168:171], v[216:219], v[48:51]
    v_exp_f32 v35, v35
    v_mfma_f32_16x16x32_bf16 v[48:51], a[164:167], v[212:215], v[48:51]
    v_exp_f32 v36, v36
    v_mfma_f32_16x16x32_bf16 v[48:51], a[160:163], v[208:211], v[48:51]
    v_exp_f32 v37, v37
    v_add_f32 v152, v152, v32
    v_mfma_f32_16x16x32_bf16 v[52:55], a[160:163], v[224:227], v[144:147]
    v_exp_f32 v38, v38
    v_mfma_f32_16x16x32_bf16 v[52:55], a[164:167], v[228:231], v[52:55]
    v_exp_f32 v39, v39
    v_mfma_f32_16x16x32_bf16 v[52:55], a[168:171], v[232:235], v[52:55]
    v_cvt_pk_bf16_f32 v72, v32, v33
    v_add_f32 v152, v152, v33
    v_mfma_f32_16x16x32_bf16 v[52:55], a[172:175], v[236:239], v[52:55]
    s_waitcnt lgkmcnt(6)
    ds_read_b128 a[160:163], v241
    v_add_f32 v152, v152, v34
    v_cvt_pk_bf16_f32 v73, v34, v35
    v_mfma_f32_16x16x32_bf16 a[40:43], a[176:179], v[92:95], a[40:43]
    s_waitcnt lgkmcnt(5)
    v_add_f32 v152, v152, v35
    v_add_f32 v148, v148, v36
    v_mfma_f32_16x16x32_bf16 a[40:43], a[180:183], v[112:115], a[40:43]
    ds_read_b128 a[164:167], v243
    v_cvt_pk_bf16_f32 v58, v36, v37
    v_mfma_f32_16x16x32_bf16 a[44:47], a[180:183], v[116:119], a[44:47]
    v_add_f32 v148, v148, v37
    v_add_f32 v148, v148, v38
    v_mfma_f32_16x16x32_bf16 a[44:47], a[176:179], v[96:99], a[44:47]
    s_waitcnt vmcnt(4)
    ds_read_b128 a[168:171], v241 offset:512
    v_cvt_pk_bf16_f32 v59, v38, v39
    v_add_f32 v148, v148, v39
    v_mfma_f32_16x16x32_bf16 a[48:51], a[176:179], v[100:103], a[48:51]
    buffer_load_dwordx4 v15, s[16:19], s91 offen offset:3072 nt lds
    v_mfma_f32_16x16x32_bf16 a[48:51], a[180:183], v[120:123], a[48:51]
    ds_read_b128 a[172:175], v243 offset:512
    v_mfma_f32_16x16x32_bf16 a[52:55], a[180:183], v[124:127], a[52:55]
    v_exp_f32 v40, v40
    v_mfma_f32_16x16x32_bf16 a[52:55], a[176:179], v[104:107], a[52:55]
    v_exp_f32 v41, v41
    v_mfma_f32_16x16x32_bf16 a[56:59], a[176:179], v[108:111], a[56:59]
    s_waitcnt lgkmcnt(6)
    ds_read_b64_tr_b16 a[176:177], v244 offset:512
    v_add_f32 v149, v149, v40
    v_mfma_f32_16x16x32_bf16 a[76:79], a[184:187], v[108:111], a[76:79]
    v_exp_f32 v42, v42
    v_mfma_f32_16x16x32_bf16 a[72:75], a[184:187], v[104:107], a[72:75]
    s_waitcnt lgkmcnt(5)
    ds_read_b64_tr_b16 a[178:179], v244 offset:4608
    v_exp_f32 v43, v43
    v_mfma_f32_16x16x32_bf16 a[72:75], a[188:191], v[124:127], a[72:75]
    s_add_u32 m0, s78, 0x20000
    v_cvt_pk_bf16_f32 v62, v40, v41
    v_add_f32 v149, v149, v41
    v_mfma_f32_16x16x32_bf16 a[68:71], a[188:191], v[120:123], a[68:71]
    s_add_u32 s91, s77, 0x10000
    ds_read_b64_tr_b16 a[180:181], v245 offset:512
    v_add_f32 v149, v149, v42
    v_mfma_f32_16x16x32_bf16 a[68:71], a[184:187], v[100:103], a[68:71]
    s_xor_b32 s91, s91, s47
    v_cvt_pk_bf16_f32 v63, v42, v43
    v_add_f32 v149, v149, v43
    v_mfma_f32_16x16x32_bf16 a[64:67], a[184:187], v[96:99], a[64:67]
    s_waitcnt vmcnt(4)
    ds_read_b64_tr_b16 a[182:183], v245 offset:4608
    v_mfma_f32_16x16x32_bf16 a[64:67], a[188:191], v[116:119], a[64:67]
    buffer_load_dwordx4 v3, s[12:15], s91 offen nt lds
    v_mfma_f32_16x16x32_bf16 a[60:63], a[188:191], v[112:115], a[60:63]
    v_exp_f32 v44, v44
    v_mfma_f32_16x16x32_bf16 a[60:63], a[184:187], v[92:95], a[60:63]
    s_waitcnt lgkmcnt(7)
    ds_read_b64_tr_b16 a[184:185], v246 offset:512
    v_exp_f32 v45, v45
    v_mfma_f32_16x16x32_bf16 v[16:19], a[160:163], v[160:163], v[128:131]
    s_waitcnt lgkmcnt(7)
    ds_read_b64_tr_b16 a[186:187], v246 offset:4608
    v_add_f32 v150, v150, v44
    v_mfma_f32_16x16x32_bf16 v[16:19], a[164:167], v[164:167], v[16:19]
    s_waitcnt lgkmcnt(7)
    v_exp_f32 v46, v46
    v_mfma_f32_16x16x32_bf16 v[16:19], a[168:171], v[168:171], v[16:19]
    s_waitcnt lgkmcnt(6)
    ds_read_b64_tr_b16 a[188:189], v247 offset:512
    v_cvt_pk_bf16_f32 v66, v44, v45
    v_mfma_f32_16x16x32_bf16 v[16:19], a[172:175], v[172:175], v[16:19]
    v_exp_f32 v47, v47
    v_add_f32 v150, v150, v45
    v_mfma_f32_16x16x32_bf16 v[20:23], a[172:175], v[188:191], v[132:135]
    ds_read_b64_tr_b16 a[190:191], v247 offset:4608
    v_add_f32 v150, v150, v46
    v_mfma_f32_16x16x32_bf16 v[20:23], a[168:171], v[184:187], v[20:23]
    v_cvt_pk_bf16_f32 v67, v46, v47
    v_add_f32 v150, v150, v47
    v_mfma_f32_16x16x32_bf16 v[20:23], a[164:167], v[180:183], v[20:23]
    v_exp_f32 v48, v48
    v_add_u32 v244, 0x10000, v244
    v_mfma_f32_16x16x32_bf16 v[20:23], a[160:163], v[176:179], v[20:23]
    s_waitcnt vmcnt(4)
    v_exp_f32 v49, v49
    v_mfma_f32_16x16x32_bf16 v[24:27], a[160:163], v[192:195], v[136:139]
    buffer_load_dwordx4 v15, s[12:15], s91 offen offset:1024 nt lds
    v_add_f32 v151, v151, v48
    v_mfma_f32_16x16x32_bf16 v[24:27], a[164:167], v[196:199], v[24:27]
    v_exp_f32 v50, v50
    v_mfma_f32_16x16x32_bf16 v[24:27], a[168:171], v[200:203], v[24:27]
    v_exp_f32 v51, v51
    v_cvt_pk_bf16_f32 v70, v48, v49
    v_mfma_f32_16x16x32_bf16 v[24:27], a[172:175], v[204:207], v[24:27]
    v_add_f32 v151, v151, v49
    v_add_f32 v151, v151, v50
    v_mfma_f32_16x16x32_bf16 v[28:31], a[172:175], v[220:223], v[140:143]
    v_cvt_pk_bf16_f32 v71, v50, v51
    v_add_f32 v151, v151, v51
    v_mfma_f32_16x16x32_bf16 v[28:31], a[168:171], v[216:219], v[28:31]
    v_add_u32 v245, 0x10000, v245
    v_add_u32 v246, 0x10000, v246
    v_add_u32 v247, 0x10000, v247
    v_mfma_f32_16x16x32_bf16 v[28:31], a[164:167], v[212:215], v[28:31]
    v_exp_f32 v52, v52
    v_mfma_f32_16x16x32_bf16 v[28:31], a[160:163], v[208:211], v[28:31]
    s_waitcnt lgkmcnt(6)
    ds_read_b128 a[160:163], v241 offset:4096
    v_mfma_f32_16x16x32_bf16 a[80:83], a[176:179], v[92:95], a[80:83]
    s_waitcnt lgkmcnt(5)
    v_exp_f32 v53, v53
    v_mfma_f32_16x16x32_bf16 a[80:83], a[180:183], v[112:115], a[80:83]
    ds_read_b128 a[164:167], v243 offset:4096
    v_exp_f32 v54, v54
    v_mfma_f32_16x16x32_bf16 a[84:87], a[180:183], v[116:119], a[84:87]
    v_exp_f32 v55, v55
    v_mfma_f32_16x16x32_bf16 a[84:87], a[176:179], v[96:99], a[84:87]
    s_waitcnt vmcnt(4)
    ds_read_b128 a[168:171], v241 offset:4608
    v_add_f32 v152, v152, v52
    v_mfma_f32_16x16x32_bf16 a[88:91], a[176:179], v[100:103], a[88:91]
    buffer_load_dwordx4 v3, s[12:15], s91 offen offset:2048 nt lds
    v_cvt_pk_bf16_f32 v74, v52, v53
    v_mfma_f32_16x16x32_bf16 a[88:91], a[180:183], v[120:123], a[88:91]
    ds_read_b128 a[172:175], v243 offset:4608
    v_add_u32 v241, 0x10000, v241
    v_add_u32 v243, 0x10000, v243
    v_mfma_f32_16x16x32_bf16 a[92:95], a[180:183], v[124:127], a[92:95]
    v_exp_f32 v16, v16
    v_mfma_f32_16x16x32_bf16 a[92:95], a[176:179], v[104:107], a[92:95]
    v_exp_f32 v17, v17
    v_mfma_f32_16x16x32_bf16 a[96:99], a[176:179], v[108:111], a[96:99]
    s_waitcnt lgkmcnt(6)
    ds_read_b64_tr_b16 a[176:177], v248 offset:512
    v_exp_f32 v18, v18
    v_mfma_f32_16x16x32_bf16 a[116:119], a[184:187], v[108:111], a[116:119]
    v_exp_f32 v19, v19
    v_mfma_f32_16x16x32_bf16 a[112:115], a[184:187], v[104:107], a[112:115]
    s_waitcnt lgkmcnt(5)
    ds_read_b64_tr_b16 a[178:179], v248 offset:4608
    v_add_f32 v152, v152, v53
    v_mfma_f32_16x16x32_bf16 a[112:115], a[188:191], v[124:127], a[112:115]
    v_exp_f32 v20, v20
    v_mfma_f32_16x16x32_bf16 a[108:111], a[188:191], v[120:123], a[108:111]
    ds_read_b64_tr_b16 a[180:181], v249 offset:512
    v_exp_f32 v21, v21
    v_mfma_f32_16x16x32_bf16 a[108:111], a[184:187], v[100:103], a[108:111]
    v_exp_f32 v22, v22
    v_mfma_f32_16x16x32_bf16 a[104:107], a[184:187], v[96:99], a[104:107]
    s_waitcnt vmcnt(4)
    ds_read_b64_tr_b16 a[182:183], v249 offset:4608
    v_add_u32 v248, 0x10000, v248
    v_mfma_f32_16x16x32_bf16 a[104:107], a[188:191], v[116:119], a[104:107]
    buffer_load_dwordx4 v15, s[12:15], s91 offen offset:3072 nt lds
    v_add_u32 v249, 0x10000, v249
    v_add_f32 v152, v152, v54
    v_mfma_f32_16x16x32_bf16 a[100:103], a[188:191], v[112:115], a[100:103]
    v_exp_f32 v23, v23
    v_mfma_f32_16x16x32_bf16 a[100:103], a[184:187], v[92:95], a[100:103]
    s_waitcnt lgkmcnt(7)
    ds_read_b64_tr_b16 a[184:185], v250 offset:512
    v_cvt_pk_bf16_f32 v75, v54, v55
    v_mfma_f32_16x16x32_bf16 v[36:39], a[160:163], v[160:163], v[128:131]
    s_waitcnt lgkmcnt(7)
    ds_read_b64_tr_b16 a[186:187], v250 offset:4608
    v_add_f32 v152, v152, v55
    v_mfma_f32_16x16x32_bf16 v[36:39], a[164:167], v[164:167], v[36:39]
    s_waitcnt lgkmcnt(7)
    v_exp_f32 v24, v24
    v_add_f32 v148, v148, v16
    v_mfma_f32_16x16x32_bf16 v[36:39], a[168:171], v[168:171], v[36:39]
    s_waitcnt lgkmcnt(6)
    ds_read_b64_tr_b16 a[188:189], v251 offset:512
    v_cvt_pk_bf16_f32 v76, v16, v17
    v_mfma_f32_16x16x32_bf16 v[36:39], a[172:175], v[172:175], v[36:39]
    v_exp_f32 v25, v25
    v_mfma_f32_16x16x32_bf16 v[40:43], a[172:175], v[188:191], v[132:135]
    ds_read_b64_tr_b16 a[190:191], v251 offset:4608
    v_add_u32 v250, 0x10000, v250
    v_mfma_f32_16x16x32_bf16 v[40:43], a[168:171], v[184:187], v[40:43]
    v_add_u32 v251, 0x10000, v251
    v_exp_f32 v26, v26
    v_mfma_f32_16x16x32_bf16 v[40:43], a[164:167], v[180:183], v[40:43]
    v_exp_f32 v27, v27
    v_mfma_f32_16x16x32_bf16 v[40:43], a[160:163], v[176:179], v[40:43]
    v_exp_f32 v28, v28
    v_mfma_f32_16x16x32_bf16 v[44:47], a[160:163], v[192:195], v[136:139]
    v_exp_f32 v29, v29
    v_add_f32 v148, v148, v17
    v_mfma_f32_16x16x32_bf16 v[44:47], a[164:167], v[196:199], v[44:47]
    v_exp_f32 v30, v30
    v_mfma_f32_16x16x32_bf16 v[44:47], a[168:171], v[200:203], v[44:47]
    v_exp_f32 v31, v31
    v_mfma_f32_16x16x32_bf16 v[44:47], a[172:175], v[204:207], v[44:47]
    v_add_f32 v148, v148, v18
    v_cvt_pk_bf16_f32 v77, v18, v19
    v_mfma_f32_16x16x32_bf16 v[48:51], a[172:175], v[220:223], v[140:143]
    v_add_f32 v148, v148, v19
    v_add_f32 v149, v149, v20
    v_cvt_pk_bf16_f32 v80, v20, v21
    v_mfma_f32_16x16x32_bf16 v[48:51], a[168:171], v[216:219], v[48:51]
    s_waitcnt vmcnt(4) lgkmcnt(0)
    v_add_f32 v149, v149, v21
    v_add_f32 v149, v149, v22
    v_mfma_f32_16x16x32_bf16 v[48:51], a[164:167], v[212:215], v[48:51]
    s_barrier
    v_cvt_pk_bf16_f32 v81, v22, v23
    v_add_f32 v149, v149, v23
    v_mfma_f32_16x16x32_bf16 v[48:51], a[160:163], v[208:211], v[48:51]
    v_add_f32 v150, v150, v24
    v_cvt_pk_bf16_f32 v84, v24, v25
    v_add_f32 v150, v150, v25
    v_add_f32 v150, v150, v26
    v_cvt_pk_bf16_f32 v85, v26, v27
    v_add_f32 v150, v150, v27
    v_add_f32 v151, v151, v28
    v_cvt_pk_bf16_f32 v88, v28, v29
    v_add_f32 v151, v151, v29
    v_add_f32 v151, v151, v30
    v_cvt_pk_bf16_f32 v89, v30, v31
    v_add_f32 v151, v151, v31
    v_mfma_f32_16x16x32_bf16 a[120:123], a[176:179], v[92:95], a[120:123]
    s_add_u32 m0, m0, 0x1000
    ds_read_b128 a[160:163], v240
    v_mfma_f32_16x16x32_bf16 a[120:123], a[180:183], v[112:115], a[120:123]
    s_add_u32 s91, s77, 0x11000
    ds_read_b128 a[164:167], v242
    v_exp_f32 v36, v36
    v_mfma_f32_16x16x32_bf16 a[124:127], a[180:183], v[116:119], a[124:127]
    s_xor_b32 s91, s91, s47
    v_exp_f32 v37, v37
    v_mfma_f32_16x16x32_bf16 a[124:127], a[176:179], v[96:99], a[124:127]
    s_waitcnt vmcnt(4)
    ds_read_b128 a[168:171], v240 offset:512
    buffer_load_dwordx4 v3, s[12:15], s91 offen nt lds
    v_add_f32 v148, v148, v36
    v_mfma_f32_16x16x32_bf16 a[128:131], a[176:179], v[100:103], a[128:131]
    v_exp_f32 v38, v38
    v_mfma_f32_16x16x32_bf16 a[128:131], a[180:183], v[120:123], a[128:131]
    ds_read_b128 a[172:175], v242 offset:512
    v_exp_f32 v39, v39
    v_mfma_f32_16x16x32_bf16 a[132:135], a[180:183], v[124:127], a[132:135]
    v_exp_f32 v40, v40
    v_mfma_f32_16x16x32_bf16 a[132:135], a[176:179], v[104:107], a[132:135]
    v_exp_f32 v41, v41
    v_cvt_pk_bf16_f32 v78, v36, v37
    v_mfma_f32_16x16x32_bf16 a[136:139], a[176:179], v[108:111], a[136:139]
    ds_read_b64_tr_b16 a[176:177], v244
    v_exp_f32 v42, v42
    v_mfma_f32_16x16x32_bf16 a[156:159], a[184:187], v[108:111], a[156:159]
    v_exp_f32 v43, v43
    v_mfma_f32_16x16x32_bf16 a[152:155], a[184:187], v[104:107], a[152:155]
    ds_read_b64_tr_b16 a[178:179], v244 offset:4096
    v_exp_f32 v44, v44
    v_mfma_f32_16x16x32_bf16 a[152:155], a[188:191], v[124:127], a[152:155]
    v_exp_f32 v45, v45
    v_mfma_f32_16x16x32_bf16 a[148:151], a[188:191], v[120:123], a[148:151]
    ds_read_b64_tr_b16 a[180:181], v245
    v_exp_f32 v46, v46
    v_mfma_f32_16x16x32_bf16 a[148:151], a[184:187], v[100:103], a[148:151]
    s_waitcnt vmcnt(4)
    v_exp_f32 v47, v47
    v_mfma_f32_16x16x32_bf16 a[144:147], a[184:187], v[96:99], a[144:147]
    ds_read_b64_tr_b16 a[182:183], v245 offset:4096
    buffer_load_dwordx4 v15, s[12:15], s91 offen offset:1024 nt lds
    v_add_f32 v148, v148, v37
    v_mfma_f32_16x16x32_bf16 a[144:147], a[188:191], v[116:119], a[144:147]
    v_exp_f32 v48, v48
    v_mfma_f32_16x16x32_bf16 a[140:143], a[188:191], v[112:115], a[140:143]
    v_exp_f32 v49, v49
    v_add_f32 v148, v148, v38
    v_mfma_f32_16x16x32_bf16 a[140:143], a[184:187], v[92:95], a[140:143]
    s_waitcnt lgkmcnt(7)
    ds_read_b64_tr_b16 a[184:185], v246
    v_exp_f32 v50, v50
    v_mfma_f32_16x16x32_bf16 v[16:19], a[160:163], v[160:163], v[128:131]
    s_waitcnt lgkmcnt(7)
    ds_read_b64_tr_b16 a[186:187], v246 offset:4096
    v_cvt_pk_bf16_f32 v79, v38, v39
    v_mfma_f32_16x16x32_bf16 v[16:19], a[164:167], v[164:167], v[16:19]
    s_waitcnt lgkmcnt(7)
    v_exp_f32 v51, v51
    v_add_f32 v148, v148, v39
    v_mfma_f32_16x16x32_bf16 v[16:19], a[168:171], v[168:171], v[16:19]
    s_waitcnt lgkmcnt(6)
    ds_read_b64_tr_b16 a[188:189], v247
    v_add_f32 v149, v149, v40
    v_mfma_f32_16x16x32_bf16 v[16:19], a[172:175], v[172:175], v[16:19]
    ds_write_b128 v254, a[192:195]
    v_mfma_f32_16x16x32_bf16 v[20:23], a[172:175], v[188:191], v[132:135]
    ds_read_b64_tr_b16 a[190:191], v247 offset:4096
    v_cvt_pk_bf16_f32 v82, v40, v41
    v_mfma_f32_16x16x32_bf16 v[20:23], a[168:171], v[184:187], v[20:23]
    v_add_f32 v149, v149, v41
    v_add_f32 v149, v149, v42
    v_cvt_pk_bf16_f32 v83, v42, v43
    v_mfma_f32_16x16x32_bf16 v[20:23], a[164:167], v[180:183], v[20:23]
    v_add_f32 v149, v149, v43
    v_add_f32 v150, v150, v44
    v_mfma_f32_16x16x32_bf16 v[20:23], a[160:163], v[176:179], v[20:23]
    s_waitcnt vmcnt(4)
    v_cvt_pk_bf16_f32 v86, v44, v45
    v_add_f32 v150, v150, v45
    v_add_f32 v150, v150, v46
    v_mfma_f32_16x16x32_bf16 v[24:27], a[160:163], v[192:195], v[136:139]
    buffer_load_dwordx4 v3, s[12:15], s91 offen offset:2048 nt lds
    v_cvt_pk_bf16_f32 v87, v46, v47
    v_add_f32 v150, v150, v47
    v_mfma_f32_16x16x32_bf16 v[24:27], a[164:167], v[196:199], v[24:27]
    v_add_f32 v151, v151, v48
    v_cvt_pk_bf16_f32 v90, v48, v49
    v_mfma_f32_16x16x32_bf16 v[24:27], a[168:171], v[200:203], v[24:27]
    v_add_f32 v151, v151, v49
    v_add_f32 v151, v151, v50
    v_cvt_pk_bf16_f32 v91, v50, v51
    v_mfma_f32_16x16x32_bf16 v[24:27], a[172:175], v[204:207], v[24:27]
    v_add_f32 v151, v151, v51
    v_mfma_f32_16x16x32_bf16 v[28:31], a[172:175], v[220:223], v[140:143]
    v_exp_f32 v16, v16
    v_mfma_f32_16x16x32_bf16 v[28:31], a[168:171], v[216:219], v[28:31]
    ds_write_b128 v254, a[196:199] offset:1024
    v_mfma_f32_16x16x32_bf16 v[28:31], a[164:167], v[212:215], v[28:31]
    v_exp_f32 v17, v17
    v_add_f32 v148, v148, v16
    v_mfma_f32_16x16x32_bf16 v[28:31], a[160:163], v[208:211], v[28:31]
    v_exp_f32 v18, v18
    v_mfma_f32_16x16x32_bf16 v[32:35], a[160:163], v[224:227], v[144:147]
    v_exp_f32 v19, v19
    v_cvt_pk_bf16_f32 v92, v16, v17
    v_mfma_f32_16x16x32_bf16 v[32:35], a[164:167], v[228:231], v[32:35]
    v_add_f32 v148, v148, v17
    v_add_f32 v148, v148, v18
    v_cvt_pk_bf16_f32 v93, v18, v19
    v_mfma_f32_16x16x32_bf16 v[32:35], a[168:171], v[232:235], v[32:35]
    s_waitcnt vmcnt(4)
    v_add_f32 v148, v148, v19
    v_mfma_f32_16x16x32_bf16 v[32:35], a[172:175], v[236:239], v[32:35]
    s_waitcnt lgkmcnt(8)
    ds_read_b128 a[160:163], v240 offset:4096
    buffer_load_dwordx4 v15, s[12:15], s91 offen offset:3072 nt lds
    v_mfma_f32_16x16x32_bf16 a[0:3], a[176:179], v[56:59], a[0:3]
    s_waitcnt lgkmcnt(7)
    v_exp_f32 v20, v20
    v_mfma_f32_16x16x32_bf16 a[0:3], a[180:183], v[76:79], a[0:3]
    ds_read_b128 a[164:167], v242 offset:4096
    v_exp_f32 v21, v21
    v_mfma_f32_16x16x32_bf16 a[4:7], a[180:183], v[80:83], a[4:7]
    v_exp_f32 v22, v22
    v_mfma_f32_16x16x32_bf16 a[4:7], a[176:179], v[60:63], a[4:7]
    ds_read_b128 a[168:171], v240 offset:4608
    v_exp_f32 v23, v23
    v_mfma_f32_16x16x32_bf16 a[8:11], a[176:179], v[64:67], a[8:11]
    v_add_f32 v149, v149, v20
    v_cvt_pk_bf16_f32 v96, v20, v21
    v_mfma_f32_16x16x32_bf16 a[8:11], a[180:183], v[84:87], a[8:11]
    ds_read_b128 a[172:175], v242 offset:4608
    ds_write_b128 v254, a[200:203] offset:2048
    v_mfma_f32_16x16x32_bf16 a[12:15], a[180:183], v[88:91], a[12:15]
    v_add_f32 v149, v149, v21
    v_add_f32 v149, v149, v22
    v_cvt_pk_bf16_f32 v97, v22, v23
    v_mfma_f32_16x16x32_bf16 a[12:15], a[176:179], v[68:71], a[12:15]
    s_add_u32 m0, s78, 0x8000
    v_add_f32 v149, v149, v23
    v_add_u32 v240, 0x10000, v240
    v_mfma_f32_16x16x32_bf16 a[16:19], a[176:179], v[72:75], a[16:19]
    s_waitcnt lgkmcnt(9)
    s_add_u32 s91, s77, 0x14000
    ds_read_b64_tr_b16 a[176:177], v248
    v_exp_f32 v24, v24
    v_mfma_f32_16x16x32_bf16 a[36:39], a[184:187], v[72:75], a[36:39]
    s_xor_b32 s91, s91, s47
    v_exp_f32 v25, v25
    v_mfma_f32_16x16x32_bf16 a[32:35], a[184:187], v[68:71], a[32:35]
    s_waitcnt lgkmcnt(7)
    s_waitcnt vmcnt(4)
    ds_read_b64_tr_b16 a[178:179], v248 offset:4096
    v_exp_f32 v26, v26
    v_mfma_f32_16x16x32_bf16 a[32:35], a[188:191], v[88:91], a[32:35]
    buffer_load_dwordx4 v3, s[12:15], s91 offen nt lds
    v_add_f32 v150, v150, v24
    v_mfma_f32_16x16x32_bf16 a[28:31], a[188:191], v[84:87], a[28:31]
    ds_read_b64_tr_b16 a[180:181], v249
    v_exp_f32 v27, v27
    v_mfma_f32_16x16x32_bf16 a[28:31], a[184:187], v[64:67], a[28:31]
    v_cvt_pk_bf16_f32 v100, v24, v25
    v_add_f32 v150, v150, v25
    v_mfma_f32_16x16x32_bf16 a[24:27], a[184:187], v[60:63], a[24:27]
    ds_read_b64_tr_b16 a[182:183], v249 offset:4096
    v_add_f32 v150, v150, v26
    v_cvt_pk_bf16_f32 v101, v26, v27
    v_mfma_f32_16x16x32_bf16 a[24:27], a[188:191], v[80:83], a[24:27]
    v_add_f32 v150, v150, v27
    v_exp_f32 v28, v28
    v_mfma_f32_16x16x32_bf16 a[20:23], a[188:191], v[76:79], a[20:23]
    v_exp_f32 v29, v29
    v_mfma_f32_16x16x32_bf16 a[20:23], a[184:187], v[56:59], a[20:23]
    s_waitcnt lgkmcnt(8)
    ds_read_b64_tr_b16 a[184:185], v250
    ds_write_b128 v254, a[204:207] offset:3072
    v_mfma_f32_16x16x32_bf16 v[36:39], a[160:163], v[160:163], v[128:131]
    s_waitcnt lgkmcnt(9)
    ds_read_b64_tr_b16 a[186:187], v250 offset:4096
    v_add_f32 v151, v151, v28
    v_mfma_f32_16x16x32_bf16 v[36:39], a[164:167], v[164:167], v[36:39]
    s_waitcnt lgkmcnt(9)
    v_exp_f32 v30, v30
    v_cvt_pk_bf16_f32 v104, v28, v29
    v_mfma_f32_16x16x32_bf16 v[36:39], a[168:171], v[168:171], v[36:39]
    s_waitcnt lgkmcnt(8)
    ds_read_b64_tr_b16 a[188:189], v251
    v_add_f32 v151, v151, v29
    v_mfma_f32_16x16x32_bf16 v[36:39], a[172:175], v[172:175], v[36:39]
    s_waitcnt vmcnt(4)
    v_exp_f32 v31, v31
    v_add_f32 v151, v151, v30
    v_mfma_f32_16x16x32_bf16 v[40:43], a[172:175], v[188:191], v[132:135]
    ds_read_b64_tr_b16 a[190:191], v251 offset:4096
    buffer_load_dwordx4 v15, s[12:15], s91 offen offset:1024 nt lds
    v_mfma_f32_16x16x32_bf16 v[40:43], a[168:171], v[184:187], v[40:43]
    v_cvt_pk_bf16_f32 v105, v30, v31
    v_add_f32 v151, v151, v31
    v_add_u32 v242, 0x10000, v242
    v_mfma_f32_16x16x32_bf16 v[40:43], a[164:167], v[180:183], v[40:43]
    v_exp_f32 v32, v32
    v_mfma_f32_16x16x32_bf16 v[40:43], a[160:163], v[176:179], v[40:43]
    v_exp_f32 v33, v33
    v_mfma_f32_16x16x32_bf16 v[44:47], a[160:163], v[192:195], v[136:139]
    v_exp_f32 v34, v34
    v_add_f32 v152, v152, v32
    v_mfma_f32_16x16x32_bf16 v[44:47], a[164:167], v[196:199], v[44:47]
    v_exp_f32 v35, v35
    v_mfma_f32_16x16x32_bf16 v[44:47], a[168:171], v[200:203], v[44:47]
    v_exp_f32 v36, v36
    v_cvt_pk_bf16_f32 v108, v32, v33
    v_mfma_f32_16x16x32_bf16 v[44:47], a[172:175], v[204:207], v[44:47]
    ds_write_b128 v254, a[208:211] offset:4096
    v_mfma_f32_16x16x32_bf16 v[48:51], a[172:175], v[220:223], v[140:143]
    v_exp_f32 v37, v37
    v_add_f32 v152, v152, v33
    v_mfma_f32_16x16x32_bf16 v[48:51], a[168:171], v[216:219], v[48:51]
    v_exp_f32 v38, v38
    v_mfma_f32_16x16x32_bf16 v[48:51], a[164:167], v[212:215], v[48:51]
    v_exp_f32 v39, v39
    v_add_f32 v152, v152, v34
    v_mfma_f32_16x16x32_bf16 v[48:51], a[160:163], v[208:211], v[48:51]
    s_waitcnt vmcnt(4)
    v_cvt_pk_bf16_f32 v109, v34, v35
    v_add_f32 v152, v152, v35
    v_add_f32 v148, v148, v36
    v_mfma_f32_16x16x32_bf16 v[52:55], a[160:163], v[224:227], v[144:147]
    buffer_load_dwordx4 v3, s[12:15], s91 offen offset:2048 nt lds
    v_cvt_pk_bf16_f32 v94, v36, v37
    v_mfma_f32_16x16x32_bf16 v[52:55], a[164:167], v[228:231], v[52:55]
    v_add_f32 v148, v148, v37
    v_add_f32 v148, v148, v38
    v_cvt_pk_bf16_f32 v95, v38, v39
    v_mfma_f32_16x16x32_bf16 v[52:55], a[168:171], v[232:235], v[52:55]
    v_add_f32 v148, v148, v39
    v_mfma_f32_16x16x32_bf16 v[52:55], a[172:175], v[236:239], v[52:55]
    s_waitcnt lgkmcnt(8)
    ds_read_b128 a[160:163], v241
    v_exp_f32 v40, v40
    v_mfma_f32_16x16x32_bf16 a[40:43], a[176:179], v[56:59], a[40:43]
    s_waitcnt lgkmcnt(7)
    v_exp_f32 v41, v41
    v_mfma_f32_16x16x32_bf16 a[40:43], a[180:183], v[76:79], a[40:43]
    ds_read_b128 a[164:167], v243
    v_exp_f32 v42, v42
    v_mfma_f32_16x16x32_bf16 a[44:47], a[180:183], v[80:83], a[44:47]
    ds_write_b128 v254, a[212:215] offset:5120
    v_mfma_f32_16x16x32_bf16 a[44:47], a[176:179], v[60:63], a[44:47]
    ds_read_b128 a[168:171], v241 offset:512
    v_exp_f32 v43, v43
    v_mfma_f32_16x16x32_bf16 a[48:51], a[176:179], v[64:67], a[48:51]
    v_add_f32 v149, v149, v40
    v_cvt_pk_bf16_f32 v98, v40, v41
    v_add_f32 v149, v149, v41
    v_mfma_f32_16x16x32_bf16 a[48:51], a[180:183], v[84:87], a[48:51]
    ds_read_b128 a[172:175], v243 offset:512
    v_add_f32 v149, v149, v42
    v_mfma_f32_16x16x32_bf16 a[52:55], a[180:183], v[88:91], a[52:55]
    s_waitcnt vmcnt(4)
    v_cvt_pk_bf16_f32 v99, v42, v43
    v_add_f32 v149, v149, v43
    v_mfma_f32_16x16x32_bf16 a[52:55], a[176:179], v[68:71], a[52:55]
    buffer_load_dwordx4 v15, s[12:15], s91 offen offset:3072 nt lds
    v_mfma_f32_16x16x32_bf16 a[56:59], a[176:179], v[72:75], a[56:59]
    s_waitcnt lgkmcnt(8)
    ds_read_b64_tr_b16 a[176:177], v244 offset:512
    v_exp_f32 v44, v44
    v_mfma_f32_16x16x32_bf16 a[76:79], a[184:187], v[72:75], a[76:79]
    v_exp_f32 v45, v45
    v_mfma_f32_16x16x32_bf16 a[72:75], a[184:187], v[68:71], a[72:75]
    s_waitcnt lgkmcnt(7)
    ds_read_b64_tr_b16 a[178:179], v244 offset:4608
    v_exp_f32 v46, v46
    v_mfma_f32_16x16x32_bf16 a[72:75], a[188:191], v[88:91], a[72:75]
    v_exp_f32 v47, v47
    v_mfma_f32_16x16x32_bf16 a[68:71], a[188:191], v[84:87], a[68:71]
    ds_read_b64_tr_b16 a[180:181], v245 offset:512
    v_add_f32 v150, v150, v44
    v_cvt_pk_bf16_f32 v102, v44, v45
    v_mfma_f32_16x16x32_bf16 a[68:71], a[184:187], v[64:67], a[68:71]
    v_add_f32 v150, v150, v45
    v_add_f32 v150, v150, v46
    v_cvt_pk_bf16_f32 v103, v46, v47
    v_mfma_f32_16x16x32_bf16 a[64:67], a[184:187], v[60:63], a[64:67]
    s_add_u32 m0, m0, 0x1000
    ds_read_b64_tr_b16 a[182:183], v245 offset:4608
    v_add_f32 v150, v150, v47
    v_mfma_f32_16x16x32_bf16 a[64:67], a[188:191], v[80:83], a[64:67]
    s_add_u32 s91, s77, 0x15000
    ds_write_b128 v254, a[216:219] offset:6144
    v_mfma_f32_16x16x32_bf16 a[60:63], a[188:191], v[76:79], a[60:63]
    s_xor_b32 s91, s91, s47
    v_exp_f32 v48, v48
    v_mfma_f32_16x16x32_bf16 a[60:63], a[184:187], v[56:59], a[60:63]
    s_waitcnt lgkmcnt(9)
    s_waitcnt vmcnt(4)
    ds_read_b64_tr_b16 a[184:185], v246 offset:512
    v_exp_f32 v49, v49
    v_mfma_f32_16x16x32_bf16 v[16:19], a[160:163], v[160:163], v[128:131]
    s_waitcnt lgkmcnt(9)
    ds_read_b64_tr_b16 a[186:187], v246 offset:4608
    buffer_load_dwordx4 v3, s[12:15], s91 offen nt lds
    v_mfma_f32_16x16x32_bf16 v[16:19], a[164:167], v[164:167], v[16:19]
    s_waitcnt lgkmcnt(8)
    v_exp_f32 v50, v50
    v_add_f32 v151, v151, v48
    v_mfma_f32_16x16x32_bf16 v[16:19], a[168:171], v[168:171], v[16:19]
    s_waitcnt lgkmcnt(7)
    ds_read_b64_tr_b16 a[188:189], v247 offset:512
    v_cvt_pk_bf16_f32 v106, v48, v49
    v_mfma_f32_16x16x32_bf16 v[16:19], a[172:175], v[172:175], v[16:19]
    v_exp_f32 v51, v51
    v_add_f32 v151, v151, v49
    v_mfma_f32_16x16x32_bf16 v[20:23], a[172:175], v[188:191], v[132:135]
    ds_read_b64_tr_b16 a[190:191], v247 offset:4608
    v_add_f32 v151, v151, v50
    v_cvt_pk_bf16_f32 v107, v50, v51
    v_mfma_f32_16x16x32_bf16 v[20:23], a[168:171], v[184:187], v[20:23]
    v_add_f32 v151, v151, v51
    v_add_u32 v244, 0xfffe8000, v244
    v_mfma_f32_16x16x32_bf16 v[20:23], a[164:167], v[180:183], v[20:23]
    v_add_u32 v245, 0xfffe8000, v245
    v_add_u32 v246, 0xfffe8000, v246
    v_add_u32 v247, 0xfffe8000, v247
    v_mfma_f32_16x16x32_bf16 v[20:23], a[160:163], v[176:179], v[20:23]
    v_exp_f32 v52, v52
    v_mfma_f32_16x16x32_bf16 v[24:27], a[160:163], v[192:195], v[136:139]
    ds_write_b128 v254, a[220:223] offset:7168
    v_mfma_f32_16x16x32_bf16 v[24:27], a[164:167], v[196:199], v[24:27]
    v_exp_f32 v53, v53
    v_mfma_f32_16x16x32_bf16 v[24:27], a[168:171], v[200:203], v[24:27]
    v_exp_f32 v54, v54
    v_add_f32 v152, v152, v52
    v_mfma_f32_16x16x32_bf16 v[24:27], a[172:175], v[204:207], v[24:27]
    s_waitcnt vmcnt(4)
    v_exp_f32 v55, v55
    v_mfma_f32_16x16x32_bf16 v[28:31], a[172:175], v[220:223], v[140:143]
    buffer_load_dwordx4 v15, s[12:15], s91 offen offset:1024 nt lds
    v_exp_f32 v16, v16
    v_mfma_f32_16x16x32_bf16 v[28:31], a[168:171], v[216:219], v[28:31]
    v_exp_f32 v17, v17
    v_cvt_pk_bf16_f32 v110, v52, v53
    v_mfma_f32_16x16x32_bf16 v[28:31], a[164:167], v[212:215], v[28:31]
    v_exp_f32 v18, v18
    v_mfma_f32_16x16x32_bf16 v[28:31], a[160:163], v[208:211], v[28:31]
    s_waitcnt lgkmcnt(8)
    ds_read_b128 a[160:163], v241 offset:4096
    v_exp_f32 v19, v19
    v_mfma_f32_16x16x32_bf16 a[80:83], a[176:179], v[56:59], a[80:83]
    s_waitcnt lgkmcnt(7)
    v_exp_f32 v20, v20
    v_mfma_f32_16x16x32_bf16 a[80:83], a[180:183], v[76:79], a[80:83]
    ds_read_b128 a[164:167], v243 offset:4096
    v_exp_f32 v21, v21
    v_mfma_f32_16x16x32_bf16 a[84:87], a[180:183], v[80:83], a[84:87]
    v_exp_f32 v22, v22
    v_mfma_f32_16x16x32_bf16 a[84:87], a[176:179], v[60:63], a[84:87]
    ds_read_b128 a[168:171], v241 offset:4608
    v_exp_f32 v23, v23
    v_mfma_f32_16x16x32_bf16 a[88:91], a[176:179], v[64:67], a[88:91]
    v_exp_f32 v24, v24
    v_mfma_f32_16x16x32_bf16 a[88:91], a[180:183], v[84:87], a[88:91]
    ds_read_b128 a[172:175], v243 offset:4608
    v_add_u32 v241, 0x10000, v241
    v_add_u32 v243, 0x10000, v243
    v_mfma_f32_16x16x32_bf16 a[92:95], a[180:183], v[88:91], a[92:95]
    s_waitcnt vmcnt(4)
    v_exp_f32 v25, v25
    v_add_f32 v152, v152, v53
    v_mfma_f32_16x16x32_bf16 a[92:95], a[176:179], v[68:71], a[92:95]
    buffer_load_dwordx4 v3, s[12:15], s91 offen offset:2048 nt lds
    v_add_f32 v152, v152, v54
    v_mfma_f32_16x16x32_bf16 a[96:99], a[176:179], v[72:75], a[96:99]
    s_waitcnt lgkmcnt(7)
    ds_read_b64_tr_b16 a[176:177], v248 offset:512
    v_exp_f32 v26, v26
    v_mfma_f32_16x16x32_bf16 a[116:119], a[184:187], v[72:75], a[116:119]
    v_exp_f32 v27, v27
    v_mfma_f32_16x16x32_bf16 a[112:115], a[184:187], v[68:71], a[112:115]
    s_waitcnt lgkmcnt(6)
    ds_read_b64_tr_b16 a[178:179], v248 offset:4608
    v_exp_f32 v28, v28
    v_mfma_f32_16x16x32_bf16 a[112:115], a[188:191], v[88:91], a[112:115]
    v_exp_f32 v29, v29
    v_mfma_f32_16x16x32_bf16 a[108:111], a[188:191], v[84:87], a[108:111]
    ds_read_b64_tr_b16 a[180:181], v249 offset:512
    v_exp_f32 v30, v30
    v_mfma_f32_16x16x32_bf16 a[108:111], a[184:187], v[64:67], a[108:111]
    v_exp_f32 v31, v31
    v_mfma_f32_16x16x32_bf16 a[104:107], a[184:187], v[60:63], a[104:107]
    ds_read_b64_tr_b16 a[182:183], v249 offset:4608
    v_add_u32 v248, 0xfffe8000, v248
    v_add_u32 v249, 0xfffe8000, v249
    v_mfma_f32_16x16x32_bf16 a[104:107], a[188:191], v[80:83], a[104:107]
    v_cvt_pk_bf16_f32 v111, v54, v55
    v_add_f32 v152, v152, v55
    v_add_f32 v148, v148, v16
    v_mfma_f32_16x16x32_bf16 a[100:103], a[188:191], v[76:79], a[100:103]
    v_cvt_pk_bf16_f32 v112, v16, v17
    v_add_f32 v148, v148, v17
    v_mfma_f32_16x16x32_bf16 a[100:103], a[184:187], v[56:59], a[100:103]
    s_waitcnt lgkmcnt(7)
    ds_read_b64_tr_b16 a[184:185], v250 offset:512
    v_add_f32 v148, v148, v18
    v_cvt_pk_bf16_f32 v113, v18, v19
    v_mfma_f32_16x16x32_bf16 v[36:39], a[160:163], v[160:163], v[128:131]
    s_waitcnt lgkmcnt(7)
    s_waitcnt vmcnt(4)
    ds_read_b64_tr_b16 a[186:187], v250 offset:4608
    v_add_f32 v148, v148, v19
    v_mfma_f32_16x16x32_bf16 v[36:39], a[164:167], v[164:167], v[36:39]
    s_waitcnt lgkmcnt(7)
    buffer_load_dwordx4 v15, s[12:15], s91 offen offset:3072 nt lds
    v_add_f32 v149, v149, v20
    v_cvt_pk_bf16_f32 v116, v20, v21
    v_mfma_f32_16x16x32_bf16 v[36:39], a[168:171], v[168:171], v[36:39]
    s_waitcnt lgkmcnt(6)
    ds_read_b64_tr_b16 a[188:189], v251 offset:512
    v_add_f32 v149, v149, v21
    v_mfma_f32_16x16x32_bf16 v[36:39], a[172:175], v[172:175], v[36:39]
    v_add_f32 v149, v149, v22
    v_cvt_pk_bf16_f32 v117, v22, v23
    v_add_f32 v149, v149, v23
    v_mfma_f32_16x16x32_bf16 v[40:43], a[172:175], v[188:191], v[132:135]
    ds_read_b64_tr_b16 a[190:191], v251 offset:4608
    v_add_u32 v250, 0xfffe8000, v250
    v_mfma_f32_16x16x32_bf16 v[40:43], a[168:171], v[184:187], v[40:43]
    v_add_u32 v251, 0xfffe8000, v251
    v_add_f32 v150, v150, v24
    v_cvt_pk_bf16_f32 v120, v24, v25
    v_mfma_f32_16x16x32_bf16 v[40:43], a[164:167], v[180:183], v[40:43]
    v_add_f32 v150, v150, v25
    v_add_f32 v150, v150, v26
    v_cvt_pk_bf16_f32 v121, v26, v27
    v_mfma_f32_16x16x32_bf16 v[40:43], a[160:163], v[176:179], v[40:43]
    v_add_f32 v150, v150, v27
    v_add_f32 v151, v151, v28
    v_mfma_f32_16x16x32_bf16 v[44:47], a[160:163], v[192:195], v[136:139]
    v_cvt_pk_bf16_f32 v124, v28, v29
    v_add_f32 v151, v151, v29
    v_add_f32 v151, v151, v30
    v_mfma_f32_16x16x32_bf16 v[44:47], a[164:167], v[196:199], v[44:47]
    v_cvt_pk_bf16_f32 v125, v30, v31
    v_add_f32 v151, v151, v31
    v_mfma_f32_16x16x32_bf16 v[44:47], a[168:171], v[200:203], v[44:47]
    v_mfma_f32_16x16x32_bf16 v[44:47], a[172:175], v[204:207], v[44:47]
    v_mfma_f32_16x16x32_bf16 v[48:51], a[172:175], v[220:223], v[140:143]
    v_mfma_f32_16x16x32_bf16 v[48:51], a[168:171], v[216:219], v[48:51]
    s_waitcnt vmcnt(8) lgkmcnt(0)
    v_mfma_f32_16x16x32_bf16 v[48:51], a[164:167], v[212:215], v[48:51]
    s_barrier
    v_mfma_f32_16x16x32_bf16 v[48:51], a[160:163], v[208:211], v[48:51]
    v_mfma_f32_16x16x32_bf16 a[120:123], a[176:179], v[56:59], a[120:123]
    ds_read_b128 a[160:163], v240
    v_mfma_f32_16x16x32_bf16 a[120:123], a[180:183], v[76:79], a[120:123]
    ds_read_b128 a[164:167], v242
    v_mfma_f32_16x16x32_bf16 a[124:127], a[180:183], v[80:83], a[124:127]
    s_add_u32 m0, s78, 0x10000
    v_exp_f32 v36, v36
    v_mfma_f32_16x16x32_bf16 a[124:127], a[176:179], v[60:63], a[124:127]
    s_add_u32 s91, s77, 0x10000
    ds_read_b128 a[168:171], v240 offset:512
    v_exp_f32 v37, v37
    v_mfma_f32_16x16x32_bf16 a[128:131], a[176:179], v[64:67], a[128:131]
    s_xor_b32 s91, s91, s47
    v_exp_f32 v38, v38
    v_mfma_f32_16x16x32_bf16 a[128:131], a[180:183], v[84:87], a[128:131]
    s_waitcnt vmcnt(4)
    ds_read_b128 a[172:175], v242 offset:512
    v_add_f32 v148, v148, v36
    v_mfma_f32_16x16x32_bf16 a[132:135], a[180:183], v[88:91], a[132:135]
    buffer_load_dwordx4 v3, s[16:19], s91 offen nt lds
    v_cvt_pk_bf16_f32 v114, v36, v37
    v_mfma_f32_16x16x32_bf16 a[132:135], a[176:179], v[68:71], a[132:135]
    v_exp_f32 v39, v39
    v_add_f32 v148, v148, v37
    v_mfma_f32_16x16x32_bf16 a[136:139], a[176:179], v[72:75], a[136:139]
    ds_read_b64_tr_b16 a[176:177], v244
    v_add_f32 v148, v148, v38
    v_mfma_f32_16x16x32_bf16 a[156:159], a[184:187], v[72:75], a[156:159]
    v_exp_f32 v40, v40
    v_mfma_f32_16x16x32_bf16 a[152:155], a[184:187], v[68:71], a[152:155]
    ds_read_b64_tr_b16 a[178:179], v244 offset:4096
    v_exp_f32 v41, v41
    v_mfma_f32_16x16x32_bf16 a[152:155], a[188:191], v[88:91], a[152:155]
    v_exp_f32 v42, v42
    v_mfma_f32_16x16x32_bf16 a[148:151], a[188:191], v[84:87], a[148:151]
    ds_read_b64_tr_b16 a[180:181], v245
    v_cvt_pk_bf16_f32 v115, v38, v39
    v_mfma_f32_16x16x32_bf16 a[148:151], a[184:187], v[64:67], a[148:151]
    v_exp_f32 v43, v43
    v_mfma_f32_16x16x32_bf16 a[144:147], a[184:187], v[60:63], a[144:147]
    ds_read_b64_tr_b16 a[182:183], v245 offset:4096
    v_exp_f32 v44, v44
    v_mfma_f32_16x16x32_bf16 a[144:147], a[188:191], v[80:83], a[144:147]
    v_exp_f32 v45, v45
    v_mfma_f32_16x16x32_bf16 a[140:143], a[188:191], v[76:79], a[140:143]
    v_exp_f32 v46, v46
    v_mfma_f32_16x16x32_bf16 a[140:143], a[184:187], v[56:59], a[140:143]
    s_waitcnt lgkmcnt(7)
    s_waitcnt vmcnt(4)
    ds_read_b64_tr_b16 a[184:185], v246
    v_exp_f32 v47, v47
    v_mfma_f32_16x16x32_bf16 v[16:19], a[160:163], v[160:163], v[128:131]
    s_waitcnt lgkmcnt(7)
    ds_read_b64_tr_b16 a[186:187], v246 offset:4096
    buffer_load_dwordx4 v15, s[16:19], s91 offen offset:1024 nt lds
    v_mfma_f32_16x16x32_bf16 v[16:19], a[164:167], v[164:167], v[16:19]
    s_waitcnt lgkmcnt(7)
    v_exp_f32 v48, v48
    v_mfma_f32_16x16x32_bf16 v[16:19], a[168:171], v[168:171], v[16:19]
    s_waitcnt lgkmcnt(6)
    ds_read_b64_tr_b16 a[188:189], v247
    v_add_f32 v148, v148, v39
    v_mfma_f32_16x16x32_bf16 v[16:19], a[172:175], v[172:175], v[16:19]
    v_exp_f32 v49, v49
    v_add_f32 v149, v149, v40
    v_mfma_f32_16x16x32_bf16 v[20:23], a[172:175], v[188:191], v[132:135]
    ds_read_b64_tr_b16 a[190:191], v247 offset:4096
    v_cvt_pk_bf16_f32 v118, v40, v41
    v_mfma_f32_16x16x32_bf16 v[20:23], a[168:171], v[184:187], v[20:23]
    v_exp_f32 v50, v50
    v_mfma_f32_16x16x32_bf16 v[20:23], a[164:167], v[180:183], v[20:23]
    v_exp_f32 v51, v51
    v_mfma_f32_16x16x32_bf16 v[20:23], a[160:163], v[176:179], v[20:23]
    v_add_f32 v149, v149, v41
    v_add_f32 v149, v149, v42
    v_cvt_pk_bf16_f32 v119, v42, v43
    v_mfma_f32_16x16x32_bf16 v[24:27], a[160:163], v[192:195], v[136:139]
    v_add_f32 v149, v149, v43
    v_add_f32 v150, v150, v44
    v_mfma_f32_16x16x32_bf16 v[24:27], a[164:167], v[196:199], v[24:27]
    v_cvt_pk_bf16_f32 v122, v44, v45
    v_add_f32 v150, v150, v45
    v_mfma_f32_16x16x32_bf16 v[24:27], a[168:171], v[200:203], v[24:27]
    s_waitcnt vmcnt(4)
    v_add_f32 v150, v150, v46
    v_cvt_pk_bf16_f32 v123, v46, v47
    v_add_f32 v150, v150, v47
    v_mfma_f32_16x16x32_bf16 v[24:27], a[172:175], v[204:207], v[24:27]
    buffer_load_dwordx4 v3, s[16:19], s91 offen offset:2048 nt lds
    v_add_f32 v151, v151, v48
    v_mfma_f32_16x16x32_bf16 v[28:31], a[172:175], v[220:223], v[140:143]
    v_cvt_pk_bf16_f32 v126, v48, v49
    v_add_f32 v151, v151, v49
    v_mfma_f32_16x16x32_bf16 v[28:31], a[168:171], v[216:219], v[28:31]
    v_add_f32 v151, v151, v50
    v_cvt_pk_bf16_f32 v127, v50, v51
    v_mfma_f32_16x16x32_bf16 v[28:31], a[164:167], v[212:215], v[28:31]
    v_add_f32 v151, v151, v51
    v_exp_f32 v16, v16
    v_mfma_f32_16x16x32_bf16 v[28:31], a[160:163], v[208:211], v[28:31]
    v_exp_f32 v17, v17
    v_mfma_f32_16x16x32_bf16 v[32:35], a[160:163], v[224:227], v[144:147]
    v_exp_f32 v18, v18
    v_mfma_f32_16x16x32_bf16 v[32:35], a[164:167], v[228:231], v[32:35]
    v_exp_f32 v19, v19
    v_add_f32 v148, v148, v16
    v_mfma_f32_16x16x32_bf16 v[32:35], a[168:171], v[232:235], v[32:35]
    v_cvt_pk_bf16_f32 v56, v16, v17
    v_add_f32 v148, v148, v17
    v_mfma_f32_16x16x32_bf16 v[32:35], a[172:175], v[236:239], v[32:35]
    s_waitcnt lgkmcnt(6)
    ds_read_b128 a[160:163], v240 offset:4096
    v_add_f32 v148, v148, v18
    v_mfma_f32_16x16x32_bf16 a[0:3], a[176:179], v[92:95], a[0:3]
    s_waitcnt lgkmcnt(5)
    v_cvt_pk_bf16_f32 v57, v18, v19
    v_add_f32 v148, v148, v19
    v_mfma_f32_16x16x32_bf16 a[0:3], a[180:183], v[112:115], a[0:3]
    ds_read_b128 a[164:167], v242 offset:4096
    v_exp_f32 v20, v20
    v_mfma_f32_16x16x32_bf16 a[4:7], a[180:183], v[116:119], a[4:7]
    s_waitcnt vmcnt(4)
    v_exp_f32 v21, v21
    v_mfma_f32_16x16x32_bf16 a[4:7], a[176:179], v[96:99], a[4:7]
    ds_read_b128 a[168:171], v240 offset:4608
    buffer_load_dwordx4 v15, s[16:19], s91 offen offset:3072 nt lds
    v_mfma_f32_16x16x32_bf16 a[8:11], a[176:179], v[100:103], a[8:11]
    v_exp_f32 v22, v22
    v_mfma_f32_16x16x32_bf16 a[8:11], a[180:183], v[120:123], a[8:11]
    ds_read_b128 a[172:175], v242 offset:4608
    v_exp_f32 v23, v23
    v_mfma_f32_16x16x32_bf16 a[12:15], a[180:183], v[124:127], a[12:15]
    v_add_f32 v149, v149, v20
    v_cvt_pk_bf16_f32 v60, v20, v21
    v_mfma_f32_16x16x32_bf16 a[12:15], a[176:179], v[104:107], a[12:15]
    v_add_f32 v149, v149, v21
    v_add_f32 v149, v149, v22
    v_mfma_f32_16x16x32_bf16 a[16:19], a[176:179], v[108:111], a[16:19]
    s_waitcnt lgkmcnt(6)
    ds_read_b64_tr_b16 a[176:177], v248
    v_cvt_pk_bf16_f32 v61, v22, v23
    v_add_f32 v149, v149, v23
    v_mfma_f32_16x16x32_bf16 a[36:39], a[184:187], v[108:111], a[36:39]
    v_exp_f32 v24, v24
    v_mfma_f32_16x16x32_bf16 a[32:35], a[184:187], v[104:107], a[32:35]
    s_waitcnt lgkmcnt(5)
    s_add_u32 m0, m0, 0x1000
    ds_read_b64_tr_b16 a[178:179], v248 offset:4096
    v_add_u32 v240, 0xfffe8000, v240
    v_mfma_f32_16x16x32_bf16 a[32:35], a[188:191], v[124:127], a[32:35]
    s_add_u32 s91, s77, 0x11000
    v_exp_f32 v25, v25
    v_mfma_f32_16x16x32_bf16 a[28:31], a[188:191], v[120:123], a[28:31]
    s_xor_b32 s91, s91, s47
    ds_read_b64_tr_b16 a[180:181], v249
    v_exp_f32 v26, v26
    v_mfma_f32_16x16x32_bf16 a[28:31], a[184:187], v[100:103], a[28:31]
    s_waitcnt vmcnt(4)
    v_exp_f32 v27, v27
    v_mfma_f32_16x16x32_bf16 a[24:27], a[184:187], v[96:99], a[24:27]
    ds_read_b64_tr_b16 a[182:183], v249 offset:4096
    buffer_load_dwordx4 v3, s[16:19], s91 offen nt lds
    v_mfma_f32_16x16x32_bf16 a[24:27], a[188:191], v[116:119], a[24:27]
    v_add_f32 v150, v150, v24
    v_cvt_pk_bf16_f32 v64, v24, v25
    v_add_f32 v150, v150, v25
    v_mfma_f32_16x16x32_bf16 a[20:23], a[188:191], v[112:115], a[20:23]
    v_add_f32 v150, v150, v26
    v_cvt_pk_bf16_f32 v65, v26, v27
    v_mfma_f32_16x16x32_bf16 a[20:23], a[184:187], v[92:95], a[20:23]
    s_waitcnt lgkmcnt(7)
    ds_read_b64_tr_b16 a[184:185], v250
    v_add_f32 v150, v150, v27
    v_mfma_f32_16x16x32_bf16 v[36:39], a[160:163], v[160:163], v[128:131]
    s_waitcnt lgkmcnt(7)
    ds_read_b64_tr_b16 a[186:187], v250 offset:4096
    v_add_u32 v242, 0xfffe8000, v242
    v_mfma_f32_16x16x32_bf16 v[36:39], a[164:167], v[164:167], v[36:39]
    s_waitcnt lgkmcnt(7)
    v_exp_f32 v28, v28
    v_mfma_f32_16x16x32_bf16 v[36:39], a[168:171], v[168:171], v[36:39]
    s_waitcnt lgkmcnt(6)
    ds_read_b64_tr_b16 a[188:189], v251
    v_mfma_f32_16x16x32_bf16 v[36:39], a[172:175], v[172:175], v[36:39]
    v_exp_f32 v29, v29
    v_mfma_f32_16x16x32_bf16 v[40:43], a[172:175], v[188:191], v[132:135]
    ds_read_b64_tr_b16 a[190:191], v251 offset:4096
    v_add_f32 v151, v151, v28
    v_mfma_f32_16x16x32_bf16 v[40:43], a[168:171], v[184:187], v[40:43]
    v_exp_f32 v30, v30
    v_cvt_pk_bf16_f32 v68, v28, v29
    v_mfma_f32_16x16x32_bf16 v[40:43], a[164:167], v[180:183], v[40:43]
    v_exp_f32 v31, v31
    v_mfma_f32_16x16x32_bf16 v[40:43], a[160:163], v[176:179], v[40:43]
    s_waitcnt vmcnt(4)
    v_add_f32 v151, v151, v29
    v_add_f32 v151, v151, v30
    v_mfma_f32_16x16x32_bf16 v[44:47], a[160:163], v[192:195], v[136:139]
    buffer_load_dwordx4 v15, s[16:19], s91 offen offset:1024 nt lds
    v_cvt_pk_bf16_f32 v69, v30, v31
    v_add_f32 v151, v151, v31
    v_mfma_f32_16x16x32_bf16 v[44:47], a[164:167], v[196:199], v[44:47]
    v_exp_f32 v32, v32
    v_mfma_f32_16x16x32_bf16 v[44:47], a[168:171], v[200:203], v[44:47]
    v_exp_f32 v33, v33
    v_mfma_f32_16x16x32_bf16 v[44:47], a[172:175], v[204:207], v[44:47]
    v_exp_f32 v34, v34
    v_mfma_f32_16x16x32_bf16 v[48:51], a[172:175], v[220:223], v[140:143]
    v_exp_f32 v35, v35
    v_add_f32 v152, v152, v32
    v_mfma_f32_16x16x32_bf16 v[48:51], a[168:171], v[216:219], v[48:51]
    v_exp_f32 v36, v36
    v_mfma_f32_16x16x32_bf16 v[48:51], a[164:167], v[212:215], v[48:51]
    v_exp_f32 v37, v37
    v_mfma_f32_16x16x32_bf16 v[48:51], a[160:163], v[208:211], v[48:51]
    v_exp_f32 v38, v38
    v_cvt_pk_bf16_f32 v72, v32, v33
    v_mfma_f32_16x16x32_bf16 v[52:55], a[160:163], v[224:227], v[144:147]
    v_exp_f32 v39, v39
    v_mfma_f32_16x16x32_bf16 v[52:55], a[164:167], v[228:231], v[52:55]
    v_add_f32 v152, v152, v33
    v_add_f32 v152, v152, v34
    v_mfma_f32_16x16x32_bf16 v[52:55], a[168:171], v[232:235], v[52:55]
    s_waitcnt vmcnt(4)
    v_cvt_pk_bf16_f32 v73, v34, v35
    v_add_f32 v152, v152, v35
    v_mfma_f32_16x16x32_bf16 v[52:55], a[172:175], v[236:239], v[52:55]
    s_waitcnt lgkmcnt(6)
    ds_read_b128 a[160:163], v241
    buffer_load_dwordx4 v3, s[16:19], s91 offen offset:2048 nt lds
    v_add_f32 v148, v148, v36
    v_mfma_f32_16x16x32_bf16 a[40:43], a[176:179], v[92:95], a[40:43]
    s_waitcnt lgkmcnt(5)
    v_cvt_pk_bf16_f32 v58, v36, v37
    v_add_f32 v148, v148, v37
    v_mfma_f32_16x16x32_bf16 a[40:43], a[180:183], v[112:115], a[40:43]
    ds_read_b128 a[164:167], v243
    v_add_f32 v148, v148, v38
    v_mfma_f32_16x16x32_bf16 a[44:47], a[180:183], v[116:119], a[44:47]
    v_cvt_pk_bf16_f32 v59, v38, v39
    v_add_f32 v148, v148, v39
    v_mfma_f32_16x16x32_bf16 a[44:47], a[176:179], v[96:99], a[44:47]
    ds_read_b128 a[168:171], v241 offset:512
    v_exp_f32 v40, v40
    v_mfma_f32_16x16x32_bf16 a[48:51], a[176:179], v[100:103], a[48:51]
    v_exp_f32 v41, v41
    v_mfma_f32_16x16x32_bf16 a[48:51], a[180:183], v[120:123], a[48:51]
    ds_read_b128 a[172:175], v243 offset:512
    v_add_f32 v149, v149, v40
    v_mfma_f32_16x16x32_bf16 a[52:55], a[180:183], v[124:127], a[52:55]
    v_exp_f32 v42, v42
    v_cvt_pk_bf16_f32 v62, v40, v41
    v_mfma_f32_16x16x32_bf16 a[52:55], a[176:179], v[104:107], a[52:55]
    v_exp_f32 v43, v43
    v_mfma_f32_16x16x32_bf16 a[56:59], a[176:179], v[108:111], a[56:59]
    s_waitcnt lgkmcnt(6)
    ds_read_b64_tr_b16 a[176:177], v244 offset:512
    v_add_f32 v149, v149, v41
    v_mfma_f32_16x16x32_bf16 a[76:79], a[184:187], v[108:111], a[76:79]
    s_waitcnt vmcnt(4)
    v_add_f32 v149, v149, v42
    v_cvt_pk_bf16_f32 v63, v42, v43
    v_mfma_f32_16x16x32_bf16 a[72:75], a[184:187], v[104:107], a[72:75]
    s_waitcnt lgkmcnt(5)
    ds_read_b64_tr_b16 a[178:179], v244 offset:4608
    buffer_load_dwordx4 v15, s[16:19], s91 offen offset:3072 nt lds
    v_add_f32 v149, v149, v43
    v_mfma_f32_16x16x32_bf16 a[72:75], a[188:191], v[124:127], a[72:75]
    v_exp_f32 v44, v44
    v_mfma_f32_16x16x32_bf16 a[68:71], a[188:191], v[120:123], a[68:71]
    ds_read_b64_tr_b16 a[180:181], v245 offset:512
    v_mfma_f32_16x16x32_bf16 a[68:71], a[184:187], v[100:103], a[68:71]
    v_exp_f32 v45, v45
    v_add_f32 v150, v150, v44
    v_mfma_f32_16x16x32_bf16 a[64:67], a[184:187], v[96:99], a[64:67]
    ds_read_b64_tr_b16 a[182:183], v245 offset:4608
    v_mfma_f32_16x16x32_bf16 a[64:67], a[188:191], v[116:119], a[64:67]
    v_exp_f32 v46, v46
    v_mfma_f32_16x16x32_bf16 a[60:63], a[188:191], v[112:115], a[60:63]
    v_exp_f32 v47, v47
    v_mfma_f32_16x16x32_bf16 a[60:63], a[184:187], v[92:95], a[60:63]
    s_waitcnt lgkmcnt(7)
    ds_read_b64_tr_b16 a[184:185], v246 offset:512
    v_cvt_pk_bf16_f32 v66, v44, v45
    v_add_f32 v150, v150, v45
    v_mfma_f32_16x16x32_bf16 v[16:19], a[160:163], v[160:163], v[128:131]
    s_waitcnt lgkmcnt(7)
    s_add_u32 m0, s78, 0x18000
    ds_read_b64_tr_b16 a[186:187], v246 offset:4608
    v_add_f32 v150, v150, v46
    v_mfma_f32_16x16x32_bf16 v[16:19], a[164:167], v[164:167], v[16:19]
    s_waitcnt lgkmcnt(7)
    s_add_u32 s91, s77, 0x18000
    v_cvt_pk_bf16_f32 v67, v46, v47
    v_add_f32 v150, v150, v47
    v_mfma_f32_16x16x32_bf16 v[16:19], a[168:171], v[168:171], v[16:19]
    s_waitcnt lgkmcnt(6)
    s_xor_b32 s91, s91, s47
    ds_read_b64_tr_b16 a[188:189], v247 offset:512
    v_mfma_f32_16x16x32_bf16 v[16:19], a[172:175], v[172:175], v[16:19]
    s_waitcnt vmcnt(4)
    v_exp_f32 v48, v48
    v_mfma_f32_16x16x32_bf16 v[20:23], a[172:175], v[188:191], v[132:135]
    ds_read_b64_tr_b16 a[190:191], v247 offset:4608
    buffer_load_dwordx4 v3, s[12:15], s91 offen nt lds
    v_mfma_f32_16x16x32_bf16 v[20:23], a[168:171], v[184:187], v[20:23]
    v_exp_f32 v49, v49
    v_mfma_f32_16x16x32_bf16 v[20:23], a[164:167], v[180:183], v[20:23]
    v_exp_f32 v50, v50
    v_add_f32 v151, v151, v48
    v_mfma_f32_16x16x32_bf16 v[20:23], a[160:163], v[176:179], v[20:23]
    v_exp_f32 v51, v51
    v_mfma_f32_16x16x32_bf16 v[24:27], a[160:163], v[192:195], v[136:139]
    v_cvt_pk_bf16_f32 v70, v48, v49
    v_add_f32 v151, v151, v49
    v_mfma_f32_16x16x32_bf16 v[24:27], a[164:167], v[196:199], v[24:27]
    v_add_f32 v151, v151, v50
    v_cvt_pk_bf16_f32 v71, v50, v51
    v_mfma_f32_16x16x32_bf16 v[24:27], a[168:171], v[200:203], v[24:27]
    v_add_f32 v151, v151, v51
    v_add_u32 v244, 0x10000, v244
    v_add_u32 v245, 0x10000, v245
    v_mfma_f32_16x16x32_bf16 v[24:27], a[172:175], v[204:207], v[24:27]
    v_add_u32 v246, 0x10000, v246
    v_add_u32 v247, 0x10000, v247
    v_mfma_f32_16x16x32_bf16 v[28:31], a[172:175], v[220:223], v[140:143]
    v_exp_f32 v52, v52
    v_mfma_f32_16x16x32_bf16 v[28:31], a[168:171], v[216:219], v[28:31]
    v_exp_f32 v53, v53
    v_add_f32 v152, v152, v52
    v_mfma_f32_16x16x32_bf16 v[28:31], a[164:167], v[212:215], v[28:31]
    s_waitcnt vmcnt(4)
    v_exp_f32 v54, v54
    v_mfma_f32_16x16x32_bf16 v[28:31], a[160:163], v[208:211], v[28:31]
    s_waitcnt lgkmcnt(6)
    ds_read_b128 a[160:163], v241 offset:4096
    buffer_load_dwordx4 v15, s[12:15], s91 offen offset:1024 nt lds
    v_mfma_f32_16x16x32_bf16 a[80:83], a[176:179], v[92:95], a[80:83]
    s_waitcnt lgkmcnt(5)
    v_exp_f32 v55, v55
    v_mfma_f32_16x16x32_bf16 a[80:83], a[180:183], v[112:115], a[80:83]
    ds_read_b128 a[164:167], v243 offset:4096
    v_exp_f32 v16, v16
    v_mfma_f32_16x16x32_bf16 a[84:87], a[180:183], v[116:119], a[84:87]
    v_exp_f32 v17, v17
    v_mfma_f32_16x16x32_bf16 a[84:87], a[176:179], v[96:99], a[84:87]
    ds_read_b128 a[168:171], v241 offset:4608
    v_cvt_pk_bf16_f32 v74, v52, v53
    v_mfma_f32_16x16x32_bf16 a[88:91], a[176:179], v[100:103], a[88:91]
    v_exp_f32 v18, v18
    v_mfma_f32_16x16x32_bf16 a[88:91], a[180:183], v[120:123], a[88:91]
    ds_read_b128 a[172:175], v243 offset:4608
    v_add_u32 v241, 0xfffe8000, v241
    v_add_u32 v243, 0xfffe8000, v243
    v_mfma_f32_16x16x32_bf16 a[92:95], a[180:183], v[124:127], a[92:95]
    v_exp_f32 v19, v19
    v_mfma_f32_16x16x32_bf16 a[92:95], a[176:179], v[104:107], a[92:95]
    v_exp_f32 v20, v20
    v_mfma_f32_16x16x32_bf16 a[96:99], a[176:179], v[108:111], a[96:99]
    s_waitcnt lgkmcnt(6)
    ds_read_b64_tr_b16 a[176:177], v248 offset:512
    v_exp_f32 v21, v21
    v_mfma_f32_16x16x32_bf16 a[116:119], a[184:187], v[108:111], a[116:119]
    v_exp_f32 v22, v22
    v_mfma_f32_16x16x32_bf16 a[112:115], a[184:187], v[104:107], a[112:115]
    s_waitcnt lgkmcnt(5)
    s_waitcnt vmcnt(4)
    ds_read_b64_tr_b16 a[178:179], v248 offset:4608
    v_add_f32 v152, v152, v53
    v_mfma_f32_16x16x32_bf16 a[112:115], a[188:191], v[124:127], a[112:115]
    buffer_load_dwordx4 v3, s[12:15], s91 offen offset:2048 nt lds
    v_add_f32 v152, v152, v54
    v_mfma_f32_16x16x32_bf16 a[108:111], a[188:191], v[120:123], a[108:111]
    ds_read_b64_tr_b16 a[180:181], v249 offset:512
    v_exp_f32 v23, v23
    v_mfma_f32_16x16x32_bf16 a[108:111], a[184:187], v[100:103], a[108:111]
    v_exp_f32 v24, v24
    v_mfma_f32_16x16x32_bf16 a[104:107], a[184:187], v[96:99], a[104:107]
    ds_read_b64_tr_b16 a[182:183], v249 offset:4608
    v_add_u32 v248, 0x10000, v248
    v_mfma_f32_16x16x32_bf16 a[104:107], a[188:191], v[116:119], a[104:107]
    v_add_u32 v249, 0x10000, v249
    v_exp_f32 v25, v25
    v_mfma_f32_16x16x32_bf16 a[100:103], a[188:191], v[112:115], a[100:103]
    v_exp_f32 v26, v26
    v_mfma_f32_16x16x32_bf16 a[100:103], a[184:187], v[92:95], a[100:103]
    s_waitcnt lgkmcnt(7)
    ds_read_b64_tr_b16 a[184:185], v250 offset:512
    v_cvt_pk_bf16_f32 v75, v54, v55
    v_mfma_f32_16x16x32_bf16 v[36:39], a[160:163], v[160:163], v[128:131]
    s_waitcnt lgkmcnt(7)
    ds_read_b64_tr_b16 a[186:187], v250 offset:4608
    v_add_f32 v152, v152, v55
    v_mfma_f32_16x16x32_bf16 v[36:39], a[164:167], v[164:167], v[36:39]
    s_waitcnt lgkmcnt(7)
    v_exp_f32 v27, v27
    v_add_f32 v148, v148, v16
    v_mfma_f32_16x16x32_bf16 v[36:39], a[168:171], v[168:171], v[36:39]
    s_waitcnt lgkmcnt(6)
    ds_read_b64_tr_b16 a[188:189], v251 offset:512
    v_cvt_pk_bf16_f32 v76, v16, v17
    v_mfma_f32_16x16x32_bf16 v[36:39], a[172:175], v[172:175], v[36:39]
    s_waitcnt vmcnt(4)
    v_exp_f32 v28, v28
    v_mfma_f32_16x16x32_bf16 v[40:43], a[172:175], v[188:191], v[132:135]
    ds_read_b64_tr_b16 a[190:191], v251 offset:4608
    buffer_load_dwordx4 v15, s[12:15], s91 offen offset:3072 nt lds
    v_mfma_f32_16x16x32_bf16 v[40:43], a[168:171], v[184:187], v[40:43]
    v_add_u32 v250, 0x10000, v250
    v_add_u32 v251, 0x10000, v251
    v_add_f32 v148, v148, v17
    v_mfma_f32_16x16x32_bf16 v[40:43], a[164:167], v[180:183], v[40:43]
    v_exp_f32 v29, v29
    v_mfma_f32_16x16x32_bf16 v[40:43], a[160:163], v[176:179], v[40:43]
    v_exp_f32 v30, v30
    v_mfma_f32_16x16x32_bf16 v[44:47], a[160:163], v[192:195], v[136:139]
    v_exp_f32 v31, v31
    v_add_f32 v148, v148, v18
    v_mfma_f32_16x16x32_bf16 v[44:47], a[164:167], v[196:199], v[44:47]
    v_cvt_pk_bf16_f32 v77, v18, v19
    v_add_f32 v148, v148, v19
    v_mfma_f32_16x16x32_bf16 v[44:47], a[168:171], v[200:203], v[44:47]
    v_add_f32 v149, v149, v20
    v_cvt_pk_bf16_f32 v80, v20, v21
    v_mfma_f32_16x16x32_bf16 v[44:47], a[172:175], v[204:207], v[44:47]
    v_add_f32 v149, v149, v21
    v_add_f32 v149, v149, v22
    v_mfma_f32_16x16x32_bf16 v[48:51], a[172:175], v[220:223], v[140:143]
    v_cvt_pk_bf16_f32 v81, v22, v23
    v_add_f32 v149, v149, v23
    v_add_f32 v150, v150, v24
    v_mfma_f32_16x16x32_bf16 v[48:51], a[168:171], v[216:219], v[48:51]
    s_waitcnt vmcnt(4) lgkmcnt(0)
    v_cvt_pk_bf16_f32 v84, v24, v25
    v_add_f32 v150, v150, v25
    v_mfma_f32_16x16x32_bf16 v[48:51], a[164:167], v[212:215], v[48:51]
    s_barrier
    v_add_f32 v150, v150, v26
    v_cvt_pk_bf16_f32 v85, v26, v27
    v_mfma_f32_16x16x32_bf16 v[48:51], a[160:163], v[208:211], v[48:51]
    v_add_f32 v150, v150, v27
    v_add_f32 v151, v151, v28
    v_cvt_pk_bf16_f32 v88, v28, v29
    v_add_f32 v151, v151, v29
    v_add_f32 v151, v151, v30
    v_cvt_pk_bf16_f32 v89, v30, v31
    v_add_f32 v151, v151, v31
    v_mfma_f32_16x16x32_bf16 a[120:123], a[176:179], v[92:95], a[120:123]
    ds_read_b128 a[160:163], v240
    v_mfma_f32_16x16x32_bf16 a[120:123], a[180:183], v[112:115], a[120:123]
    ds_read_b128 a[164:167], v242
    v_exp_f32 v36, v36
    v_mfma_f32_16x16x32_bf16 a[124:127], a[180:183], v[116:119], a[124:127]
    v_exp_f32 v37, v37
    v_mfma_f32_16x16x32_bf16 a[124:127], a[176:179], v[96:99], a[124:127]
    ds_read_b128 a[168:171], v240 offset:512
    v_exp_f32 v38, v38
    v_mfma_f32_16x16x32_bf16 a[128:131], a[176:179], v[100:103], a[128:131]
    v_exp_f32 v39, v39
    v_mfma_f32_16x16x32_bf16 a[128:131], a[180:183], v[120:123], a[128:131]
    ds_read_b128 a[172:175], v242 offset:512
    v_exp_f32 v40, v40
    v_mfma_f32_16x16x32_bf16 a[132:135], a[180:183], v[124:127], a[132:135]
    s_add_u32 m0, m0, 0x1000
    v_exp_f32 v41, v41
    v_mfma_f32_16x16x32_bf16 a[132:135], a[176:179], v[104:107], a[132:135]
    s_add_u32 s91, s77, 0x19000
    v_exp_f32 v42, v42
    v_add_f32 v148, v148, v36
    v_mfma_f32_16x16x32_bf16 a[136:139], a[176:179], v[108:111], a[136:139]
    s_xor_b32 s91, s91, s47
    ds_read_b64_tr_b16 a[176:177], v244
    v_exp_f32 v43, v43
    v_mfma_f32_16x16x32_bf16 a[156:159], a[184:187], v[108:111], a[156:159]
    s_waitcnt vmcnt(4)
    v_exp_f32 v44, v44
    v_mfma_f32_16x16x32_bf16 a[152:155], a[184:187], v[104:107], a[152:155]
    ds_read_b64_tr_b16 a[178:179], v244 offset:4096
    buffer_load_dwordx4 v3, s[12:15], s91 offen nt lds
    v_cvt_pk_bf16_f32 v78, v36, v37
    v_mfma_f32_16x16x32_bf16 a[152:155], a[188:191], v[124:127], a[152:155]
    v_exp_f32 v45, v45
    v_mfma_f32_16x16x32_bf16 a[148:151], a[188:191], v[120:123], a[148:151]
    ds_read_b64_tr_b16 a[180:181], v245
    v_exp_f32 v46, v46
    v_mfma_f32_16x16x32_bf16 a[148:151], a[184:187], v[100:103], a[148:151]
    v_exp_f32 v47, v47
    v_mfma_f32_16x16x32_bf16 a[144:147], a[184:187], v[96:99], a[144:147]
    ds_read_b64_tr_b16 a[182:183], v245 offset:4096
    v_exp_f32 v48, v48
    v_mfma_f32_16x16x32_bf16 a[144:147], a[188:191], v[116:119], a[144:147]
    v_exp_f32 v49, v49
    v_mfma_f32_16x16x32_bf16 a[140:143], a[188:191], v[112:115], a[140:143]
    v_exp_f32 v50, v50
    v_add_f32 v148, v148, v37
    v_mfma_f32_16x16x32_bf16 a[140:143], a[184:187], v[92:95], a[140:143]
    s_waitcnt lgkmcnt(7)
    ds_read_b64_tr_b16 a[184:185], v246
    v_exp_f32 v51, v51
    v_mfma_f32_16x16x32_bf16 v[16:19], a[160:163], v[160:163], v[128:131]
    s_waitcnt lgkmcnt(7)
    ds_read_b64_tr_b16 a[186:187], v246 offset:4096
    v_add_f32 v148, v148, v38
    v_mfma_f32_16x16x32_bf16 v[16:19], a[164:167], v[164:167], v[16:19]
    s_waitcnt lgkmcnt(7)
    v_cvt_pk_bf16_f32 v79, v38, v39
    v_add_f32 v148, v148, v39
    v_add_f32 v149, v149, v40
    v_mfma_f32_16x16x32_bf16 v[16:19], a[168:171], v[168:171], v[16:19]
    s_waitcnt lgkmcnt(6)
    s_waitcnt vmcnt(4)
    ds_read_b64_tr_b16 a[188:189], v247
    v_add_u32 v10, 0x20000, v254
    v_mfma_f32_16x16x32_bf16 v[16:19], a[172:175], v[172:175], v[16:19]
    buffer_load_dwordx4 v15, s[12:15], s91 offen offset:1024 nt lds
    v_cvt_pk_bf16_f32 v82, v40, v41
    v_add_f32 v149, v149, v41
    v_mfma_f32_16x16x32_bf16 v[20:23], a[172:175], v[188:191], v[132:135]
    ds_read_b64_tr_b16 a[190:191], v247 offset:4096
    v_add_f32 v149, v149, v42
    v_mfma_f32_16x16x32_bf16 v[20:23], a[168:171], v[184:187], v[20:23]
    v_cvt_pk_bf16_f32 v83, v42, v43
    v_add_f32 v149, v149, v43
    v_add_f32 v150, v150, v44
    v_mfma_f32_16x16x32_bf16 v[20:23], a[164:167], v[180:183], v[20:23]
    v_cvt_pk_bf16_f32 v86, v44, v45
    v_add_f32 v150, v150, v45
    v_mfma_f32_16x16x32_bf16 v[20:23], a[160:163], v[176:179], v[20:23]
    v_add_f32 v150, v150, v46
    v_cvt_pk_bf16_f32 v87, v46, v47
    v_add_f32 v150, v150, v47
    v_mfma_f32_16x16x32_bf16 v[24:27], a[160:163], v[192:195], v[136:139]
    v_add_f32 v151, v151, v48
    v_cvt_pk_bf16_f32 v90, v48, v49
    v_add_f32 v151, v151, v49
    v_mfma_f32_16x16x32_bf16 v[24:27], a[164:167], v[196:199], v[24:27]
    v_add_f32 v151, v151, v50
    v_cvt_pk_bf16_f32 v91, v50, v51
    v_mfma_f32_16x16x32_bf16 v[24:27], a[168:171], v[200:203], v[24:27]
    v_add_f32 v151, v151, v51
    v_exp_f32 v16, v16
    v_mfma_f32_16x16x32_bf16 v[24:27], a[172:175], v[204:207], v[24:27]
    v_exp_f32 v17, v17
    v_mfma_f32_16x16x32_bf16 v[28:31], a[172:175], v[220:223], v[140:143]
    ds_write_b128 v10, a[224:227]
    v_mfma_f32_16x16x32_bf16 v[28:31], a[168:171], v[216:219], v[28:31]
    v_exp_f32 v18, v18
    v_mfma_f32_16x16x32_bf16 v[28:31], a[164:167], v[212:215], v[28:31]
    s_waitcnt vmcnt(4)
    v_exp_f32 v19, v19
    v_add_f32 v148, v148, v16
    v_mfma_f32_16x16x32_bf16 v[28:31], a[160:163], v[208:211], v[28:31]
    buffer_load_dwordx4 v3, s[12:15], s91 offen offset:2048 nt lds
    v_cvt_pk_bf16_f32 v92, v16, v17
    v_mfma_f32_16x16x32_bf16 v[32:35], a[160:163], v[224:227], v[144:147]
    v_add_f32 v148, v148, v17
    v_add_f32 v148, v148, v18
    v_cvt_pk_bf16_f32 v93, v18, v19
    v_mfma_f32_16x16x32_bf16 v[32:35], a[164:167], v[228:231], v[32:35]
    v_add_f32 v148, v148, v19
    v_exp_f32 v20, v20
    v_mfma_f32_16x16x32_bf16 v[32:35], a[168:171], v[232:235], v[32:35]
    v_exp_f32 v21, v21
    v_mfma_f32_16x16x32_bf16 v[32:35], a[172:175], v[236:239], v[32:35]
    s_waitcnt lgkmcnt(7)
    ds_read_b128 a[160:163], v240 offset:4096
    v_exp_f32 v22, v22
    v_mfma_f32_16x16x32_bf16 a[0:3], a[176:179], v[56:59], a[0:3]
    s_waitcnt lgkmcnt(6)
    v_exp_f32 v23, v23
    v_mfma_f32_16x16x32_bf16 a[0:3], a[180:183], v[76:79], a[0:3]
    ds_read_b128 a[164:167], v242 offset:4096
    v_add_f32 v149, v149, v20
    v_cvt_pk_bf16_f32 v96, v20, v21
    v_mfma_f32_16x16x32_bf16 a[4:7], a[180:183], v[80:83], a[4:7]
    ds_write_b128 v10, a[228:231] offset:1024
    v_mfma_f32_16x16x32_bf16 a[4:7], a[176:179], v[60:63], a[4:7]
    ds_read_b128 a[168:171], v240 offset:4608
    v_add_f32 v149, v149, v21
    v_add_f32 v149, v149, v22
    v_mfma_f32_16x16x32_bf16 a[8:11], a[176:179], v[64:67], a[8:11]
    v_cvt_pk_bf16_f32 v97, v22, v23
    v_add_f32 v149, v149, v23
    v_mfma_f32_16x16x32_bf16 a[8:11], a[180:183], v[84:87], a[8:11]
    s_waitcnt vmcnt(4)
    ds_read_b128 a[172:175], v242 offset:4608
    v_exp_f32 v24, v24
    v_mfma_f32_16x16x32_bf16 a[12:15], a[180:183], v[88:91], a[12:15]
    buffer_load_dwordx4 v15, s[12:15], s91 offen offset:3072 nt lds
    v_exp_f32 v25, v25
    v_mfma_f32_16x16x32_bf16 a[12:15], a[176:179], v[68:71], a[12:15]
    v_exp_f32 v26, v26
    v_mfma_f32_16x16x32_bf16 a[16:19], a[176:179], v[72:75], a[16:19]
    s_waitcnt lgkmcnt(8)
    ds_read_b64_tr_b16 a[176:177], v248
    v_exp_f32 v27, v27
    v_mfma_f32_16x16x32_bf16 a[36:39], a[184:187], v[72:75], a[36:39]
    v_add_f32 v150, v150, v24
    v_cvt_pk_bf16_f32 v100, v24, v25
    v_mfma_f32_16x16x32_bf16 a[32:35], a[184:187], v[68:71], a[32:35]
    s_waitcnt lgkmcnt(7)
    ds_read_b64_tr_b16 a[178:179], v248 offset:4096
    v_add_f32 v150, v150, v25
    v_add_f32 v150, v150, v26
    v_mfma_f32_16x16x32_bf16 a[32:35], a[188:191], v[88:91], a[32:35]
    v_cvt_pk_bf16_f32 v101, v26, v27
    v_add_f32 v150, v150, v27
    v_mfma_f32_16x16x32_bf16 a[28:31], a[188:191], v[84:87], a[28:31]
    ds_read_b64_tr_b16 a[180:181], v249
    v_exp_f32 v28, v28
    v_mfma_f32_16x16x32_bf16 a[28:31], a[184:187], v[64:67], a[28:31]
    ds_write_b128 v10, a[232:235] offset:2048
    v_mfma_f32_16x16x32_bf16 a[24:27], a[184:187], v[60:63], a[24:27]
    s_add_u32 m0, s78, 0
    ds_read_b64_tr_b16 a[182:183], v249 offset:4096
    v_exp_f32 v29, v29
    v_mfma_f32_16x16x32_bf16 a[24:27], a[188:191], v[80:83], a[24:27]
    s_add_u32 s91, s77, 0x1c000
    v_exp_f32 v30, v30
    v_add_f32 v151, v151, v28
    v_mfma_f32_16x16x32_bf16 a[20:23], a[188:191], v[76:79], a[20:23]
    s_xor_b32 s91, s91, s47
    v_exp_f32 v31, v31
    v_mfma_f32_16x16x32_bf16 a[20:23], a[184:187], v[56:59], a[20:23]
    s_waitcnt lgkmcnt(9)
    s_waitcnt vmcnt(4)
    ds_read_b64_tr_b16 a[184:185], v250
    v_cvt_pk_bf16_f32 v104, v28, v29
    v_add_f32 v151, v151, v29
    v_mfma_f32_16x16x32_bf16 v[36:39], a[160:163], v[160:163], v[128:131]
    s_waitcnt lgkmcnt(9)
    ds_read_b64_tr_b16 a[186:187], v250 offset:4096
    buffer_load_dwordx4 v3, s[12:15], s91 offen nt lds
    v_mfma_f32_16x16x32_bf16 v[36:39], a[164:167], v[164:167], v[36:39]
    s_waitcnt lgkmcnt(8)
    v_add_f32 v151, v151, v30
    v_cvt_pk_bf16_f32 v105, v30, v31
    v_add_f32 v151, v151, v31
    v_mfma_f32_16x16x32_bf16 v[36:39], a[168:171], v[168:171], v[36:39]
    s_waitcnt lgkmcnt(7)
    ds_read_b64_tr_b16 a[188:189], v251
    v_add_u32 v240, 0x10000, v240
    v_mfma_f32_16x16x32_bf16 v[36:39], a[172:175], v[172:175], v[36:39]
    v_exp_f32 v32, v32
    v_add_u32 v242, 0x10000, v242
    v_mfma_f32_16x16x32_bf16 v[40:43], a[172:175], v[188:191], v[132:135]
    ds_read_b64_tr_b16 a[190:191], v251 offset:4096
    v_mfma_f32_16x16x32_bf16 v[40:43], a[168:171], v[184:187], v[40:43]
    ds_write_b128 v10, a[236:239] offset:3072
    v_mfma_f32_16x16x32_bf16 v[40:43], a[164:167], v[180:183], v[40:43]
    v_exp_f32 v33, v33
    v_add_f32 v152, v152, v32
    v_mfma_f32_16x16x32_bf16 v[40:43], a[160:163], v[176:179], v[40:43]
    v_exp_f32 v34, v34
    v_mfma_f32_16x16x32_bf16 v[44:47], a[160:163], v[192:195], v[136:139]
    v_exp_f32 v35, v35
    v_cvt_pk_bf16_f32 v108, v32, v33
    v_mfma_f32_16x16x32_bf16 v[44:47], a[164:167], v[196:199], v[44:47]
    v_exp_f32 v36, v36
    v_mfma_f32_16x16x32_bf16 v[44:47], a[168:171], v[200:203], v[44:47]
    s_waitcnt vmcnt(4)
    v_exp_f32 v37, v37
    v_add_f32 v152, v152, v33
    v_mfma_f32_16x16x32_bf16 v[44:47], a[172:175], v[204:207], v[44:47]
    buffer_load_dwordx4 v15, s[12:15], s91 offen offset:1024 nt lds
    v_add_f32 v152, v152, v34
    v_mfma_f32_16x16x32_bf16 v[48:51], a[172:175], v[220:223], v[140:143]
    v_exp_f32 v38, v38
    v_cvt_pk_bf16_f32 v109, v34, v35
    v_mfma_f32_16x16x32_bf16 v[48:51], a[168:171], v[216:219], v[48:51]
    v_exp_f32 v39, v39
    v_mfma_f32_16x16x32_bf16 v[48:51], a[164:167], v[212:215], v[48:51]
    v_add_f32 v152, v152, v35
    v_add_f32 v148, v148, v36
    v_cvt_pk_bf16_f32 v94, v36, v37
    v_mfma_f32_16x16x32_bf16 v[48:51], a[160:163], v[208:211], v[48:51]
    v_add_f32 v148, v148, v37
    v_add_f32 v148, v148, v38
    v_cvt_pk_bf16_f32 v95, v38, v39
    v_mfma_f32_16x16x32_bf16 v[52:55], a[160:163], v[224:227], v[144:147]
    ds_write_b128 v10, a[240:243] offset:4096
    v_mfma_f32_16x16x32_bf16 v[52:55], a[164:167], v[228:231], v[52:55]
    v_add_f32 v148, v148, v39
    v_exp_f32 v40, v40
    v_mfma_f32_16x16x32_bf16 v[52:55], a[168:171], v[232:235], v[52:55]
    v_exp_f32 v41, v41
    v_mfma_f32_16x16x32_bf16 v[52:55], a[172:175], v[236:239], v[52:55]
    s_waitcnt lgkmcnt(9)
    ds_read_b128 a[160:163], v241
    v_exp_f32 v42, v42
    v_mfma_f32_16x16x32_bf16 a[40:43], a[176:179], v[56:59], a[40:43]
    s_waitcnt lgkmcnt(7)
    v_exp_f32 v43, v43
    v_mfma_f32_16x16x32_bf16 a[40:43], a[180:183], v[76:79], a[40:43]
    s_waitcnt vmcnt(4)
    ds_read_b128 a[164:167], v243
    v_add_f32 v149, v149, v40
    v_cvt_pk_bf16_f32 v98, v40, v41
    v_mfma_f32_16x16x32_bf16 a[44:47], a[180:183], v[80:83], a[44:47]
    buffer_load_dwordx4 v3, s[12:15], s91 offen offset:2048 nt lds
    v_add_f32 v149, v149, v41
    v_mfma_f32_16x16x32_bf16 a[44:47], a[176:179], v[60:63], a[44:47]
    ds_read_b128 a[168:171], v241 offset:512
    v_add_f32 v149, v149, v42
    v_cvt_pk_bf16_f32 v99, v42, v43
    v_mfma_f32_16x16x32_bf16 a[48:51], a[176:179], v[64:67], a[48:51]
    v_add_f32 v149, v149, v43
    v_exp_f32 v44, v44
    v_mfma_f32_16x16x32_bf16 a[48:51], a[180:183], v[84:87], a[48:51]
    ds_read_b128 a[172:175], v243 offset:512
    v_mfma_f32_16x16x32_bf16 a[52:55], a[180:183], v[88:91], a[52:55]
    ds_write_b128 v10, a[244:247] offset:5120
    v_mfma_f32_16x16x32_bf16 a[52:55], a[176:179], v[68:71], a[52:55]
    v_exp_f32 v45, v45
    v_mfma_f32_16x16x32_bf16 a[56:59], a[176:179], v[72:75], a[56:59]
    s_waitcnt lgkmcnt(9)
    ds_read_b64_tr_b16 a[176:177], v244 offset:512
    v_exp_f32 v46, v46
    v_mfma_f32_16x16x32_bf16 a[76:79], a[184:187], v[72:75], a[76:79]
    v_exp_f32 v47, v47
    v_mfma_f32_16x16x32_bf16 a[72:75], a[184:187], v[68:71], a[72:75]
    s_waitcnt lgkmcnt(8)
    ds_read_b64_tr_b16 a[178:179], v244 offset:4608
    v_add_f32 v150, v150, v44
    v_cvt_pk_bf16_f32 v102, v44, v45
    v_mfma_f32_16x16x32_bf16 a[72:75], a[188:191], v[88:91], a[72:75]
    v_add_f32 v150, v150, v45
    v_add_f32 v150, v150, v46
    v_mfma_f32_16x16x32_bf16 a[68:71], a[188:191], v[84:87], a[68:71]
    ds_read_b64_tr_b16 a[180:181], v245 offset:512
    v_cvt_pk_bf16_f32 v103, v46, v47
    v_add_f32 v150, v150, v47
    v_mfma_f32_16x16x32_bf16 a[68:71], a[184:187], v[64:67], a[68:71]
    s_waitcnt vmcnt(4)
    v_exp_f32 v48, v48
    v_mfma_f32_16x16x32_bf16 a[64:67], a[184:187], v[60:63], a[64:67]
    ds_read_b64_tr_b16 a[182:183], v245 offset:4608
    buffer_load_dwordx4 v15, s[12:15], s91 offen offset:3072 nt lds
    v_mfma_f32_16x16x32_bf16 a[64:67], a[188:191], v[80:83], a[64:67]
    v_exp_f32 v49, v49
    v_add_f32 v151, v151, v48
    v_mfma_f32_16x16x32_bf16 a[60:63], a[188:191], v[76:79], a[60:63]
    v_exp_f32 v50, v50
    v_mfma_f32_16x16x32_bf16 a[60:63], a[184:187], v[56:59], a[60:63]
    s_waitcnt lgkmcnt(8)
    ds_read_b64_tr_b16 a[184:185], v246 offset:512
    ds_write_b128 v10, a[248:251] offset:6144
    v_mfma_f32_16x16x32_bf16 v[16:19], a[160:163], v[160:163], v[128:131]
    s_waitcnt lgkmcnt(9)
    ds_read_b64_tr_b16 a[186:187], v246 offset:4608
    v_cvt_pk_bf16_f32 v106, v48, v49
    v_mfma_f32_16x16x32_bf16 v[16:19], a[164:167], v[164:167], v[16:19]
    s_waitcnt lgkmcnt(9)
    v_exp_f32 v51, v51
    v_add_f32 v151, v151, v49
    v_mfma_f32_16x16x32_bf16 v[16:19], a[168:171], v[168:171], v[16:19]
    s_waitcnt lgkmcnt(8)
    ds_read_b64_tr_b16 a[188:189], v247 offset:512
    v_add_f32 v151, v151, v50
    v_mfma_f32_16x16x32_bf16 v[16:19], a[172:175], v[172:175], v[16:19]
    s_add_u32 m0, m0, 0x1000
    v_cvt_pk_bf16_f32 v107, v50, v51
    v_add_f32 v151, v151, v51
    v_mfma_f32_16x16x32_bf16 v[20:23], a[172:175], v[188:191], v[132:135]
    s_add_u32 s91, s77, 0x1d000
    ds_read_b64_tr_b16 a[190:191], v247 offset:4608
    v_add_u32 v244, 0x10000, v244
    v_add_u32 v245, 0x10000, v245
    v_mfma_f32_16x16x32_bf16 v[20:23], a[168:171], v[184:187], v[20:23]
    s_xor_b32 s91, s91, s47
    v_add_u32 v246, 0x10000, v246
    v_add_u32 v247, 0x10000, v247
    v_mfma_f32_16x16x32_bf16 v[20:23], a[164:167], v[180:183], v[20:23]
    s_waitcnt vmcnt(4)
    v_exp_f32 v52, v52
    v_mfma_f32_16x16x32_bf16 v[20:23], a[160:163], v[176:179], v[20:23]
    buffer_load_dwordx4 v3, s[12:15], s91 offen nt lds
    v_mfma_f32_16x16x32_bf16 v[24:27], a[160:163], v[192:195], v[136:139]
    v_exp_f32 v53, v53
    v_add_f32 v152, v152, v52
    v_mfma_f32_16x16x32_bf16 v[24:27], a[164:167], v[196:199], v[24:27]
    ds_write_b128 v10, a[252:255] offset:7168
    v_mfma_f32_16x16x32_bf16 v[24:27], a[168:171], v[200:203], v[24:27]
    v_exp_f32 v54, v54
    v_cvt_pk_bf16_f32 v110, v52, v53
    v_mfma_f32_16x16x32_bf16 v[24:27], a[172:175], v[204:207], v[24:27]
    v_exp_f32 v55, v55
    v_mfma_f32_16x16x32_bf16 v[28:31], a[172:175], v[220:223], v[140:143]
    v_exp_f32 v16, v16
    v_add_f32 v152, v152, v53
    v_mfma_f32_16x16x32_bf16 v[28:31], a[168:171], v[216:219], v[28:31]
    v_exp_f32 v17, v17
    v_add_f32 v152, v152, v54
    v_mfma_f32_16x16x32_bf16 v[28:31], a[164:167], v[212:215], v[28:31]
    v_exp_f32 v18, v18
    v_mfma_f32_16x16x32_bf16 v[28:31], a[160:163], v[208:211], v[28:31]
    s_waitcnt lgkmcnt(8)
    ds_read_b128 a[160:163], v241 offset:4096
    v_exp_f32 v19, v19
    v_mfma_f32_16x16x32_bf16 a[80:83], a[176:179], v[56:59], a[80:83]
    s_waitcnt lgkmcnt(7)
    v_exp_f32 v20, v20
    v_mfma_f32_16x16x32_bf16 a[80:83], a[180:183], v[76:79], a[80:83]
    ds_read_b128 a[164:167], v243 offset:4096
    v_exp_f32 v21, v21
    v_mfma_f32_16x16x32_bf16 a[84:87], a[180:183], v[80:83], a[84:87]
    s_waitcnt vmcnt(4)
    v_exp_f32 v22, v22
    v_mfma_f32_16x16x32_bf16 a[84:87], a[176:179], v[60:63], a[84:87]
    ds_read_b128 a[168:171], v241 offset:4608
    buffer_load_dwordx4 v15, s[12:15], s91 offen offset:1024 nt lds
    v_cvt_pk_bf16_f32 v111, v54, v55
    v_mfma_f32_16x16x32_bf16 a[88:91], a[176:179], v[64:67], a[88:91]
    v_exp_f32 v23, v23
    v_mfma_f32_16x16x32_bf16 a[88:91], a[180:183], v[84:87], a[88:91]
    ds_read_b128 a[172:175], v243 offset:4608
    v_add_u32 v241, 0x10000, v241
    v_add_u32 v243, 0x10000, v243
    v_mfma_f32_16x16x32_bf16 a[92:95], a[180:183], v[88:91], a[92:95]
    v_exp_f32 v24, v24
    v_add_f32 v152, v152, v55
    v_mfma_f32_16x16x32_bf16 a[92:95], a[176:179], v[68:71], a[92:95]
    v_exp_f32 v25, v25
    v_mfma_f32_16x16x32_bf16 a[96:99], a[176:179], v[72:75], a[96:99]
    s_waitcnt lgkmcnt(7)
    ds_read_b64_tr_b16 a[176:177], v248 offset:512
    v_exp_f32 v26, v26
    v_mfma_f32_16x16x32_bf16 a[116:119], a[184:187], v[72:75], a[116:119]
    v_exp_f32 v27, v27
    v_mfma_f32_16x16x32_bf16 a[112:115], a[184:187], v[68:71], a[112:115]
    s_waitcnt lgkmcnt(6)
    ds_read_b64_tr_b16 a[178:179], v248 offset:4608
    v_exp_f32 v28, v28
    v_mfma_f32_16x16x32_bf16 a[112:115], a[188:191], v[88:91], a[112:115]
    v_exp_f32 v29, v29
    v_mfma_f32_16x16x32_bf16 a[108:111], a[188:191], v[84:87], a[108:111]
    ds_read_b64_tr_b16 a[180:181], v249 offset:512
    v_exp_f32 v30, v30
    v_mfma_f32_16x16x32_bf16 a[108:111], a[184:187], v[64:67], a[108:111]
    s_waitcnt vmcnt(4)
    v_exp_f32 v31, v31
    v_mfma_f32_16x16x32_bf16 a[104:107], a[184:187], v[60:63], a[104:107]
    ds_read_b64_tr_b16 a[182:183], v249 offset:4608
    buffer_load_dwordx4 v3, s[12:15], s91 offen offset:2048 nt lds
    v_add_u32 v248, 0x10000, v248
    v_mfma_f32_16x16x32_bf16 a[104:107], a[188:191], v[80:83], a[104:107]
    v_add_u32 v249, 0x10000, v249
    v_add_f32 v148, v148, v16
    v_cvt_pk_bf16_f32 v112, v16, v17
    v_mfma_f32_16x16x32_bf16 a[100:103], a[188:191], v[76:79], a[100:103]
    v_add_f32 v148, v148, v17
    v_add_f32 v148, v148, v18
    v_mfma_f32_16x16x32_bf16 a[100:103], a[184:187], v[56:59], a[100:103]
    s_waitcnt lgkmcnt(7)
    ds_read_b64_tr_b16 a[184:185], v250 offset:512
    v_cvt_pk_bf16_f32 v113, v18, v19
    v_add_f32 v148, v148, v19
    v_mfma_f32_16x16x32_bf16 v[36:39], a[160:163], v[160:163], v[128:131]
    s_waitcnt lgkmcnt(7)
    ds_read_b64_tr_b16 a[186:187], v250 offset:4608
    v_add_f32 v149, v149, v20
    v_mfma_f32_16x16x32_bf16 v[36:39], a[164:167], v[164:167], v[36:39]
    s_waitcnt lgkmcnt(7)
    v_cvt_pk_bf16_f32 v116, v20, v21
    v_add_f32 v149, v149, v21
    v_add_f32 v149, v149, v22
    v_mfma_f32_16x16x32_bf16 v[36:39], a[168:171], v[168:171], v[36:39]
    s_waitcnt lgkmcnt(6)
    ds_read_b64_tr_b16 a[188:189], v251 offset:512
    v_cvt_pk_bf16_f32 v117, v22, v23
    v_mfma_f32_16x16x32_bf16 v[36:39], a[172:175], v[172:175], v[36:39]
    v_add_f32 v149, v149, v23
    v_add_f32 v150, v150, v24
    v_cvt_pk_bf16_f32 v120, v24, v25
    v_mfma_f32_16x16x32_bf16 v[40:43], a[172:175], v[188:191], v[132:135]
    ds_read_b64_tr_b16 a[190:191], v251 offset:4608
    v_add_u32 v250, 0x10000, v250
    v_mfma_f32_16x16x32_bf16 v[40:43], a[168:171], v[184:187], v[40:43]
    v_add_u32 v251, 0x10000, v251
    v_add_f32 v150, v150, v25
    v_add_f32 v150, v150, v26
    v_mfma_f32_16x16x32_bf16 v[40:43], a[164:167], v[180:183], v[40:43]
    v_cvt_pk_bf16_f32 v121, v26, v27
    v_add_f32 v150, v150, v27
    v_add_f32 v151, v151, v28
    v_mfma_f32_16x16x32_bf16 v[40:43], a[160:163], v[176:179], v[40:43]
    v_cvt_pk_bf16_f32 v124, v28, v29
    v_add_f32 v151, v151, v29
    v_mfma_f32_16x16x32_bf16 v[44:47], a[160:163], v[192:195], v[136:139]
    v_add_f32 v151, v151, v30
    v_cvt_pk_bf16_f32 v125, v30, v31
    v_add_f32 v151, v151, v31
    v_mfma_f32_16x16x32_bf16 v[44:47], a[164:167], v[196:199], v[44:47]
    v_mfma_f32_16x16x32_bf16 v[44:47], a[168:171], v[200:203], v[44:47]
    v_mfma_f32_16x16x32_bf16 v[44:47], a[172:175], v[204:207], v[44:47]
    v_mfma_f32_16x16x32_bf16 v[48:51], a[172:175], v[220:223], v[140:143]
    v_mfma_f32_16x16x32_bf16 v[48:51], a[168:171], v[216:219], v[48:51]
    s_waitcnt vmcnt(7) lgkmcnt(0)
    v_mfma_f32_16x16x32_bf16 v[48:51], a[164:167], v[212:215], v[48:51]
    s_barrier
    v_mfma_f32_16x16x32_bf16 v[48:51], a[160:163], v[208:211], v[48:51]
    v_mfma_f32_16x16x32_bf16 a[120:123], a[176:179], v[56:59], a[120:123]
    ds_read_b128 a[160:163], v240
    v_mfma_f32_16x16x32_bf16 a[120:123], a[180:183], v[76:79], a[120:123]
    ds_read_b128 a[164:167], v242
    v_mfma_f32_16x16x32_bf16 a[124:127], a[180:183], v[80:83], a[124:127]
    s_waitcnt vmcnt(4)
    v_exp_f32 v36, v36
    v_mfma_f32_16x16x32_bf16 a[124:127], a[176:179], v[60:63], a[124:127]
    ds_read_b128 a[168:171], v240 offset:512
    buffer_load_dwordx4 v15, s[12:15], s91 offen offset:3072 nt lds
    v_mfma_f32_16x16x32_bf16 a[128:131], a[176:179], v[64:67], a[128:131]
    v_exp_f32 v37, v37
    v_mfma_f32_16x16x32_bf16 a[128:131], a[180:183], v[84:87], a[128:131]
    ds_read_b128 a[172:175], v242 offset:512
    v_exp_f32 v38, v38
    v_mfma_f32_16x16x32_bf16 a[132:135], a[180:183], v[88:91], a[132:135]
    v_exp_f32 v39, v39
    v_mfma_f32_16x16x32_bf16 a[132:135], a[176:179], v[68:71], a[132:135]
    v_exp_f32 v40, v40
    v_add_f32 v148, v148, v36
    v_mfma_f32_16x16x32_bf16 a[136:139], a[176:179], v[72:75], a[136:139]
    ds_read_b64_tr_b16 a[176:177], v244
    v_cvt_pk_bf16_f32 v114, v36, v37
    v_mfma_f32_16x16x32_bf16 a[156:159], a[184:187], v[72:75], a[156:159]
    s_add_u32 m0, s78, 0x8000
    v_exp_f32 v41, v41
    v_mfma_f32_16x16x32_bf16 a[152:155], a[184:187], v[68:71], a[152:155]
    s_add_u32 s91, s77, 0x18000
    ds_read_b64_tr_b16 a[178:179], v244 offset:4096
    v_exp_f32 v42, v42
    v_mfma_f32_16x16x32_bf16 a[152:155], a[188:191], v[88:91], a[152:155]
    s_xor_b32 s91, s91, s47
    v_exp_f32 v43, v43
    v_mfma_f32_16x16x32_bf16 a[148:151], a[188:191], v[84:87], a[148:151]
    s_waitcnt vmcnt(4)
    ds_read_b64_tr_b16 a[180:181], v245
    v_add_f32 v148, v148, v37
    v_mfma_f32_16x16x32_bf16 a[148:151], a[184:187], v[64:67], a[148:151]
    buffer_load_dwordx4 v3, s[16:19], s91 offen nt lds
    v_exp_f32 v44, v44
    v_mfma_f32_16x16x32_bf16 a[144:147], a[184:187], v[60:63], a[144:147]
    ds_read_b64_tr_b16 a[182:183], v245 offset:4096
    v_add_f32 v148, v148, v38
    v_mfma_f32_16x16x32_bf16 a[144:147], a[188:191], v[80:83], a[144:147]
    v_exp_f32 v45, v45
    v_cvt_pk_bf16_f32 v115, v38, v39
    v_mfma_f32_16x16x32_bf16 a[140:143], a[188:191], v[76:79], a[140:143]
    v_exp_f32 v46, v46
    v_mfma_f32_16x16x32_bf16 a[140:143], a[184:187], v[56:59], a[140:143]
    s_waitcnt lgkmcnt(7)
    ds_read_b64_tr_b16 a[184:185], v246
    v_add_f32 v148, v148, v39
    v_mfma_f32_16x16x32_bf16 v[16:19], a[160:163], v[160:163], v[128:131]
    s_waitcnt lgkmcnt(7)
    ds_read_b64_tr_b16 a[186:187], v246 offset:4096
    v_exp_f32 v47, v47
    v_mfma_f32_16x16x32_bf16 v[16:19], a[164:167], v[164:167], v[16:19]
    s_waitcnt lgkmcnt(7)
    v_exp_f32 v48, v48
    v_mfma_f32_16x16x32_bf16 v[16:19], a[168:171], v[168:171], v[16:19]
    s_waitcnt lgkmcnt(6)
    ds_read_b64_tr_b16 a[188:189], v247
    v_exp_f32 v49, v49
    v_mfma_f32_16x16x32_bf16 v[16:19], a[172:175], v[172:175], v[16:19]
    v_exp_f32 v50, v50
    v_mfma_f32_16x16x32_bf16 v[20:23], a[172:175], v[188:191], v[132:135]
    ds_read_b64_tr_b16 a[190:191], v247 offset:4096
    v_add_f32 v149, v149, v40
    v_mfma_f32_16x16x32_bf16 v[20:23], a[168:171], v[184:187], v[20:23]
    v_exp_f32 v51, v51
    v_cvt_pk_bf16_f32 v118, v40, v41
    v_mfma_f32_16x16x32_bf16 v[20:23], a[164:167], v[180:183], v[20:23]
    s_waitcnt vmcnt(4)
    v_add_f32 v149, v149, v41
    v_add_f32 v149, v149, v42
    v_mfma_f32_16x16x32_bf16 v[20:23], a[160:163], v[176:179], v[20:23]
    buffer_load_dwordx4 v15, s[16:19], s91 offen offset:1024 nt lds
    v_cvt_pk_bf16_f32 v119, v42, v43
    v_mfma_f32_16x16x32_bf16 v[24:27], a[160:163], v[192:195], v[136:139]
    v_add_f32 v149, v149, v43
    v_add_f32 v150, v150, v44
    v_cvt_pk_bf16_f32 v122, v44, v45
    v_mfma_f32_16x16x32_bf16 v[24:27], a[164:167], v[196:199], v[24:27]
    v_add_f32 v150, v150, v45
    v_add_f32 v150, v150, v46
    v_mfma_f32_16x16x32_bf16 v[24:27], a[168:171], v[200:203], v[24:27]
    v_cvt_pk_bf16_f32 v123, v46, v47
    v_add_f32 v150, v150, v47
    v_add_f32 v151, v151, v48
    v_mfma_f32_16x16x32_bf16 v[24:27], a[172:175], v[204:207], v[24:27]
    v_cvt_pk_bf16_f32 v126, v48, v49
    v_add_f32 v151, v151, v49
    v_mfma_f32_16x16x32_bf16 v[28:31], a[172:175], v[220:223], v[140:143]
    v_add_f32 v151, v151, v50
    v_cvt_pk_bf16_f32 v127, v50, v51
    v_mfma_f32_16x16x32_bf16 v[28:31], a[168:171], v[216:219], v[28:31]
    v_add_f32 v151, v151, v51
    v_exp_f32 v16, v16
    v_mfma_f32_16x16x32_bf16 v[28:31], a[164:167], v[212:215], v[28:31]
    v_exp_f32 v17, v17
    v_mfma_f32_16x16x32_bf16 v[28:31], a[160:163], v[208:211], v[28:31]
    v_exp_f32 v18, v18
    v_mfma_f32_16x16x32_bf16 v[32:35], a[160:163], v[224:227], v[144:147]
    v_exp_f32 v19, v19
    v_add_f32 v148, v148, v16
    v_mfma_f32_16x16x32_bf16 v[32:35], a[164:167], v[228:231], v[32:35]
    s_waitcnt vmcnt(4)
    v_cvt_pk_bf16_f32 v56, v16, v17
    v_add_f32 v148, v148, v17
    v_mfma_f32_16x16x32_bf16 v[32:35], a[168:171], v[232:235], v[32:35]
    buffer_load_dwordx4 v3, s[16:19], s91 offen offset:2048 nt lds
    v_add_f32 v148, v148, v18
    v_cvt_pk_bf16_f32 v57, v18, v19
    v_mfma_f32_16x16x32_bf16 v[32:35], a[172:175], v[236:239], v[32:35]
    s_waitcnt lgkmcnt(6)
    ds_read_b128 a[160:163], v240 offset:4096
    v_add_f32 v148, v148, v19
    v_mfma_f32_16x16x32_bf16 a[0:3], a[176:179], v[92:95], a[0:3]
    s_waitcnt lgkmcnt(5)
    v_exp_f32 v20, v20
    v_mfma_f32_16x16x32_bf16 a[0:3], a[180:183], v[112:115], a[0:3]
    ds_read_b128 a[164:167], v242 offset:4096
    v_exp_f32 v21, v21
    v_mfma_f32_16x16x32_bf16 a[4:7], a[180:183], v[116:119], a[4:7]
    v_exp_f32 v22, v22
    v_mfma_f32_16x16x32_bf16 a[4:7], a[176:179], v[96:99], a[4:7]
    ds_read_b128 a[168:171], v240 offset:4608
    v_exp_f32 v23, v23
    v_mfma_f32_16x16x32_bf16 a[8:11], a[176:179], v[100:103], a[8:11]
    v_add_f32 v149, v149, v20
    v_cvt_pk_bf16_f32 v60, v20, v21
    v_mfma_f32_16x16x32_bf16 a[8:11], a[180:183], v[120:123], a[8:11]
    ds_read_b128 a[172:175], v242 offset:4608
    v_add_f32 v149, v149, v21
    v_mfma_f32_16x16x32_bf16 a[12:15], a[180:183], v[124:127], a[12:15]
    v_add_f32 v149, v149, v22
    v_cvt_pk_bf16_f32 v61, v22, v23
    v_add_f32 v149, v149, v23
    v_mfma_f32_16x16x32_bf16 a[12:15], a[176:179], v[104:107], a[12:15]
    v_exp_f32 v24, v24
    v_mfma_f32_16x16x32_bf16 a[16:19], a[176:179], v[108:111], a[16:19]
    s_waitcnt lgkmcnt(6)
    s_waitcnt vmcnt(4)
    ds_read_b64_tr_b16 a[176:177], v248
    v_add_u32 v240, 0xfffe8000, v240
    v_mfma_f32_16x16x32_bf16 a[36:39], a[184:187], v[108:111], a[36:39]
    buffer_load_dwordx4 v15, s[16:19], s91 offen offset:3072 nt lds
    v_exp_f32 v25, v25
    v_mfma_f32_16x16x32_bf16 a[32:35], a[184:187], v[104:107], a[32:35]
    s_waitcnt lgkmcnt(5)
    ds_read_b64_tr_b16 a[178:179], v248 offset:4096
    v_add_f32 v150, v150, v24
    v_mfma_f32_16x16x32_bf16 a[32:35], a[188:191], v[124:127], a[32:35]
    v_exp_f32 v26, v26
    v_cvt_pk_bf16_f32 v64, v24, v25
    v_mfma_f32_16x16x32_bf16 a[28:31], a[188:191], v[120:123], a[28:31]
    ds_read_b64_tr_b16 a[180:181], v249
    v_add_f32 v150, v150, v25
    v_mfma_f32_16x16x32_bf16 a[28:31], a[184:187], v[100:103], a[28:31]
    v_exp_f32 v27, v27
    v_mfma_f32_16x16x32_bf16 a[24:27], a[184:187], v[96:99], a[24:27]
    ds_read_b64_tr_b16 a[182:183], v249 offset:4096
    v_add_f32 v150, v150, v26
    v_cvt_pk_bf16_f32 v65, v26, v27
    v_mfma_f32_16x16x32_bf16 a[24:27], a[188:191], v[116:119], a[24:27]
    v_add_f32 v150, v150, v27
    v_add_u32 v242, 0xfffe8000, v242
    v_mfma_f32_16x16x32_bf16 a[20:23], a[188:191], v[112:115], a[20:23]
    v_exp_f32 v28, v28
    v_lshrrev_b32 v11, 4, v0
    v_mfma_f32_16x16x32_bf16 a[20:23], a[184:187], v[92:95], a[20:23]
    s_waitcnt lgkmcnt(7)
    s_add_u32 m0, m0, 0x1000
    ds_read_b64_tr_b16 a[184:185], v250
    v_bfe_u32 v12, v0, 2, 2
    v_mfma_f32_16x16x32_bf16 v[36:39], a[160:163], v[160:163], v[128:131]
    s_waitcnt lgkmcnt(7)
    s_add_u32 s91, s77, 0x19000
    ds_read_b64_tr_b16 a[186:187], v250 offset:4096
    v_and_b32 v13, 3, v0
    v_mfma_f32_16x16x32_bf16 v[36:39], a[164:167], v[164:167], v[36:39]
    s_waitcnt lgkmcnt(7)
    s_xor_b32 s91, s91, s47
    v_exp_f32 v29, v29
    v_add_f32 v151, v151, v28
    v_mfma_f32_16x16x32_bf16 v[36:39], a[168:171], v[168:171], v[36:39]
    s_waitcnt lgkmcnt(6)
    s_waitcnt vmcnt(4)
    ds_read_b64_tr_b16 a[188:189], v251
    v_and_b32 v14, 1, v11
    v_mfma_f32_16x16x32_bf16 v[36:39], a[172:175], v[172:175], v[36:39]
    buffer_load_dwordx4 v3, s[16:19], s91 offen nt lds
    v_lshl_add_u32 v14, v14, 2, v12
    v_mfma_f32_16x16x32_bf16 v[40:43], a[172:175], v[188:191], v[132:135]
    ds_read_b64_tr_b16 a[190:191], v251 offset:4096
    v_exp_f32 v30, v30
    v_mfma_f32_16x16x32_bf16 v[40:43], a[168:171], v[184:187], v[40:43]
    v_exp_f32 v31, v31
    v_mfma_f32_16x16x32_bf16 v[40:43], a[164:167], v[180:183], v[40:43]
    v_cvt_pk_bf16_f32 v68, v28, v29
    v_add_f32 v151, v151, v29
    v_add_f32 v151, v151, v30
    v_mfma_f32_16x16x32_bf16 v[40:43], a[160:163], v[176:179], v[40:43]
    v_cvt_pk_bf16_f32 v69, v30, v31
    v_add_f32 v151, v151, v31
    v_mfma_f32_16x16x32_bf16 v[44:47], a[160:163], v[192:195], v[136:139]
    v_exp_f32 v32, v32
    v_mfma_f32_16x16x32_bf16 v[44:47], a[164:167], v[196:199], v[44:47]
    v_exp_f32 v33, v33
    v_add_f32 v152, v152, v32
    v_mfma_f32_16x16x32_bf16 v[44:47], a[168:171], v[200:203], v[44:47]
    v_exp_f32 v34, v34
    v_mfma_f32_16x16x32_bf16 v[44:47], a[172:175], v[204:207], v[44:47]
    v_exp_f32 v35, v35
    v_mfma_f32_16x16x32_bf16 v[48:51], a[172:175], v[220:223], v[140:143]
    v_exp_f32 v36, v36
    v_cvt_pk_bf16_f32 v72, v32, v33
    v_mfma_f32_16x16x32_bf16 v[48:51], a[168:171], v[216:219], v[48:51]
    s_waitcnt vmcnt(4)
    v_exp_f32 v37, v37
    v_mfma_f32_16x16x32_bf16 v[48:51], a[164:167], v[212:215], v[48:51]
    buffer_load_dwordx4 v15, s[16:19], s91 offen offset:1024 nt lds
    v_exp_f32 v38, v38
    v_mfma_f32_16x16x32_bf16 v[48:51], a[160:163], v[208:211], v[48:51]
    v_exp_f32 v39, v39
    v_mfma_f32_16x16x32_bf16 v[52:55], a[160:163], v[224:227], v[144:147]
    v_add_f32 v152, v152, v33
    v_add_f32 v152, v152, v34
    v_mfma_f32_16x16x32_bf16 v[52:55], a[164:167], v[228:231], v[52:55]
    v_cvt_pk_bf16_f32 v73, v34, v35
    v_add_f32 v152, v152, v35
    v_add_f32 v148, v148, v36
    v_mfma_f32_16x16x32_bf16 v[52:55], a[168:171], v[232:235], v[52:55]
    v_cvt_pk_bf16_f32 v58, v36, v37
    v_add_f32 v148, v148, v37
    v_mfma_f32_16x16x32_bf16 v[52:55], a[172:175], v[236:239], v[52:55]
    s_waitcnt lgkmcnt(6)
    ds_read_b128 a[160:163], v241
    v_add_f32 v148, v148, v38
    v_cvt_pk_bf16_f32 v59, v38, v39
    v_mfma_f32_16x16x32_bf16 a[40:43], a[176:179], v[92:95], a[40:43]
    s_waitcnt lgkmcnt(5)
    v_add_f32 v148, v148, v39
    v_lshrrev_b32 v12, 1, v14
    v_mfma_f32_16x16x32_bf16 a[40:43], a[180:183], v[112:115], a[40:43]
    ds_read_b128 a[164:167], v243
    v_lshlrev_b32 v12, 5, v12
    v_mfma_f32_16x16x32_bf16 a[44:47], a[180:183], v[116:119], a[44:47]
    v_exp_f32 v40, v40
    v_lshl_add_u32 v12, v13, 3, v12
    v_mfma_f32_16x16x32_bf16 a[44:47], a[176:179], v[96:99], a[44:47]
    ds_read_b128 a[168:171], v241 offset:512
    v_lshl_add_u32 v12, v14, 7, v12
    v_mfma_f32_16x16x32_bf16 a[48:51], a[176:179], v[100:103], a[48:51]
    v_exp_f32 v41, v41
    v_mfma_f32_16x16x32_bf16 a[48:51], a[180:183], v[120:123], a[48:51]
    s_waitcnt vmcnt(4)
    ds_read_b128 a[172:175], v243 offset:512
    v_exp_f32 v42, v42
    v_mfma_f32_16x16x32_bf16 a[52:55], a[180:183], v[124:127], a[52:55]
    buffer_load_dwordx4 v3, s[16:19], s91 offen offset:2048 nt lds
    v_add_f32 v149, v149, v40
    v_mfma_f32_16x16x32_bf16 a[52:55], a[176:179], v[104:107], a[52:55]
    v_exp_f32 v43, v43
    v_cvt_pk_bf16_f32 v62, v40, v41
    v_mfma_f32_16x16x32_bf16 a[56:59], a[176:179], v[108:111], a[56:59]
    s_waitcnt lgkmcnt(6)
    ds_read_b64_tr_b16 a[176:177], v244 offset:512
    v_add_f32 v149, v149, v41
    v_mfma_f32_16x16x32_bf16 a[76:79], a[184:187], v[108:111], a[76:79]
    v_add_f32 v149, v149, v42
    v_cvt_pk_bf16_f32 v63, v42, v43
    v_mfma_f32_16x16x32_bf16 a[72:75], a[184:187], v[104:107], a[72:75]
    s_waitcnt lgkmcnt(5)
    ds_read_b64_tr_b16 a[178:179], v244 offset:4608
    v_add_f32 v149, v149, v43
    v_lshrrev_b32 v11, 1, v11
    v_mfma_f32_16x16x32_bf16 a[72:75], a[188:191], v[124:127], a[72:75]
    v_exp_f32 v44, v44
    v_mfma_f32_16x16x32_bf16 a[68:71], a[188:191], v[120:123], a[68:71]
    ds_read_b64_tr_b16 a[180:181], v245 offset:512
    v_lshl_add_u32 v12, v11, 10, v12
    v_mfma_f32_16x16x32_bf16 a[68:71], a[184:187], v[100:103], a[68:71]
    v_exp_f32 v45, v45
    v_add_f32 v150, v150, v44
    v_mfma_f32_16x16x32_bf16 a[64:67], a[184:187], v[96:99], a[64:67]
    ds_read_b64_tr_b16 a[182:183], v245 offset:4608
    v_add_u32 v5, s78, v12
    v_mfma_f32_16x16x32_bf16 a[64:67], a[188:191], v[116:119], a[64:67]
    v_exp_f32 v46, v46
    v_cvt_pk_bf16_f32 v66, v44, v45
    v_mfma_f32_16x16x32_bf16 a[60:63], a[188:191], v[112:115], a[60:63]
    s_waitcnt vmcnt(4)
    v_exp_f32 v47, v47
    v_mfma_f32_16x16x32_bf16 a[60:63], a[184:187], v[92:95], a[60:63]
    s_waitcnt lgkmcnt(7)
    ds_read_b64_tr_b16 a[184:185], v246 offset:512
    buffer_load_dwordx4 v15, s[16:19], s91 offen offset:3072 nt lds
    v_mfma_f32_16x16x32_bf16 v[16:19], a[160:163], v[160:163], v[128:131]
    s_waitcnt lgkmcnt(7)
    ds_read_b64_tr_b16 a[186:187], v246 offset:4608
    v_add_f32 v150, v150, v45
    v_add_f32 v150, v150, v46
    v_mfma_f32_16x16x32_bf16 v[16:19], a[164:167], v[164:167], v[16:19]
    s_waitcnt lgkmcnt(7)
    v_cvt_pk_bf16_f32 v67, v46, v47
    v_add_f32 v150, v150, v47
    v_mfma_f32_16x16x32_bf16 v[16:19], a[168:171], v[168:171], v[16:19]
    s_waitcnt lgkmcnt(6)
    ds_read_b64_tr_b16 a[188:189], v247 offset:512
    v_exp_f32 v48, v48
    v_mfma_f32_16x16x32_bf16 v[16:19], a[172:175], v[172:175], v[16:19]
    v_exp_f32 v49, v49
    v_mfma_f32_16x16x32_bf16 v[20:23], a[172:175], v[188:191], v[132:135]
    ds_read_b64_tr_b16 a[190:191], v247 offset:4608
    v_add_f32 v151, v151, v48
    v_mfma_f32_16x16x32_bf16 v[20:23], a[168:171], v[184:187], v[20:23]
    v_exp_f32 v50, v50
    v_cvt_pk_bf16_f32 v70, v48, v49
    v_mfma_f32_16x16x32_bf16 v[20:23], a[164:167], v[180:183], v[20:23]
    v_exp_f32 v51, v51
    v_mfma_f32_16x16x32_bf16 v[20:23], a[160:163], v[176:179], v[20:23]
    s_add_u32 m0, s78, 0x10000
    v_add_f32 v151, v151, v49
    v_add_f32 v151, v151, v50
    v_mfma_f32_16x16x32_bf16 v[24:27], a[160:163], v[192:195], v[136:139]
    s_add_u32 s91, s77, 0x1c000
    v_cvt_pk_bf16_f32 v71, v50, v51
    v_add_f32 v151, v151, v51
    v_add_u32 v244, 0xfffe8000, v244
    v_mfma_f32_16x16x32_bf16 v[24:27], a[164:167], v[196:199], v[24:27]
    s_xor_b32 s91, s91, s47
    v_add_u32 v245, 0xfffe8000, v245
    v_add_u32 v246, 0xfffe8000, v246
    v_mfma_f32_16x16x32_bf16 v[24:27], a[168:171], v[200:203], v[24:27]
    s_waitcnt vmcnt(4)
    v_add_u32 v247, 0xfffe8000, v247
    v_exp_f32 v52, v52
    v_mfma_f32_16x16x32_bf16 v[24:27], a[172:175], v[204:207], v[24:27]
    buffer_load_dwordx4 v3, s[16:19], s91 offen nt lds
    v_xor_b32 v6, 32, v5
    v_mfma_f32_16x16x32_bf16 v[28:31], a[172:175], v[220:223], v[140:143]
    v_exp_f32 v53, v53
    v_mfma_f32_16x16x32_bf16 v[28:31], a[168:171], v[216:219], v[28:31]
    v_exp_f32 v54, v54
    v_add_f32 v152, v152, v52
    v_mfma_f32_16x16x32_bf16 v[28:31], a[164:167], v[212:215], v[28:31]
    v_exp_f32 v55, v55
    v_mfma_f32_16x16x32_bf16 v[28:31], a[160:163], v[208:211], v[28:31]
    s_waitcnt lgkmcnt(6)
    ds_read_b128 a[160:163], v241 offset:4096
    v_exp_f32 v16, v16
    v_mfma_f32_16x16x32_bf16 a[80:83], a[176:179], v[92:95], a[80:83]
    s_waitcnt lgkmcnt(5)
    v_exp_f32 v17, v17
    v_mfma_f32_16x16x32_bf16 a[80:83], a[180:183], v[112:115], a[80:83]
    ds_read_b128 a[164:167], v243 offset:4096
    v_cvt_pk_bf16_f32 v74, v52, v53
    v_mfma_f32_16x16x32_bf16 a[84:87], a[180:183], v[116:119], a[84:87]
    v_exp_f32 v18, v18
    v_add_f32 v152, v152, v53
    v_mfma_f32_16x16x32_bf16 a[84:87], a[176:179], v[96:99], a[84:87]
    ds_read_b128 a[168:171], v241 offset:4608
    v_add_f32 v152, v152, v54
    v_mfma_f32_16x16x32_bf16 a[88:91], a[176:179], v[100:103], a[88:91]
    v_exp_f32 v19, v19
    v_mfma_f32_16x16x32_bf16 a[88:91], a[180:183], v[120:123], a[88:91]
    ds_read_b128 a[172:175], v243 offset:4608
    v_add_u32 v241, 0xfffe8000, v241
    v_add_u32 v243, 0xfffe8000, v243
    v_mfma_f32_16x16x32_bf16 a[92:95], a[180:183], v[124:127], a[92:95]
    s_waitcnt vmcnt(4)
    v_exp_f32 v20, v20
    v_mfma_f32_16x16x32_bf16 a[92:95], a[176:179], v[104:107], a[92:95]
    buffer_load_dwordx4 v15, s[16:19], s91 offen offset:1024 nt lds
    v_exp_f32 v21, v21
    v_mfma_f32_16x16x32_bf16 a[96:99], a[176:179], v[108:111], a[96:99]
    s_waitcnt lgkmcnt(6)
    ds_read_b64_tr_b16 a[176:177], v248 offset:512
    v_cvt_pk_bf16_f32 v75, v54, v55
    v_mfma_f32_16x16x32_bf16 a[116:119], a[184:187], v[108:111], a[116:119]
    v_exp_f32 v22, v22
    v_mfma_f32_16x16x32_bf16 a[112:115], a[184:187], v[104:107], a[112:115]
    s_waitcnt lgkmcnt(5)
    ds_read_b64_tr_b16 a[178:179], v248 offset:4608
    v_exp_f32 v23, v23
    v_mfma_f32_16x16x32_bf16 a[112:115], a[188:191], v[124:127], a[112:115]
    v_exp_f32 v24, v24
    v_mfma_f32_16x16x32_bf16 a[108:111], a[188:191], v[120:123], a[108:111]
    ds_read_b64_tr_b16 a[180:181], v249 offset:512
    v_add_f32 v152, v152, v55
    v_mfma_f32_16x16x32_bf16 a[108:111], a[184:187], v[100:103], a[108:111]
    v_exp_f32 v25, v25
    v_add_f32 v148, v148, v16
    v_mfma_f32_16x16x32_bf16 a[104:107], a[184:187], v[96:99], a[104:107]
    ds_read_b64_tr_b16 a[182:183], v249 offset:4608
    v_add_u32 v248, 0xfffe8000, v248
    v_mfma_f32_16x16x32_bf16 a[104:107], a[188:191], v[116:119], a[104:107]
    v_add_u32 v249, 0xfffe8000, v249
    v_exp_f32 v26, v26
    v_mfma_f32_16x16x32_bf16 a[100:103], a[188:191], v[112:115], a[100:103]
    v_exp_f32 v27, v27
    v_mfma_f32_16x16x32_bf16 a[100:103], a[184:187], v[92:95], a[100:103]
    s_waitcnt lgkmcnt(7)
    ds_read_b64_tr_b16 a[184:185], v250 offset:512
    v_cvt_pk_bf16_f32 v76, v16, v17
    v_mfma_f32_16x16x32_bf16 v[36:39], a[160:163], v[160:163], v[128:131]
    s_waitcnt lgkmcnt(7)
    s_waitcnt vmcnt(4)
    ds_read_b64_tr_b16 a[186:187], v250 offset:4608
    v_exp_f32 v28, v28
    v_mfma_f32_16x16x32_bf16 v[36:39], a[164:167], v[164:167], v[36:39]
    s_waitcnt lgkmcnt(7)
    buffer_load_dwordx4 v3, s[16:19], s91 offen offset:2048 nt lds
    v_add_f32 v148, v148, v17
    v_mfma_f32_16x16x32_bf16 v[36:39], a[168:171], v[168:171], v[36:39]
    s_waitcnt lgkmcnt(6)
    ds_read_b64_tr_b16 a[188:189], v251 offset:512
    v_exp_f32 v29, v29
    v_mfma_f32_16x16x32_bf16 v[36:39], a[172:175], v[172:175], v[36:39]
    v_exp_f32 v30, v30
    v_mfma_f32_16x16x32_bf16 v[40:43], a[172:175], v[188:191], v[132:135]
    ds_read_b64_tr_b16 a[190:191], v251 offset:4608
    v_add_u32 v250, 0xfffe8000, v250
    v_mfma_f32_16x16x32_bf16 v[40:43], a[168:171], v[184:187], v[40:43]
    v_add_u32 v251, 0xfffe8000, v251
    v_exp_f32 v31, v31
    v_mfma_f32_16x16x32_bf16 v[40:43], a[164:167], v[180:183], v[40:43]
    v_add_f32 v148, v148, v18
    v_cvt_pk_bf16_f32 v77, v18, v19
    v_mfma_f32_16x16x32_bf16 v[40:43], a[160:163], v[176:179], v[40:43]
    v_add_f32 v148, v148, v19
    v_add_f32 v149, v149, v20
    v_mfma_f32_16x16x32_bf16 v[44:47], a[160:163], v[192:195], v[136:139]
    v_cvt_pk_bf16_f32 v80, v20, v21
    v_add_f32 v149, v149, v21
    v_add_f32 v149, v149, v22
    v_mfma_f32_16x16x32_bf16 v[44:47], a[164:167], v[196:199], v[44:47]
    v_cvt_pk_bf16_f32 v81, v22, v23
    v_add_f32 v149, v149, v23
    v_mfma_f32_16x16x32_bf16 v[44:47], a[168:171], v[200:203], v[44:47]
    v_add_f32 v150, v150, v24
    v_cvt_pk_bf16_f32 v84, v24, v25
    v_add_f32 v150, v150, v25
    v_mfma_f32_16x16x32_bf16 v[44:47], a[172:175], v[204:207], v[44:47]
    v_add_f32 v150, v150, v26
    v_cvt_pk_bf16_f32 v85, v26, v27
    v_mfma_f32_16x16x32_bf16 v[48:51], a[172:175], v[220:223], v[140:143]
    v_add_f32 v150, v150, v27
    v_add_f32 v151, v151, v28
    v_mfma_f32_16x16x32_bf16 v[48:51], a[168:171], v[216:219], v[48:51]
    s_waitcnt vmcnt(3) lgkmcnt(0)
    v_cvt_pk_bf16_f32 v88, v28, v29
    v_add_f32 v151, v151, v29
    v_add_f32 v151, v151, v30
    v_mfma_f32_16x16x32_bf16 v[48:51], a[164:167], v[212:215], v[48:51]
    s_barrier
    v_cvt_pk_bf16_f32 v89, v30, v31
    v_add_f32 v151, v151, v31
    v_mfma_f32_16x16x32_bf16 v[48:51], a[160:163], v[208:211], v[48:51]
    v_xor_b32 v7, 64, v5
    v_xor_b32 v8, 0x60, v5
    s_lshl_b32 s93, s56, 21
    s_lshl_b32 s62, s94, 7
    s_add_u32 s93, s93, s62
    s_lshl_b32 s62, s3, 7
    s_lshl_b32 s63, s56, 5
    s_add_u32 s62, s62, s63
    s_mul_i32 s67, s62, 0x2400
    s_xor_b32 s95, s3, s94
    s_and_b32 s95, s95, 3
    v_mfma_f32_16x16x32_bf16 a[120:123], a[176:179], v[92:95], a[120:123]
    ds_read_b128 a[160:163], v240
    v_mfma_f32_16x16x32_bf16 a[120:123], a[180:183], v[112:115], a[120:123]
    ds_read_b128 a[164:167], v242
    v_mfma_f32_16x16x32_bf16 a[124:127], a[180:183], v[116:119], a[124:127]
    v_exp_f32 v36, v36
    v_mfma_f32_16x16x32_bf16 a[124:127], a[176:179], v[96:99], a[124:127]
    ds_read_b128 a[168:171], v240 offset:512
    v_mfma_f32_16x16x32_bf16 a[128:131], a[176:179], v[100:103], a[128:131]
    v_exp_f32 v37, v37
    v_mfma_f32_16x16x32_bf16 a[128:131], a[180:183], v[120:123], a[128:131]
    ds_read_b128 a[172:175], v242 offset:512
    v_exp_f32 v38, v38
    v_mfma_f32_16x16x32_bf16 a[132:135], a[180:183], v[124:127], a[132:135]
    s_waitcnt vmcnt(4)
    v_exp_f32 v39, v39
    v_mfma_f32_16x16x32_bf16 a[132:135], a[176:179], v[104:107], a[132:135]
    buffer_load_dwordx4 v15, s[16:19], s91 offen offset:3072 nt lds
    v_add_f32 v148, v148, v36
    v_mfma_f32_16x16x32_bf16 a[136:139], a[176:179], v[108:111], a[136:139]
    ds_read_b64_tr_b16 a[176:177], v244
    v_exp_f32 v40, v40
    v_mfma_f32_16x16x32_bf16 a[156:159], a[184:187], v[108:111], a[156:159]
    v_exp_f32 v41, v41
    v_mfma_f32_16x16x32_bf16 a[152:155], a[184:187], v[104:107], a[152:155]
    ds_read_b64_tr_b16 a[178:179], v244 offset:4096
    v_cvt_pk_bf16_f32 v78, v36, v37
    v_mfma_f32_16x16x32_bf16 a[152:155], a[188:191], v[124:127], a[152:155]
    v_exp_f32 v42, v42
    v_add_f32 v148, v148, v37
    v_mfma_f32_16x16x32_bf16 a[148:151], a[188:191], v[120:123], a[148:151]
    ds_read_b64_tr_b16 a[180:181], v245
    v_add_f32 v148, v148, v38
    v_mfma_f32_16x16x32_bf16 a[148:151], a[184:187], v[100:103], a[148:151]
    v_exp_f32 v43, v43
    v_mfma_f32_16x16x32_bf16 a[144:147], a[184:187], v[96:99], a[144:147]
    ds_read_b64_tr_b16 a[182:183], v245 offset:4096
    v_exp_f32 v44, v44
    v_mfma_f32_16x16x32_bf16 a[144:147], a[188:191], v[116:119], a[144:147]
    s_add_u32 m0, m0, 0x1000
    v_exp_f32 v45, v45
    v_mfma_f32_16x16x32_bf16 a[140:143], a[188:191], v[112:115], a[140:143]
    s_add_u32 s91, s77, 0x1d000
    v_exp_f32 v46, v46
    v_mfma_f32_16x16x32_bf16 a[140:143], a[184:187], v[92:95], a[140:143]
    s_waitcnt lgkmcnt(7)
    s_xor_b32 s91, s91, s47
    ds_read_b64_tr_b16 a[184:185], v246
    v_exp_f32 v47, v47
    v_mfma_f32_16x16x32_bf16 v[16:19], a[160:163], v[160:163], v[128:131]
    s_waitcnt lgkmcnt(7)
    s_waitcnt vmcnt(4)
    ds_read_b64_tr_b16 a[186:187], v246 offset:4096
    v_cvt_pk_bf16_f32 v79, v38, v39
    v_mfma_f32_16x16x32_bf16 v[16:19], a[164:167], v[164:167], v[16:19]
    s_waitcnt lgkmcnt(7)
    buffer_load_dwordx4 v3, s[16:19], s91 offen nt lds
    v_add_f32 v148, v148, v39
    v_mfma_f32_16x16x32_bf16 v[16:19], a[168:171], v[168:171], v[16:19]
    s_waitcnt lgkmcnt(6)
    ds_read_b64_tr_b16 a[188:189], v247
    v_exp_f32 v48, v48
    v_mfma_f32_16x16x32_bf16 v[16:19], a[172:175], v[172:175], v[16:19]
    v_exp_f32 v49, v49
    v_mfma_f32_16x16x32_bf16 v[20:23], a[172:175], v[188:191], v[132:135]
    ds_read_b64_tr_b16 a[190:191], v247 offset:4096
    v_add_f32 v149, v149, v40
    v_mfma_f32_16x16x32_bf16 v[20:23], a[168:171], v[184:187], v[20:23]
    v_exp_f32 v50, v50
    v_cvt_pk_bf16_f32 v82, v40, v41
    v_mfma_f32_16x16x32_bf16 v[20:23], a[164:167], v[180:183], v[20:23]
    v_exp_f32 v51, v51
    v_mfma_f32_16x16x32_bf16 v[20:23], a[160:163], v[176:179], v[20:23]
    v_add_f32 v149, v149, v41
    v_add_f32 v149, v149, v42
    v_mfma_f32_16x16x32_bf16 v[24:27], a[160:163], v[192:195], v[136:139]
    v_cvt_pk_bf16_f32 v83, v42, v43
    v_add_f32 v149, v149, v43
    v_add_f32 v150, v150, v44
    v_mfma_f32_16x16x32_bf16 v[24:27], a[164:167], v[196:199], v[24:27]
    v_cvt_pk_bf16_f32 v86, v44, v45
    v_add_f32 v150, v150, v45
    v_mfma_f32_16x16x32_bf16 v[24:27], a[168:171], v[200:203], v[24:27]
    v_add_f32 v150, v150, v46
    v_cvt_pk_bf16_f32 v87, v46, v47
    v_mfma_f32_16x16x32_bf16 v[24:27], a[172:175], v[204:207], v[24:27]
    v_add_f32 v150, v150, v47
    v_add_f32 v151, v151, v48
    v_cvt_pk_bf16_f32 v90, v48, v49
    v_mfma_f32_16x16x32_bf16 v[28:31], a[172:175], v[220:223], v[140:143]
    s_waitcnt vmcnt(4)
    v_add_f32 v151, v151, v49
    v_add_f32 v151, v151, v50
    v_mfma_f32_16x16x32_bf16 v[28:31], a[168:171], v[216:219], v[28:31]
    buffer_load_dwordx4 v15, s[16:19], s91 offen offset:1024 nt lds
    v_cvt_pk_bf16_f32 v91, v50, v51
    v_mfma_f32_16x16x32_bf16 v[28:31], a[164:167], v[212:215], v[28:31]
    v_add_f32 v151, v151, v51
    v_exp_f32 v16, v16
    v_mfma_f32_16x16x32_bf16 v[28:31], a[160:163], v[208:211], v[28:31]
    v_exp_f32 v17, v17
    v_mfma_f32_16x16x32_bf16 v[32:35], a[160:163], v[224:227], v[144:147]
    v_exp_f32 v18, v18
    v_mfma_f32_16x16x32_bf16 v[32:35], a[164:167], v[228:231], v[32:35]
    v_exp_f32 v19, v19
    v_add_f32 v148, v148, v16
    v_mfma_f32_16x16x32_bf16 v[32:35], a[168:171], v[232:235], v[32:35]
    v_cvt_pk_bf16_f32 v92, v16, v17
    v_add_f32 v148, v148, v17
    v_mfma_f32_16x16x32_bf16 v[32:35], a[172:175], v[236:239], v[32:35]
    s_waitcnt lgkmcnt(6)
    ds_read_b128 a[160:163], v240 offset:4096
    v_add_f32 v148, v148, v18
    v_mfma_f32_16x16x32_bf16 a[0:3], a[176:179], v[56:59], a[0:3]
    s_waitcnt lgkmcnt(5)
    v_cvt_pk_bf16_f32 v93, v18, v19
    v_add_f32 v148, v148, v19
    v_mfma_f32_16x16x32_bf16 a[0:3], a[180:183], v[76:79], a[0:3]
    ds_read_b128 a[164:167], v242 offset:4096
    v_mfma_f32_16x16x32_bf16 a[4:7], a[180:183], v[80:83], a[4:7]
    v_exp_f32 v20, v20
    v_mfma_f32_16x16x32_bf16 a[4:7], a[176:179], v[60:63], a[4:7]
    ds_read_b128 a[168:171], v240 offset:4608
    v_exp_f32 v21, v21
    v_mfma_f32_16x16x32_bf16 a[8:11], a[176:179], v[64:67], a[8:11]
    s_waitcnt vmcnt(4)
    v_exp_f32 v22, v22
    v_mfma_f32_16x16x32_bf16 a[8:11], a[180:183], v[84:87], a[8:11]
    ds_read_b128 a[172:175], v242 offset:4608
    buffer_load_dwordx4 v3, s[16:19], s91 offen offset:2048 nt lds
    v_mfma_f32_16x16x32_bf16 a[12:15], a[180:183], v[88:91], a[12:15]
    v_exp_f32 v23, v23
    v_add_f32 v149, v149, v20
    v_mfma_f32_16x16x32_bf16 a[12:15], a[176:179], v[68:71], a[12:15]
    v_cvt_pk_bf16_f32 v96, v20, v21
    v_add_f32 v149, v149, v21
    v_mfma_f32_16x16x32_bf16 a[16:19], a[176:179], v[72:75], a[16:19]
    s_waitcnt lgkmcnt(6)
    ds_read_b64_tr_b16 a[176:177], v248
    v_add_f32 v149, v149, v22
    v_mfma_f32_16x16x32_bf16 a[36:39], a[184:187], v[72:75], a[36:39]
    v_cvt_pk_bf16_f32 v97, v22, v23
    v_add_f32 v149, v149, v23
    v_add_u32 v240, 0x10000, v240
    v_mfma_f32_16x16x32_bf16 a[32:35], a[184:187], v[68:71], a[32:35]
    s_waitcnt lgkmcnt(5)
    ds_read_b64_tr_b16 a[178:179], v248 offset:4096
    v_add_u32 v242, 0x10000, v242
    v_mfma_f32_16x16x32_bf16 a[32:35], a[188:191], v[88:91], a[32:35]
    v_exp_f32 v24, v24
    v_mfma_f32_16x16x32_bf16 a[28:31], a[188:191], v[84:87], a[28:31]
    ds_read_b64_tr_b16 a[180:181], v249
    v_mfma_f32_16x16x32_bf16 a[28:31], a[184:187], v[64:67], a[28:31]
    v_exp_f32 v25, v25
    v_mfma_f32_16x16x32_bf16 a[24:27], a[184:187], v[60:63], a[24:27]
    ds_read_b64_tr_b16 a[182:183], v249 offset:4096
    v_exp_f32 v26, v26
    v_mfma_f32_16x16x32_bf16 a[24:27], a[188:191], v[80:83], a[24:27]
    v_exp_f32 v27, v27
    v_mfma_f32_16x16x32_bf16 a[20:23], a[188:191], v[76:79], a[20:23]
    s_waitcnt vmcnt(4)
    v_add_f32 v150, v150, v24
    v_cvt_pk_bf16_f32 v100, v24, v25
    v_mfma_f32_16x16x32_bf16 a[20:23], a[184:187], v[56:59], a[20:23]
    s_waitcnt lgkmcnt(7)
    ds_read_b64_tr_b16 a[184:185], v250
    buffer_load_dwordx4 v15, s[16:19], s91 offen offset:3072 nt lds
    v_add_f32 v150, v150, v25
    v_mfma_f32_16x16x32_bf16 v[36:39], a[160:163], v[160:163], v[128:131]
    s_waitcnt lgkmcnt(7)
    ds_read_b64_tr_b16 a[186:187], v250 offset:4096
    v_add_f32 v150, v150, v26
    v_mfma_f32_16x16x32_bf16 v[36:39], a[164:167], v[164:167], v[36:39]
    s_waitcnt lgkmcnt(7)
    v_cvt_pk_bf16_f32 v101, v26, v27
    v_add_f32 v150, v150, v27
    v_mfma_f32_16x16x32_bf16 v[36:39], a[168:171], v[168:171], v[36:39]
    s_waitcnt lgkmcnt(6)
    ds_read_b64_tr_b16 a[188:189], v251
    v_exp_f32 v28, v28
    v_mfma_f32_16x16x32_bf16 v[36:39], a[172:175], v[172:175], v[36:39]
    v_exp_f32 v29, v29
    v_mfma_f32_16x16x32_bf16 v[40:43], a[172:175], v[188:191], v[132:135]
    ds_read_b64_tr_b16 a[190:191], v251 offset:4096
    v_add_f32 v151, v151, v28
    v_mfma_f32_16x16x32_bf16 v[40:43], a[168:171], v[184:187], v[40:43]
    v_exp_f32 v30, v30
    v_cvt_pk_bf16_f32 v104, v28, v29
    v_mfma_f32_16x16x32_bf16 v[40:43], a[164:167], v[180:183], v[40:43]
    v_exp_f32 v31, v31
    v_mfma_f32_16x16x32_bf16 v[40:43], a[160:163], v[176:179], v[40:43]
    v_add_f32 v151, v151, v29
    v_add_f32 v151, v151, v30
    v_mfma_f32_16x16x32_bf16 v[44:47], a[160:163], v[192:195], v[136:139]
    v_cvt_pk_bf16_f32 v105, v30, v31
    v_add_f32 v151, v151, v31
    v_mfma_f32_16x16x32_bf16 v[44:47], a[164:167], v[196:199], v[44:47]
    s_xor_b32 s91, s95, 0
    v_exp_f32 v32, v32
    v_mfma_f32_16x16x32_bf16 v[44:47], a[168:171], v[200:203], v[44:47]
    s_lshl_b32 s91, s91, 17
    v_exp_f32 v33, v33
    v_mfma_f32_16x16x32_bf16 v[44:47], a[172:175], v[204:207], v[44:47]
    s_add_u32 s91, s91, s93
    v_exp_f32 v34, v34
    v_add_f32 v152, v152, v32
    v_mfma_f32_16x16x32_bf16 v[48:51], a[172:175], v[220:223], v[140:143]
    s_add_u32 m0, s78, 0x18000
    v_exp_f32 v35, v35
    v_mfma_f32_16x16x32_bf16 v[48:51], a[168:171], v[216:219], v[48:51]
    buffer_load_dwordx4 v1, s[24:27], s91 offen lds
    v_cvt_pk_bf16_f32 v108, v32, v33
    v_mfma_f32_16x16x32_bf16 v[48:51], a[164:167], v[212:215], v[48:51]
    v_exp_f32 v36, v36
    v_add_f32 v152, v152, v33
    v_mfma_f32_16x16x32_bf16 v[48:51], a[160:163], v[208:211], v[48:51]
    s_add_u32 m0, m0, 0x400
    v_exp_f32 v37, v37
    v_mfma_f32_16x16x32_bf16 v[52:55], a[160:163], v[224:227], v[144:147]
    s_add_u32 s91, s91, 0x4000
    v_exp_f32 v38, v38
    v_mfma_f32_16x16x32_bf16 v[52:55], a[164:167], v[228:231], v[52:55]
    buffer_load_dwordx4 v1, s[24:27], s91 offen lds
    v_exp_f32 v39, v39
    v_mfma_f32_16x16x32_bf16 v[52:55], a[168:171], v[232:235], v[52:55]
    v_add_f32 v152, v152, v34
    v_cvt_pk_bf16_f32 v109, v34, v35
    v_mfma_f32_16x16x32_bf16 v[52:55], a[172:175], v[236:239], v[52:55]
    s_waitcnt lgkmcnt(6)
    s_add_u32 m0, m0, 0x400
    ds_read_b128 a[160:163], v241
    v_add_f32 v152, v152, v35
    v_mfma_f32_16x16x32_bf16 a[40:43], a[176:179], v[56:59], a[40:43]
    s_waitcnt lgkmcnt(5)
    s_add_u32 s91, s91, 0x4000
    v_add_f32 v148, v148, v36
    v_cvt_pk_bf16_f32 v94, v36, v37
    v_add_f32 v148, v148, v37
    v_mfma_f32_16x16x32_bf16 a[40:43], a[180:183], v[76:79], a[40:43]
    ds_read_b128 a[164:167], v243
    buffer_load_dwordx4 v1, s[24:27], s91 offen lds
    v_mfma_f32_16x16x32_bf16 a[44:47], a[180:183], v[80:83], a[44:47]
    v_add_f32 v148, v148, v38
    v_cvt_pk_bf16_f32 v95, v38, v39
    v_mfma_f32_16x16x32_bf16 a[44:47], a[176:179], v[60:63], a[44:47]
    s_add_u32 m0, m0, 0x400
    ds_read_b128 a[168:171], v241 offset:512
    v_add_f32 v148, v148, v39
    v_mfma_f32_16x16x32_bf16 a[48:51], a[176:179], v[64:67], a[48:51]
    s_add_u32 s91, s91, 0x4000
    v_exp_f32 v40, v40
    v_mfma_f32_16x16x32_bf16 a[48:51], a[180:183], v[84:87], a[48:51]
    ds_read_b128 a[172:175], v243 offset:512
    buffer_load_dwordx4 v1, s[24:27], s91 offen lds
    v_mfma_f32_16x16x32_bf16 a[52:55], a[180:183], v[88:91], a[52:55]
    v_exp_f32 v41, v41
    v_add_f32 v149, v149, v40
    v_mfma_f32_16x16x32_bf16 a[52:55], a[176:179], v[68:71], a[52:55]
    v_exp_f32 v42, v42
    v_mfma_f32_16x16x32_bf16 a[56:59], a[176:179], v[72:75], a[56:59]
    s_waitcnt lgkmcnt(6)
    s_add_u32 m0, m0, 0x400
    ds_read_b64_tr_b16 a[176:177], v244 offset:512
    v_cvt_pk_bf16_f32 v98, v40, v41
    v_mfma_f32_16x16x32_bf16 a[76:79], a[184:187], v[72:75], a[76:79]
    s_add_u32 s91, s91, 0x4000
    v_exp_f32 v43, v43
    v_add_f32 v149, v149, v41
    v_mfma_f32_16x16x32_bf16 a[72:75], a[184:187], v[68:71], a[72:75]
    s_waitcnt lgkmcnt(5)
    ds_read_b64_tr_b16 a[178:179], v244 offset:4608
    buffer_load_dwordx4 v1, s[24:27], s91 offen lds
    v_mfma_f32_16x16x32_bf16 a[72:75], a[188:191], v[88:91], a[72:75]
    v_add_f32 v149, v149, v42
    v_cvt_pk_bf16_f32 v99, v42, v43
    v_mfma_f32_16x16x32_bf16 a[68:71], a[188:191], v[84:87], a[68:71]
    s_add_u32 m0, m0, 0x400
    ds_read_b64_tr_b16 a[180:181], v245 offset:512
    v_add_f32 v149, v149, v43
    v_mfma_f32_16x16x32_bf16 a[68:71], a[184:187], v[64:67], a[68:71]
    s_add_u32 s91, s91, 0x4000
    v_exp_f32 v44, v44
    v_mfma_f32_16x16x32_bf16 a[64:67], a[184:187], v[60:63], a[64:67]
    ds_read_b64_tr_b16 a[182:183], v245 offset:4608
    buffer_load_dwordx4 v1, s[24:27], s91 offen lds
    v_mfma_f32_16x16x32_bf16 a[64:67], a[188:191], v[80:83], a[64:67]
    v_exp_f32 v45, v45
    v_add_f32 v150, v150, v44
    v_mfma_f32_16x16x32_bf16 a[60:63], a[188:191], v[76:79], a[60:63]
    s_add_u32 m0, m0, 0x400
    v_exp_f32 v46, v46
    v_mfma_f32_16x16x32_bf16 a[60:63], a[184:187], v[56:59], a[60:63]
    s_waitcnt lgkmcnt(7)
    s_add_u32 s91, s91, 0x4000
    ds_read_b64_tr_b16 a[184:185], v246 offset:512
    v_cvt_pk_bf16_f32 v102, v44, v45
    v_mfma_f32_16x16x32_bf16 v[16:19], a[160:163], v[160:163], v[128:131]
    s_waitcnt lgkmcnt(7)
    ds_read_b64_tr_b16 a[186:187], v246 offset:4608
    buffer_load_dwordx4 v1, s[24:27], s91 offen lds
    v_add_f32 v150, v150, v45
    v_mfma_f32_16x16x32_bf16 v[16:19], a[164:167], v[164:167], v[16:19]
    s_waitcnt lgkmcnt(7)
    v_exp_f32 v47, v47
    v_mfma_f32_16x16x32_bf16 v[16:19], a[168:171], v[168:171], v[16:19]
    s_waitcnt lgkmcnt(6)
    s_add_u32 m0, m0, 0x400
    ds_read_b64_tr_b16 a[188:189], v247 offset:512
    v_add_f32 v150, v150, v46
    v_cvt_pk_bf16_f32 v103, v46, v47
    v_mfma_f32_16x16x32_bf16 v[16:19], a[172:175], v[172:175], v[16:19]
    s_add_u32 s91, s91, 0x4000
    v_add_f32 v150, v150, v47
    v_mfma_f32_16x16x32_bf16 v[20:23], a[172:175], v[188:191], v[132:135]
    ds_read_b64_tr_b16 a[190:191], v247 offset:4608
    buffer_load_dwordx4 v1, s[24:27], s91 offen lds
    v_mfma_f32_16x16x32_bf16 v[20:23], a[168:171], v[184:187], v[20:23]
    s_xor_b32 s91, s95, 1
    v_exp_f32 v48, v48
    v_add_u32 v244, 0x8000, v244
    v_mfma_f32_16x16x32_bf16 v[20:23], a[164:167], v[180:183], v[20:23]
    s_lshl_b32 s91, s91, 17
    v_exp_f32 v49, v49
    v_mfma_f32_16x16x32_bf16 v[20:23], a[160:163], v[176:179], v[20:23]
    s_add_u32 s91, s91, s93
    v_exp_f32 v50, v50
    v_mfma_f32_16x16x32_bf16 v[24:27], a[160:163], v[192:195], v[136:139]
    s_add_u32 m0, s78, 0x20000
    v_exp_f32 v51, v51
    v_add_f32 v151, v151, v48
    v_mfma_f32_16x16x32_bf16 v[24:27], a[164:167], v[196:199], v[24:27]
    buffer_load_dwordx4 v1, s[24:27], s91 offen lds
    v_cvt_pk_bf16_f32 v106, v48, v49
    v_mfma_f32_16x16x32_bf16 v[24:27], a[168:171], v[200:203], v[24:27]
    v_add_f32 v151, v151, v49
    v_add_f32 v151, v151, v50
    v_mfma_f32_16x16x32_bf16 v[24:27], a[172:175], v[204:207], v[24:27]
    s_add_u32 m0, m0, 0x400
    v_cvt_pk_bf16_f32 v107, v50, v51
    v_add_f32 v151, v151, v51
    v_add_u32 v245, 0x8000, v245
    v_mfma_f32_16x16x32_bf16 v[28:31], a[172:175], v[220:223], v[140:143]
    s_add_u32 s91, s91, 0x4000
    v_add_u32 v246, 0x8000, v246
    v_add_u32 v247, 0x8000, v247
    v_mfma_f32_16x16x32_bf16 v[28:31], a[168:171], v[216:219], v[28:31]
    buffer_load_dwordx4 v1, s[24:27], s91 offen lds
    v_mfma_f32_16x16x32_bf16 v[28:31], a[164:167], v[212:215], v[28:31]
    v_exp_f32 v52, v52
    v_mfma_f32_16x16x32_bf16 v[28:31], a[160:163], v[208:211], v[28:31]
    s_waitcnt lgkmcnt(6)
    s_add_u32 m0, m0, 0x400
    ds_read_b128 a[160:163], v241 offset:4096
    v_mfma_f32_16x16x32_bf16 a[80:83], a[176:179], v[56:59], a[80:83]
    s_waitcnt lgkmcnt(5)
    s_add_u32 s91, s91, 0x4000
    v_exp_f32 v53, v53
    v_mfma_f32_16x16x32_bf16 a[80:83], a[180:183], v[76:79], a[80:83]
    ds_read_b128 a[164:167], v243 offset:4096
    buffer_load_dwordx4 v1, s[24:27], s91 offen lds
    v_add_f32 v152, v152, v52
    v_mfma_f32_16x16x32_bf16 a[84:87], a[180:183], v[80:83], a[84:87]
    v_exp_f32 v54, v54
    v_mfma_f32_16x16x32_bf16 a[84:87], a[176:179], v[60:63], a[84:87]
    s_add_u32 m0, m0, 0x400
    ds_read_b128 a[168:171], v241 offset:4608
    v_cvt_pk_bf16_f32 v110, v52, v53
    v_mfma_f32_16x16x32_bf16 a[88:91], a[176:179], v[64:67], a[88:91]
    s_add_u32 s91, s91, 0x4000
    v_exp_f32 v55, v55
    v_add_f32 v152, v152, v53
    v_mfma_f32_16x16x32_bf16 a[88:91], a[180:183], v[84:87], a[88:91]
    ds_read_b128 a[172:175], v243 offset:4608
    buffer_load_dwordx4 v1, s[24:27], s91 offen lds
    v_mfma_f32_16x16x32_bf16 a[92:95], a[180:183], v[88:91], a[92:95]
    v_add_u32 v241, 0x10000, v241
    v_add_u32 v243, 0x10000, v243
    v_mfma_f32_16x16x32_bf16 a[92:95], a[176:179], v[68:71], a[92:95]
    s_add_u32 m0, m0, 0x400
    v_exp_f32 v16, v16
    v_add_f32 v152, v152, v54
    v_mfma_f32_16x16x32_bf16 a[96:99], a[176:179], v[72:75], a[96:99]
    s_waitcnt lgkmcnt(6)
    s_add_u32 s91, s91, 0x4000
    ds_read_b64_tr_b16 a[176:177], v248 offset:512
    v_cvt_pk_bf16_f32 v111, v54, v55
    v_mfma_f32_16x16x32_bf16 a[116:119], a[184:187], v[72:75], a[116:119]
    buffer_load_dwordx4 v1, s[24:27], s91 offen lds
    v_add_f32 v152, v152, v55
    v_mfma_f32_16x16x32_bf16 a[112:115], a[184:187], v[68:71], a[112:115]
    s_waitcnt lgkmcnt(5)
    ds_read_b64_tr_b16 a[178:179], v248 offset:4608
    v_exp_f32 v17, v17
    v_mfma_f32_16x16x32_bf16 a[112:115], a[188:191], v[88:91], a[112:115]
    s_add_u32 m0, m0, 0x400
    v_exp_f32 v18, v18
    v_mfma_f32_16x16x32_bf16 a[108:111], a[188:191], v[84:87], a[108:111]
    s_add_u32 s91, s91, 0x4000
    ds_read_b64_tr_b16 a[180:181], v249 offset:512
    v_add_f32 v148, v148, v16
    v_mfma_f32_16x16x32_bf16 a[108:111], a[184:187], v[64:67], a[108:111]
    buffer_load_dwordx4 v1, s[24:27], s91 offen lds
    v_exp_f32 v19, v19
    v_mfma_f32_16x16x32_bf16 a[104:107], a[184:187], v[60:63], a[104:107]
    ds_read_b64_tr_b16 a[182:183], v249 offset:4608
    v_add_u32 v248, 0x8000, v248
    v_mfma_f32_16x16x32_bf16 a[104:107], a[188:191], v[80:83], a[104:107]
    s_add_u32 m0, m0, 0x400
    v_add_u32 v249, 0x8000, v249
    v_cvt_pk_bf16_f32 v112, v16, v17
    v_mfma_f32_16x16x32_bf16 a[100:103], a[188:191], v[76:79], a[100:103]
    s_add_u32 s91, s91, 0x4000
    v_exp_f32 v20, v20
    v_add_f32 v148, v148, v17
    v_mfma_f32_16x16x32_bf16 a[100:103], a[184:187], v[56:59], a[100:103]
    s_waitcnt lgkmcnt(7)
    ds_read_b64_tr_b16 a[184:185], v250 offset:512
    buffer_load_dwordx4 v1, s[24:27], s91 offen lds
    v_mfma_f32_16x16x32_bf16 v[36:39], a[160:163], v[160:163], v[128:131]
    s_waitcnt lgkmcnt(7)
    ds_read_b64_tr_b16 a[186:187], v250 offset:4608
    v_add_f32 v148, v148, v18
    v_mfma_f32_16x16x32_bf16 v[36:39], a[164:167], v[164:167], v[36:39]
    s_waitcnt lgkmcnt(7)
    s_add_u32 m0, m0, 0x400
    v_exp_f32 v21, v21
    v_cvt_pk_bf16_f32 v113, v18, v19
    v_mfma_f32_16x16x32_bf16 v[36:39], a[168:171], v[168:171], v[36:39]
    s_waitcnt lgkmcnt(6)
    s_add_u32 s91, s91, 0x4000
    ds_read_b64_tr_b16 a[188:189], v251 offset:512
    v_add_f32 v148, v148, v19
    v_mfma_f32_16x16x32_bf16 v[36:39], a[172:175], v[172:175], v[36:39]
    buffer_load_dwordx4 v1, s[24:27], s91 offen lds
    v_add_f32 v149, v149, v20
    v_mfma_f32_16x16x32_bf16 v[40:43], a[172:175], v[188:191], v[132:135]
    ds_read_b64_tr_b16 a[190:191], v251 offset:4608
    v_add_u32 v250, 0x8000, v250
    v_add_u32 v251, 0x8000, v251
    v_mfma_f32_16x16x32_bf16 v[40:43], a[168:171], v[184:187], v[40:43]
    v_exp_f32 v22, v22
    v_mfma_f32_16x16x32_bf16 v[40:43], a[164:167], v[180:183], v[40:43]
    v_exp_f32 v23, v23
    v_mfma_f32_16x16x32_bf16 v[40:43], a[160:163], v[176:179], v[40:43]
    v_exp_f32 v24, v24
    v_cvt_pk_bf16_f32 v116, v20, v21
    v_mfma_f32_16x16x32_bf16 v[44:47], a[160:163], v[192:195], v[136:139]
    v_exp_f32 v25, v25
    v_mfma_f32_16x16x32_bf16 v[44:47], a[164:167], v[196:199], v[44:47]
    v_exp_f32 v26, v26
    v_mfma_f32_16x16x32_bf16 v[44:47], a[168:171], v[200:203], v[44:47]
    v_exp_f32 v27, v27
    v_add_f32 v149, v149, v21
    v_mfma_f32_16x16x32_bf16 v[44:47], a[172:175], v[204:207], v[44:47]
    v_exp_f32 v28, v28
    v_mfma_f32_16x16x32_bf16 v[48:51], a[172:175], v[220:223], v[140:143]
    v_exp_f32 v29, v29
    v_mfma_f32_16x16x32_bf16 v[48:51], a[168:171], v[216:219], v[48:51]
    s_waitcnt vmcnt(16) lgkmcnt(0)
    v_exp_f32 v30, v30
    v_add_f32 v149, v149, v22
    v_mfma_f32_16x16x32_bf16 v[48:51], a[164:167], v[212:215], v[48:51]
    s_barrier
    v_exp_f32 v31, v31
    v_mfma_f32_16x16x32_bf16 v[48:51], a[160:163], v[208:211], v[48:51]
    v_cvt_pk_bf16_f32 v117, v22, v23
    v_add_f32 v149, v149, v23
    v_add_f32 v150, v150, v24
    v_cvt_pk_bf16_f32 v120, v24, v25
    v_add_f32 v150, v150, v25
    v_add_f32 v150, v150, v26
    v_cvt_pk_bf16_f32 v121, v26, v27
    v_add_f32 v150, v150, v27
    v_add_f32 v151, v151, v28
    v_cvt_pk_bf16_f32 v124, v28, v29
    v_add_f32 v151, v151, v29
    v_add_f32 v151, v151, v30
    v_cvt_pk_bf16_f32 v125, v30, v31
    v_add_f32 v151, v151, v31
    v_mfma_f32_16x16x32_bf16 a[120:123], a[176:179], v[56:59], a[120:123]
    ds_read_b64_tr_b16 a[160:161], v244
    ds_read_b64_tr_b16 a[162:163], v244 offset:4096
    v_exp_f32 v36, v36
    v_mfma_f32_16x16x32_bf16 a[120:123], a[180:183], v[76:79], a[120:123]
    v_exp_f32 v37, v37
    v_exp_f32 v38, v38
    v_mfma_f32_16x16x32_bf16 a[124:127], a[180:183], v[80:83], a[124:127]
    s_xor_b32 s91, s95, 2
    ds_read_b64_tr_b16 a[164:165], v245
    v_exp_f32 v39, v39
    v_exp_f32 v40, v40
    v_mfma_f32_16x16x32_bf16 a[124:127], a[176:179], v[60:63], a[124:127]
    s_lshl_b32 s91, s91, 17
    ds_read_b64_tr_b16 a[166:167], v245 offset:4096
    v_exp_f32 v41, v41
    v_add_f32 v148, v148, v36
    v_mfma_f32_16x16x32_bf16 a[128:131], a[176:179], v[64:67], a[128:131]
    s_waitcnt vmcnt(8)
    v_exp_f32 v42, v42
    v_exp_f32 v43, v43
    v_mfma_f32_16x16x32_bf16 a[128:131], a[180:183], v[84:87], a[128:131]
    s_add_u32 s91, s91, s93
    ds_read_b64_tr_b16 a[168:169], v246
    v_exp_f32 v44, v44
    v_exp_f32 v45, v45
    v_mfma_f32_16x16x32_bf16 a[132:135], a[180:183], v[88:91], a[132:135]
    s_add_u32 m0, s78, 0
    s_nop 0
    buffer_load_dwordx4 v1, s[24:27], s91 offen lds
    v_add_u32 v5, 0x10000, v5
    v_exp_f32 v46, v46
    v_mfma_f32_16x16x32_bf16 a[132:135], a[176:179], v[68:71], a[132:135]
    s_add_u32 m0, m0, 0x400
    ds_read_b64_tr_b16 a[170:171], v246 offset:4096
    v_add_u32 v6, 0x10000, v6
    v_exp_f32 v47, v47
    v_mfma_f32_16x16x32_bf16 a[136:139], a[176:179], v[72:75], a[136:139]
    s_add_u32 s91, s91, 0x4000
    ds_read_b64_tr_b16 a[172:173], v247
    v_add_u32 v7, 0x10000, v7
    v_exp_f32 v48, v48
    v_cvt_pk_bf16_f32 v114, v36, v37
    v_mfma_f32_16x16x32_bf16 a[156:159], a[184:187], v[72:75], a[156:159]
    buffer_load_dwordx4 v1, s[24:27], s91 offen lds
    v_add_u32 v8, 0x10000, v8
    v_exp_f32 v49, v49
    v_mfma_f32_16x16x32_bf16 a[152:155], a[184:187], v[68:71], a[152:155]
    s_add_u32 m0, m0, 0x400
    ds_read_b64_tr_b16 a[174:175], v247 offset:4096
    ds_read_b64_tr_b16 a[192:193], v5 offset:32768
    v_exp_f32 v50, v50
    v_mfma_f32_16x16x32_bf16 a[152:155], a[188:191], v[88:91], a[152:155]
    s_add_u32 s91, s91, 0x4000
    v_exp_f32 v51, v51
    v_add_f32 v148, v148, v37
    v_add_f32 v148, v148, v38
    v_cvt_pk_bf16_f32 v115, v38, v39
    v_mfma_f32_16x16x32_bf16 a[148:151], a[188:191], v[84:87], a[148:151]
    buffer_load_dwordx4 v1, s[24:27], s91 offen lds
    ds_read_b64_tr_b16 a[194:195], v5 offset:34816
    v_add_f32 v148, v148, v39
    v_add_f32 v149, v149, v40
    v_mfma_f32_16x16x32_bf16 a[148:151], a[184:187], v[64:67], a[148:151]
    s_add_u32 m0, m0, 0x400
    ds_read_b64_tr_b16 a[196:197], v5 offset:36864
    v_cvt_pk_bf16_f32 v118, v40, v41
    v_add_f32 v149, v149, v41
    v_add_f32 v149, v149, v42
    v_mfma_f32_16x16x32_bf16 a[144:147], a[184:187], v[60:63], a[144:147]
    s_add_u32 s91, s91, 0x4000
    v_cvt_pk_bf16_f32 v119, v42, v43
    v_add_f32 v149, v149, v43
    v_add_f32 v150, v150, v44
    v_cvt_pk_bf16_f32 v122, v44, v45
    v_add_f32 v150, v150, v45
    v_mfma_f32_16x16x32_bf16 a[144:147], a[188:191], v[80:83], a[144:147]
    v_add_f32 v150, v150, v46
    v_cvt_pk_bf16_f32 v123, v46, v47
    v_add_f32 v150, v150, v47
    v_add_f32 v151, v151, v48
    v_mfma_f32_16x16x32_bf16 a[140:143], a[188:191], v[76:79], a[140:143]
    v_cvt_pk_bf16_f32 v126, v48, v49
    v_add_f32 v151, v151, v49
    v_add_f32 v151, v151, v50
    v_cvt_pk_bf16_f32 v127, v50, v51
    v_add_f32 v151, v151, v51
    ds_read_b64_tr_b16 a[198:199], v5 offset:38912
    v_mfma_f32_16x16x32_bf16 a[140:143], a[184:187], v[56:59], a[140:143]
    s_waitcnt lgkmcnt(10)
    buffer_load_dwordx4 v1, s[24:27], s91 offen lds
    ds_read_b64_tr_b16 a[200:201], v6 offset:32768
    ds_read_b64_tr_b16 a[202:203], v6 offset:34816
    ds_read_b64_tr_b16 a[176:177], v248
    v_mov_b32 v12, v148
    v_mfma_f32_16x16x32_bf16 a[0:3], a[160:163], v[92:95], a[0:3]
    s_waitcnt lgkmcnt(11)
    s_add_u32 m0, m0, 0x400
    ds_read_b64_tr_b16 a[178:179], v248 offset:4096
    ds_read_b64_tr_b16 a[204:205], v6 offset:36864
    v_permlane32_swap_b32 v148, v12
    v_mfma_f32_16x16x32_bf16 a[0:3], a[164:167], v[112:115], a[0:3]
    s_add_u32 s91, s91, 0x4000
    buffer_load_dwordx4 v1, s[24:27], s91 offen lds
    ds_read_b64_tr_b16 a[206:207], v6 offset:38912
    v_add_f32 v148, v148, v12
    v_mov_b32 v12, v148
    v_mfma_f32_16x16x32_bf16 a[4:7], a[164:167], v[116:119], a[4:7]
    s_add_u32 m0, m0, 0x400
    ds_read_b64_tr_b16 a[180:181], v249
    ds_read_b64_tr_b16 a[208:209], v7 offset:32768
    v_permlane16_swap_b32 v148, v12
    v_add_f32 v148, v148, v12
    v_mfma_f32_16x16x32_bf16 a[4:7], a[160:163], v[96:99], a[4:7]
    s_add_u32 s91, s91, 0x4000
    ds_read_b64_tr_b16 a[182:183], v249 offset:4096
    buffer_load_dwordx4 v1, s[24:27], s91 offen lds
    ds_read_b64_tr_b16 a[210:211], v7 offset:34816
    v_mov_b32 v13, v149
    v_mfma_f32_16x16x32_bf16 a[8:11], a[160:163], v[100:103], a[8:11]
    s_add_u32 m0, m0, 0x400
    ds_read_b64_tr_b16 a[212:213], v7 offset:36864
    v_permlane32_swap_b32 v149, v13
    v_add_f32 v149, v149, v13
    v_mfma_f32_16x16x32_bf16 a[8:11], a[164:167], v[120:123], a[8:11]
    s_add_u32 s91, s91, 0x4000
    ds_read_b64_tr_b16 a[184:185], v250
    v_mov_b32 v13, v149
    s_nop 1
    v_permlane16_swap_b32 v149, v13
    v_add_f32 v149, v149, v13
    v_mfma_f32_16x16x32_bf16 a[12:15], a[164:167], v[124:127], a[12:15]
    buffer_load_dwordx4 v1, s[24:27], s91 offen lds
    ds_read_b64_tr_b16 a[214:215], v7 offset:38912
    v_mov_b32 v12, v150
    v_mfma_f32_16x16x32_bf16 a[12:15], a[160:163], v[104:107], a[12:15]
    s_add_u32 m0, m0, 0x400
    ds_read_b64_tr_b16 a[186:187], v250 offset:4096
    ds_read_b64_tr_b16 a[216:217], v8 offset:32768
    v_permlane32_swap_b32 v150, v12
    v_mfma_f32_16x16x32_bf16 a[16:19], a[160:163], v[108:111], a[16:19]
    s_waitcnt lgkmcnt(14)
    s_add_u32 s91, s91, 0x4000
    ds_read_b64_tr_b16 a[188:189], v251
    ds_read_b64_tr_b16 a[218:219], v8 offset:34816
    v_add_f32 v150, v150, v12
    v_mov_b32 v12, v150
    v_mfma_f32_16x16x32_bf16 a[36:39], a[168:171], v[108:111], a[36:39]
    buffer_load_dwordx4 v1, s[24:27], s91 offen lds
    ds_read_b64_tr_b16 a[220:221], v8 offset:36864
    v_permlane16_swap_b32 v150, v12
    v_mfma_f32_16x16x32_bf16 a[32:35], a[168:171], v[104:107], a[32:35]
    ds_read_b64_tr_b16 a[190:191], v251 offset:4096
    ds_read_b64_tr_b16 a[222:223], v8 offset:38912
    v_add_f32 v150, v150, v12
    v_mov_b32 v13, v151
    v_mfma_f32_16x16x32_bf16 a[32:35], a[172:175], v[124:127], a[32:35]
    s_nop 0
    v_permlane32_swap_b32 v151, v13
    v_add_f32 v151, v151, v13
    v_mov_b32 v13, v151
    v_mfma_f32_16x16x32_bf16 a[28:31], a[172:175], v[120:123], a[28:31]
    s_waitcnt vmcnt(8)
    v_permlane16_swap_b32 v151, v13
    v_add_f32 v151, v151, v13
    v_mov_b32 v12, v152
    v_mfma_f32_16x16x32_bf16 a[28:31], a[168:171], v[100:103], a[28:31]
    s_nop 0
    v_permlane32_swap_b32 v152, v12
    v_add_f32 v152, v152, v12
    v_mov_b32 v12, v152
    v_mfma_f32_16x16x32_bf16 a[24:27], a[168:171], v[96:99], a[24:27]
    v_add_u32 v5, 0x10000, v5
    v_permlane16_swap_b32 v152, v12
    v_add_f32 v152, v152, v12
    v_mfma_f32_16x16x32_bf16 a[24:27], a[172:175], v[116:119], a[24:27]
    v_add_u32 v6, 0x10000, v6
    v_add_f32 v12, v148, v149
    v_add_f32 v13, v150, v151
    v_add_f32 v12, v12, v152
    v_mfma_f32_16x16x32_bf16 a[20:23], a[172:175], v[112:115], a[20:23]
    v_add_u32 v7, 0x10000, v7
    v_add_f32 v12, v12, v13
    v_mfma_f32_16x16x32_bf16 a[20:23], a[168:171], v[92:95], a[20:23]
    s_waitcnt lgkmcnt(14)
    s_mov_b32 s64, 0x4b800000
    ds_read_b64_tr_b16 a[160:161], v244 offset:512
    v_add_u32 v8, 0x10000, v8
    v_cmp_nge_f32 vcc, s64, v12
    v_mov_b32 v145, v152
    v_mfma_f32_16x16x32_bf16 a[40:43], a[176:179], v[92:95], a[40:43]
    s_waitcnt lgkmcnt(12)
    ds_read_b64_tr_b16 a[162:163], v244 offset:4608
    ds_read_b64_tr_b16 a[224:225], v5
    v_xor_b32 v10, 0xa000, v254
    v_mfma_f32_16x16x32_bf16 a[40:43], a[180:183], v[112:115], a[40:43]
    s_or_b32 s64, vcc_lo, vcc_hi
    v_mov_b32 v12, s64
    v_mfma_f32_16x16x32_bf16 a[44:47], a[180:183], v[116:119], a[44:47]
    s_waitcnt lgkmcnt(0)
    ds_read_b64_tr_b16 a[164:165], v245 offset:512
    ds_read_b64_tr_b16 a[226:227], v5 offset:2048
    v_mfma_f32_16x16x32_bf16 a[44:47], a[176:179], v[96:99], a[44:47]
    s_lshl_b32 s65, s56, 2
    ds_read_b64_tr_b16 a[166:167], v245 offset:4608
    ds_read_b64_tr_b16 a[228:229], v5 offset:4096
    v_mfma_f32_16x16x32_bf16 a[48:51], a[176:179], v[100:103], a[48:51]
    s_add_u32 s65, s65, 0x9800
    ds_read_b64_tr_b16 a[230:231], v5 offset:6144
    v_and_b32 v13, 3, v0
    v_lshlrev_b32 v13, 13, v13
    v_add_u32 v13, s65, v13
    ds_write_b32 v13, v12
    v_mfma_f32_16x16x32_bf16 a[48:51], a[180:183], v[120:123], a[48:51]
    ds_read_b64_tr_b16 a[168:169], v246 offset:512
    ds_read_b64_tr_b16 a[232:233], v6
    ds_write_b64 v10, v[144:145] offset:4096
    v_mfma_f32_16x16x32_bf16 a[52:55], a[180:183], v[124:127], a[52:55]
    s_xor_b32 s91, s95, 3
    ds_read_b64_tr_b16 a[234:235], v6 offset:2048
    v_rcp_f32 v148, v148
    v_mfma_f32_16x16x32_bf16 a[52:55], a[176:179], v[104:107], a[52:55]
    s_lshl_b32 s91, s91, 17
    ds_read_b64_tr_b16 a[170:171], v246 offset:4608
    v_rcp_f32 v149, v149
    v_rcp_f32 v150, v150
    v_mfma_f32_16x16x32_bf16 a[56:59], a[176:179], v[108:111], a[56:59]
    s_add_u32 s91, s91, s93
    ds_read_b64_tr_b16 a[172:173], v247 offset:512
    ds_read_b64_tr_b16 a[236:237], v6 offset:4096
    v_rcp_f32 v151, v151
    v_mfma_f32_16x16x32_bf16 a[76:79], a[184:187], v[108:111], a[76:79]
    s_add_u32 m0, s78, 0x18000
    ds_read_b64_tr_b16 a[238:239], v6 offset:6144
    v_mfma_f32_16x16x32_bf16 a[72:75], a[184:187], v[104:107], a[72:75]
    s_lshl_b32 s90, s58, 12
    ds_read_b64_tr_b16 a[174:175], v247 offset:4608
    buffer_load_dwordx4 v1, s[24:27], s91 offen lds
    ds_read_b64_tr_b16 a[240:241], v7
    v_mfma_f32_16x16x32_bf16 a[72:75], a[188:191], v[124:127], a[72:75]
    s_add_u32 m0, m0, 0x400
    ds_read_b64_tr_b16 a[242:243], v7 offset:2048
    v_mfma_f32_16x16x32_bf16 a[68:71], a[188:191], v[120:123], a[68:71]
    s_add_u32 s91, s91, 0x4000
    buffer_load_dwordx4 v1, s[24:27], s91 offen lds
    ds_read_b64_tr_b16 a[244:245], v7 offset:4096
    v_mfma_f32_16x16x32_bf16 a[68:71], a[184:187], v[100:103], a[68:71]
    s_add_u32 m0, m0, 0x400
    v_mfma_f32_16x16x32_bf16 a[64:67], a[184:187], v[96:99], a[64:67]
    s_add_u32 s91, s91, 0x4000
    buffer_load_dwordx4 v1, s[24:27], s91 offen lds
    ds_read_b64_tr_b16 a[246:247], v7 offset:6144
    v_mfma_f32_16x16x32_bf16 a[64:67], a[188:191], v[116:119], a[64:67]
    s_add_u32 m0, m0, 0x400
    ds_read_b64_tr_b16 a[248:249], v8
    v_mfma_f32_16x16x32_bf16 a[60:63], a[188:191], v[112:115], a[60:63]
    s_add_u32 s91, s91, 0x4000
    buffer_load_dwordx4 v1, s[24:27], s91 offen lds
    ds_read_b64_tr_b16 a[250:251], v8 offset:2048
    v_mfma_f32_16x16x32_bf16 a[60:63], a[184:187], v[92:95], a[60:63]
    s_add_u32 m0, m0, 0x400
    ds_read_b64_tr_b16 a[176:177], v248 offset:512
    ds_read_b64_tr_b16 a[252:253], v8 offset:4096
    v_mfma_f32_16x16x32_bf16 a[80:83], a[160:163], v[92:95], a[80:83]
    s_waitcnt lgkmcnt(14)
    s_add_u32 s91, s91, 0x4000
    ds_read_b64_tr_b16 a[178:179], v248 offset:4608
    ds_read_b64_tr_b16 a[254:255], v8 offset:6144
    v_mfma_f32_16x16x32_bf16 a[80:83], a[164:167], v[112:115], a[80:83]
    s_add_u32 s90, s90, s87
    buffer_load_dwordx4 v1, s[24:27], s91 offen lds
    v_accvgpr_read_b32 v16, a0
    v_accvgpr_read_b32 v17, a1
    v_accvgpr_read_b32 v18, a2
    v_accvgpr_read_b32 v19, a3
    v_mfma_f32_16x16x32_bf16 a[84:87], a[164:167], v[116:119], a[84:87]
    s_add_u32 m0, m0, 0x400
    ds_read_b64_tr_b16 a[180:181], v249 offset:512
    v_accvgpr_read_b32 v20, a20
    v_accvgpr_read_b32 v21, a21
    v_accvgpr_read_b32 v22, a22
    v_mfma_f32_16x16x32_bf16 a[84:87], a[160:163], v[96:99], a[84:87]
    s_add_u32 s91, s91, 0x4000
    ds_read_b64_tr_b16 a[182:183], v249 offset:4608
    buffer_load_dwordx4 v1, s[24:27], s91 offen lds
    v_accvgpr_read_b32 v23, a23
    v_mul_f32 v16, v16, v148
    v_mfma_f32_16x16x32_bf16 a[88:91], a[160:163], v[100:103], a[88:91]
    s_add_u32 m0, m0, 0x400
    v_mul_f32 v17, v17, v148
    v_mul_f32 v18, v18, v148
    v_mul_f32 v19, v19, v148
    v_mul_f32 v20, v20, v148
    v_mul_f32 v21, v21, v148
    v_mfma_f32_16x16x32_bf16 a[88:91], a[164:167], v[120:123], a[88:91]
    s_add_u32 s91, s91, 0x4000
    ds_read_b64_tr_b16 a[184:185], v250 offset:512
    buffer_load_dwordx4 v1, s[24:27], s91 offen lds
    v_mul_f32 v22, v22, v148
    v_mul_f32 v23, v23, v148
    v_mfma_f32_16x16x32_bf16 a[92:95], a[164:167], v[124:127], a[92:95]
    s_add_u32 m0, m0, 0x400
    v_cvt_pk_bf16_f32 v56, v16, v17
    v_cvt_pk_bf16_f32 v57, v18, v19
    v_cvt_pk_bf16_f32 v58, v20, v21
    v_cvt_pk_bf16_f32 v59, v22, v23
    buffer_store_dwordx4 v[56:59], v4, s[20:23], s90 offen sc1
    v_mfma_f32_16x16x32_bf16 a[92:95], a[160:163], v[104:107], a[92:95]
    s_add_u32 s91, s91, 0x4000
    ds_read_b64_tr_b16 a[186:187], v250 offset:4608
    buffer_load_dwordx4 v1, s[24:27], s91 offen lds
    v_accvgpr_read_b32 v24, a4
    v_accvgpr_read_b32 v25, a5
    v_mfma_f32_16x16x32_bf16 a[96:99], a[160:163], v[108:111], a[96:99]
    s_waitcnt lgkmcnt(14)
    ds_read_b64_tr_b16 a[188:189], v251 offset:512
    v_accvgpr_read_b32 v26, a6
    v_accvgpr_read_b32 v27, a7
    v_accvgpr_read_b32 v28, a24
    v_mfma_f32_16x16x32_bf16 a[116:119], a[168:171], v[108:111], a[116:119]
    v_accvgpr_read_b32 v29, a25
    v_accvgpr_read_b32 v30, a26
    v_accvgpr_read_b32 v31, a27
    v_mul_f32 v24, v24, v149
    v_mul_f32 v25, v25, v149
    v_mfma_f32_16x16x32_bf16 a[112:115], a[168:171], v[104:107], a[112:115]
    s_waitcnt lgkmcnt(0)
    ds_read_b64_tr_b16 a[190:191], v251 offset:4608
    v_mul_f32 v26, v26, v149
    v_mul_f32 v27, v27, v149
    v_mul_f32 v28, v28, v149
    v_mfma_f32_16x16x32_bf16 a[112:115], a[172:175], v[124:127], a[112:115]
    v_mul_f32 v29, v29, v149
    v_mul_f32 v30, v30, v149
    v_mul_f32 v31, v31, v149
    v_cvt_pk_bf16_f32 v60, v24, v25
    v_mfma_f32_16x16x32_bf16 a[108:111], a[172:175], v[120:123], a[108:111]
    v_cvt_pk_bf16_f32 v61, v26, v27
    v_cvt_pk_bf16_f32 v62, v28, v29
    v_cvt_pk_bf16_f32 v63, v30, v31
    buffer_store_dwordx4 v[60:63], v4, s[20:23], s90 offen offset:1024 sc1
    v_accvgpr_read_b32 v32, a8
    v_mfma_f32_16x16x32_bf16 a[108:111], a[168:171], v[100:103], a[108:111]
    v_accvgpr_read_b32 v33, a9
    v_accvgpr_read_b32 v34, a10
    v_accvgpr_read_b32 v35, a11
    v_accvgpr_read_b32 v36, a28
    v_mfma_f32_16x16x32_bf16 a[104:107], a[168:171], v[96:99], a[104:107]
    s_xor_b32 s91, s95, 4
    v_accvgpr_read_b32 v37, a29
    v_accvgpr_read_b32 v38, a30
    v_accvgpr_read_b32 v39, a31
    v_mul_f32 v32, v32, v150
    v_mfma_f32_16x16x32_bf16 a[104:107], a[172:175], v[116:119], a[104:107]
    s_lshl_b32 s91, s91, 17
    v_mul_f32 v33, v33, v150
    v_mul_f32 v34, v34, v150
    v_mul_f32 v35, v35, v150
    v_mul_f32 v36, v36, v150
    v_mul_f32 v37, v37, v150
    v_mfma_f32_16x16x32_bf16 a[100:103], a[172:175], v[112:115], a[100:103]
    s_add_u32 s91, s91, s93
    v_mul_f32 v38, v38, v150
    v_mul_f32 v39, v39, v150
    v_cvt_pk_bf16_f32 v64, v32, v33
    v_cvt_pk_bf16_f32 v65, v34, v35
    v_mfma_f32_16x16x32_bf16 a[100:103], a[168:171], v[92:95], a[100:103]
    s_add_u32 m0, s78, 0x20000
    v_cvt_pk_bf16_f32 v66, v36, v37
    v_cvt_pk_bf16_f32 v67, v38, v39
    buffer_store_dwordx4 v[64:67], v4, s[20:23], s90 offen offset:2048 sc1
    v_accvgpr_read_b32 v40, a12
    v_mfma_f32_16x16x32_bf16 a[120:123], a[176:179], v[92:95], a[120:123]
    buffer_load_dwordx4 v1, s[24:27], s91 offen lds
    v_accvgpr_read_b32 v41, a13
    v_accvgpr_read_b32 v42, a14
    v_accvgpr_read_b32 v43, a15
    v_accvgpr_read_b32 v44, a32
    v_mfma_f32_16x16x32_bf16 a[120:123], a[180:183], v[112:115], a[120:123]
    s_add_u32 m0, m0, 0x400
    s_add_u32 s91, s91, 0x4000
    v_accvgpr_read_b32 v45, a33
    v_accvgpr_read_b32 v46, a34
    v_accvgpr_read_b32 v47, a35
    v_mfma_f32_16x16x32_bf16 a[124:127], a[180:183], v[116:119], a[124:127]
    buffer_load_dwordx4 v1, s[24:27], s91 offen lds
    v_mul_f32 v40, v40, v151
    v_mul_f32 v41, v41, v151
    v_mul_f32 v42, v42, v151
    v_mfma_f32_16x16x32_bf16 a[124:127], a[176:179], v[96:99], a[124:127]
    s_add_u32 m0, m0, 0x400
    s_add_u32 s91, s91, 0x4000
    v_mul_f32 v43, v43, v151
    v_mul_f32 v44, v44, v151
    v_mul_f32 v45, v45, v151
    v_mul_f32 v46, v46, v151
    v_mfma_f32_16x16x32_bf16 a[128:131], a[176:179], v[100:103], a[128:131]
    buffer_load_dwordx4 v1, s[24:27], s91 offen lds
    v_mul_f32 v47, v47, v151
    v_cvt_pk_bf16_f32 v68, v40, v41
    v_cvt_pk_bf16_f32 v69, v42, v43
    v_mfma_f32_16x16x32_bf16 a[128:131], a[180:183], v[120:123], a[128:131]
    s_add_u32 m0, m0, 0x400
    s_add_u32 s91, s91, 0x4000
    v_cvt_pk_bf16_f32 v70, v44, v45
    v_cvt_pk_bf16_f32 v71, v46, v47
    buffer_store_dwordx4 v[68:71], v4, s[20:23], s90 offen offset:3072 sc1
    v_mfma_f32_16x16x32_bf16 a[132:135], a[180:183], v[124:127], a[132:135]
    buffer_load_dwordx4 v1, s[24:27], s91 offen lds
    ds_write_b128 v10, a[56:59]
    v_mfma_f32_16x16x32_bf16 a[132:135], a[176:179], v[104:107], a[132:135]
    s_add_u32 m0, m0, 0x400
    s_add_u32 s91, s91, 0x4000
    ds_write_b128 v10, a[76:79] offset:1024
    v_mfma_f32_16x16x32_bf16 a[136:139], a[176:179], v[108:111], a[136:139]
    s_lshl_b32 s90, s58, 12
    buffer_load_dwordx4 v1, s[24:27], s91 offen lds
    v_mfma_f32_16x16x32_bf16 a[156:159], a[184:187], v[108:111], a[156:159]
    s_add_u32 m0, m0, 0x400
    s_add_u32 s91, s91, 0x4000
    v_mfma_f32_16x16x32_bf16 a[152:155], a[184:187], v[104:107], a[152:155]
    s_waitcnt lgkmcnt(2)
    s_add_u32 s90, s90, s88
    buffer_load_dwordx4 v1, s[24:27], s91 offen lds
    v_accvgpr_read_b32 v16, a40
    v_accvgpr_read_b32 v17, a41
    v_accvgpr_read_b32 v18, a42
    v_mfma_f32_16x16x32_bf16 a[152:155], a[188:191], v[124:127], a[152:155]
    s_add_u32 m0, m0, 0x400
    s_add_u32 s91, s91, 0x4000
    v_accvgpr_read_b32 v19, a43
    v_accvgpr_read_b32 v20, a60
    v_accvgpr_read_b32 v21, a61
    v_mfma_f32_16x16x32_bf16 a[148:151], a[188:191], v[120:123], a[148:151]
    buffer_load_dwordx4 v1, s[24:27], s91 offen lds
    v_accvgpr_read_b32 v22, a62
    v_accvgpr_read_b32 v23, a63
    v_mul_f32 v16, v16, v148
    v_mul_f32 v17, v17, v148
    v_mfma_f32_16x16x32_bf16 a[148:151], a[184:187], v[100:103], a[148:151]
    s_add_u32 m0, m0, 0x400
    s_add_u32 s91, s91, 0x4000
    v_mul_f32 v18, v18, v148
    v_mul_f32 v19, v19, v148
    v_mul_f32 v20, v20, v148
    v_mfma_f32_16x16x32_bf16 a[144:147], a[184:187], v[96:99], a[144:147]
    buffer_load_dwordx4 v1, s[24:27], s91 offen lds
    v_mul_f32 v21, v21, v148
    v_mul_f32 v22, v22, v148
    v_mul_f32 v23, v23, v148
    v_mfma_f32_16x16x32_bf16 a[144:147], a[188:191], v[116:119], a[144:147]
    v_cvt_pk_bf16_f32 v72, v16, v17
    v_cvt_pk_bf16_f32 v73, v18, v19
    v_cvt_pk_bf16_f32 v74, v20, v21
    v_cvt_pk_bf16_f32 v75, v22, v23
    buffer_store_dwordx4 v[72:75], v4, s[20:23], s90 offen sc1
    v_mfma_f32_16x16x32_bf16 a[140:143], a[188:191], v[112:115], a[140:143]
    v_accvgpr_read_b32 v24, a44
    v_accvgpr_read_b32 v25, a45
    v_accvgpr_read_b32 v26, a46
    v_accvgpr_read_b32 v27, a47
    v_mfma_f32_16x16x32_bf16 a[140:143], a[184:187], v[92:95], a[140:143]
    v_accvgpr_read_b32 v28, a64
    v_accvgpr_read_b32 v29, a65
    v_accvgpr_read_b32 v30, a66
    v_accvgpr_read_b32 v31, a67
    v_mul_f32 v24, v24, v149
    v_mul_f32 v25, v25, v149
    v_mul_f32 v26, v26, v149
    v_mul_f32 v27, v27, v149
    v_mul_f32 v28, v28, v149
    v_mul_f32 v29, v29, v149
    v_mul_f32 v30, v30, v149
    v_mul_f32 v31, v31, v149
    v_cvt_pk_bf16_f32 v76, v24, v25
    v_cvt_pk_bf16_f32 v77, v26, v27
    v_cvt_pk_bf16_f32 v78, v28, v29
    v_cvt_pk_bf16_f32 v79, v30, v31
    buffer_store_dwordx4 v[76:79], v4, s[20:23], s90 offen offset:1024 sc1
    v_accvgpr_read_b32 v32, a48
    v_accvgpr_read_b32 v33, a49
    v_accvgpr_read_b32 v34, a50
    v_accvgpr_read_b32 v35, a51
    v_accvgpr_read_b32 v36, a68
    v_accvgpr_read_b32 v37, a69
    v_accvgpr_read_b32 v38, a70
    v_accvgpr_read_b32 v39, a71
    v_mul_f32 v32, v32, v150
    v_mul_f32 v33, v33, v150
    v_mul_f32 v34, v34, v150
    v_mul_f32 v35, v35, v150
    v_mul_f32 v36, v36, v150
    v_mul_f32 v37, v37, v150
    v_mul_f32 v38, v38, v150
    v_mul_f32 v39, v39, v150
    v_cvt_pk_bf16_f32 v80, v32, v33
    v_cvt_pk_bf16_f32 v81, v34, v35
    v_cvt_pk_bf16_f32 v82, v36, v37
    v_cvt_pk_bf16_f32 v83, v38, v39
    buffer_store_dwordx4 v[80:83], v4, s[20:23], s90 offen offset:2048 sc1
    v_accvgpr_read_b32 v40, a52
    v_accvgpr_read_b32 v41, a53
    v_accvgpr_read_b32 v42, a54
    v_accvgpr_read_b32 v43, a55
    v_accvgpr_read_b32 v44, a72
    v_accvgpr_read_b32 v45, a73
    v_accvgpr_read_b32 v46, a74
    v_accvgpr_read_b32 v47, a75
    v_mul_f32 v40, v40, v151
    v_mul_f32 v41, v41, v151
    v_mul_f32 v42, v42, v151
    v_mul_f32 v43, v43, v151
    v_mul_f32 v44, v44, v151
    v_mul_f32 v45, v45, v151
    v_mul_f32 v46, v46, v151
    v_mul_f32 v47, v47, v151
    v_cvt_pk_bf16_f32 v84, v40, v41
    v_cvt_pk_bf16_f32 v85, v42, v43
    v_cvt_pk_bf16_f32 v86, v44, v45
    v_cvt_pk_bf16_f32 v87, v46, v47
    buffer_store_dwordx4 v[84:87], v4, s[20:23], s90 offen offset:3072 sc1
    s_lshl_b32 s90, s58, 12
    s_add_u32 s90, s90, s87
    s_add_u32 s90, s90, 0x4800
    v_accvgpr_read_b32 v16, a80
    v_accvgpr_read_b32 v17, a81
    v_accvgpr_read_b32 v18, a82
    v_accvgpr_read_b32 v19, a83
    v_accvgpr_read_b32 v20, a100
    v_accvgpr_read_b32 v21, a101
    v_accvgpr_read_b32 v22, a102
    v_accvgpr_read_b32 v23, a103
    v_pk_mul_f32 v[16:17], v[16:17], v[148:149] op_sel_hi:[1,0]
    v_pk_mul_f32 v[18:19], v[18:19], v[148:149] op_sel_hi:[1,0]
    v_pk_mul_f32 v[20:21], v[20:21], v[148:149] op_sel_hi:[1,0]
    v_pk_mul_f32 v[22:23], v[22:23], v[148:149] op_sel_hi:[1,0]
    v_cvt_pk_bf16_f32 v56, v16, v17
    v_cvt_pk_bf16_f32 v57, v18, v19
    v_cvt_pk_bf16_f32 v58, v20, v21
    v_cvt_pk_bf16_f32 v59, v22, v23
    buffer_store_dwordx4 v[56:59], v4, s[20:23], s90 offen sc1
    ds_write_b128 v10, a[136:139] offset:2048
    ds_write_b128 v10, a[156:159] offset:3072
    s_add_u32 s65, s78, 0x9800
    v_mov_b32 v13, s65
    v_add_u32 v11, 0x8000, v254
    s_waitcnt vmcnt(25) lgkmcnt(0)
    s_barrier
    ds_read_b128 v[52:55], v13
    ds_read_b64 v[48:49], v11 offset:4096
    ds_read_b128 v[128:131], v11
    ds_read_b128 v[132:135], v11 offset:1024
    ds_read_b128 v[136:139], v11 offset:2048
    ds_read_b128 v[140:143], v11 offset:3072
    v_add_u32 v5, 0xfffe0000, v5
    v_add_u32 v6, 0xfffe0000, v6
    v_add_u32 v7, 0xfffe0000, v7
    v_add_u32 v8, 0xfffe0000, v8
    ds_read_b64_tr_b16 a[160:161], v5
    ds_read_b64_tr_b16 a[162:163], v5 offset:2048
    ds_read_b64_tr_b16 a[164:165], v5 offset:4096
    ds_read_b64_tr_b16 a[166:167], v5 offset:6144
    ds_read_b64_tr_b16 a[168:169], v6
    ds_read_b64_tr_b16 a[170:171], v6 offset:2048
    ds_read_b64_tr_b16 a[172:173], v6 offset:4096
    ds_read_b64_tr_b16 a[174:175], v6 offset:6144
    ds_read_b64_tr_b16 a[176:177], v7
    ds_read_b64_tr_b16 a[178:179], v7 offset:2048
    ds_read_b64_tr_b16 a[180:181], v7 offset:4096
    ds_read_b64_tr_b16 a[182:183], v7 offset:6144
    ds_read_b64_tr_b16 a[184:185], v8
    ds_read_b64_tr_b16 a[186:187], v8 offset:2048
    ds_read_b64_tr_b16 a[188:189], v8 offset:4096
    ds_read_b64_tr_b16 a[190:191], v8 offset:6144
    v_accvgpr_read_b32 v24, a84
    v_accvgpr_read_b32 v25, a85
    v_accvgpr_read_b32 v26, a86
    v_accvgpr_read_b32 v27, a87
    v_accvgpr_read_b32 v28, a104
    v_accvgpr_read_b32 v29, a105
    v_accvgpr_read_b32 v30, a106
    v_accvgpr_read_b32 v31, a107
    v_pk_mul_f32 v[24:25], v[24:25], v[148:149] op_sel:[0,1] op_sel_hi:[1,1]
    v_pk_mul_f32 v[26:27], v[26:27], v[148:149] op_sel:[0,1] op_sel_hi:[1,1]
    v_pk_mul_f32 v[28:29], v[28:29], v[148:149] op_sel:[0,1] op_sel_hi:[1,1]
    v_pk_mul_f32 v[30:31], v[30:31], v[148:149] op_sel:[0,1] op_sel_hi:[1,1]
    v_cvt_pk_bf16_f32 v60, v24, v25
    v_cvt_pk_bf16_f32 v61, v26, v27
    v_cvt_pk_bf16_f32 v62, v28, v29
    v_cvt_pk_bf16_f32 v63, v30, v31
    buffer_store_dwordx4 v[60:63], v4, s[20:23], s90 offen offset:1024 sc1
    s_waitcnt lgkmcnt(14)
    v_or3_b32 v52, v52, v53, v54
    v_or_b32 v52, v52, v55
    s_nop 0
    v_readfirstlane_b32 s64, v52
    v_min_f32 v12, v144, v48
    v_sub_f32 v13, v12, v144
    v_sub_f32 v14, v12, v48
    v_exp_f32 v13, v13
    v_exp_f32 v14, v14
    s_andn2_b32 s64, s64, s66
    s_cmp_lg_u32 s64, 0
    s_cbranch_scc1 mha_fallback
    v_mul_f32 v152, v152, v13
    v_fmac_f32 v152, v49, v14
    v_rcp_f32 v152, v152
    s_add_u32 s65, s87, 0x2000
    v_mul_f32 v13, v13, v152
    v_mul_f32 v14, v14, v152
    v_accvgpr_read_b32 v96, a16
    v_accvgpr_read_b32 v97, a17
    v_accvgpr_read_b32 v98, a18
    v_accvgpr_read_b32 v99, a19
    v_accvgpr_read_b32 v100, a36
    v_accvgpr_read_b32 v101, a37
    v_accvgpr_read_b32 v102, a38
    v_accvgpr_read_b32 v103, a39
    v_mul_f32 v96, v96, v13
    v_mul_f32 v97, v97, v13
    v_mul_f32 v98, v98, v13
    v_mul_f32 v99, v99, v13
    v_mul_f32 v100, v100, v13
    v_mul_f32 v101, v101, v13
    v_mul_f32 v102, v102, v13
    v_mul_f32 v103, v103, v13
    v_fmac_f32 v96, v128, v14
    v_fmac_f32 v97, v129, v14
    v_fmac_f32 v98, v130, v14
    v_fmac_f32 v99, v131, v14
    v_fmac_f32 v100, v132, v14
    v_fmac_f32 v101, v133, v14
    v_fmac_f32 v102, v134, v14
    v_fmac_f32 v103, v135, v14
    v_cvt_pk_bf16_f32 v112, v96, v97
    v_cvt_pk_bf16_f32 v113, v98, v99
    v_cvt_pk_bf16_f32 v114, v100, v101
    v_cvt_pk_bf16_f32 v115, v102, v103
    buffer_store_dwordx4 v[112:115], v4, s[20:23], s65 offen sc1
    s_add_u32 s65, s65, 0x4800
    v_accvgpr_read_b32 v104, a96
    v_accvgpr_read_b32 v105, a97
    v_accvgpr_read_b32 v106, a98
    v_accvgpr_read_b32 v107, a99
    v_accvgpr_read_b32 v108, a116
    v_accvgpr_read_b32 v109, a117
    v_accvgpr_read_b32 v110, a118
    v_accvgpr_read_b32 v111, a119
    v_mul_f32 v104, v104, v13
    v_mul_f32 v105, v105, v13
    v_mul_f32 v106, v106, v13
    v_mul_f32 v107, v107, v13
    v_mul_f32 v108, v108, v13
    v_mul_f32 v109, v109, v13
    v_mul_f32 v110, v110, v13
    v_mul_f32 v111, v111, v13
    v_fmac_f32 v104, v136, v14
    v_fmac_f32 v105, v137, v14
    v_fmac_f32 v106, v138, v14
    v_fmac_f32 v107, v139, v14
    v_fmac_f32 v108, v140, v14
    v_fmac_f32 v109, v141, v14
    v_fmac_f32 v110, v142, v14
    v_fmac_f32 v111, v143, v14
    v_cvt_pk_bf16_f32 v116, v104, v105
    v_cvt_pk_bf16_f32 v117, v106, v107
    v_cvt_pk_bf16_f32 v118, v108, v109
    v_cvt_pk_bf16_f32 v119, v110, v111
    buffer_store_dwordx4 v[116:119], v4, s[20:23], s65 offen sc1
    v_accvgpr_read_b32 v32, a88
    v_accvgpr_read_b32 v33, a89
    v_accvgpr_read_b32 v34, a90
    v_accvgpr_read_b32 v35, a91
    v_accvgpr_read_b32 v36, a108
    v_accvgpr_read_b32 v37, a109
    v_accvgpr_read_b32 v38, a110
    v_accvgpr_read_b32 v39, a111
    v_pk_mul_f32 v[32:33], v[32:33], v[150:151] op_sel_hi:[1,0]
    v_pk_mul_f32 v[34:35], v[34:35], v[150:151] op_sel_hi:[1,0]
    v_pk_mul_f32 v[36:37], v[36:37], v[150:151] op_sel_hi:[1,0]
    v_pk_mul_f32 v[38:39], v[38:39], v[150:151] op_sel_hi:[1,0]
    v_cvt_pk_bf16_f32 v64, v32, v33
    v_cvt_pk_bf16_f32 v65, v34, v35
    v_cvt_pk_bf16_f32 v66, v36, v37
    v_cvt_pk_bf16_f32 v67, v38, v39
    buffer_store_dwordx4 v[64:67], v4, s[20:23], s90 offen offset:2048 sc1
    v_accvgpr_read_b32 v40, a92
    v_accvgpr_read_b32 v41, a93
    v_accvgpr_read_b32 v42, a94
    v_accvgpr_read_b32 v43, a95
    v_accvgpr_read_b32 v44, a112
    v_accvgpr_read_b32 v45, a113
    v_accvgpr_read_b32 v46, a114
    v_accvgpr_read_b32 v47, a115
    v_pk_mul_f32 v[40:41], v[40:41], v[150:151] op_sel:[0,1] op_sel_hi:[1,1]
    v_pk_mul_f32 v[42:43], v[42:43], v[150:151] op_sel:[0,1] op_sel_hi:[1,1]
    v_pk_mul_f32 v[44:45], v[44:45], v[150:151] op_sel:[0,1] op_sel_hi:[1,1]
    v_pk_mul_f32 v[46:47], v[46:47], v[150:151] op_sel:[0,1] op_sel_hi:[1,1]
    v_cvt_pk_bf16_f32 v68, v40, v41
    v_cvt_pk_bf16_f32 v69, v42, v43
    v_cvt_pk_bf16_f32 v70, v44, v45
    v_cvt_pk_bf16_f32 v71, v46, v47
    buffer_store_dwordx4 v[68:71], v4, s[20:23], s90 offen offset:3072 sc1
    s_lshl_b32 s90, s58, 12
    s_add_u32 s90, s90, s88
    s_add_u32 s90, s90, 0x4800
    v_accvgpr_read_b32 v16, a120
    v_accvgpr_read_b32 v17, a121
    v_accvgpr_read_b32 v18, a122
    v_accvgpr_read_b32 v19, a123
    v_accvgpr_read_b32 v20, a140
    v_accvgpr_read_b32 v21, a141
    v_accvgpr_read_b32 v22, a142
    v_accvgpr_read_b32 v23, a143
    v_pk_mul_f32 v[16:17], v[16:17], v[148:149] op_sel_hi:[1,0]
    v_pk_mul_f32 v[18:19], v[18:19], v[148:149] op_sel_hi:[1,0]
    v_pk_mul_f32 v[20:21], v[20:21], v[148:149] op_sel_hi:[1,0]
    v_pk_mul_f32 v[22:23], v[22:23], v[148:149] op_sel_hi:[1,0]
    v_cvt_pk_bf16_f32 v72, v16, v17
    v_cvt_pk_bf16_f32 v73, v18, v19
    v_cvt_pk_bf16_f32 v74, v20, v21
    v_cvt_pk_bf16_f32 v75, v22, v23
    buffer_store_dwordx4 v[72:75], v4, s[20:23], s90 offen sc1
    v_accvgpr_read_b32 v24, a124
    v_accvgpr_read_b32 v25, a125
    v_accvgpr_read_b32 v26, a126
    v_accvgpr_read_b32 v27, a127
    v_accvgpr_read_b32 v28, a144
    v_accvgpr_read_b32 v29, a145
    v_accvgpr_read_b32 v30, a146
    v_accvgpr_read_b32 v31, a147
    v_pk_mul_f32 v[24:25], v[24:25], v[148:149] op_sel:[0,1] op_sel_hi:[1,1]
    v_pk_mul_f32 v[26:27], v[26:27], v[148:149] op_sel:[0,1] op_sel_hi:[1,1]
    v_pk_mul_f32 v[28:29], v[28:29], v[148:149] op_sel:[0,1] op_sel_hi:[1,1]
    v_pk_mul_f32 v[30:31], v[30:31], v[148:149] op_sel:[0,1] op_sel_hi:[1,1]
    v_cvt_pk_bf16_f32 v76, v24, v25
    v_cvt_pk_bf16_f32 v77, v26, v27
    v_cvt_pk_bf16_f32 v78, v28, v29
    v_cvt_pk_bf16_f32 v79, v30, v31
    buffer_store_dwordx4 v[76:79], v4, s[20:23], s90 offen offset:1024 sc1
    v_accvgpr_read_b32 v32, a128
    v_accvgpr_read_b32 v33, a129
    v_accvgpr_read_b32 v34, a130
    v_accvgpr_read_b32 v35, a131
    v_accvgpr_read_b32 v36, a148
    v_accvgpr_read_b32 v37, a149
    v_accvgpr_read_b32 v38, a150
    v_accvgpr_read_b32 v39, a151
    v_pk_mul_f32 v[32:33], v[32:33], v[150:151] op_sel_hi:[1,0]
    v_pk_mul_f32 v[34:35], v[34:35], v[150:151] op_sel_hi:[1,0]
    v_pk_mul_f32 v[36:37], v[36:37], v[150:151] op_sel_hi:[1,0]
    v_pk_mul_f32 v[38:39], v[38:39], v[150:151] op_sel_hi:[1,0]
    v_cvt_pk_bf16_f32 v80, v32, v33
    v_cvt_pk_bf16_f32 v81, v34, v35
    v_cvt_pk_bf16_f32 v82, v36, v37
    v_cvt_pk_bf16_f32 v83, v38, v39
    buffer_store_dwordx4 v[80:83], v4, s[20:23], s90 offen offset:2048 sc1
    v_accvgpr_read_b32 v40, a132
    v_accvgpr_read_b32 v41, a133
    v_accvgpr_read_b32 v42, a134
    v_accvgpr_read_b32 v43, a135
    v_accvgpr_read_b32 v44, a152
    v_accvgpr_read_b32 v45, a153
    v_accvgpr_read_b32 v46, a154
    v_accvgpr_read_b32 v47, a155
    v_pk_mul_f32 v[40:41], v[40:41], v[150:151] op_sel:[0,1] op_sel_hi:[1,1]
    v_pk_mul_f32 v[42:43], v[42:43], v[150:151] op_sel:[0,1] op_sel_hi:[1,1]
    v_pk_mul_f32 v[44:45], v[44:45], v[150:151] op_sel:[0,1] op_sel_hi:[1,1]
    v_pk_mul_f32 v[46:47], v[46:47], v[150:151] op_sel:[0,1] op_sel_hi:[1,1]
    v_cvt_pk_bf16_f32 v84, v40, v41
    v_cvt_pk_bf16_f32 v85, v42, v43
    v_cvt_pk_bf16_f32 v86, v44, v45
    v_cvt_pk_bf16_f32 v87, v46, v47
    buffer_store_dwordx4 v[84:87], v4, s[20:23], s90 offen offset:3072 sc1
    s_xor_b32 s91, s95, 5
    s_lshl_b32 s91, s91, 17
    s_add_u32 s91, s91, s93
    s_add_u32 m0, s78, 0x10000
    s_nop 0
    buffer_load_dwordx4 v1, s[24:27], s91 offen lds
    s_add_u32 m0, m0, 0x400
    s_add_u32 s91, s91, 0x4000
    buffer_load_dwordx4 v1, s[24:27], s91 offen lds
    s_add_u32 m0, m0, 0x400
    s_add_u32 s91, s91, 0x4000
    buffer_load_dwordx4 v1, s[24:27], s91 offen lds
    s_add_u32 m0, m0, 0x400
    s_add_u32 s91, s91, 0x4000
    buffer_load_dwordx4 v1, s[24:27], s91 offen lds
    s_add_u32 m0, m0, 0x400
    s_add_u32 s91, s91, 0x4000
    buffer_load_dwordx4 v1, s[24:27], s91 offen lds
    s_add_u32 m0, m0, 0x400
    s_add_u32 s91, s91, 0x4000
    buffer_load_dwordx4 v1, s[24:27], s91 offen lds
    s_add_u32 m0, m0, 0x400
    s_add_u32 s91, s91, 0x4000
    buffer_load_dwordx4 v1, s[24:27], s91 offen lds
    s_add_u32 m0, m0, 0x400
    s_add_u32 s91, s91, 0x4000
    buffer_load_dwordx4 v1, s[24:27], s91 offen lds
    v_add_u32 v160, 0, v4
    v_add_u32 v161, 0x1000, v4
    v_add_u32 v162, 0x2000, v4
    v_add_u32 v163, 0x3000, v4
    v_add_u32 v164, 0x4000, v4
    s_lshl_b32 s62, s59, 12
    s_add_u32 s62, s62, 0x1800000
    s_cmp_eq_u32 s56, 0
    s_cselect_b32 s62, s62, 0x10000000
    v_lshlrev_b32 v184, 8, v0
    v_mov_b32 v185, 1
    s_waitcnt vmcnt(8)
    s_barrier
    s_mov_b64 exec, 0xffff
    buffer_atomic_add v185, v184, s[20:23], s62 offen sc1
    s_mov_b64 exec, -1
    s_waitcnt lgkmcnt(0)
    s_xor_b32 s91, s95, 6
    s_lshl_b32 s91, s91, 17
    s_add_u32 s91, s91, s93
    s_add_u32 m0, s78, 0x8000
    s_nop 0
    buffer_load_dwordx4 v1, s[24:27], s91 offen lds
    s_add_u32 m0, m0, 0x400
    s_add_u32 s91, s91, 0x4000
    buffer_load_dwordx4 v1, s[24:27], s91 offen lds
    s_add_u32 m0, m0, 0x400
    s_add_u32 s91, s91, 0x4000
    buffer_load_dwordx4 v1, s[24:27], s91 offen lds
    s_add_u32 m0, m0, 0x400
    s_add_u32 s91, s91, 0x4000
    buffer_load_dwordx4 v1, s[24:27], s91 offen lds
    s_add_u32 m0, m0, 0x400
    s_add_u32 s91, s91, 0x4000
    buffer_load_dwordx4 v1, s[24:27], s91 offen lds
    s_add_u32 m0, m0, 0x400
    s_add_u32 s91, s91, 0x4000
    buffer_load_dwordx4 v1, s[24:27], s91 offen lds
    s_add_u32 m0, m0, 0x400
    s_add_u32 s91, s91, 0x4000
    buffer_load_dwordx4 v1, s[24:27], s91 offen lds
    s_add_u32 m0, m0, 0x400
    s_add_u32 s91, s91, 0x4000
    buffer_load_dwordx4 v1, s[24:27], s91 offen lds
    v_add_u32 v5, 0x10000, v5
    v_add_u32 v6, 0x10000, v6
    v_add_u32 v7, 0x10000, v7
    v_add_u32 v8, 0x10000, v8
    ds_read_b64_tr_b16 v[186:187], v5 offset:32768
    ds_read_b64_tr_b16 v[188:189], v5 offset:34816
    ds_read_b64_tr_b16 v[190:191], v5 offset:36864
    ds_read_b64_tr_b16 v[192:193], v5 offset:38912
    ds_read_b64_tr_b16 v[194:195], v6 offset:32768
    ds_read_b64_tr_b16 v[196:197], v6 offset:34816
    ds_read_b64_tr_b16 v[198:199], v6 offset:36864
    ds_read_b64_tr_b16 v[200:201], v6 offset:38912
    ds_read_b64_tr_b16 v[202:203], v7 offset:32768
    ds_read_b64_tr_b16 v[204:205], v7 offset:34816
    ds_read_b64_tr_b16 v[206:207], v7 offset:36864
    ds_read_b64_tr_b16 v[208:209], v7 offset:38912
    ds_read_b64_tr_b16 v[210:211], v8 offset:32768
    ds_read_b64_tr_b16 v[212:213], v8 offset:34816
    ds_read_b64_tr_b16 v[214:215], v8 offset:36864
    ds_read_b64_tr_b16 v[216:217], v8 offset:38912
    s_xor_b32 s91, s95, 7
    s_lshl_b32 s91, s91, 17
    s_add_u32 s91, s91, s93
    s_add_u32 m0, s78, 0
    s_nop 0
    buffer_load_dwordx4 v1, s[24:27], s91 offen lds
    s_add_u32 m0, m0, 0x400
    s_add_u32 s91, s91, 0x4000
    buffer_load_dwordx4 v1, s[24:27], s91 offen lds
    s_add_u32 m0, m0, 0x400
    s_add_u32 s91, s91, 0x4000
    buffer_load_dwordx4 v1, s[24:27], s91 offen lds
    s_add_u32 m0, m0, 0x400
    s_add_u32 s91, s91, 0x4000
    buffer_load_dwordx4 v1, s[24:27], s91 offen lds
    s_add_u32 m0, m0, 0x400
    s_add_u32 s91, s91, 0x4000
    buffer_load_dwordx4 v1, s[24:27], s91 offen lds
    s_add_u32 m0, m0, 0x400
    s_add_u32 s91, s91, 0x4000
    buffer_load_dwordx4 v1, s[24:27], s91 offen lds
    s_add_u32 m0, m0, 0x400
    s_add_u32 s91, s91, 0x4000
    buffer_load_dwordx4 v1, s[24:27], s91 offen lds
    s_add_u32 m0, m0, 0x400
    s_add_u32 s91, s91, 0x4000
    buffer_load_dwordx4 v1, s[24:27], s91 offen lds
    v_add_u32 v5, 0x10000, v5
    v_add_u32 v6, 0x10000, v6
    v_add_u32 v7, 0x10000, v7
    v_add_u32 v8, 0x10000, v8
    ds_read_b64_tr_b16 v[218:219], v5
    ds_read_b64_tr_b16 v[220:221], v5 offset:2048
    ds_read_b64_tr_b16 v[222:223], v5 offset:4096
    ds_read_b64_tr_b16 v[224:225], v5 offset:6144
    ds_read_b64_tr_b16 v[226:227], v6
    ds_read_b64_tr_b16 v[228:229], v6 offset:2048
    ds_read_b64_tr_b16 v[230:231], v6 offset:4096
    ds_read_b64_tr_b16 v[232:233], v6 offset:6144
    ds_read_b64_tr_b16 v[234:235], v7
    ds_read_b64_tr_b16 v[236:237], v7 offset:2048
    ds_read_b64_tr_b16 v[238:239], v7 offset:4096
    ds_read_b64_tr_b16 v[240:241], v7 offset:6144
    ds_read_b64_tr_b16 v[242:243], v8
    ds_read_b64_tr_b16 v[244:245], v8 offset:2048
    ds_read_b64_tr_b16 v[246:247], v8 offset:4096
    ds_read_b64_tr_b16 v[248:249], v8 offset:6144
    s_waitcnt lgkmcnt(14)
    s_xor_b32 s91, s95, 8
    s_lshl_b32 s91, s91, 17
    s_add_u32 s91, s91, s93
    s_add_u32 m0, s78, 0x18000
    s_nop 0
    buffer_load_dwordx4 v1, s[24:27], s91 offen lds
    s_add_u32 m0, m0, 0x400
    s_add_u32 s91, s91, 0x4000
    buffer_load_dwordx4 v1, s[24:27], s91 offen lds
    s_add_u32 m0, m0, 0x400
    s_add_u32 s91, s91, 0x4000
    buffer_load_dwordx4 v1, s[24:27], s91 offen lds
    s_add_u32 m0, m0, 0x400
    s_add_u32 s91, s91, 0x4000
    buffer_load_dwordx4 v1, s[24:27], s91 offen lds
    s_add_u32 m0, m0, 0x400
    s_add_u32 s91, s91, 0x4000
    buffer_load_dwordx4 v1, s[24:27], s91 offen lds
    s_add_u32 m0, m0, 0x400
    s_add_u32 s91, s91, 0x4000
    buffer_load_dwordx4 v1, s[24:27], s91 offen lds
    s_add_u32 m0, m0, 0x400
    s_add_u32 s91, s91, 0x4000
    buffer_load_dwordx4 v1, s[24:27], s91 offen lds
    s_add_u32 m0, m0, 0x400
    s_add_u32 s91, s91, 0x4000
    buffer_load_dwordx4 v1, s[24:27], s91 offen lds
    s_waitcnt vmcnt(25)
    v_add_u32 v5, 0xffff0000, v5
    v_add_u32 v6, 0xffff0000, v6
    v_add_u32 v7, 0xffff0000, v7
    v_add_u32 v8, 0xffff0000, v8
    ds_read_b64_tr_b16 a[0:1], v5
    ds_read_b64_tr_b16 a[2:3], v5 offset:2048
    ds_read_b64_tr_b16 a[4:5], v5 offset:4096
    ds_read_b64_tr_b16 a[6:7], v5 offset:6144
    ds_read_b64_tr_b16 a[8:9], v6
    ds_read_b64_tr_b16 a[10:11], v6 offset:2048
    ds_read_b64_tr_b16 a[12:13], v6 offset:4096
    ds_read_b64_tr_b16 a[14:15], v6 offset:6144
    ds_read_b64_tr_b16 a[16:17], v7
    ds_read_b64_tr_b16 a[18:19], v7 offset:2048
    ds_read_b64_tr_b16 a[20:21], v7 offset:4096
    ds_read_b64_tr_b16 a[22:23], v7 offset:6144
    ds_read_b64_tr_b16 a[24:25], v8
    ds_read_b64_tr_b16 a[26:27], v8 offset:2048
    ds_read_b64_tr_b16 a[28:29], v8 offset:4096
    ds_read_b64_tr_b16 a[30:31], v8 offset:6144
    s_waitcnt lgkmcnt(14)
    s_xor_b32 s91, s95, 9
    s_lshl_b32 s91, s91, 17
    s_add_u32 s91, s91, s93
    s_add_u32 m0, s78, 0x20000
    s_nop 0
    buffer_load_dwordx4 v1, s[24:27], s91 offen lds
    s_add_u32 m0, m0, 0x400
    s_add_u32 s91, s91, 0x4000
    buffer_load_dwordx4 v1, s[24:27], s91 offen lds
    s_add_u32 m0, m0, 0x400
    s_add_u32 s91, s91, 0x4000
    buffer_load_dwordx4 v1, s[24:27], s91 offen lds
    s_add_u32 m0, m0, 0x400
    s_add_u32 s91, s91, 0x4000
    buffer_load_dwordx4 v1, s[24:27], s91 offen lds
    s_add_u32 m0, m0, 0x400
    s_add_u32 s91, s91, 0x4000
    buffer_load_dwordx4 v1, s[24:27], s91 offen lds
    s_add_u32 m0, m0, 0x400
    s_add_u32 s91, s91, 0x4000
    buffer_load_dwordx4 v1, s[24:27], s91 offen lds
    s_add_u32 m0, m0, 0x400
    s_add_u32 s91, s91, 0x4000
    buffer_load_dwordx4 v1, s[24:27], s91 offen lds
    s_add_u32 m0, m0, 0x400
    s_add_u32 s91, s91, 0x4000
    buffer_load_dwordx4 v1, s[24:27], s91 offen lds
    s_waitcnt vmcnt(24)
    v_add_u32 v5, 0xffff0000, v5
    v_add_u32 v6, 0xffff0000, v6
    v_add_u32 v7, 0xffff0000, v7
    v_add_u32 v8, 0xffff0000, v8
    ds_read_b64_tr_b16 a[32:33], v5 offset:32768
    ds_read_b64_tr_b16 a[34:35], v5 offset:34816
    ds_read_b64_tr_b16 a[36:37], v5 offset:36864
    ds_read_b64_tr_b16 a[38:39], v5 offset:38912
    ds_read_b64_tr_b16 a[40:41], v6 offset:32768
    ds_read_b64_tr_b16 a[42:43], v6 offset:34816
    ds_read_b64_tr_b16 a[44:45], v6 offset:36864
    ds_read_b64_tr_b16 a[46:47], v6 offset:38912
    ds_read_b64_tr_b16 a[48:49], v7 offset:32768
    ds_read_b64_tr_b16 a[50:51], v7 offset:34816
    ds_read_b64_tr_b16 a[52:53], v7 offset:36864
    ds_read_b64_tr_b16 a[54:55], v7 offset:38912
    ds_read_b64_tr_b16 a[56:57], v8 offset:32768
    ds_read_b64_tr_b16 a[58:59], v8 offset:34816
    ds_read_b64_tr_b16 a[60:61], v8 offset:36864
    ds_read_b64_tr_b16 a[62:63], v8 offset:38912
    s_waitcnt lgkmcnt(14)
    s_xor_b32 s91, s95, 10
    s_lshl_b32 s91, s91, 17
    s_add_u32 s91, s91, s93
    s_add_u32 m0, s78, 0x10000
    s_nop 0
    buffer_load_dwordx4 v1, s[24:27], s91 offen lds
    s_add_u32 m0, m0, 0x400
    s_add_u32 s91, s91, 0x4000
    buffer_load_dwordx4 v1, s[24:27], s91 offen lds
    s_add_u32 m0, m0, 0x400
    s_add_u32 s91, s91, 0x4000
    buffer_load_dwordx4 v1, s[24:27], s91 offen lds
    s_add_u32 m0, m0, 0x400
    s_add_u32 s91, s91, 0x4000
    buffer_load_dwordx4 v1, s[24:27], s91 offen lds
    s_add_u32 m0, m0, 0x400
    s_add_u32 s91, s91, 0x4000
    buffer_load_dwordx4 v1, s[24:27], s91 offen lds
    s_add_u32 m0, m0, 0x400
    s_add_u32 s91, s91, 0x4000
    buffer_load_dwordx4 v1, s[24:27], s91 offen lds
    s_add_u32 m0, m0, 0x400
    s_add_u32 s91, s91, 0x4000
    buffer_load_dwordx4 v1, s[24:27], s91 offen lds
    s_add_u32 m0, m0, 0x400
    s_add_u32 s91, s91, 0x4000
    buffer_load_dwordx4 v1, s[24:27], s91 offen lds
    v_lshrrev_b32 v12, 4, v0
    v_and_b32 v10, 15, v0
    v_and_b32 v11, 7, v0
    v_xor_b32 v14, v11, v12
    v_lshlrev_b32 v14, 4, v14
    v_lshl_add_u32 v14, v10, 8, v14
    v_add_u32 v170, s78, v14
    v_xor_b32 v171, 64, v170
    v_add_u32 v172, 0x10000, v170
    v_add_u32 v173, 0x10000, v171
    v_add_u32 v174, 0x10000, v172
    v_add_u32 v175, 0x10000, v173
    v_lshrrev_b32 v10, 3, v0
    v_lshlrev_b32 v14, 1, v11
    v_xor_b32 v14, v14, v10
    v_lshlrev_b32 v14, 4, v14
    s_lshl_b32 s62, s56, 3
    v_add_u32 v10, s62, v10
    v_lshl_add_u32 v176, v10, 8, v14
    v_xor_b32 v177, 16, v176
    v_add_u32 v178, 0x10000, v176
    v_add_u32 v179, 0x10000, v177
    v_add_u32 v180, 0x10000, v178
    v_add_u32 v181, 0x10000, v179
    v_lshlrev_b32 v182, 11, v10
    v_lshl_add_u32 v182, v11, 4, v182
    v_mov_b32 v184, 0
    s_mov_b64 exec, 1
    buffer_load_dword v183, v184, s[20:23], s46 offen sc1
    s_mov_b64 exec, -1
    s_waitcnt lgkmcnt(0)
    s_xor_b32 s91, s95, 11
    s_lshl_b32 s91, s91, 17
    s_add_u32 s91, s91, s93
    s_add_u32 m0, s78, 0x8000
    s_nop 0
    buffer_load_dwordx4 v1, s[24:27], s91 offen lds
    s_add_u32 m0, m0, 0x400
    s_add_u32 s91, s91, 0x4000
    buffer_load_dwordx4 v1, s[24:27], s91 offen lds
    s_add_u32 m0, m0, 0x400
    s_add_u32 s91, s91, 0x4000
    buffer_load_dwordx4 v1, s[24:27], s91 offen lds
    s_add_u32 m0, m0, 0x400
    s_add_u32 s91, s91, 0x4000
    buffer_load_dwordx4 v1, s[24:27], s91 offen lds
    s_add_u32 m0, m0, 0x400
    s_add_u32 s91, s91, 0x4000
    buffer_load_dwordx4 v1, s[24:27], s91 offen lds
    s_add_u32 m0, m0, 0x400
    s_add_u32 s91, s91, 0x4000
    buffer_load_dwordx4 v1, s[24:27], s91 offen lds
    s_add_u32 m0, m0, 0x400
    s_add_u32 s91, s91, 0x4000
    buffer_load_dwordx4 v1, s[24:27], s91 offen lds
    s_add_u32 m0, m0, 0x400
    s_add_u32 s91, s91, 0x4000
    buffer_load_dwordx4 v1, s[24:27], s91 offen lds
    s_xor_b32 s69, s95, 0
    s_mul_i32 s69, s69, 0x4800
    s_add_u32 s92, s67, s69
    s_waitcnt vmcnt(8)
    v_readfirstlane_b32 s63, v183
    s_nop 0
    s_cmp_ge_u32 s63, 16
    s_cbranch_scc1 mha_polled
    s_mov_b32 s68, 0x20000
    s_mov_b64 exec, 1
mha_poll:
    buffer_load_dword v183, v184, s[20:23], s46 offen sc1
    s_waitcnt vmcnt(0)
    v_readfirstlane_b32 s63, v183
    s_nop 0
    s_cmp_ge_u32 s63, 16
    s_cbranch_scc1 mha_pollok
    s_sleep 4
    s_sub_u32 s68, s68, 1
    s_cmp_lg_u32 s68, 0
    s_cbranch_scc1 mha_poll
mha_pollok:
    s_mov_b64 exec, -1
mha_polled:
    buffer_load_dwordx4 a[88:91], v160, s[20:23], s92 offen sc1
    buffer_load_dwordx4 a[92:95], v162, s[20:23], s92 offen offset:1024 sc1
    buffer_load_dwordx4 a[96:99], v160, s[20:23], s92 offen offset:1024 sc1
    buffer_load_dwordx4 a[100:103], v162, s[20:23], s92 offen offset:2048 sc1
    buffer_load_dwordx4 a[104:107], v160, s[20:23], s92 offen offset:2048 sc1
    buffer_load_dwordx4 a[108:111], v162, s[20:23], s92 offen offset:3072 sc1
    buffer_load_dwordx4 a[112:115], v160, s[20:23], s92 offen offset:3072 sc1
    buffer_load_dwordx4 a[116:119], v163, s[20:23], s92 offen sc1
    buffer_load_dwordx4 a[120:123], v161, s[20:23], s92 offen sc1
    buffer_load_dwordx4 a[124:127], v163, s[20:23], s92 offen offset:1024 sc1
    buffer_load_dwordx4 a[128:131], v161, s[20:23], s92 offen offset:1024 sc1
    buffer_load_dwordx4 a[132:135], v163, s[20:23], s92 offen offset:2048 sc1
    buffer_load_dwordx4 a[136:139], v161, s[20:23], s92 offen offset:2048 sc1
    buffer_load_dwordx4 a[140:143], v163, s[20:23], s92 offen offset:3072 sc1
    buffer_load_dwordx4 a[144:147], v161, s[20:23], s92 offen offset:3072 sc1
    buffer_load_dwordx4 a[148:151], v164, s[20:23], s92 offen sc1
    buffer_load_dwordx4 a[152:155], v162, s[20:23], s92 offen sc1
    buffer_load_dwordx4 a[156:159], v164, s[20:23], s92 offen offset:1024 sc1
    s_waitcnt vmcnt(17)
    v_mfma_f32_16x16x32_bf16 v[16:19], a[192:195], a[88:91], 0
    s_waitcnt vmcnt(16)
    s_xor_b32 s69, s95, 1
    v_mfma_f32_16x16x32_bf16 v[16:19], a[196:199], a[92:95], v[16:19]
    s_mul_i32 s69, s69, 0x4800
    v_mfma_f32_16x16x32_bf16 v[20:23], a[204:207], a[92:95], 0
    s_add_u32 s85, s67, s69
    v_mfma_f32_16x16x32_bf16 v[20:23], a[200:203], a[88:91], v[20:23]
    v_mfma_f32_16x16x32_bf16 v[24:27], a[208:211], a[88:91], 0
    v_mfma_f32_16x16x32_bf16 v[24:27], a[212:215], a[92:95], v[24:27]
    v_mfma_f32_16x16x32_bf16 v[28:31], a[220:223], a[92:95], 0
    v_mfma_f32_16x16x32_bf16 v[28:31], a[216:219], a[88:91], v[28:31]
    s_waitcnt vmcnt(15)
    buffer_load_dwordx4 a[88:91], v160, s[20:23], s85 offen sc1
    v_mfma_f32_16x16x32_bf16 v[44:47], a[216:219], a[96:99], 0
    s_waitcnt vmcnt(15)
    v_mfma_f32_16x16x32_bf16 v[44:47], a[220:223], a[100:103], v[44:47]
    v_mfma_f32_16x16x32_bf16 v[40:43], a[212:215], a[100:103], 0
    buffer_load_dwordx4 a[92:95], v162, s[20:23], s85 offen offset:1024 sc1
    v_mfma_f32_16x16x32_bf16 v[40:43], a[208:211], a[96:99], v[40:43]
    v_mfma_f32_16x16x32_bf16 v[36:39], a[200:203], a[96:99], 0
    v_mfma_f32_16x16x32_bf16 v[36:39], a[204:207], a[100:103], v[36:39]
    v_mfma_f32_16x16x32_bf16 v[32:35], a[196:199], a[100:103], 0
    v_mfma_f32_16x16x32_bf16 v[32:35], a[192:195], a[96:99], v[32:35]
    s_waitcnt vmcnt(15)
    buffer_load_dwordx4 a[96:99], v160, s[20:23], s85 offen offset:1024 sc1
    v_mfma_f32_16x16x32_bf16 v[48:51], a[192:195], a[104:107], 0
    s_waitcnt vmcnt(15)
    v_mfma_f32_16x16x32_bf16 v[48:51], a[196:199], a[108:111], v[48:51]
    v_mfma_f32_16x16x32_bf16 v[52:55], a[204:207], a[108:111], 0
    buffer_load_dwordx4 a[100:103], v162, s[20:23], s85 offen offset:2048 sc1
    v_mfma_f32_16x16x32_bf16 v[52:55], a[200:203], a[104:107], v[52:55]
    v_mfma_f32_16x16x32_bf16 v[56:59], a[208:211], a[104:107], 0
    v_mfma_f32_16x16x32_bf16 v[56:59], a[212:215], a[108:111], v[56:59]
    v_mfma_f32_16x16x32_bf16 v[60:63], a[220:223], a[108:111], 0
    v_mfma_f32_16x16x32_bf16 v[60:63], a[216:219], a[104:107], v[60:63]
    s_waitcnt vmcnt(15)
    buffer_load_dwordx4 a[104:107], v160, s[20:23], s85 offen offset:2048 sc1
    v_mfma_f32_16x16x32_bf16 v[76:79], a[216:219], a[112:115], 0
    s_waitcnt vmcnt(15)
    v_mfma_f32_16x16x32_bf16 v[76:79], a[220:223], a[116:119], v[76:79]
    v_mfma_f32_16x16x32_bf16 v[72:75], a[212:215], a[116:119], 0
    buffer_load_dwordx4 a[108:111], v162, s[20:23], s85 offen offset:3072 sc1
    v_mfma_f32_16x16x32_bf16 v[72:75], a[208:211], a[112:115], v[72:75]
    v_mfma_f32_16x16x32_bf16 v[68:71], a[200:203], a[112:115], 0
    v_mfma_f32_16x16x32_bf16 v[68:71], a[204:207], a[116:119], v[68:71]
    v_mfma_f32_16x16x32_bf16 v[64:67], a[196:199], a[116:119], 0
    v_mfma_f32_16x16x32_bf16 v[64:67], a[192:195], a[112:115], v[64:67]
    s_waitcnt vmcnt(15)
    buffer_load_dwordx4 a[112:115], v160, s[20:23], s85 offen offset:3072 sc1
    v_mfma_f32_16x16x32_bf16 v[80:83], a[192:195], a[120:123], 0
    s_waitcnt vmcnt(15)
    v_mfma_f32_16x16x32_bf16 v[80:83], a[196:199], a[124:127], v[80:83]
    v_mfma_f32_16x16x32_bf16 v[84:87], a[204:207], a[124:127], 0
    buffer_load_dwordx4 a[116:119], v163, s[20:23], s85 offen sc1
    v_mfma_f32_16x16x32_bf16 v[84:87], a[200:203], a[120:123], v[84:87]
    v_mfma_f32_16x16x32_bf16 v[88:91], a[208:211], a[120:123], 0
    v_mfma_f32_16x16x32_bf16 v[88:91], a[212:215], a[124:127], v[88:91]
    v_mfma_f32_16x16x32_bf16 v[92:95], a[220:223], a[124:127], 0
    v_mfma_f32_16x16x32_bf16 v[92:95], a[216:219], a[120:123], v[92:95]
    s_waitcnt vmcnt(15)
    buffer_load_dwordx4 a[120:123], v161, s[20:23], s85 offen sc1
    v_mfma_f32_16x16x32_bf16 v[108:111], a[216:219], a[128:131], 0
    s_waitcnt vmcnt(15)
    v_mfma_f32_16x16x32_bf16 v[108:111], a[220:223], a[132:135], v[108:111]
    v_mfma_f32_16x16x32_bf16 v[104:107], a[212:215], a[132:135], 0
    buffer_load_dwordx4 a[124:127], v163, s[20:23], s85 offen offset:1024 sc1
    v_mfma_f32_16x16x32_bf16 v[104:107], a[208:211], a[128:131], v[104:107]
    v_mfma_f32_16x16x32_bf16 v[100:103], a[200:203], a[128:131], 0
    v_mfma_f32_16x16x32_bf16 v[100:103], a[204:207], a[132:135], v[100:103]
    v_mfma_f32_16x16x32_bf16 v[96:99], a[196:199], a[132:135], 0
    v_mfma_f32_16x16x32_bf16 v[96:99], a[192:195], a[128:131], v[96:99]
    s_waitcnt vmcnt(15)
    buffer_load_dwordx4 a[128:131], v161, s[20:23], s85 offen offset:1024 sc1
    v_mfma_f32_16x16x32_bf16 v[112:115], a[192:195], a[136:139], 0
    s_waitcnt vmcnt(15)
    v_mfma_f32_16x16x32_bf16 v[112:115], a[196:199], a[140:143], v[112:115]
    v_mfma_f32_16x16x32_bf16 v[116:119], a[204:207], a[140:143], 0
    buffer_load_dwordx4 a[132:135], v163, s[20:23], s85 offen offset:2048 sc1
    v_mfma_f32_16x16x32_bf16 v[116:119], a[200:203], a[136:139], v[116:119]
    v_mfma_f32_16x16x32_bf16 v[120:123], a[208:211], a[136:139], 0
    v_mfma_f32_16x16x32_bf16 v[120:123], a[212:215], a[140:143], v[120:123]
    v_mfma_f32_16x16x32_bf16 v[124:127], a[220:223], a[140:143], 0
    v_mfma_f32_16x16x32_bf16 v[124:127], a[216:219], a[136:139], v[124:127]
    s_waitcnt vmcnt(15)
    buffer_load_dwordx4 a[136:139], v161, s[20:23], s85 offen offset:2048 sc1
    v_mfma_f32_16x16x32_bf16 v[140:143], a[216:219], a[144:147], 0
    s_waitcnt vmcnt(15)
    v_mfma_f32_16x16x32_bf16 v[140:143], a[220:223], a[148:151], v[140:143]
    v_mfma_f32_16x16x32_bf16 v[136:139], a[212:215], a[148:151], 0
    buffer_load_dwordx4 a[140:143], v163, s[20:23], s85 offen offset:3072 sc1
    v_mfma_f32_16x16x32_bf16 v[136:139], a[208:211], a[144:147], v[136:139]
    v_mfma_f32_16x16x32_bf16 v[132:135], a[200:203], a[144:147], 0
    v_mfma_f32_16x16x32_bf16 v[132:135], a[204:207], a[148:151], v[132:135]
    v_mfma_f32_16x16x32_bf16 v[128:131], a[196:199], a[148:151], 0
    v_mfma_f32_16x16x32_bf16 v[128:131], a[192:195], a[144:147], v[128:131]
    s_waitcnt vmcnt(15)
    buffer_load_dwordx4 a[144:147], v161, s[20:23], s85 offen offset:3072 sc1
    v_mfma_f32_16x16x32_bf16 v[144:147], a[192:195], a[152:155], 0
    s_waitcnt vmcnt(15)
    v_mfma_f32_16x16x32_bf16 v[144:147], a[196:199], a[156:159], v[144:147]
    v_mfma_f32_16x16x32_bf16 v[148:151], a[204:207], a[156:159], 0
    buffer_load_dwordx4 a[148:151], v164, s[20:23], s85 offen sc1
    v_mfma_f32_16x16x32_bf16 v[148:151], a[200:203], a[152:155], v[148:151]
    v_mfma_f32_16x16x32_bf16 v[152:155], a[208:211], a[152:155], 0
    v_mfma_f32_16x16x32_bf16 v[152:155], a[212:215], a[156:159], v[152:155]
    v_mfma_f32_16x16x32_bf16 v[156:159], a[220:223], a[156:159], 0
    v_mfma_f32_16x16x32_bf16 v[156:159], a[216:219], a[152:155], v[156:159]
    s_waitcnt vmcnt(15)
    buffer_load_dwordx4 a[152:155], v162, s[20:23], s85 offen sc1
    buffer_load_dwordx4 a[156:159], v164, s[20:23], s85 offen offset:1024 sc1
    v_mfma_f32_16x16x32_bf16 v[28:31], a[248:251], a[88:91], v[28:31]
    s_waitcnt vmcnt(16)
    s_xor_b32 s69, s95, 2
    v_mfma_f32_16x16x32_bf16 v[28:31], a[252:255], a[92:95], v[28:31]
    s_mul_i32 s69, s69, 0x4800
    v_mfma_f32_16x16x32_bf16 v[24:27], a[244:247], a[92:95], v[24:27]
    s_add_u32 s92, s67, s69
    v_mfma_f32_16x16x32_bf16 v[24:27], a[240:243], a[88:91], v[24:27]
    v_mfma_f32_16x16x32_bf16 v[20:23], a[232:235], a[88:91], v[20:23]
    v_mfma_f32_16x16x32_bf16 v[20:23], a[236:239], a[92:95], v[20:23]
    v_mfma_f32_16x16x32_bf16 v[16:19], a[228:231], a[92:95], v[16:19]
    v_mfma_f32_16x16x32_bf16 v[16:19], a[224:227], a[88:91], v[16:19]
    s_waitcnt vmcnt(15)
    buffer_load_dwordx4 a[88:91], v160, s[20:23], s92 offen sc1
    v_mfma_f32_16x16x32_bf16 v[32:35], a[224:227], a[96:99], v[32:35]
    s_waitcnt vmcnt(15)
    v_mfma_f32_16x16x32_bf16 v[32:35], a[228:231], a[100:103], v[32:35]
    v_mfma_f32_16x16x32_bf16 v[36:39], a[236:239], a[100:103], v[36:39]
    ds_read_b64_tr_b16 a[192:193], v5
    buffer_load_dwordx4 a[92:95], v162, s[20:23], s92 offen offset:1024 sc1
    v_mfma_f32_16x16x32_bf16 v[36:39], a[232:235], a[96:99], v[36:39]
    v_mfma_f32_16x16x32_bf16 v[40:43], a[240:243], a[96:99], v[40:43]
    ds_read_b64_tr_b16 a[194:195], v5 offset:2048
    v_mfma_f32_16x16x32_bf16 v[40:43], a[244:247], a[100:103], v[40:43]
    v_mfma_f32_16x16x32_bf16 v[44:47], a[252:255], a[100:103], v[44:47]
    v_mfma_f32_16x16x32_bf16 v[44:47], a[248:251], a[96:99], v[44:47]
    s_waitcnt vmcnt(15)
    ds_read_b64_tr_b16 a[196:197], v5 offset:4096
    buffer_load_dwordx4 a[96:99], v160, s[20:23], s92 offen offset:1024 sc1
    v_mfma_f32_16x16x32_bf16 v[60:63], a[248:251], a[104:107], v[60:63]
    s_waitcnt vmcnt(15)
    v_mfma_f32_16x16x32_bf16 v[60:63], a[252:255], a[108:111], v[60:63]
    v_mfma_f32_16x16x32_bf16 v[56:59], a[244:247], a[108:111], v[56:59]
    ds_read_b64_tr_b16 a[198:199], v5 offset:6144
    buffer_load_dwordx4 a[100:103], v162, s[20:23], s92 offen offset:2048 sc1
    v_mfma_f32_16x16x32_bf16 v[56:59], a[240:243], a[104:107], v[56:59]
    v_mfma_f32_16x16x32_bf16 v[52:55], a[232:235], a[104:107], v[52:55]
    v_mfma_f32_16x16x32_bf16 v[52:55], a[236:239], a[108:111], v[52:55]
    ds_read_b64_tr_b16 a[200:201], v6
    v_mfma_f32_16x16x32_bf16 v[48:51], a[228:231], a[108:111], v[48:51]
    v_mfma_f32_16x16x32_bf16 v[48:51], a[224:227], a[104:107], v[48:51]
    s_waitcnt vmcnt(15)
    buffer_load_dwordx4 a[104:107], v160, s[20:23], s92 offen offset:2048 sc1
    v_mfma_f32_16x16x32_bf16 v[64:67], a[224:227], a[112:115], v[64:67]
    s_waitcnt vmcnt(15)
    ds_read_b64_tr_b16 a[202:203], v6 offset:2048
    v_mfma_f32_16x16x32_bf16 v[64:67], a[228:231], a[116:119], v[64:67]
    v_mfma_f32_16x16x32_bf16 v[68:71], a[236:239], a[116:119], v[68:71]
    buffer_load_dwordx4 a[108:111], v162, s[20:23], s92 offen offset:3072 sc1
    v_mfma_f32_16x16x32_bf16 v[68:71], a[232:235], a[112:115], v[68:71]
    ds_read_b64_tr_b16 a[204:205], v6 offset:4096
    v_mfma_f32_16x16x32_bf16 v[72:75], a[240:243], a[112:115], v[72:75]
    v_mfma_f32_16x16x32_bf16 v[72:75], a[244:247], a[116:119], v[72:75]
    v_mfma_f32_16x16x32_bf16 v[76:79], a[252:255], a[116:119], v[76:79]
    ds_read_b64_tr_b16 a[206:207], v6 offset:6144
    v_mfma_f32_16x16x32_bf16 v[76:79], a[248:251], a[112:115], v[76:79]
    s_waitcnt vmcnt(15)
    buffer_load_dwordx4 a[112:115], v160, s[20:23], s92 offen offset:3072 sc1
    v_mfma_f32_16x16x32_bf16 v[92:95], a[248:251], a[120:123], v[92:95]
    s_waitcnt vmcnt(15)
    v_mfma_f32_16x16x32_bf16 v[92:95], a[252:255], a[124:127], v[92:95]
    ds_read_b64_tr_b16 a[208:209], v7
    v_mfma_f32_16x16x32_bf16 v[88:91], a[244:247], a[124:127], v[88:91]
    buffer_load_dwordx4 a[116:119], v163, s[20:23], s92 offen sc1
    v_mfma_f32_16x16x32_bf16 v[88:91], a[240:243], a[120:123], v[88:91]
    ds_read_b64_tr_b16 a[210:211], v7 offset:2048
    v_mfma_f32_16x16x32_bf16 v[84:87], a[232:235], a[120:123], v[84:87]
    v_mfma_f32_16x16x32_bf16 v[84:87], a[236:239], a[124:127], v[84:87]
    v_mfma_f32_16x16x32_bf16 v[80:83], a[228:231], a[124:127], v[80:83]
    ds_read_b64_tr_b16 a[212:213], v7 offset:4096
    v_mfma_f32_16x16x32_bf16 v[80:83], a[224:227], a[120:123], v[80:83]
    s_waitcnt vmcnt(15)
    buffer_load_dwordx4 a[120:123], v161, s[20:23], s92 offen sc1
    v_mfma_f32_16x16x32_bf16 v[96:99], a[224:227], a[128:131], v[96:99]
    s_waitcnt vmcnt(15)
    v_mfma_f32_16x16x32_bf16 v[96:99], a[228:231], a[132:135], v[96:99]
    ds_read_b64_tr_b16 a[214:215], v7 offset:6144
    v_mfma_f32_16x16x32_bf16 v[100:103], a[236:239], a[132:135], v[100:103]
    buffer_load_dwordx4 a[124:127], v163, s[20:23], s92 offen offset:1024 sc1
    v_mfma_f32_16x16x32_bf16 v[100:103], a[232:235], a[128:131], v[100:103]
    v_mfma_f32_16x16x32_bf16 v[104:107], a[240:243], a[128:131], v[104:107]
    ds_read_b64_tr_b16 a[216:217], v8
    v_mfma_f32_16x16x32_bf16 v[104:107], a[244:247], a[132:135], v[104:107]
    v_mfma_f32_16x16x32_bf16 v[108:111], a[252:255], a[132:135], v[108:111]
    v_mfma_f32_16x16x32_bf16 v[108:111], a[248:251], a[128:131], v[108:111]
    s_waitcnt vmcnt(15)
    ds_read_b64_tr_b16 a[218:219], v8 offset:2048
    buffer_load_dwordx4 a[128:131], v161, s[20:23], s92 offen offset:1024 sc1
    v_mfma_f32_16x16x32_bf16 v[124:127], a[248:251], a[136:139], v[124:127]
    s_waitcnt vmcnt(15)
    v_mfma_f32_16x16x32_bf16 v[124:127], a[252:255], a[140:143], v[124:127]
    v_mfma_f32_16x16x32_bf16 v[120:123], a[244:247], a[140:143], v[120:123]
    ds_read_b64_tr_b16 a[220:221], v8 offset:4096
    buffer_load_dwordx4 a[132:135], v163, s[20:23], s92 offen offset:2048 sc1
    v_mfma_f32_16x16x32_bf16 v[120:123], a[240:243], a[136:139], v[120:123]
    v_mfma_f32_16x16x32_bf16 v[116:119], a[232:235], a[136:139], v[116:119]
    v_mfma_f32_16x16x32_bf16 v[116:119], a[236:239], a[140:143], v[116:119]
    ds_read_b64_tr_b16 a[222:223], v8 offset:6144
    v_mfma_f32_16x16x32_bf16 v[112:115], a[228:231], a[140:143], v[112:115]
    v_mfma_f32_16x16x32_bf16 v[112:115], a[224:227], a[136:139], v[112:115]
    s_waitcnt vmcnt(15)
    buffer_load_dwordx4 a[136:139], v161, s[20:23], s92 offen offset:2048 sc1
    v_mfma_f32_16x16x32_bf16 v[128:131], a[224:227], a[144:147], v[128:131]
    s_waitcnt vmcnt(15)
    v_mfma_f32_16x16x32_bf16 v[128:131], a[228:231], a[148:151], v[128:131]
    v_mfma_f32_16x16x32_bf16 v[132:135], a[236:239], a[148:151], v[132:135]
    buffer_load_dwordx4 a[140:143], v163, s[20:23], s92 offen offset:3072 sc1
    v_mfma_f32_16x16x32_bf16 v[132:135], a[232:235], a[144:147], v[132:135]
    v_mfma_f32_16x16x32_bf16 v[136:139], a[240:243], a[144:147], v[136:139]
    v_mfma_f32_16x16x32_bf16 v[136:139], a[244:247], a[148:151], v[136:139]
    v_mfma_f32_16x16x32_bf16 v[140:143], a[252:255], a[148:151], v[140:143]
    v_mfma_f32_16x16x32_bf16 v[140:143], a[248:251], a[144:147], v[140:143]
    s_waitcnt vmcnt(15)
    buffer_load_dwordx4 a[144:147], v161, s[20:23], s92 offen offset:3072 sc1
    v_mfma_f32_16x16x32_bf16 v[156:159], a[248:251], a[152:155], v[156:159]
    s_waitcnt vmcnt(15)
    v_mfma_f32_16x16x32_bf16 v[156:159], a[252:255], a[156:159], v[156:159]
    v_mfma_f32_16x16x32_bf16 v[152:155], a[244:247], a[156:159], v[152:155]
    buffer_load_dwordx4 a[148:151], v164, s[20:23], s92 offen sc1
    v_mfma_f32_16x16x32_bf16 v[152:155], a[240:243], a[152:155], v[152:155]
    v_mfma_f32_16x16x32_bf16 v[148:151], a[232:235], a[152:155], v[148:151]
    s_waitcnt lgkmcnt(0)
    v_mfma_f32_16x16x32_bf16 v[148:151], a[236:239], a[156:159], v[148:151]
    v_mfma_f32_16x16x32_bf16 v[144:147], a[228:231], a[156:159], v[144:147]
    v_mfma_f32_16x16x32_bf16 v[144:147], a[224:227], a[152:155], v[144:147]
    s_waitcnt vmcnt(15)
    buffer_load_dwordx4 a[152:155], v162, s[20:23], s92 offen sc1
    buffer_load_dwordx4 a[156:159], v164, s[20:23], s92 offen offset:1024 sc1
    v_mfma_f32_16x16x32_bf16 v[16:19], a[160:163], a[88:91], v[16:19]
    s_waitcnt vmcnt(16)
    s_xor_b32 s69, s95, 3
    v_mfma_f32_16x16x32_bf16 v[16:19], a[164:167], a[92:95], v[16:19]
    s_mul_i32 s69, s69, 0x4800
    v_mfma_f32_16x16x32_bf16 v[20:23], a[172:175], a[92:95], v[20:23]
    s_add_u32 s85, s67, s69
    v_mfma_f32_16x16x32_bf16 v[20:23], a[168:171], a[88:91], v[20:23]
    v_mfma_f32_16x16x32_bf16 v[24:27], a[176:179], a[88:91], v[24:27]
    v_mfma_f32_16x16x32_bf16 v[24:27], a[180:183], a[92:95], v[24:27]
    v_mfma_f32_16x16x32_bf16 v[28:31], a[188:191], a[92:95], v[28:31]
    v_mfma_f32_16x16x32_bf16 v[28:31], a[184:187], a[88:91], v[28:31]
    s_waitcnt vmcnt(15)
    buffer_load_dwordx4 a[88:91], v160, s[20:23], s85 offen sc1
    v_mfma_f32_16x16x32_bf16 v[44:47], a[184:187], a[96:99], v[44:47]
    s_waitcnt vmcnt(15)
    v_mfma_f32_16x16x32_bf16 v[44:47], a[188:191], a[100:103], v[44:47]
    s_xor_b32 s91, s95, 12
    v_mfma_f32_16x16x32_bf16 v[40:43], a[180:183], a[100:103], v[40:43]
    s_lshl_b32 s91, s91, 17
    v_add_u32 v5, 0x10000, v5
    buffer_load_dwordx4 a[92:95], v162, s[20:23], s85 offen offset:1024 sc1
    v_mfma_f32_16x16x32_bf16 v[40:43], a[176:179], a[96:99], v[40:43]
    s_add_u32 s91, s91, s93
    v_mfma_f32_16x16x32_bf16 v[36:39], a[168:171], a[96:99], v[36:39]
    s_add_u32 m0, s78, 0
    v_add_u32 v6, 0x10000, v6
    buffer_load_dwordx4 v1, s[24:27], s91 offen lds
    v_mfma_f32_16x16x32_bf16 v[36:39], a[172:175], a[100:103], v[36:39]
    v_mfma_f32_16x16x32_bf16 v[32:35], a[164:167], a[100:103], v[32:35]
    v_add_u32 v7, 0x10000, v7
    v_mfma_f32_16x16x32_bf16 v[32:35], a[160:163], a[96:99], v[32:35]
    s_waitcnt vmcnt(16)
    buffer_load_dwordx4 a[96:99], v160, s[20:23], s85 offen offset:1024 sc1
    v_mfma_f32_16x16x32_bf16 v[48:51], a[160:163], a[104:107], v[48:51]
    s_waitcnt vmcnt(16)
    v_add_u32 v8, 0x10000, v8
    v_mfma_f32_16x16x32_bf16 v[48:51], a[164:167], a[108:111], v[48:51]
    s_add_u32 m0, m0, 0x400
    v_mfma_f32_16x16x32_bf16 v[52:55], a[172:175], a[108:111], v[52:55]
    s_add_u32 s91, s91, 0x4000
    buffer_load_dwordx4 a[100:103], v162, s[20:23], s85 offen offset:2048 sc1
    v_mfma_f32_16x16x32_bf16 v[52:55], a[168:171], a[104:107], v[52:55]
    ds_read_b64_tr_b16 a[224:225], v5 offset:32768
    buffer_load_dwordx4 v1, s[24:27], s91 offen lds
    v_mfma_f32_16x16x32_bf16 v[56:59], a[176:179], a[104:107], v[56:59]
    v_mfma_f32_16x16x32_bf16 v[56:59], a[180:183], a[108:111], v[56:59]
    ds_read_b64_tr_b16 a[226:227], v5 offset:34816
    v_mfma_f32_16x16x32_bf16 v[60:63], a[188:191], a[108:111], v[60:63]
    v_mfma_f32_16x16x32_bf16 v[60:63], a[184:187], a[104:107], v[60:63]
    s_waitcnt vmcnt(17)
    ds_read_b64_tr_b16 a[228:229], v5 offset:36864
    buffer_load_dwordx4 a[104:107], v160, s[20:23], s85 offen offset:2048 sc1
    v_mfma_f32_16x16x32_bf16 v[76:79], a[184:187], a[112:115], v[76:79]
    s_waitcnt vmcnt(17)
    s_add_u32 m0, m0, 0x400
    v_mfma_f32_16x16x32_bf16 v[76:79], a[188:191], a[116:119], v[76:79]
    s_add_u32 s91, s91, 0x4000
    v_mfma_f32_16x16x32_bf16 v[72:75], a[180:183], a[116:119], v[72:75]
    ds_read_b64_tr_b16 a[230:231], v5 offset:38912
    buffer_load_dwordx4 v1, s[24:27], s91 offen lds
    v_mfma_f32_16x16x32_bf16 v[72:75], a[176:179], a[112:115], v[72:75]
    buffer_load_dwordx4 a[108:111], v162, s[20:23], s85 offen offset:3072 sc1
    v_mfma_f32_16x16x32_bf16 v[68:71], a[168:171], a[112:115], v[68:71]
    ds_read_b64_tr_b16 a[232:233], v6 offset:32768
    v_mfma_f32_16x16x32_bf16 v[68:71], a[172:175], a[116:119], v[68:71]
    v_mfma_f32_16x16x32_bf16 v[64:67], a[164:167], a[116:119], v[64:67]
    ds_read_b64_tr_b16 a[234:235], v6 offset:34816
    v_mfma_f32_16x16x32_bf16 v[64:67], a[160:163], a[112:115], v[64:67]
    s_waitcnt vmcnt(18)
    s_add_u32 m0, m0, 0x400
    buffer_load_dwordx4 a[112:115], v160, s[20:23], s85 offen offset:3072 sc1
    v_mfma_f32_16x16x32_bf16 v[80:83], a[160:163], a[120:123], v[80:83]
    s_waitcnt vmcnt(18)
    s_add_u32 s91, s91, 0x4000
    v_mfma_f32_16x16x32_bf16 v[80:83], a[164:167], a[124:127], v[80:83]
    ds_read_b64_tr_b16 a[236:237], v6 offset:36864
    buffer_load_dwordx4 v1, s[24:27], s91 offen lds
    v_mfma_f32_16x16x32_bf16 v[84:87], a[172:175], a[124:127], v[84:87]
    buffer_load_dwordx4 a[116:119], v163, s[20:23], s85 offen sc1
    v_mfma_f32_16x16x32_bf16 v[84:87], a[168:171], a[120:123], v[84:87]
    ds_read_b64_tr_b16 a[238:239], v6 offset:38912
    v_mfma_f32_16x16x32_bf16 v[88:91], a[176:179], a[120:123], v[88:91]
    v_mfma_f32_16x16x32_bf16 v[88:91], a[180:183], a[124:127], v[88:91]
    ds_read_b64_tr_b16 a[240:241], v7 offset:32768
    v_mfma_f32_16x16x32_bf16 v[92:95], a[188:191], a[124:127], v[92:95]
    s_add_u32 m0, m0, 0x400
    v_mfma_f32_16x16x32_bf16 v[92:95], a[184:187], a[120:123], v[92:95]
    s_waitcnt vmcnt(19)
    s_add_u32 s91, s91, 0x4000
    ds_read_b64_tr_b16 a[242:243], v7 offset:34816
    buffer_load_dwordx4 a[120:123], v161, s[20:23], s85 offen sc1
    v_mfma_f32_16x16x32_bf16 v[108:111], a[184:187], a[128:131], v[108:111]
    s_waitcnt vmcnt(19)
    buffer_load_dwordx4 v1, s[24:27], s91 offen lds
    v_mfma_f32_16x16x32_bf16 v[108:111], a[188:191], a[132:135], v[108:111]
    v_mfma_f32_16x16x32_bf16 v[104:107], a[180:183], a[132:135], v[104:107]
    ds_read_b64_tr_b16 a[244:245], v7 offset:36864
    buffer_load_dwordx4 a[124:127], v163, s[20:23], s85 offen offset:1024 sc1
    v_mfma_f32_16x16x32_bf16 v[104:107], a[176:179], a[128:131], v[104:107]
    v_mfma_f32_16x16x32_bf16 v[100:103], a[168:171], a[128:131], v[100:103]
    ds_read_b64_tr_b16 a[246:247], v7 offset:38912
    v_mfma_f32_16x16x32_bf16 v[100:103], a[172:175], a[132:135], v[100:103]
    s_add_u32 m0, m0, 0x400
    v_mfma_f32_16x16x32_bf16 v[96:99], a[164:167], a[132:135], v[96:99]
    s_add_u32 s91, s91, 0x4000
    ds_read_b64_tr_b16 a[248:249], v8 offset:32768
    v_mfma_f32_16x16x32_bf16 v[96:99], a[160:163], a[128:131], v[96:99]
    s_waitcnt vmcnt(20)
    buffer_load_dwordx4 v1, s[24:27], s91 offen lds
    buffer_load_dwordx4 a[128:131], v161, s[20:23], s85 offen offset:1024 sc1
    v_mfma_f32_16x16x32_bf16 v[112:115], a[160:163], a[136:139], v[112:115]
    s_waitcnt vmcnt(21)
    v_mfma_f32_16x16x32_bf16 v[112:115], a[164:167], a[140:143], v[112:115]
    ds_read_b64_tr_b16 a[250:251], v8 offset:34816
    v_mfma_f32_16x16x32_bf16 v[116:119], a[172:175], a[140:143], v[116:119]
    buffer_load_dwordx4 a[132:135], v163, s[20:23], s85 offen offset:2048 sc1
    v_mfma_f32_16x16x32_bf16 v[116:119], a[168:171], a[136:139], v[116:119]
    ds_read_b64_tr_b16 a[252:253], v8 offset:36864
    v_mfma_f32_16x16x32_bf16 v[120:123], a[176:179], a[136:139], v[120:123]
    s_add_u32 m0, m0, 0x400
    v_mfma_f32_16x16x32_bf16 v[120:123], a[180:183], a[140:143], v[120:123]
    s_add_u32 s91, s91, 0x4000
    ds_read_b64_tr_b16 a[254:255], v8 offset:38912
    v_mfma_f32_16x16x32_bf16 v[124:127], a[188:191], a[140:143], v[124:127]
    buffer_load_dwordx4 v1, s[24:27], s91 offen lds
    v_mfma_f32_16x16x32_bf16 v[124:127], a[184:187], a[136:139], v[124:127]
    s_waitcnt vmcnt(22)
    buffer_load_dwordx4 a[136:139], v161, s[20:23], s85 offen offset:2048 sc1
    v_mfma_f32_16x16x32_bf16 v[140:143], a[184:187], a[144:147], v[140:143]
    s_waitcnt vmcnt(22)
    v_mfma_f32_16x16x32_bf16 v[140:143], a[188:191], a[148:151], v[140:143]
    v_mfma_f32_16x16x32_bf16 v[136:139], a[180:183], a[148:151], v[136:139]
    buffer_load_dwordx4 a[140:143], v163, s[20:23], s85 offen offset:3072 sc1
    v_mfma_f32_16x16x32_bf16 v[136:139], a[176:179], a[144:147], v[136:139]
    s_add_u32 m0, m0, 0x400
    v_mfma_f32_16x16x32_bf16 v[132:135], a[168:171], a[144:147], v[132:135]
    s_add_u32 s91, s91, 0x4000
    v_mfma_f32_16x16x32_bf16 v[132:135], a[172:175], a[148:151], v[132:135]
    buffer_load_dwordx4 v1, s[24:27], s91 offen lds
    v_mfma_f32_16x16x32_bf16 v[128:131], a[164:167], a[148:151], v[128:131]
    v_mfma_f32_16x16x32_bf16 v[128:131], a[160:163], a[144:147], v[128:131]
    s_waitcnt vmcnt(23)
    buffer_load_dwordx4 a[144:147], v161, s[20:23], s85 offen offset:3072 sc1
    v_mfma_f32_16x16x32_bf16 v[144:147], a[160:163], a[152:155], v[144:147]
    s_waitcnt vmcnt(23)
    v_mfma_f32_16x16x32_bf16 v[144:147], a[164:167], a[156:159], v[144:147]
    v_mfma_f32_16x16x32_bf16 v[148:151], a[172:175], a[156:159], v[148:151]
    buffer_load_dwordx4 a[148:151], v164, s[20:23], s85 offen sc1
    v_mfma_f32_16x16x32_bf16 v[148:151], a[168:171], a[152:155], v[148:151]
    v_mfma_f32_16x16x32_bf16 v[152:155], a[176:179], a[152:155], v[152:155]
    s_waitcnt lgkmcnt(0)
    v_mfma_f32_16x16x32_bf16 v[152:155], a[180:183], a[156:159], v[152:155]
    v_mfma_f32_16x16x32_bf16 v[156:159], a[188:191], a[156:159], v[156:159]
    v_mfma_f32_16x16x32_bf16 v[156:159], a[184:187], a[152:155], v[156:159]
    s_waitcnt vmcnt(23)
    buffer_load_dwordx4 a[152:155], v162, s[20:23], s85 offen sc1
    buffer_load_dwordx4 a[156:159], v164, s[20:23], s85 offen offset:1024 sc1
    v_mfma_f32_16x16x32_bf16 v[28:31], v[210:213], a[88:91], v[28:31]
    s_waitcnt vmcnt(24)
    s_xor_b32 s69, s95, 4
    v_mfma_f32_16x16x32_bf16 v[28:31], v[214:217], a[92:95], v[28:31]
    s_mul_i32 s69, s69, 0x4800
    v_mfma_f32_16x16x32_bf16 v[24:27], v[206:209], a[92:95], v[24:27]
    s_add_u32 s92, s67, s69
    v_mfma_f32_16x16x32_bf16 v[24:27], v[202:205], a[88:91], v[24:27]
    v_mfma_f32_16x16x32_bf16 v[20:23], v[194:197], a[88:91], v[20:23]
    v_mfma_f32_16x16x32_bf16 v[20:23], v[198:201], a[92:95], v[20:23]
    v_mfma_f32_16x16x32_bf16 v[16:19], v[190:193], a[92:95], v[16:19]
    v_mfma_f32_16x16x32_bf16 v[16:19], v[186:189], a[88:91], v[16:19]
    s_waitcnt vmcnt(22)
    buffer_load_dwordx4 a[88:91], v160, s[20:23], s92 offen sc1
    v_mfma_f32_16x16x32_bf16 v[32:35], v[186:189], a[96:99], v[32:35]
    s_waitcnt vmcnt(22)
    v_mfma_f32_16x16x32_bf16 v[32:35], v[190:193], a[100:103], v[32:35]
    s_xor_b32 s91, s95, 13
    v_mfma_f32_16x16x32_bf16 v[36:39], v[198:201], a[100:103], v[36:39]
    s_lshl_b32 s91, s91, 17
    v_add_u32 v5, 0x10000, v5
    buffer_load_dwordx4 a[92:95], v162, s[20:23], s92 offen offset:1024 sc1
    v_mfma_f32_16x16x32_bf16 v[36:39], v[194:197], a[96:99], v[36:39]
    s_add_u32 s91, s91, s93
    v_mfma_f32_16x16x32_bf16 v[40:43], v[202:205], a[96:99], v[40:43]
    s_add_u32 m0, s78, 0x18000
    v_add_u32 v6, 0x10000, v6
    buffer_load_dwordx4 v1, s[24:27], s91 offen lds
    v_mfma_f32_16x16x32_bf16 v[40:43], v[206:209], a[100:103], v[40:43]
    v_mfma_f32_16x16x32_bf16 v[44:47], v[214:217], a[100:103], v[44:47]
    v_add_u32 v7, 0x10000, v7
    v_mfma_f32_16x16x32_bf16 v[44:47], v[210:213], a[96:99], v[44:47]
    s_waitcnt vmcnt(22)
    buffer_load_dwordx4 a[96:99], v160, s[20:23], s92 offen offset:1024 sc1
    v_mfma_f32_16x16x32_bf16 v[60:63], v[210:213], a[104:107], v[60:63]
    s_waitcnt vmcnt(21)
    v_add_u32 v8, 0x10000, v8
    v_mfma_f32_16x16x32_bf16 v[60:63], v[214:217], a[108:111], v[60:63]
    s_add_u32 m0, m0, 0x400
    v_mfma_f32_16x16x32_bf16 v[56:59], v[206:209], a[108:111], v[56:59]
    s_add_u32 s91, s91, 0x4000
    buffer_load_dwordx4 a[100:103], v162, s[20:23], s92 offen offset:2048 sc1
    v_mfma_f32_16x16x32_bf16 v[56:59], v[202:205], a[104:107], v[56:59]
    ds_read_b64_tr_b16 a[160:161], v5
    buffer_load_dwordx4 v1, s[24:27], s91 offen lds
    v_mfma_f32_16x16x32_bf16 v[52:55], v[194:197], a[104:107], v[52:55]
    v_mfma_f32_16x16x32_bf16 v[52:55], v[198:201], a[108:111], v[52:55]
    ds_read_b64_tr_b16 a[162:163], v5 offset:2048
    v_mfma_f32_16x16x32_bf16 v[48:51], v[190:193], a[108:111], v[48:51]
    v_mfma_f32_16x16x32_bf16 v[48:51], v[186:189], a[104:107], v[48:51]
    s_waitcnt vmcnt(22)
    ds_read_b64_tr_b16 a[164:165], v5 offset:4096
    buffer_load_dwordx4 a[104:107], v160, s[20:23], s92 offen offset:2048 sc1
    v_mfma_f32_16x16x32_bf16 v[64:67], v[186:189], a[112:115], v[64:67]
    s_waitcnt vmcnt(21)
    s_add_u32 m0, m0, 0x400
    v_mfma_f32_16x16x32_bf16 v[64:67], v[190:193], a[116:119], v[64:67]
    s_add_u32 s91, s91, 0x4000
    v_mfma_f32_16x16x32_bf16 v[68:71], v[198:201], a[116:119], v[68:71]
    ds_read_b64_tr_b16 a[166:167], v5 offset:6144
    buffer_load_dwordx4 v1, s[24:27], s91 offen lds
    v_mfma_f32_16x16x32_bf16 v[68:71], v[194:197], a[112:115], v[68:71]
    buffer_load_dwordx4 a[108:111], v162, s[20:23], s92 offen offset:3072 sc1
    v_mfma_f32_16x16x32_bf16 v[72:75], v[202:205], a[112:115], v[72:75]
    ds_read_b64_tr_b16 a[168:169], v6
    v_mfma_f32_16x16x32_bf16 v[72:75], v[206:209], a[116:119], v[72:75]
    v_mfma_f32_16x16x32_bf16 v[76:79], v[214:217], a[116:119], v[76:79]
    ds_read_b64_tr_b16 a[170:171], v6 offset:2048
    v_mfma_f32_16x16x32_bf16 v[76:79], v[210:213], a[112:115], v[76:79]
    s_waitcnt vmcnt(22)
    s_add_u32 m0, m0, 0x400
    buffer_load_dwordx4 a[112:115], v160, s[20:23], s92 offen offset:3072 sc1
    v_mfma_f32_16x16x32_bf16 v[92:95], v[210:213], a[120:123], v[92:95]
    s_waitcnt vmcnt(21)
    s_add_u32 s91, s91, 0x4000
    v_mfma_f32_16x16x32_bf16 v[92:95], v[214:217], a[124:127], v[92:95]
    ds_read_b64_tr_b16 a[172:173], v6 offset:4096
    buffer_load_dwordx4 v1, s[24:27], s91 offen lds
    v_mfma_f32_16x16x32_bf16 v[88:91], v[206:209], a[124:127], v[88:91]
    buffer_load_dwordx4 a[116:119], v163, s[20:23], s92 offen sc1
    v_mfma_f32_16x16x32_bf16 v[88:91], v[202:205], a[120:123], v[88:91]
    ds_read_b64_tr_b16 a[174:175], v6 offset:6144
    v_mfma_f32_16x16x32_bf16 v[84:87], v[194:197], a[120:123], v[84:87]
    v_mfma_f32_16x16x32_bf16 v[84:87], v[198:201], a[124:127], v[84:87]
    ds_read_b64_tr_b16 a[176:177], v7
    v_mfma_f32_16x16x32_bf16 v[80:83], v[190:193], a[124:127], v[80:83]
    s_add_u32 m0, m0, 0x400
    v_mfma_f32_16x16x32_bf16 v[80:83], v[186:189], a[120:123], v[80:83]
    s_waitcnt vmcnt(21)
    s_add_u32 s91, s91, 0x4000
    ds_read_b64_tr_b16 a[178:179], v7 offset:2048
    buffer_load_dwordx4 a[120:123], v161, s[20:23], s92 offen sc1
    v_mfma_f32_16x16x32_bf16 v[96:99], v[186:189], a[128:131], v[96:99]
    s_waitcnt vmcnt(21)
    buffer_load_dwordx4 v1, s[24:27], s91 offen lds
    v_mfma_f32_16x16x32_bf16 v[96:99], v[190:193], a[132:135], v[96:99]
    v_mfma_f32_16x16x32_bf16 v[100:103], v[198:201], a[132:135], v[100:103]
    ds_read_b64_tr_b16 a[180:181], v7 offset:4096
    buffer_load_dwordx4 a[124:127], v163, s[20:23], s92 offen offset:1024 sc1
    v_mfma_f32_16x16x32_bf16 v[100:103], v[194:197], a[128:131], v[100:103]
    v_mfma_f32_16x16x32_bf16 v[104:107], v[202:205], a[128:131], v[104:107]
    ds_read_b64_tr_b16 a[182:183], v7 offset:6144
    v_mfma_f32_16x16x32_bf16 v[104:107], v[206:209], a[132:135], v[104:107]
    s_add_u32 m0, m0, 0x400
    v_mfma_f32_16x16x32_bf16 v[108:111], v[214:217], a[132:135], v[108:111]
    s_add_u32 s91, s91, 0x4000
    ds_read_b64_tr_b16 a[184:185], v8
    v_mfma_f32_16x16x32_bf16 v[108:111], v[210:213], a[128:131], v[108:111]
    s_waitcnt vmcnt(21)
    buffer_load_dwordx4 v1, s[24:27], s91 offen lds
    buffer_load_dwordx4 a[128:131], v161, s[20:23], s92 offen offset:1024 sc1
    v_mfma_f32_16x16x32_bf16 v[124:127], v[210:213], a[136:139], v[124:127]
    s_waitcnt vmcnt(22)
    v_mfma_f32_16x16x32_bf16 v[124:127], v[214:217], a[140:143], v[124:127]
    ds_read_b64_tr_b16 a[186:187], v8 offset:2048
    v_mfma_f32_16x16x32_bf16 v[120:123], v[206:209], a[140:143], v[120:123]
    buffer_load_dwordx4 a[132:135], v163, s[20:23], s92 offen offset:2048 sc1
    v_mfma_f32_16x16x32_bf16 v[120:123], v[202:205], a[136:139], v[120:123]
    ds_read_b64_tr_b16 a[188:189], v8 offset:4096
    v_mfma_f32_16x16x32_bf16 v[116:119], v[194:197], a[136:139], v[116:119]
    s_add_u32 m0, m0, 0x400
    v_mfma_f32_16x16x32_bf16 v[116:119], v[198:201], a[140:143], v[116:119]
    s_add_u32 s91, s91, 0x4000
    ds_read_b64_tr_b16 a[190:191], v8 offset:6144
    v_mfma_f32_16x16x32_bf16 v[112:115], v[190:193], a[140:143], v[112:115]
    buffer_load_dwordx4 v1, s[24:27], s91 offen lds
    v_mfma_f32_16x16x32_bf16 v[112:115], v[186:189], a[136:139], v[112:115]
    s_waitcnt vmcnt(22)
    buffer_load_dwordx4 a[136:139], v161, s[20:23], s92 offen offset:2048 sc1
    v_mfma_f32_16x16x32_bf16 v[128:131], v[186:189], a[144:147], v[128:131]
    s_waitcnt vmcnt(22)
    v_mfma_f32_16x16x32_bf16 v[128:131], v[190:193], a[148:151], v[128:131]
    v_mfma_f32_16x16x32_bf16 v[132:135], v[198:201], a[148:151], v[132:135]
    buffer_load_dwordx4 a[140:143], v163, s[20:23], s92 offen offset:3072 sc1
    v_mfma_f32_16x16x32_bf16 v[132:135], v[194:197], a[144:147], v[132:135]
    s_add_u32 m0, m0, 0x400
    v_mfma_f32_16x16x32_bf16 v[136:139], v[202:205], a[144:147], v[136:139]
    s_add_u32 s91, s91, 0x4000
    v_mfma_f32_16x16x32_bf16 v[136:139], v[206:209], a[148:151], v[136:139]
    buffer_load_dwordx4 v1, s[24:27], s91 offen lds
    v_mfma_f32_16x16x32_bf16 v[140:143], v[214:217], a[148:151], v[140:143]
    v_mfma_f32_16x16x32_bf16 v[140:143], v[210:213], a[144:147], v[140:143]
    s_waitcnt vmcnt(23)
    buffer_load_dwordx4 a[144:147], v161, s[20:23], s92 offen offset:3072 sc1
    v_mfma_f32_16x16x32_bf16 v[156:159], v[210:213], a[152:155], v[156:159]
    s_waitcnt vmcnt(23)
    v_mfma_f32_16x16x32_bf16 v[156:159], v[214:217], a[156:159], v[156:159]
    v_mfma_f32_16x16x32_bf16 v[152:155], v[206:209], a[156:159], v[152:155]
    buffer_load_dwordx4 a[148:151], v164, s[20:23], s92 offen sc1
    v_mfma_f32_16x16x32_bf16 v[152:155], v[202:205], a[152:155], v[152:155]
    v_mfma_f32_16x16x32_bf16 v[148:151], v[194:197], a[152:155], v[148:151]
    s_waitcnt lgkmcnt(0)
    v_mfma_f32_16x16x32_bf16 v[148:151], v[198:201], a[156:159], v[148:151]
    v_mfma_f32_16x16x32_bf16 v[144:147], v[190:193], a[156:159], v[144:147]
    v_mfma_f32_16x16x32_bf16 v[144:147], v[186:189], a[152:155], v[144:147]
    s_waitcnt vmcnt(23)
    buffer_load_dwordx4 a[152:155], v162, s[20:23], s92 offen sc1
    buffer_load_dwordx4 a[156:159], v164, s[20:23], s92 offen offset:1024 sc1
    v_mfma_f32_16x16x32_bf16 v[16:19], v[218:221], a[88:91], v[16:19]
    s_waitcnt vmcnt(24)
    s_xor_b32 s69, s95, 5
    v_mfma_f32_16x16x32_bf16 v[16:19], v[222:225], a[92:95], v[16:19]
    s_mul_i32 s69, s69, 0x4800
    v_mfma_f32_16x16x32_bf16 v[20:23], v[230:233], a[92:95], v[20:23]
    s_add_u32 s85, s67, s69
    v_mfma_f32_16x16x32_bf16 v[20:23], v[226:229], a[88:91], v[20:23]
    v_mfma_f32_16x16x32_bf16 v[24:27], v[234:237], a[88:91], v[24:27]
    v_mfma_f32_16x16x32_bf16 v[24:27], v[238:241], a[92:95], v[24:27]
    v_mfma_f32_16x16x32_bf16 v[28:31], v[246:249], a[92:95], v[28:31]
    v_mfma_f32_16x16x32_bf16 v[28:31], v[242:245], a[88:91], v[28:31]
    s_waitcnt vmcnt(22)
    buffer_load_dwordx4 a[88:91], v160, s[20:23], s85 offen sc1
    v_mfma_f32_16x16x32_bf16 v[44:47], v[242:245], a[96:99], v[44:47]
    s_waitcnt vmcnt(22)
    v_mfma_f32_16x16x32_bf16 v[44:47], v[246:249], a[100:103], v[44:47]
    s_xor_b32 s91, s95, 14
    v_mfma_f32_16x16x32_bf16 v[40:43], v[238:241], a[100:103], v[40:43]
    s_lshl_b32 s91, s91, 17
    v_add_u32 v5, 0xffff0000, v5
    buffer_load_dwordx4 a[92:95], v162, s[20:23], s85 offen offset:1024 sc1
    v_mfma_f32_16x16x32_bf16 v[40:43], v[234:237], a[96:99], v[40:43]
    s_add_u32 s91, s91, s93
    v_mfma_f32_16x16x32_bf16 v[36:39], v[226:229], a[96:99], v[36:39]
    s_add_u32 m0, s78, 0x20000
    v_add_u32 v6, 0xffff0000, v6
    buffer_load_dwordx4 v1, s[24:27], s91 offen lds
    v_mfma_f32_16x16x32_bf16 v[36:39], v[230:233], a[100:103], v[36:39]
    v_mfma_f32_16x16x32_bf16 v[32:35], v[222:225], a[100:103], v[32:35]
    v_add_u32 v7, 0xffff0000, v7
    v_mfma_f32_16x16x32_bf16 v[32:35], v[218:221], a[96:99], v[32:35]
    s_waitcnt vmcnt(22)
    buffer_load_dwordx4 a[96:99], v160, s[20:23], s85 offen offset:1024 sc1
    v_mfma_f32_16x16x32_bf16 v[48:51], v[218:221], a[104:107], v[48:51]
    s_waitcnt vmcnt(21)
    v_add_u32 v8, 0xffff0000, v8
    v_mfma_f32_16x16x32_bf16 v[48:51], v[222:225], a[108:111], v[48:51]
    s_add_u32 m0, m0, 0x400
    v_mfma_f32_16x16x32_bf16 v[52:55], v[230:233], a[108:111], v[52:55]
    s_add_u32 s91, s91, 0x4000
    buffer_load_dwordx4 a[100:103], v162, s[20:23], s85 offen offset:2048 sc1
    v_mfma_f32_16x16x32_bf16 v[52:55], v[226:229], a[104:107], v[52:55]
    ds_read_b64_tr_b16 v[186:187], v5
    buffer_load_dwordx4 v1, s[24:27], s91 offen lds
    v_mfma_f32_16x16x32_bf16 v[56:59], v[234:237], a[104:107], v[56:59]
    v_mfma_f32_16x16x32_bf16 v[56:59], v[238:241], a[108:111], v[56:59]
    ds_read_b64_tr_b16 v[188:189], v5 offset:2048
    v_mfma_f32_16x16x32_bf16 v[60:63], v[246:249], a[108:111], v[60:63]
    v_mfma_f32_16x16x32_bf16 v[60:63], v[242:245], a[104:107], v[60:63]
    s_waitcnt vmcnt(22)
    ds_read_b64_tr_b16 v[190:191], v5 offset:4096
    buffer_load_dwordx4 a[104:107], v160, s[20:23], s85 offen offset:2048 sc1
    v_mfma_f32_16x16x32_bf16 v[76:79], v[242:245], a[112:115], v[76:79]
    s_waitcnt vmcnt(21)
    s_add_u32 m0, m0, 0x400
    v_mfma_f32_16x16x32_bf16 v[76:79], v[246:249], a[116:119], v[76:79]
    s_add_u32 s91, s91, 0x4000
    v_mfma_f32_16x16x32_bf16 v[72:75], v[238:241], a[116:119], v[72:75]
    ds_read_b64_tr_b16 v[192:193], v5 offset:6144
    buffer_load_dwordx4 v1, s[24:27], s91 offen lds
    v_mfma_f32_16x16x32_bf16 v[72:75], v[234:237], a[112:115], v[72:75]
    buffer_load_dwordx4 a[108:111], v162, s[20:23], s85 offen offset:3072 sc1
    v_mfma_f32_16x16x32_bf16 v[68:71], v[226:229], a[112:115], v[68:71]
    ds_read_b64_tr_b16 v[194:195], v6
    v_mfma_f32_16x16x32_bf16 v[68:71], v[230:233], a[116:119], v[68:71]
    v_mfma_f32_16x16x32_bf16 v[64:67], v[222:225], a[116:119], v[64:67]
    ds_read_b64_tr_b16 v[196:197], v6 offset:2048
    v_mfma_f32_16x16x32_bf16 v[64:67], v[218:221], a[112:115], v[64:67]
    s_waitcnt vmcnt(22)
    s_add_u32 m0, m0, 0x400
    buffer_load_dwordx4 a[112:115], v160, s[20:23], s85 offen offset:3072 sc1
    v_mfma_f32_16x16x32_bf16 v[80:83], v[218:221], a[120:123], v[80:83]
    s_waitcnt vmcnt(21)
    s_add_u32 s91, s91, 0x4000
    v_mfma_f32_16x16x32_bf16 v[80:83], v[222:225], a[124:127], v[80:83]
    ds_read_b64_tr_b16 v[198:199], v6 offset:4096
    buffer_load_dwordx4 v1, s[24:27], s91 offen lds
    v_mfma_f32_16x16x32_bf16 v[84:87], v[230:233], a[124:127], v[84:87]
    buffer_load_dwordx4 a[116:119], v163, s[20:23], s85 offen sc1
    v_mfma_f32_16x16x32_bf16 v[84:87], v[226:229], a[120:123], v[84:87]
    ds_read_b64_tr_b16 v[200:201], v6 offset:6144
    v_mfma_f32_16x16x32_bf16 v[88:91], v[234:237], a[120:123], v[88:91]
    v_mfma_f32_16x16x32_bf16 v[88:91], v[238:241], a[124:127], v[88:91]
    ds_read_b64_tr_b16 v[202:203], v7
    v_mfma_f32_16x16x32_bf16 v[92:95], v[246:249], a[124:127], v[92:95]
    s_add_u32 m0, m0, 0x400
    v_mfma_f32_16x16x32_bf16 v[92:95], v[242:245], a[120:123], v[92:95]
    s_waitcnt vmcnt(21)
    s_add_u32 s91, s91, 0x4000
    ds_read_b64_tr_b16 v[204:205], v7 offset:2048
    buffer_load_dwordx4 a[120:123], v161, s[20:23], s85 offen sc1
    v_mfma_f32_16x16x32_bf16 v[108:111], v[242:245], a[128:131], v[108:111]
    s_waitcnt vmcnt(21)
    buffer_load_dwordx4 v1, s[24:27], s91 offen lds
    v_mfma_f32_16x16x32_bf16 v[108:111], v[246:249], a[132:135], v[108:111]
    v_mfma_f32_16x16x32_bf16 v[104:107], v[238:241], a[132:135], v[104:107]
    ds_read_b64_tr_b16 v[206:207], v7 offset:4096
    buffer_load_dwordx4 a[124:127], v163, s[20:23], s85 offen offset:1024 sc1
    v_mfma_f32_16x16x32_bf16 v[104:107], v[234:237], a[128:131], v[104:107]
    v_mfma_f32_16x16x32_bf16 v[100:103], v[226:229], a[128:131], v[100:103]
    ds_read_b64_tr_b16 v[208:209], v7 offset:6144
    v_mfma_f32_16x16x32_bf16 v[100:103], v[230:233], a[132:135], v[100:103]
    s_add_u32 m0, m0, 0x400
    v_mfma_f32_16x16x32_bf16 v[96:99], v[222:225], a[132:135], v[96:99]
    s_add_u32 s91, s91, 0x4000
    ds_read_b64_tr_b16 v[210:211], v8
    v_mfma_f32_16x16x32_bf16 v[96:99], v[218:221], a[128:131], v[96:99]
    s_waitcnt vmcnt(21)
    buffer_load_dwordx4 v1, s[24:27], s91 offen lds
    buffer_load_dwordx4 a[128:131], v161, s[20:23], s85 offen offset:1024 sc1
    v_mfma_f32_16x16x32_bf16 v[112:115], v[218:221], a[136:139], v[112:115]
    s_waitcnt vmcnt(22)
    v_mfma_f32_16x16x32_bf16 v[112:115], v[222:225], a[140:143], v[112:115]
    ds_read_b64_tr_b16 v[212:213], v8 offset:2048
    v_mfma_f32_16x16x32_bf16 v[116:119], v[230:233], a[140:143], v[116:119]
    buffer_load_dwordx4 a[132:135], v163, s[20:23], s85 offen offset:2048 sc1
    v_mfma_f32_16x16x32_bf16 v[116:119], v[226:229], a[136:139], v[116:119]
    ds_read_b64_tr_b16 v[214:215], v8 offset:4096
    v_mfma_f32_16x16x32_bf16 v[120:123], v[234:237], a[136:139], v[120:123]
    s_add_u32 m0, m0, 0x400
    v_mfma_f32_16x16x32_bf16 v[120:123], v[238:241], a[140:143], v[120:123]
    s_add_u32 s91, s91, 0x4000
    ds_read_b64_tr_b16 v[216:217], v8 offset:6144
    v_mfma_f32_16x16x32_bf16 v[124:127], v[246:249], a[140:143], v[124:127]
    buffer_load_dwordx4 v1, s[24:27], s91 offen lds
    v_mfma_f32_16x16x32_bf16 v[124:127], v[242:245], a[136:139], v[124:127]
    s_waitcnt vmcnt(22)
    buffer_load_dwordx4 a[136:139], v161, s[20:23], s85 offen offset:2048 sc1
    v_mfma_f32_16x16x32_bf16 v[140:143], v[242:245], a[144:147], v[140:143]
    s_waitcnt vmcnt(22)
    v_mfma_f32_16x16x32_bf16 v[140:143], v[246:249], a[148:151], v[140:143]
    v_mfma_f32_16x16x32_bf16 v[136:139], v[238:241], a[148:151], v[136:139]
    buffer_load_dwordx4 a[140:143], v163, s[20:23], s85 offen offset:3072 sc1
    v_mfma_f32_16x16x32_bf16 v[136:139], v[234:237], a[144:147], v[136:139]
    s_add_u32 m0, m0, 0x400
    v_mfma_f32_16x16x32_bf16 v[132:135], v[226:229], a[144:147], v[132:135]
    s_add_u32 s91, s91, 0x4000
    v_mfma_f32_16x16x32_bf16 v[132:135], v[230:233], a[148:151], v[132:135]
    buffer_load_dwordx4 v1, s[24:27], s91 offen lds
    v_mfma_f32_16x16x32_bf16 v[128:131], v[222:225], a[148:151], v[128:131]
    v_mfma_f32_16x16x32_bf16 v[128:131], v[218:221], a[144:147], v[128:131]
    s_waitcnt vmcnt(23)
    buffer_load_dwordx4 a[144:147], v161, s[20:23], s85 offen offset:3072 sc1
    v_mfma_f32_16x16x32_bf16 v[144:147], v[218:221], a[152:155], v[144:147]
    s_waitcnt vmcnt(23)
    v_mfma_f32_16x16x32_bf16 v[144:147], v[222:225], a[156:159], v[144:147]
    v_mfma_f32_16x16x32_bf16 v[148:151], v[230:233], a[156:159], v[148:151]
    buffer_load_dwordx4 a[148:151], v164, s[20:23], s85 offen sc1
    v_mfma_f32_16x16x32_bf16 v[148:151], v[226:229], a[152:155], v[148:151]
    v_mfma_f32_16x16x32_bf16 v[152:155], v[234:237], a[152:155], v[152:155]
    s_waitcnt lgkmcnt(0)
    v_mfma_f32_16x16x32_bf16 v[152:155], v[238:241], a[156:159], v[152:155]
    v_mfma_f32_16x16x32_bf16 v[156:159], v[246:249], a[156:159], v[156:159]
    v_mfma_f32_16x16x32_bf16 v[156:159], v[242:245], a[152:155], v[156:159]
    s_waitcnt vmcnt(23)
    buffer_load_dwordx4 a[152:155], v162, s[20:23], s85 offen sc1
    buffer_load_dwordx4 a[156:159], v164, s[20:23], s85 offen offset:1024 sc1
    v_mfma_f32_16x16x32_bf16 v[28:31], a[24:27], a[88:91], v[28:31]
    s_waitcnt vmcnt(24)
    s_xor_b32 s69, s95, 6
    v_mfma_f32_16x16x32_bf16 v[28:31], a[28:31], a[92:95], v[28:31]
    s_mul_i32 s69, s69, 0x4800
    v_mfma_f32_16x16x32_bf16 v[24:27], a[20:23], a[92:95], v[24:27]
    s_add_u32 s92, s67, s69
    v_mfma_f32_16x16x32_bf16 v[24:27], a[16:19], a[88:91], v[24:27]
    v_mfma_f32_16x16x32_bf16 v[20:23], a[8:11], a[88:91], v[20:23]
    v_mfma_f32_16x16x32_bf16 v[20:23], a[12:15], a[92:95], v[20:23]
    v_mfma_f32_16x16x32_bf16 v[16:19], a[4:7], a[92:95], v[16:19]
    v_mfma_f32_16x16x32_bf16 v[16:19], a[0:3], a[88:91], v[16:19]
    s_waitcnt vmcnt(22)
    buffer_load_dwordx4 a[88:91], v160, s[20:23], s92 offen sc1
    v_mfma_f32_16x16x32_bf16 v[32:35], a[0:3], a[96:99], v[32:35]
    s_waitcnt vmcnt(22)
    v_mfma_f32_16x16x32_bf16 v[32:35], a[4:7], a[100:103], v[32:35]
    s_xor_b32 s91, s95, 15
    v_mfma_f32_16x16x32_bf16 v[36:39], a[12:15], a[100:103], v[36:39]
    s_lshl_b32 s91, s91, 17
    v_add_u32 v5, 0xffff0000, v5
    buffer_load_dwordx4 a[92:95], v162, s[20:23], s92 offen offset:1024 sc1
    v_mfma_f32_16x16x32_bf16 v[36:39], a[8:11], a[96:99], v[36:39]
    s_add_u32 s91, s91, s93
    v_mfma_f32_16x16x32_bf16 v[40:43], a[16:19], a[96:99], v[40:43]
    s_add_u32 m0, s78, 0x10000
    v_add_u32 v6, 0xffff0000, v6
    buffer_load_dwordx4 v1, s[24:27], s91 offen lds
    v_mfma_f32_16x16x32_bf16 v[40:43], a[20:23], a[100:103], v[40:43]
    v_mfma_f32_16x16x32_bf16 v[44:47], a[28:31], a[100:103], v[44:47]
    v_add_u32 v7, 0xffff0000, v7
    v_mfma_f32_16x16x32_bf16 v[44:47], a[24:27], a[96:99], v[44:47]
    s_waitcnt vmcnt(22)
    buffer_load_dwordx4 a[96:99], v160, s[20:23], s92 offen offset:1024 sc1
    v_mfma_f32_16x16x32_bf16 v[60:63], a[24:27], a[104:107], v[60:63]
    s_waitcnt vmcnt(21)
    v_add_u32 v8, 0xffff0000, v8
    v_mfma_f32_16x16x32_bf16 v[60:63], a[28:31], a[108:111], v[60:63]
    s_add_u32 m0, m0, 0x400
    v_mfma_f32_16x16x32_bf16 v[56:59], a[20:23], a[108:111], v[56:59]
    s_add_u32 s91, s91, 0x4000
    buffer_load_dwordx4 a[100:103], v162, s[20:23], s92 offen offset:2048 sc1
    v_mfma_f32_16x16x32_bf16 v[56:59], a[16:19], a[104:107], v[56:59]
    ds_read_b64_tr_b16 v[218:219], v5 offset:32768
    buffer_load_dwordx4 v1, s[24:27], s91 offen lds
    v_mfma_f32_16x16x32_bf16 v[52:55], a[8:11], a[104:107], v[52:55]
    v_mfma_f32_16x16x32_bf16 v[52:55], a[12:15], a[108:111], v[52:55]
    ds_read_b64_tr_b16 v[220:221], v5 offset:34816
    v_mfma_f32_16x16x32_bf16 v[48:51], a[4:7], a[108:111], v[48:51]
    v_mfma_f32_16x16x32_bf16 v[48:51], a[0:3], a[104:107], v[48:51]
    s_waitcnt vmcnt(22)
    ds_read_b64_tr_b16 v[222:223], v5 offset:36864
    buffer_load_dwordx4 a[104:107], v160, s[20:23], s92 offen offset:2048 sc1
    v_mfma_f32_16x16x32_bf16 v[64:67], a[0:3], a[112:115], v[64:67]
    s_waitcnt vmcnt(21)
    s_add_u32 m0, m0, 0x400
    v_mfma_f32_16x16x32_bf16 v[64:67], a[4:7], a[116:119], v[64:67]
    s_add_u32 s91, s91, 0x4000
    v_mfma_f32_16x16x32_bf16 v[68:71], a[12:15], a[116:119], v[68:71]
    ds_read_b64_tr_b16 v[224:225], v5 offset:38912
    buffer_load_dwordx4 v1, s[24:27], s91 offen lds
    v_mfma_f32_16x16x32_bf16 v[68:71], a[8:11], a[112:115], v[68:71]
    buffer_load_dwordx4 a[108:111], v162, s[20:23], s92 offen offset:3072 sc1
    v_mfma_f32_16x16x32_bf16 v[72:75], a[16:19], a[112:115], v[72:75]
    ds_read_b64_tr_b16 v[226:227], v6 offset:32768
    v_mfma_f32_16x16x32_bf16 v[72:75], a[20:23], a[116:119], v[72:75]
    v_mfma_f32_16x16x32_bf16 v[76:79], a[28:31], a[116:119], v[76:79]
    ds_read_b64_tr_b16 v[228:229], v6 offset:34816
    v_mfma_f32_16x16x32_bf16 v[76:79], a[24:27], a[112:115], v[76:79]
    s_waitcnt vmcnt(22)
    s_add_u32 m0, m0, 0x400
    buffer_load_dwordx4 a[112:115], v160, s[20:23], s92 offen offset:3072 sc1
    v_mfma_f32_16x16x32_bf16 v[92:95], a[24:27], a[120:123], v[92:95]
    s_waitcnt vmcnt(21)
    s_add_u32 s91, s91, 0x4000
    v_mfma_f32_16x16x32_bf16 v[92:95], a[28:31], a[124:127], v[92:95]
    ds_read_b64_tr_b16 v[230:231], v6 offset:36864
    buffer_load_dwordx4 v1, s[24:27], s91 offen lds
    v_mfma_f32_16x16x32_bf16 v[88:91], a[20:23], a[124:127], v[88:91]
    buffer_load_dwordx4 a[116:119], v163, s[20:23], s92 offen sc1
    v_mfma_f32_16x16x32_bf16 v[88:91], a[16:19], a[120:123], v[88:91]
    ds_read_b64_tr_b16 v[232:233], v6 offset:38912
    v_mfma_f32_16x16x32_bf16 v[84:87], a[8:11], a[120:123], v[84:87]
    v_mfma_f32_16x16x32_bf16 v[84:87], a[12:15], a[124:127], v[84:87]
    ds_read_b64_tr_b16 v[234:235], v7 offset:32768
    v_mfma_f32_16x16x32_bf16 v[80:83], a[4:7], a[124:127], v[80:83]
    s_add_u32 m0, m0, 0x400
    v_mfma_f32_16x16x32_bf16 v[80:83], a[0:3], a[120:123], v[80:83]
    s_waitcnt vmcnt(21)
    s_add_u32 s91, s91, 0x4000
    ds_read_b64_tr_b16 v[236:237], v7 offset:34816
    buffer_load_dwordx4 a[120:123], v161, s[20:23], s92 offen sc1
    v_mfma_f32_16x16x32_bf16 v[96:99], a[0:3], a[128:131], v[96:99]
    s_waitcnt vmcnt(21)
    buffer_load_dwordx4 v1, s[24:27], s91 offen lds
    v_mfma_f32_16x16x32_bf16 v[96:99], a[4:7], a[132:135], v[96:99]
    v_mfma_f32_16x16x32_bf16 v[100:103], a[12:15], a[132:135], v[100:103]
    ds_read_b64_tr_b16 v[238:239], v7 offset:36864
    buffer_load_dwordx4 a[124:127], v163, s[20:23], s92 offen offset:1024 sc1
    v_mfma_f32_16x16x32_bf16 v[100:103], a[8:11], a[128:131], v[100:103]
    v_mfma_f32_16x16x32_bf16 v[104:107], a[16:19], a[128:131], v[104:107]
    ds_read_b64_tr_b16 v[240:241], v7 offset:38912
    v_mfma_f32_16x16x32_bf16 v[104:107], a[20:23], a[132:135], v[104:107]
    s_add_u32 m0, m0, 0x400
    v_mfma_f32_16x16x32_bf16 v[108:111], a[28:31], a[132:135], v[108:111]
    s_add_u32 s91, s91, 0x4000
    ds_read_b64_tr_b16 v[242:243], v8 offset:32768
    v_mfma_f32_16x16x32_bf16 v[108:111], a[24:27], a[128:131], v[108:111]
    s_waitcnt vmcnt(21)
    buffer_load_dwordx4 v1, s[24:27], s91 offen lds
    buffer_load_dwordx4 a[128:131], v161, s[20:23], s92 offen offset:1024 sc1
    v_mfma_f32_16x16x32_bf16 v[124:127], a[24:27], a[136:139], v[124:127]
    s_waitcnt vmcnt(22)
    v_mfma_f32_16x16x32_bf16 v[124:127], a[28:31], a[140:143], v[124:127]
    ds_read_b64_tr_b16 v[244:245], v8 offset:34816
    v_mfma_f32_16x16x32_bf16 v[120:123], a[20:23], a[140:143], v[120:123]
    buffer_load_dwordx4 a[132:135], v163, s[20:23], s92 offen offset:2048 sc1
    v_mfma_f32_16x16x32_bf16 v[120:123], a[16:19], a[136:139], v[120:123]
    ds_read_b64_tr_b16 v[246:247], v8 offset:36864
    v_mfma_f32_16x16x32_bf16 v[116:119], a[8:11], a[136:139], v[116:119]
    s_add_u32 m0, m0, 0x400
    v_mfma_f32_16x16x32_bf16 v[116:119], a[12:15], a[140:143], v[116:119]
    s_add_u32 s91, s91, 0x4000
    ds_read_b64_tr_b16 v[248:249], v8 offset:38912
    v_mfma_f32_16x16x32_bf16 v[112:115], a[4:7], a[140:143], v[112:115]
    buffer_load_dwordx4 v1, s[24:27], s91 offen lds
    v_mfma_f32_16x16x32_bf16 v[112:115], a[0:3], a[136:139], v[112:115]
    s_waitcnt vmcnt(22)
    buffer_load_dwordx4 a[136:139], v161, s[20:23], s92 offen offset:2048 sc1
    v_mfma_f32_16x16x32_bf16 v[128:131], a[0:3], a[144:147], v[128:131]
    s_waitcnt vmcnt(22)
    v_mfma_f32_16x16x32_bf16 v[128:131], a[4:7], a[148:151], v[128:131]
    v_mfma_f32_16x16x32_bf16 v[132:135], a[12:15], a[148:151], v[132:135]
    buffer_load_dwordx4 a[140:143], v163, s[20:23], s92 offen offset:3072 sc1
    v_mfma_f32_16x16x32_bf16 v[132:135], a[8:11], a[144:147], v[132:135]
    s_add_u32 m0, m0, 0x400
    v_mfma_f32_16x16x32_bf16 v[136:139], a[16:19], a[144:147], v[136:139]
    s_add_u32 s91, s91, 0x4000
    v_mfma_f32_16x16x32_bf16 v[136:139], a[20:23], a[148:151], v[136:139]
    buffer_load_dwordx4 v1, s[24:27], s91 offen lds
    v_mfma_f32_16x16x32_bf16 v[140:143], a[28:31], a[148:151], v[140:143]
    v_mfma_f32_16x16x32_bf16 v[140:143], a[24:27], a[144:147], v[140:143]
    s_waitcnt vmcnt(23)
    buffer_load_dwordx4 a[144:147], v161, s[20:23], s92 offen offset:3072 sc1
    v_mfma_f32_16x16x32_bf16 v[156:159], a[24:27], a[152:155], v[156:159]
    s_waitcnt vmcnt(23)
    v_mfma_f32_16x16x32_bf16 v[156:159], a[28:31], a[156:159], v[156:159]
    v_mfma_f32_16x16x32_bf16 v[152:155], a[20:23], a[156:159], v[152:155]
    buffer_load_dwordx4 a[148:151], v164, s[20:23], s92 offen sc1
    v_mfma_f32_16x16x32_bf16 v[152:155], a[16:19], a[152:155], v[152:155]
    v_mfma_f32_16x16x32_bf16 v[148:151], a[8:11], a[152:155], v[148:151]
    s_waitcnt lgkmcnt(0)
    v_mfma_f32_16x16x32_bf16 v[148:151], a[12:15], a[156:159], v[148:151]
    v_mfma_f32_16x16x32_bf16 v[144:147], a[4:7], a[156:159], v[144:147]
    v_mfma_f32_16x16x32_bf16 v[144:147], a[0:3], a[152:155], v[144:147]
    s_waitcnt vmcnt(23)
    buffer_load_dwordx4 a[152:155], v162, s[20:23], s92 offen sc1
    buffer_load_dwordx4 a[156:159], v164, s[20:23], s92 offen offset:1024 sc1
    v_mfma_f32_16x16x32_bf16 v[16:19], a[32:35], a[88:91], v[16:19]
    s_waitcnt vmcnt(24)
    s_xor_b32 s69, s95, 7
    v_mfma_f32_16x16x32_bf16 v[16:19], a[36:39], a[92:95], v[16:19]
    s_mul_i32 s69, s69, 0x4800
    v_mfma_f32_16x16x32_bf16 v[20:23], a[44:47], a[92:95], v[20:23]
    s_add_u32 s85, s67, s69
    v_mfma_f32_16x16x32_bf16 v[20:23], a[40:43], a[88:91], v[20:23]
    v_mfma_f32_16x16x32_bf16 v[24:27], a[48:51], a[88:91], v[24:27]
    v_mfma_f32_16x16x32_bf16 v[24:27], a[52:55], a[92:95], v[24:27]
    v_mfma_f32_16x16x32_bf16 v[28:31], a[60:63], a[92:95], v[28:31]
    v_mfma_f32_16x16x32_bf16 v[28:31], a[56:59], a[88:91], v[28:31]
    s_waitcnt vmcnt(22)
    buffer_load_dwordx4 a[88:91], v160, s[20:23], s85 offen sc1
    v_mfma_f32_16x16x32_bf16 v[44:47], a[56:59], a[96:99], v[44:47]
    s_waitcnt vmcnt(22)
    v_mfma_f32_16x16x32_bf16 v[44:47], a[60:63], a[100:103], v[44:47]
    v_mfma_f32_16x16x32_bf16 v[40:43], a[52:55], a[100:103], v[40:43]
    ds_read_b64_tr_b16 a[0:1], v5
    buffer_load_dwordx4 a[92:95], v162, s[20:23], s85 offen offset:1024 sc1
    v_mfma_f32_16x16x32_bf16 v[40:43], a[48:51], a[96:99], v[40:43]
    v_mfma_f32_16x16x32_bf16 v[36:39], a[40:43], a[96:99], v[36:39]
    ds_read_b64_tr_b16 a[2:3], v5 offset:2048
    v_mfma_f32_16x16x32_bf16 v[36:39], a[44:47], a[100:103], v[36:39]
    v_mfma_f32_16x16x32_bf16 v[32:35], a[36:39], a[100:103], v[32:35]
    v_mfma_f32_16x16x32_bf16 v[32:35], a[32:35], a[96:99], v[32:35]
    s_waitcnt vmcnt(21)
    ds_read_b64_tr_b16 a[4:5], v5 offset:4096
    buffer_load_dwordx4 a[96:99], v160, s[20:23], s85 offen offset:1024 sc1
    v_mfma_f32_16x16x32_bf16 v[48:51], a[32:35], a[104:107], v[48:51]
    s_waitcnt vmcnt(20)
    v_mfma_f32_16x16x32_bf16 v[48:51], a[36:39], a[108:111], v[48:51]
    v_mfma_f32_16x16x32_bf16 v[52:55], a[44:47], a[108:111], v[52:55]
    ds_read_b64_tr_b16 a[6:7], v5 offset:6144
    buffer_load_dwordx4 a[100:103], v162, s[20:23], s85 offen offset:2048 sc1
    v_mfma_f32_16x16x32_bf16 v[52:55], a[40:43], a[104:107], v[52:55]
    v_mfma_f32_16x16x32_bf16 v[56:59], a[48:51], a[104:107], v[56:59]
    v_mfma_f32_16x16x32_bf16 v[56:59], a[52:55], a[108:111], v[56:59]
    ds_read_b64_tr_b16 a[8:9], v6
    v_mfma_f32_16x16x32_bf16 v[60:63], a[60:63], a[108:111], v[60:63]
    v_mfma_f32_16x16x32_bf16 v[60:63], a[56:59], a[104:107], v[60:63]
    s_waitcnt vmcnt(20)
    buffer_load_dwordx4 a[104:107], v160, s[20:23], s85 offen offset:2048 sc1
    v_mfma_f32_16x16x32_bf16 v[76:79], a[56:59], a[112:115], v[76:79]
    s_waitcnt vmcnt(19)
    ds_read_b64_tr_b16 a[10:11], v6 offset:2048
    v_mfma_f32_16x16x32_bf16 v[76:79], a[60:63], a[116:119], v[76:79]
    v_mfma_f32_16x16x32_bf16 v[72:75], a[52:55], a[116:119], v[72:75]
    buffer_load_dwordx4 a[108:111], v162, s[20:23], s85 offen offset:3072 sc1
    v_mfma_f32_16x16x32_bf16 v[72:75], a[48:51], a[112:115], v[72:75]
    ds_read_b64_tr_b16 a[12:13], v6 offset:4096
    v_mfma_f32_16x16x32_bf16 v[68:71], a[40:43], a[112:115], v[68:71]
    v_mfma_f32_16x16x32_bf16 v[68:71], a[44:47], a[116:119], v[68:71]
    v_mfma_f32_16x16x32_bf16 v[64:67], a[36:39], a[116:119], v[64:67]
    ds_read_b64_tr_b16 a[14:15], v6 offset:6144
    v_mfma_f32_16x16x32_bf16 v[64:67], a[32:35], a[112:115], v[64:67]
    s_waitcnt vmcnt(19)
    buffer_load_dwordx4 a[112:115], v160, s[20:23], s85 offen offset:3072 sc1
    v_mfma_f32_16x16x32_bf16 v[80:83], a[32:35], a[120:123], v[80:83]
    s_waitcnt vmcnt(18)
    v_mfma_f32_16x16x32_bf16 v[80:83], a[36:39], a[124:127], v[80:83]
    ds_read_b64_tr_b16 a[16:17], v7
    v_mfma_f32_16x16x32_bf16 v[84:87], a[44:47], a[124:127], v[84:87]
    buffer_load_dwordx4 a[116:119], v163, s[20:23], s85 offen sc1
    v_mfma_f32_16x16x32_bf16 v[84:87], a[40:43], a[120:123], v[84:87]
    ds_read_b64_tr_b16 a[18:19], v7 offset:2048
    v_mfma_f32_16x16x32_bf16 v[88:91], a[48:51], a[120:123], v[88:91]
    v_mfma_f32_16x16x32_bf16 v[88:91], a[52:55], a[124:127], v[88:91]
    v_mfma_f32_16x16x32_bf16 v[92:95], a[60:63], a[124:127], v[92:95]
    ds_read_b64_tr_b16 a[20:21], v7 offset:4096
    v_mfma_f32_16x16x32_bf16 v[92:95], a[56:59], a[120:123], v[92:95]
    s_waitcnt vmcnt(17)
    buffer_load_dwordx4 a[120:123], v161, s[20:23], s85 offen sc1
    v_mfma_f32_16x16x32_bf16 v[108:111], a[56:59], a[128:131], v[108:111]
    s_waitcnt vmcnt(17)
    v_mfma_f32_16x16x32_bf16 v[108:111], a[60:63], a[132:135], v[108:111]
    ds_read_b64_tr_b16 a[22:23], v7 offset:6144
    v_mfma_f32_16x16x32_bf16 v[104:107], a[52:55], a[132:135], v[104:107]
    buffer_load_dwordx4 a[124:127], v163, s[20:23], s85 offen offset:1024 sc1
    v_mfma_f32_16x16x32_bf16 v[104:107], a[48:51], a[128:131], v[104:107]
    v_mfma_f32_16x16x32_bf16 v[100:103], a[40:43], a[128:131], v[100:103]
    ds_read_b64_tr_b16 a[24:25], v8
    v_mfma_f32_16x16x32_bf16 v[100:103], a[44:47], a[132:135], v[100:103]
    v_mfma_f32_16x16x32_bf16 v[96:99], a[36:39], a[132:135], v[96:99]
    v_mfma_f32_16x16x32_bf16 v[96:99], a[32:35], a[128:131], v[96:99]
    s_waitcnt vmcnt(16)
    ds_read_b64_tr_b16 a[26:27], v8 offset:2048
    buffer_load_dwordx4 a[128:131], v161, s[20:23], s85 offen offset:1024 sc1
    v_mfma_f32_16x16x32_bf16 v[112:115], a[32:35], a[136:139], v[112:115]
    s_waitcnt vmcnt(16)
    v_mfma_f32_16x16x32_bf16 v[112:115], a[36:39], a[140:143], v[112:115]
    v_mfma_f32_16x16x32_bf16 v[116:119], a[44:47], a[140:143], v[116:119]
    ds_read_b64_tr_b16 a[28:29], v8 offset:4096
    buffer_load_dwordx4 a[132:135], v163, s[20:23], s85 offen offset:2048 sc1
    v_mfma_f32_16x16x32_bf16 v[116:119], a[40:43], a[136:139], v[116:119]
    v_mfma_f32_16x16x32_bf16 v[120:123], a[48:51], a[136:139], v[120:123]
    v_mfma_f32_16x16x32_bf16 v[120:123], a[52:55], a[140:143], v[120:123]
    ds_read_b64_tr_b16 a[30:31], v8 offset:6144
    v_mfma_f32_16x16x32_bf16 v[124:127], a[60:63], a[140:143], v[124:127]
    v_mfma_f32_16x16x32_bf16 v[124:127], a[56:59], a[136:139], v[124:127]
    s_waitcnt vmcnt(15)
    buffer_load_dwordx4 a[136:139], v161, s[20:23], s85 offen offset:2048 sc1
    v_mfma_f32_16x16x32_bf16 v[140:143], a[56:59], a[144:147], v[140:143]
    s_waitcnt vmcnt(15)
    v_mfma_f32_16x16x32_bf16 v[140:143], a[60:63], a[148:151], v[140:143]
    v_mfma_f32_16x16x32_bf16 v[136:139], a[52:55], a[148:151], v[136:139]
    buffer_load_dwordx4 a[140:143], v163, s[20:23], s85 offen offset:3072 sc1
    v_mfma_f32_16x16x32_bf16 v[136:139], a[48:51], a[144:147], v[136:139]
    v_mfma_f32_16x16x32_bf16 v[132:135], a[40:43], a[144:147], v[132:135]
    v_mfma_f32_16x16x32_bf16 v[132:135], a[44:47], a[148:151], v[132:135]
    v_mfma_f32_16x16x32_bf16 v[128:131], a[36:39], a[148:151], v[128:131]
    v_mfma_f32_16x16x32_bf16 v[128:131], a[32:35], a[144:147], v[128:131]
    s_waitcnt vmcnt(15)
    buffer_load_dwordx4 a[144:147], v161, s[20:23], s85 offen offset:3072 sc1
    v_mfma_f32_16x16x32_bf16 v[144:147], a[32:35], a[152:155], v[144:147]
    s_waitcnt vmcnt(15)
    v_mfma_f32_16x16x32_bf16 v[144:147], a[36:39], a[156:159], v[144:147]
    v_mfma_f32_16x16x32_bf16 v[148:151], a[44:47], a[156:159], v[148:151]
    buffer_load_dwordx4 a[148:151], v164, s[20:23], s85 offen sc1
    v_mfma_f32_16x16x32_bf16 v[148:151], a[40:43], a[152:155], v[148:151]
    v_mfma_f32_16x16x32_bf16 v[152:155], a[48:51], a[152:155], v[152:155]
    s_waitcnt lgkmcnt(0)
    v_mfma_f32_16x16x32_bf16 v[152:155], a[52:55], a[156:159], v[152:155]
    v_mfma_f32_16x16x32_bf16 v[156:159], a[60:63], a[156:159], v[156:159]
    v_mfma_f32_16x16x32_bf16 v[156:159], a[56:59], a[152:155], v[156:159]
    s_waitcnt vmcnt(15)
    buffer_load_dwordx4 a[152:155], v162, s[20:23], s85 offen sc1
    buffer_load_dwordx4 a[156:159], v164, s[20:23], s85 offen offset:1024 sc1
    v_mfma_f32_16x16x32_bf16 v[28:31], a[216:219], a[88:91], v[28:31]
    s_waitcnt vmcnt(16)
    s_xor_b32 s69, s95, 8
    v_mfma_f32_16x16x32_bf16 v[28:31], a[220:223], a[92:95], v[28:31]
    s_mul_i32 s69, s69, 0x4800
    v_mfma_f32_16x16x32_bf16 v[24:27], a[212:215], a[92:95], v[24:27]
    s_add_u32 s92, s67, s69
    v_mfma_f32_16x16x32_bf16 v[24:27], a[208:211], a[88:91], v[24:27]
    v_mfma_f32_16x16x32_bf16 v[20:23], a[200:203], a[88:91], v[20:23]
    v_mfma_f32_16x16x32_bf16 v[20:23], a[204:207], a[92:95], v[20:23]
    v_mfma_f32_16x16x32_bf16 v[16:19], a[196:199], a[92:95], v[16:19]
    v_mfma_f32_16x16x32_bf16 v[16:19], a[192:195], a[88:91], v[16:19]
    s_waitcnt vmcnt(15)
    buffer_load_dwordx4 a[88:91], v160, s[20:23], s92 offen sc1
    v_mfma_f32_16x16x32_bf16 v[32:35], a[192:195], a[96:99], v[32:35]
    s_waitcnt vmcnt(15)
    v_mfma_f32_16x16x32_bf16 v[32:35], a[196:199], a[100:103], v[32:35]
    v_mfma_f32_16x16x32_bf16 v[36:39], a[204:207], a[100:103], v[36:39]
    v_add_u32 v5, 0x10000, v5
    buffer_load_dwordx4 a[92:95], v162, s[20:23], s92 offen offset:1024 sc1
    v_mfma_f32_16x16x32_bf16 v[36:39], a[200:203], a[96:99], v[36:39]
    v_mfma_f32_16x16x32_bf16 v[40:43], a[208:211], a[96:99], v[40:43]
    v_add_u32 v6, 0x10000, v6
    v_mfma_f32_16x16x32_bf16 v[40:43], a[212:215], a[100:103], v[40:43]
    v_mfma_f32_16x16x32_bf16 v[44:47], a[220:223], a[100:103], v[44:47]
    v_add_u32 v7, 0x10000, v7
    v_mfma_f32_16x16x32_bf16 v[44:47], a[216:219], a[96:99], v[44:47]
    s_waitcnt vmcnt(15)
    buffer_load_dwordx4 a[96:99], v160, s[20:23], s92 offen offset:1024 sc1
    v_mfma_f32_16x16x32_bf16 v[60:63], a[216:219], a[104:107], v[60:63]
    s_waitcnt vmcnt(15)
    v_add_u32 v8, 0x10000, v8
    v_mfma_f32_16x16x32_bf16 v[60:63], a[220:223], a[108:111], v[60:63]
    v_mfma_f32_16x16x32_bf16 v[56:59], a[212:215], a[108:111], v[56:59]
    buffer_load_dwordx4 a[100:103], v162, s[20:23], s92 offen offset:2048 sc1
    v_mfma_f32_16x16x32_bf16 v[56:59], a[208:211], a[104:107], v[56:59]
    ds_read_b64_tr_b16 a[32:33], v5 offset:32768
    v_mfma_f32_16x16x32_bf16 v[52:55], a[200:203], a[104:107], v[52:55]
    v_mfma_f32_16x16x32_bf16 v[52:55], a[204:207], a[108:111], v[52:55]
    ds_read_b64_tr_b16 a[34:35], v5 offset:34816
    v_mfma_f32_16x16x32_bf16 v[48:51], a[196:199], a[108:111], v[48:51]
    v_mfma_f32_16x16x32_bf16 v[48:51], a[192:195], a[104:107], v[48:51]
    s_waitcnt vmcnt(15)
    ds_read_b64_tr_b16 a[36:37], v5 offset:36864
    buffer_load_dwordx4 a[104:107], v160, s[20:23], s92 offen offset:2048 sc1
    v_mfma_f32_16x16x32_bf16 v[64:67], a[192:195], a[112:115], v[64:67]
    s_waitcnt vmcnt(15)
    v_mfma_f32_16x16x32_bf16 v[64:67], a[196:199], a[116:119], v[64:67]
    v_mfma_f32_16x16x32_bf16 v[68:71], a[204:207], a[116:119], v[68:71]
    ds_read_b64_tr_b16 a[38:39], v5 offset:38912
    buffer_load_dwordx4 a[108:111], v162, s[20:23], s92 offen offset:3072 sc1
    v_mfma_f32_16x16x32_bf16 v[68:71], a[200:203], a[112:115], v[68:71]
    v_mfma_f32_16x16x32_bf16 v[72:75], a[208:211], a[112:115], v[72:75]
    ds_read_b64_tr_b16 a[40:41], v6 offset:32768
    v_mfma_f32_16x16x32_bf16 v[72:75], a[212:215], a[116:119], v[72:75]
    v_mfma_f32_16x16x32_bf16 v[76:79], a[220:223], a[116:119], v[76:79]
    ds_read_b64_tr_b16 a[42:43], v6 offset:34816
    v_mfma_f32_16x16x32_bf16 v[76:79], a[216:219], a[112:115], v[76:79]
    s_waitcnt vmcnt(15)
    buffer_load_dwordx4 a[112:115], v160, s[20:23], s92 offen offset:3072 sc1
    v_mfma_f32_16x16x32_bf16 v[92:95], a[216:219], a[120:123], v[92:95]
    s_waitcnt vmcnt(15)
    v_mfma_f32_16x16x32_bf16 v[92:95], a[220:223], a[124:127], v[92:95]
    ds_read_b64_tr_b16 a[44:45], v6 offset:36864
    v_mfma_f32_16x16x32_bf16 v[88:91], a[212:215], a[124:127], v[88:91]
    buffer_load_dwordx4 a[116:119], v163, s[20:23], s92 offen sc1
    v_mfma_f32_16x16x32_bf16 v[88:91], a[208:211], a[120:123], v[88:91]
    ds_read_b64_tr_b16 a[46:47], v6 offset:38912
    v_mfma_f32_16x16x32_bf16 v[84:87], a[200:203], a[120:123], v[84:87]
    v_mfma_f32_16x16x32_bf16 v[84:87], a[204:207], a[124:127], v[84:87]
    ds_read_b64_tr_b16 a[48:49], v7 offset:32768
    v_mfma_f32_16x16x32_bf16 v[80:83], a[196:199], a[124:127], v[80:83]
    v_mfma_f32_16x16x32_bf16 v[80:83], a[192:195], a[120:123], v[80:83]
    s_waitcnt vmcnt(15)
    ds_read_b64_tr_b16 a[50:51], v7 offset:34816
    buffer_load_dwordx4 a[120:123], v161, s[20:23], s92 offen sc1
    v_mfma_f32_16x16x32_bf16 v[96:99], a[192:195], a[128:131], v[96:99]
    s_waitcnt vmcnt(15)
    v_mfma_f32_16x16x32_bf16 v[96:99], a[196:199], a[132:135], v[96:99]
    v_mfma_f32_16x16x32_bf16 v[100:103], a[204:207], a[132:135], v[100:103]
    ds_read_b64_tr_b16 a[52:53], v7 offset:36864
    buffer_load_dwordx4 a[124:127], v163, s[20:23], s92 offen offset:1024 sc1
    v_mfma_f32_16x16x32_bf16 v[100:103], a[200:203], a[128:131], v[100:103]
    v_mfma_f32_16x16x32_bf16 v[104:107], a[208:211], a[128:131], v[104:107]
    ds_read_b64_tr_b16 a[54:55], v7 offset:38912
    v_mfma_f32_16x16x32_bf16 v[104:107], a[212:215], a[132:135], v[104:107]
    v_mfma_f32_16x16x32_bf16 v[108:111], a[220:223], a[132:135], v[108:111]
    ds_read_b64_tr_b16 a[56:57], v8 offset:32768
    v_mfma_f32_16x16x32_bf16 v[108:111], a[216:219], a[128:131], v[108:111]
    s_waitcnt vmcnt(15)
    buffer_load_dwordx4 a[128:131], v161, s[20:23], s92 offen offset:1024 sc1
    v_mfma_f32_16x16x32_bf16 v[124:127], a[216:219], a[136:139], v[124:127]
    s_waitcnt vmcnt(15)
    v_mfma_f32_16x16x32_bf16 v[124:127], a[220:223], a[140:143], v[124:127]
    ds_read_b64_tr_b16 a[58:59], v8 offset:34816
    v_mfma_f32_16x16x32_bf16 v[120:123], a[212:215], a[140:143], v[120:123]
    buffer_load_dwordx4 a[132:135], v163, s[20:23], s92 offen offset:2048 sc1
    v_mfma_f32_16x16x32_bf16 v[120:123], a[208:211], a[136:139], v[120:123]
    ds_read_b64_tr_b16 a[60:61], v8 offset:36864
    v_mfma_f32_16x16x32_bf16 v[116:119], a[200:203], a[136:139], v[116:119]
    v_mfma_f32_16x16x32_bf16 v[116:119], a[204:207], a[140:143], v[116:119]
    ds_read_b64_tr_b16 a[62:63], v8 offset:38912
    v_mfma_f32_16x16x32_bf16 v[112:115], a[196:199], a[140:143], v[112:115]
    v_mfma_f32_16x16x32_bf16 v[112:115], a[192:195], a[136:139], v[112:115]
    s_waitcnt vmcnt(15)
    buffer_load_dwordx4 a[136:139], v161, s[20:23], s92 offen offset:2048 sc1
    v_mfma_f32_16x16x32_bf16 v[128:131], a[192:195], a[144:147], v[128:131]
    s_waitcnt vmcnt(15)
    v_mfma_f32_16x16x32_bf16 v[128:131], a[196:199], a[148:151], v[128:131]
    v_mfma_f32_16x16x32_bf16 v[132:135], a[204:207], a[148:151], v[132:135]
    buffer_load_dwordx4 a[140:143], v163, s[20:23], s92 offen offset:3072 sc1
    v_mfma_f32_16x16x32_bf16 v[132:135], a[200:203], a[144:147], v[132:135]
    v_mfma_f32_16x16x32_bf16 v[136:139], a[208:211], a[144:147], v[136:139]
    v_mfma_f32_16x16x32_bf16 v[136:139], a[212:215], a[148:151], v[136:139]
    v_mfma_f32_16x16x32_bf16 v[140:143], a[220:223], a[148:151], v[140:143]
    v_mfma_f32_16x16x32_bf16 v[140:143], a[216:219], a[144:147], v[140:143]
    s_waitcnt vmcnt(15)
    buffer_load_dwordx4 a[144:147], v161, s[20:23], s92 offen offset:3072 sc1
    v_mfma_f32_16x16x32_bf16 v[156:159], a[216:219], a[152:155], v[156:159]
    s_waitcnt vmcnt(15)
    v_mfma_f32_16x16x32_bf16 v[156:159], a[220:223], a[156:159], v[156:159]
    v_mfma_f32_16x16x32_bf16 v[152:155], a[212:215], a[156:159], v[152:155]
    buffer_load_dwordx4 a[148:151], v164, s[20:23], s92 offen sc1
    v_mfma_f32_16x16x32_bf16 v[152:155], a[208:211], a[152:155], v[152:155]
    v_mfma_f32_16x16x32_bf16 v[148:151], a[200:203], a[152:155], v[148:151]
    s_waitcnt lgkmcnt(0)
    v_mfma_f32_16x16x32_bf16 v[148:151], a[204:207], a[156:159], v[148:151]
    v_mfma_f32_16x16x32_bf16 v[144:147], a[196:199], a[156:159], v[144:147]
    v_mfma_f32_16x16x32_bf16 v[144:147], a[192:195], a[152:155], v[144:147]
    s_waitcnt vmcnt(15)
    buffer_load_dwordx4 a[152:155], v162, s[20:23], s92 offen sc1
    buffer_load_dwordx4 a[156:159], v164, s[20:23], s92 offen offset:1024 sc1
    v_mfma_f32_16x16x32_bf16 v[16:19], a[224:227], a[88:91], v[16:19]
    s_waitcnt vmcnt(16)
    s_xor_b32 s69, s95, 9
    v_mfma_f32_16x16x32_bf16 v[16:19], a[228:231], a[92:95], v[16:19]
    s_mul_i32 s69, s69, 0x4800
    v_mfma_f32_16x16x32_bf16 v[20:23], a[236:239], a[92:95], v[20:23]
    s_add_u32 s85, s67, s69
    v_mfma_f32_16x16x32_bf16 v[20:23], a[232:235], a[88:91], v[20:23]
    v_mfma_f32_16x16x32_bf16 v[24:27], a[240:243], a[88:91], v[24:27]
    v_mfma_f32_16x16x32_bf16 v[24:27], a[244:247], a[92:95], v[24:27]
    v_mfma_f32_16x16x32_bf16 v[28:31], a[252:255], a[92:95], v[28:31]
    v_mfma_f32_16x16x32_bf16 v[28:31], a[248:251], a[88:91], v[28:31]
    s_waitcnt vmcnt(15)
    buffer_load_dwordx4 a[88:91], v160, s[20:23], s85 offen sc1
    v_mfma_f32_16x16x32_bf16 v[44:47], a[248:251], a[96:99], v[44:47]
    s_waitcnt vmcnt(15)
    v_mfma_f32_16x16x32_bf16 v[44:47], a[252:255], a[100:103], v[44:47]
    v_mfma_f32_16x16x32_bf16 v[40:43], a[244:247], a[100:103], v[40:43]
    v_add_u32 v5, 0x10000, v5
    buffer_load_dwordx4 a[92:95], v162, s[20:23], s85 offen offset:1024 sc1
    v_mfma_f32_16x16x32_bf16 v[40:43], a[240:243], a[96:99], v[40:43]
    v_mfma_f32_16x16x32_bf16 v[36:39], a[232:235], a[96:99], v[36:39]
    v_add_u32 v6, 0x10000, v6
    v_mfma_f32_16x16x32_bf16 v[36:39], a[236:239], a[100:103], v[36:39]
    v_mfma_f32_16x16x32_bf16 v[32:35], a[228:231], a[100:103], v[32:35]
    v_add_u32 v7, 0x10000, v7
    v_mfma_f32_16x16x32_bf16 v[32:35], a[224:227], a[96:99], v[32:35]
    s_waitcnt vmcnt(15)
    buffer_load_dwordx4 a[96:99], v160, s[20:23], s85 offen offset:1024 sc1
    v_mfma_f32_16x16x32_bf16 v[48:51], a[224:227], a[104:107], v[48:51]
    s_waitcnt vmcnt(15)
    v_add_u32 v8, 0x10000, v8
    v_mfma_f32_16x16x32_bf16 v[48:51], a[228:231], a[108:111], v[48:51]
    v_mfma_f32_16x16x32_bf16 v[52:55], a[236:239], a[108:111], v[52:55]
    buffer_load_dwordx4 a[100:103], v162, s[20:23], s85 offen offset:2048 sc1
    v_mfma_f32_16x16x32_bf16 v[52:55], a[232:235], a[104:107], v[52:55]
    ds_read_b64_tr_b16 a[192:193], v5
    v_mfma_f32_16x16x32_bf16 v[56:59], a[240:243], a[104:107], v[56:59]
    v_mfma_f32_16x16x32_bf16 v[56:59], a[244:247], a[108:111], v[56:59]
    ds_read_b64_tr_b16 a[194:195], v5 offset:2048
    v_mfma_f32_16x16x32_bf16 v[60:63], a[252:255], a[108:111], v[60:63]
    v_mfma_f32_16x16x32_bf16 v[60:63], a[248:251], a[104:107], v[60:63]
    s_waitcnt vmcnt(15)
    ds_read_b64_tr_b16 a[196:197], v5 offset:4096
    buffer_load_dwordx4 a[104:107], v160, s[20:23], s85 offen offset:2048 sc1
    v_mfma_f32_16x16x32_bf16 v[76:79], a[248:251], a[112:115], v[76:79]
    s_waitcnt vmcnt(15)
    v_mfma_f32_16x16x32_bf16 v[76:79], a[252:255], a[116:119], v[76:79]
    v_mfma_f32_16x16x32_bf16 v[72:75], a[244:247], a[116:119], v[72:75]
    ds_read_b64_tr_b16 a[198:199], v5 offset:6144
    buffer_load_dwordx4 a[108:111], v162, s[20:23], s85 offen offset:3072 sc1
    v_mfma_f32_16x16x32_bf16 v[72:75], a[240:243], a[112:115], v[72:75]
    v_mfma_f32_16x16x32_bf16 v[68:71], a[232:235], a[112:115], v[68:71]
    ds_read_b64_tr_b16 a[200:201], v6
    v_mfma_f32_16x16x32_bf16 v[68:71], a[236:239], a[116:119], v[68:71]
    v_mfma_f32_16x16x32_bf16 v[64:67], a[228:231], a[116:119], v[64:67]
    ds_read_b64_tr_b16 a[202:203], v6 offset:2048
    v_mfma_f32_16x16x32_bf16 v[64:67], a[224:227], a[112:115], v[64:67]
    s_waitcnt vmcnt(15)
    buffer_load_dwordx4 a[112:115], v160, s[20:23], s85 offen offset:3072 sc1
    v_mfma_f32_16x16x32_bf16 v[80:83], a[224:227], a[120:123], v[80:83]
    s_waitcnt vmcnt(15)
    v_mfma_f32_16x16x32_bf16 v[80:83], a[228:231], a[124:127], v[80:83]
    ds_read_b64_tr_b16 a[204:205], v6 offset:4096
    v_mfma_f32_16x16x32_bf16 v[84:87], a[236:239], a[124:127], v[84:87]
    buffer_load_dwordx4 a[116:119], v163, s[20:23], s85 offen sc1
    v_mfma_f32_16x16x32_bf16 v[84:87], a[232:235], a[120:123], v[84:87]
    ds_read_b64_tr_b16 a[206:207], v6 offset:6144
    v_mfma_f32_16x16x32_bf16 v[88:91], a[240:243], a[120:123], v[88:91]
    v_mfma_f32_16x16x32_bf16 v[88:91], a[244:247], a[124:127], v[88:91]
    ds_read_b64_tr_b16 a[208:209], v7
    v_mfma_f32_16x16x32_bf16 v[92:95], a[252:255], a[124:127], v[92:95]
    v_mfma_f32_16x16x32_bf16 v[92:95], a[248:251], a[120:123], v[92:95]
    s_waitcnt vmcnt(15)
    ds_read_b64_tr_b16 a[210:211], v7 offset:2048
    buffer_load_dwordx4 a[120:123], v161, s[20:23], s85 offen sc1
    v_mfma_f32_16x16x32_bf16 v[108:111], a[248:251], a[128:131], v[108:111]
    s_waitcnt vmcnt(15)
    v_mfma_f32_16x16x32_bf16 v[108:111], a[252:255], a[132:135], v[108:111]
    v_mfma_f32_16x16x32_bf16 v[104:107], a[244:247], a[132:135], v[104:107]
    ds_read_b64_tr_b16 a[212:213], v7 offset:4096
    buffer_load_dwordx4 a[124:127], v163, s[20:23], s85 offen offset:1024 sc1
    v_mfma_f32_16x16x32_bf16 v[104:107], a[240:243], a[128:131], v[104:107]
    v_mfma_f32_16x16x32_bf16 v[100:103], a[232:235], a[128:131], v[100:103]
    ds_read_b64_tr_b16 a[214:215], v7 offset:6144
    v_mfma_f32_16x16x32_bf16 v[100:103], a[236:239], a[132:135], v[100:103]
    v_mfma_f32_16x16x32_bf16 v[96:99], a[228:231], a[132:135], v[96:99]
    ds_read_b64_tr_b16 a[216:217], v8
    v_mfma_f32_16x16x32_bf16 v[96:99], a[224:227], a[128:131], v[96:99]
    s_waitcnt vmcnt(15)
    buffer_load_dwordx4 a[128:131], v161, s[20:23], s85 offen offset:1024 sc1
    v_mfma_f32_16x16x32_bf16 v[112:115], a[224:227], a[136:139], v[112:115]
    s_waitcnt vmcnt(15)
    v_mfma_f32_16x16x32_bf16 v[112:115], a[228:231], a[140:143], v[112:115]
    ds_read_b64_tr_b16 a[218:219], v8 offset:2048
    v_mfma_f32_16x16x32_bf16 v[116:119], a[236:239], a[140:143], v[116:119]
    buffer_load_dwordx4 a[132:135], v163, s[20:23], s85 offen offset:2048 sc1
    v_mfma_f32_16x16x32_bf16 v[116:119], a[232:235], a[136:139], v[116:119]
    ds_read_b64_tr_b16 a[220:221], v8 offset:4096
    v_mfma_f32_16x16x32_bf16 v[120:123], a[240:243], a[136:139], v[120:123]
    v_mfma_f32_16x16x32_bf16 v[120:123], a[244:247], a[140:143], v[120:123]
    ds_read_b64_tr_b16 a[222:223], v8 offset:6144
    v_mfma_f32_16x16x32_bf16 v[124:127], a[252:255], a[140:143], v[124:127]
    v_mfma_f32_16x16x32_bf16 v[124:127], a[248:251], a[136:139], v[124:127]
    s_waitcnt vmcnt(15)
    buffer_load_dwordx4 a[136:139], v161, s[20:23], s85 offen offset:2048 sc1
    v_mfma_f32_16x16x32_bf16 v[140:143], a[248:251], a[144:147], v[140:143]
    s_waitcnt vmcnt(15)
    v_mfma_f32_16x16x32_bf16 v[140:143], a[252:255], a[148:151], v[140:143]
    v_mfma_f32_16x16x32_bf16 v[136:139], a[244:247], a[148:151], v[136:139]
    buffer_load_dwordx4 a[140:143], v163, s[20:23], s85 offen offset:3072 sc1
    v_mfma_f32_16x16x32_bf16 v[136:139], a[240:243], a[144:147], v[136:139]
    v_mfma_f32_16x16x32_bf16 v[132:135], a[232:235], a[144:147], v[132:135]
    v_mfma_f32_16x16x32_bf16 v[132:135], a[236:239], a[148:151], v[132:135]
    v_mfma_f32_16x16x32_bf16 v[128:131], a[228:231], a[148:151], v[128:131]
    v_mfma_f32_16x16x32_bf16 v[128:131], a[224:227], a[144:147], v[128:131]
    s_waitcnt vmcnt(15)
    buffer_load_dwordx4 a[144:147], v161, s[20:23], s85 offen offset:3072 sc1
    v_mfma_f32_16x16x32_bf16 v[144:147], a[224:227], a[152:155], v[144:147]
    s_waitcnt vmcnt(15)
    v_mfma_f32_16x16x32_bf16 v[144:147], a[228:231], a[156:159], v[144:147]
    v_mfma_f32_16x16x32_bf16 v[148:151], a[236:239], a[156:159], v[148:151]
    buffer_load_dwordx4 a[148:151], v164, s[20:23], s85 offen sc1
    v_mfma_f32_16x16x32_bf16 v[148:151], a[232:235], a[152:155], v[148:151]
    v_mfma_f32_16x16x32_bf16 v[152:155], a[240:243], a[152:155], v[152:155]
    s_waitcnt lgkmcnt(0)
    v_mfma_f32_16x16x32_bf16 v[152:155], a[244:247], a[156:159], v[152:155]
    v_mfma_f32_16x16x32_bf16 v[156:159], a[252:255], a[156:159], v[156:159]
    v_mfma_f32_16x16x32_bf16 v[156:159], a[248:251], a[152:155], v[156:159]
    s_waitcnt vmcnt(15)
    buffer_load_dwordx4 a[152:155], v162, s[20:23], s85 offen sc1
    buffer_load_dwordx4 a[156:159], v164, s[20:23], s85 offen offset:1024 sc1
    v_mfma_f32_16x16x32_bf16 v[28:31], a[184:187], a[88:91], v[28:31]
    s_waitcnt vmcnt(16)
    s_xor_b32 s69, s95, 10
    v_mfma_f32_16x16x32_bf16 v[28:31], a[188:191], a[92:95], v[28:31]
    s_mul_i32 s69, s69, 0x4800
    v_mfma_f32_16x16x32_bf16 v[24:27], a[180:183], a[92:95], v[24:27]
    s_add_u32 s92, s67, s69
    v_mfma_f32_16x16x32_bf16 v[24:27], a[176:179], a[88:91], v[24:27]
    v_mfma_f32_16x16x32_bf16 v[20:23], a[168:171], a[88:91], v[20:23]
    v_mfma_f32_16x16x32_bf16 v[20:23], a[172:175], a[92:95], v[20:23]
    v_mfma_f32_16x16x32_bf16 v[16:19], a[164:167], a[92:95], v[16:19]
    v_mfma_f32_16x16x32_bf16 v[16:19], a[160:163], a[88:91], v[16:19]
    s_waitcnt vmcnt(15)
    buffer_load_dwordx4 a[88:91], v160, s[20:23], s92 offen sc1
    v_mfma_f32_16x16x32_bf16 v[32:35], a[160:163], a[96:99], v[32:35]
    s_waitcnt vmcnt(15)
    v_mfma_f32_16x16x32_bf16 v[32:35], a[164:167], a[100:103], v[32:35]
    v_mfma_f32_16x16x32_bf16 v[36:39], a[172:175], a[100:103], v[36:39]
    v_add_u32 v5, 0xffff0000, v5
    buffer_load_dwordx4 a[92:95], v162, s[20:23], s92 offen offset:1024 sc1
    v_mfma_f32_16x16x32_bf16 v[36:39], a[168:171], a[96:99], v[36:39]
    v_mfma_f32_16x16x32_bf16 v[40:43], a[176:179], a[96:99], v[40:43]
    v_add_u32 v6, 0xffff0000, v6
    v_mfma_f32_16x16x32_bf16 v[40:43], a[180:183], a[100:103], v[40:43]
    v_mfma_f32_16x16x32_bf16 v[44:47], a[188:191], a[100:103], v[44:47]
    v_add_u32 v7, 0xffff0000, v7
    v_mfma_f32_16x16x32_bf16 v[44:47], a[184:187], a[96:99], v[44:47]
    s_waitcnt vmcnt(15)
    buffer_load_dwordx4 a[96:99], v160, s[20:23], s92 offen offset:1024 sc1
    v_mfma_f32_16x16x32_bf16 v[60:63], a[184:187], a[104:107], v[60:63]
    s_waitcnt vmcnt(15)
    v_add_u32 v8, 0xffff0000, v8
    v_mfma_f32_16x16x32_bf16 v[60:63], a[188:191], a[108:111], v[60:63]
    v_mfma_f32_16x16x32_bf16 v[56:59], a[180:183], a[108:111], v[56:59]
    buffer_load_dwordx4 a[100:103], v162, s[20:23], s92 offen offset:2048 sc1
    v_mfma_f32_16x16x32_bf16 v[56:59], a[176:179], a[104:107], v[56:59]
    ds_read_b64_tr_b16 a[224:225], v5
    v_mfma_f32_16x16x32_bf16 v[52:55], a[168:171], a[104:107], v[52:55]
    v_mfma_f32_16x16x32_bf16 v[52:55], a[172:175], a[108:111], v[52:55]
    ds_read_b64_tr_b16 a[226:227], v5 offset:2048
    v_mfma_f32_16x16x32_bf16 v[48:51], a[164:167], a[108:111], v[48:51]
    v_mfma_f32_16x16x32_bf16 v[48:51], a[160:163], a[104:107], v[48:51]
    s_waitcnt vmcnt(15)
    ds_read_b64_tr_b16 a[228:229], v5 offset:4096
    buffer_load_dwordx4 a[104:107], v160, s[20:23], s92 offen offset:2048 sc1
    v_mfma_f32_16x16x32_bf16 v[64:67], a[160:163], a[112:115], v[64:67]
    s_waitcnt vmcnt(15)
    v_mfma_f32_16x16x32_bf16 v[64:67], a[164:167], a[116:119], v[64:67]
    v_mfma_f32_16x16x32_bf16 v[68:71], a[172:175], a[116:119], v[68:71]
    ds_read_b64_tr_b16 a[230:231], v5 offset:6144
    buffer_load_dwordx4 a[108:111], v162, s[20:23], s92 offen offset:3072 sc1
    v_mfma_f32_16x16x32_bf16 v[68:71], a[168:171], a[112:115], v[68:71]
    v_mfma_f32_16x16x32_bf16 v[72:75], a[176:179], a[112:115], v[72:75]
    ds_read_b64_tr_b16 a[232:233], v6
    v_mfma_f32_16x16x32_bf16 v[72:75], a[180:183], a[116:119], v[72:75]
    v_mfma_f32_16x16x32_bf16 v[76:79], a[188:191], a[116:119], v[76:79]
    ds_read_b64_tr_b16 a[234:235], v6 offset:2048
    v_mfma_f32_16x16x32_bf16 v[76:79], a[184:187], a[112:115], v[76:79]
    s_waitcnt vmcnt(15)
    buffer_load_dwordx4 a[112:115], v160, s[20:23], s92 offen offset:3072 sc1
    v_mfma_f32_16x16x32_bf16 v[92:95], a[184:187], a[120:123], v[92:95]
    s_waitcnt vmcnt(15)
    v_mfma_f32_16x16x32_bf16 v[92:95], a[188:191], a[124:127], v[92:95]
    ds_read_b64_tr_b16 a[236:237], v6 offset:4096
    v_mfma_f32_16x16x32_bf16 v[88:91], a[180:183], a[124:127], v[88:91]
    buffer_load_dwordx4 a[116:119], v163, s[20:23], s92 offen sc1
    v_mfma_f32_16x16x32_bf16 v[88:91], a[176:179], a[120:123], v[88:91]
    ds_read_b64_tr_b16 a[238:239], v6 offset:6144
    v_mfma_f32_16x16x32_bf16 v[84:87], a[168:171], a[120:123], v[84:87]
    v_mfma_f32_16x16x32_bf16 v[84:87], a[172:175], a[124:127], v[84:87]
    ds_read_b64_tr_b16 a[240:241], v7
    v_mfma_f32_16x16x32_bf16 v[80:83], a[164:167], a[124:127], v[80:83]
    v_mfma_f32_16x16x32_bf16 v[80:83], a[160:163], a[120:123], v[80:83]
    s_waitcnt vmcnt(15)
    ds_read_b64_tr_b16 a[242:243], v7 offset:2048
    buffer_load_dwordx4 a[120:123], v161, s[20:23], s92 offen sc1
    v_mfma_f32_16x16x32_bf16 v[96:99], a[160:163], a[128:131], v[96:99]
    s_waitcnt vmcnt(15)
    v_mfma_f32_16x16x32_bf16 v[96:99], a[164:167], a[132:135], v[96:99]
    v_mfma_f32_16x16x32_bf16 v[100:103], a[172:175], a[132:135], v[100:103]
    ds_read_b64_tr_b16 a[244:245], v7 offset:4096
    buffer_load_dwordx4 a[124:127], v163, s[20:23], s92 offen offset:1024 sc1
    v_mfma_f32_16x16x32_bf16 v[100:103], a[168:171], a[128:131], v[100:103]
    v_mfma_f32_16x16x32_bf16 v[104:107], a[176:179], a[128:131], v[104:107]
    ds_read_b64_tr_b16 a[246:247], v7 offset:6144
    v_mfma_f32_16x16x32_bf16 v[104:107], a[180:183], a[132:135], v[104:107]
    v_mfma_f32_16x16x32_bf16 v[108:111], a[188:191], a[132:135], v[108:111]
    ds_read_b64_tr_b16 a[248:249], v8
    v_mfma_f32_16x16x32_bf16 v[108:111], a[184:187], a[128:131], v[108:111]
    s_waitcnt vmcnt(15)
    buffer_load_dwordx4 a[128:131], v161, s[20:23], s92 offen offset:1024 sc1
    v_mfma_f32_16x16x32_bf16 v[124:127], a[184:187], a[136:139], v[124:127]
    s_waitcnt vmcnt(15)
    v_mfma_f32_16x16x32_bf16 v[124:127], a[188:191], a[140:143], v[124:127]
    ds_read_b64_tr_b16 a[250:251], v8 offset:2048
    v_mfma_f32_16x16x32_bf16 v[120:123], a[180:183], a[140:143], v[120:123]
    buffer_load_dwordx4 a[132:135], v163, s[20:23], s92 offen offset:2048 sc1
    v_mfma_f32_16x16x32_bf16 v[120:123], a[176:179], a[136:139], v[120:123]
    ds_read_b64_tr_b16 a[252:253], v8 offset:4096
    v_mfma_f32_16x16x32_bf16 v[116:119], a[168:171], a[136:139], v[116:119]
    v_mfma_f32_16x16x32_bf16 v[116:119], a[172:175], a[140:143], v[116:119]
    ds_read_b64_tr_b16 a[254:255], v8 offset:6144
    v_mfma_f32_16x16x32_bf16 v[112:115], a[164:167], a[140:143], v[112:115]
    v_mfma_f32_16x16x32_bf16 v[112:115], a[160:163], a[136:139], v[112:115]
    s_waitcnt vmcnt(15)
    buffer_load_dwordx4 a[136:139], v161, s[20:23], s92 offen offset:2048 sc1
    v_mfma_f32_16x16x32_bf16 v[128:131], a[160:163], a[144:147], v[128:131]
    s_waitcnt vmcnt(15)
    v_mfma_f32_16x16x32_bf16 v[128:131], a[164:167], a[148:151], v[128:131]
    v_mfma_f32_16x16x32_bf16 v[132:135], a[172:175], a[148:151], v[132:135]
    buffer_load_dwordx4 a[140:143], v163, s[20:23], s92 offen offset:3072 sc1
    v_mfma_f32_16x16x32_bf16 v[132:135], a[168:171], a[144:147], v[132:135]
    v_mfma_f32_16x16x32_bf16 v[136:139], a[176:179], a[144:147], v[136:139]
    v_mfma_f32_16x16x32_bf16 v[136:139], a[180:183], a[148:151], v[136:139]
    v_mfma_f32_16x16x32_bf16 v[140:143], a[188:191], a[148:151], v[140:143]
    v_mfma_f32_16x16x32_bf16 v[140:143], a[184:187], a[144:147], v[140:143]
    s_waitcnt vmcnt(15)
    buffer_load_dwordx4 a[144:147], v161, s[20:23], s92 offen offset:3072 sc1
    v_mfma_f32_16x16x32_bf16 v[156:159], a[184:187], a[152:155], v[156:159]
    s_waitcnt vmcnt(15)
    v_mfma_f32_16x16x32_bf16 v[156:159], a[188:191], a[156:159], v[156:159]
    v_mfma_f32_16x16x32_bf16 v[152:155], a[180:183], a[156:159], v[152:155]
    buffer_load_dwordx4 a[148:151], v164, s[20:23], s92 offen sc1
    v_mfma_f32_16x16x32_bf16 v[152:155], a[176:179], a[152:155], v[152:155]
    v_mfma_f32_16x16x32_bf16 v[148:151], a[168:171], a[152:155], v[148:151]
    s_waitcnt lgkmcnt(0)
    v_mfma_f32_16x16x32_bf16 v[148:151], a[172:175], a[156:159], v[148:151]
    v_mfma_f32_16x16x32_bf16 v[144:147], a[164:167], a[156:159], v[144:147]
    v_mfma_f32_16x16x32_bf16 v[144:147], a[160:163], a[152:155], v[144:147]
    s_waitcnt vmcnt(15)
    buffer_load_dwordx4 a[152:155], v162, s[20:23], s92 offen sc1
    buffer_load_dwordx4 a[156:159], v164, s[20:23], s92 offen offset:1024 sc1
    v_mfma_f32_16x16x32_bf16 v[16:19], v[186:189], a[88:91], v[16:19]
    s_waitcnt vmcnt(16)
    s_xor_b32 s69, s95, 11
    v_mfma_f32_16x16x32_bf16 v[16:19], v[190:193], a[92:95], v[16:19]
    s_mul_i32 s69, s69, 0x4800
    v_mfma_f32_16x16x32_bf16 v[20:23], v[198:201], a[92:95], v[20:23]
    s_add_u32 s85, s67, s69
    v_mfma_f32_16x16x32_bf16 v[20:23], v[194:197], a[88:91], v[20:23]
    v_mfma_f32_16x16x32_bf16 v[24:27], v[202:205], a[88:91], v[24:27]
    v_mfma_f32_16x16x32_bf16 v[24:27], v[206:209], a[92:95], v[24:27]
    v_mfma_f32_16x16x32_bf16 v[28:31], v[214:217], a[92:95], v[28:31]
    v_mfma_f32_16x16x32_bf16 v[28:31], v[210:213], a[88:91], v[28:31]
    s_waitcnt vmcnt(15)
    buffer_load_dwordx4 a[88:91], v160, s[20:23], s85 offen sc1
    v_mfma_f32_16x16x32_bf16 v[44:47], v[210:213], a[96:99], v[44:47]
    s_waitcnt vmcnt(15)
    v_mfma_f32_16x16x32_bf16 v[44:47], v[214:217], a[100:103], v[44:47]
    v_mfma_f32_16x16x32_bf16 v[40:43], v[206:209], a[100:103], v[40:43]
    buffer_load_dwordx4 a[92:95], v162, s[20:23], s85 offen offset:1024 sc1
    v_mfma_f32_16x16x32_bf16 v[40:43], v[202:205], a[96:99], v[40:43]
    v_mfma_f32_16x16x32_bf16 v[36:39], v[194:197], a[96:99], v[36:39]
    v_mfma_f32_16x16x32_bf16 v[36:39], v[198:201], a[100:103], v[36:39]
    v_mfma_f32_16x16x32_bf16 v[32:35], v[190:193], a[100:103], v[32:35]
    v_mfma_f32_16x16x32_bf16 v[32:35], v[186:189], a[96:99], v[32:35]
    s_waitcnt vmcnt(15)
    buffer_load_dwordx4 a[96:99], v160, s[20:23], s85 offen offset:1024 sc1
    v_mfma_f32_16x16x32_bf16 v[48:51], v[186:189], a[104:107], v[48:51]
    s_waitcnt vmcnt(15)
    v_mfma_f32_16x16x32_bf16 v[48:51], v[190:193], a[108:111], v[48:51]
    v_mfma_f32_16x16x32_bf16 v[52:55], v[198:201], a[108:111], v[52:55]
    buffer_load_dwordx4 a[100:103], v162, s[20:23], s85 offen offset:2048 sc1
    v_mfma_f32_16x16x32_bf16 v[52:55], v[194:197], a[104:107], v[52:55]
    v_mfma_f32_16x16x32_bf16 v[56:59], v[202:205], a[104:107], v[56:59]
    v_mfma_f32_16x16x32_bf16 v[56:59], v[206:209], a[108:111], v[56:59]
    v_mfma_f32_16x16x32_bf16 v[60:63], v[214:217], a[108:111], v[60:63]
    v_mfma_f32_16x16x32_bf16 v[60:63], v[210:213], a[104:107], v[60:63]
    s_waitcnt vmcnt(15)
    buffer_load_dwordx4 a[104:107], v160, s[20:23], s85 offen offset:2048 sc1
    v_mfma_f32_16x16x32_bf16 v[76:79], v[210:213], a[112:115], v[76:79]
    s_waitcnt vmcnt(15)
    v_mfma_f32_16x16x32_bf16 v[76:79], v[214:217], a[116:119], v[76:79]
    v_mfma_f32_16x16x32_bf16 v[72:75], v[206:209], a[116:119], v[72:75]
    buffer_load_dwordx4 a[108:111], v162, s[20:23], s85 offen offset:3072 sc1
    v_mfma_f32_16x16x32_bf16 v[72:75], v[202:205], a[112:115], v[72:75]
    v_mfma_f32_16x16x32_bf16 v[68:71], v[194:197], a[112:115], v[68:71]
    v_mfma_f32_16x16x32_bf16 v[68:71], v[198:201], a[116:119], v[68:71]
    v_mfma_f32_16x16x32_bf16 v[64:67], v[190:193], a[116:119], v[64:67]
    v_mfma_f32_16x16x32_bf16 v[64:67], v[186:189], a[112:115], v[64:67]
    s_waitcnt vmcnt(15)
    buffer_load_dwordx4 a[112:115], v160, s[20:23], s85 offen offset:3072 sc1
    v_mfma_f32_16x16x32_bf16 v[80:83], v[186:189], a[120:123], v[80:83]
    s_waitcnt vmcnt(15)
    v_mfma_f32_16x16x32_bf16 v[80:83], v[190:193], a[124:127], v[80:83]
    v_mfma_f32_16x16x32_bf16 v[84:87], v[198:201], a[124:127], v[84:87]
    buffer_load_dwordx4 a[116:119], v163, s[20:23], s85 offen sc1
    v_mfma_f32_16x16x32_bf16 v[84:87], v[194:197], a[120:123], v[84:87]
    v_mfma_f32_16x16x32_bf16 v[88:91], v[202:205], a[120:123], v[88:91]
    v_mfma_f32_16x16x32_bf16 v[88:91], v[206:209], a[124:127], v[88:91]
    v_mfma_f32_16x16x32_bf16 v[92:95], v[214:217], a[124:127], v[92:95]
    v_mfma_f32_16x16x32_bf16 v[92:95], v[210:213], a[120:123], v[92:95]
    s_waitcnt vmcnt(15)
    buffer_load_dwordx4 a[120:123], v161, s[20:23], s85 offen sc1
    v_mfma_f32_16x16x32_bf16 v[108:111], v[210:213], a[128:131], v[108:111]
    s_waitcnt vmcnt(15)
    v_mfma_f32_16x16x32_bf16 v[108:111], v[214:217], a[132:135], v[108:111]
    v_mfma_f32_16x16x32_bf16 v[104:107], v[206:209], a[132:135], v[104:107]
    buffer_load_dwordx4 a[124:127], v163, s[20:23], s85 offen offset:1024 sc1
    v_mfma_f32_16x16x32_bf16 v[104:107], v[202:205], a[128:131], v[104:107]
    v_mfma_f32_16x16x32_bf16 v[100:103], v[194:197], a[128:131], v[100:103]
    v_mfma_f32_16x16x32_bf16 v[100:103], v[198:201], a[132:135], v[100:103]
    v_mfma_f32_16x16x32_bf16 v[96:99], v[190:193], a[132:135], v[96:99]
    v_mfma_f32_16x16x32_bf16 v[96:99], v[186:189], a[128:131], v[96:99]
    s_waitcnt vmcnt(15)
    buffer_load_dwordx4 a[128:131], v161, s[20:23], s85 offen offset:1024 sc1
    v_mfma_f32_16x16x32_bf16 v[112:115], v[186:189], a[136:139], v[112:115]
    s_waitcnt vmcnt(15)
    v_mfma_f32_16x16x32_bf16 v[112:115], v[190:193], a[140:143], v[112:115]
    v_mfma_f32_16x16x32_bf16 v[116:119], v[198:201], a[140:143], v[116:119]
    buffer_load_dwordx4 a[132:135], v163, s[20:23], s85 offen offset:2048 sc1
    v_mfma_f32_16x16x32_bf16 v[116:119], v[194:197], a[136:139], v[116:119]
    v_mfma_f32_16x16x32_bf16 v[120:123], v[202:205], a[136:139], v[120:123]
    v_mfma_f32_16x16x32_bf16 v[120:123], v[206:209], a[140:143], v[120:123]
    v_mfma_f32_16x16x32_bf16 v[124:127], v[214:217], a[140:143], v[124:127]
    v_mfma_f32_16x16x32_bf16 v[124:127], v[210:213], a[136:139], v[124:127]
    s_waitcnt vmcnt(15)
    buffer_load_dwordx4 a[136:139], v161, s[20:23], s85 offen offset:2048 sc1
    v_mfma_f32_16x16x32_bf16 v[140:143], v[210:213], a[144:147], v[140:143]
    s_waitcnt vmcnt(15)
    v_mfma_f32_16x16x32_bf16 v[140:143], v[214:217], a[148:151], v[140:143]
    v_mfma_f32_16x16x32_bf16 v[136:139], v[206:209], a[148:151], v[136:139]
    buffer_load_dwordx4 a[140:143], v163, s[20:23], s85 offen offset:3072 sc1
    v_mfma_f32_16x16x32_bf16 v[136:139], v[202:205], a[144:147], v[136:139]
    v_mfma_f32_16x16x32_bf16 v[132:135], v[194:197], a[144:147], v[132:135]
    v_mfma_f32_16x16x32_bf16 v[132:135], v[198:201], a[148:151], v[132:135]
    v_mfma_f32_16x16x32_bf16 v[128:131], v[190:193], a[148:151], v[128:131]
    v_mfma_f32_16x16x32_bf16 v[128:131], v[186:189], a[144:147], v[128:131]
    s_waitcnt vmcnt(15)
    buffer_load_dwordx4 a[144:147], v161, s[20:23], s85 offen offset:3072 sc1
    v_mfma_f32_16x16x32_bf16 v[144:147], v[186:189], a[152:155], v[144:147]
    s_waitcnt vmcnt(15)
    v_mfma_f32_16x16x32_bf16 v[144:147], v[190:193], a[156:159], v[144:147]
    v_mfma_f32_16x16x32_bf16 v[148:151], v[198:201], a[156:159], v[148:151]
    buffer_load_dwordx4 a[148:151], v164, s[20:23], s85 offen sc1
    v_mfma_f32_16x16x32_bf16 v[148:151], v[194:197], a[152:155], v[148:151]
    v_mfma_f32_16x16x32_bf16 v[152:155], v[202:205], a[152:155], v[152:155]
    v_mfma_f32_16x16x32_bf16 v[152:155], v[206:209], a[156:159], v[152:155]
    v_mfma_f32_16x16x32_bf16 v[156:159], v[214:217], a[156:159], v[156:159]
    v_mfma_f32_16x16x32_bf16 v[156:159], v[210:213], a[152:155], v[156:159]
    s_waitcnt vmcnt(15)
    buffer_load_dwordx4 a[152:155], v162, s[20:23], s85 offen sc1
    buffer_load_dwordx4 a[156:159], v164, s[20:23], s85 offen offset:1024 sc1
    v_mfma_f32_16x16x32_bf16 v[28:31], v[242:245], a[88:91], v[28:31]
    s_waitcnt vmcnt(16)
    s_xor_b32 s69, s95, 12
    v_mfma_f32_16x16x32_bf16 v[28:31], v[246:249], a[92:95], v[28:31]
    s_mul_i32 s69, s69, 0x4800
    v_mfma_f32_16x16x32_bf16 v[24:27], v[238:241], a[92:95], v[24:27]
    s_add_u32 s92, s67, s69
    v_mfma_f32_16x16x32_bf16 v[24:27], v[234:237], a[88:91], v[24:27]
    v_mfma_f32_16x16x32_bf16 v[20:23], v[226:229], a[88:91], v[20:23]
    v_mfma_f32_16x16x32_bf16 v[20:23], v[230:233], a[92:95], v[20:23]
    v_mfma_f32_16x16x32_bf16 v[16:19], v[222:225], a[92:95], v[16:19]
    v_mfma_f32_16x16x32_bf16 v[16:19], v[218:221], a[88:91], v[16:19]
    s_waitcnt vmcnt(15)
    buffer_load_dwordx4 a[88:91], v160, s[20:23], s92 offen sc1
    v_mfma_f32_16x16x32_bf16 v[32:35], v[218:221], a[96:99], v[32:35]
    s_waitcnt vmcnt(15)
    v_mfma_f32_16x16x32_bf16 v[32:35], v[222:225], a[100:103], v[32:35]
    v_mfma_f32_16x16x32_bf16 v[36:39], v[230:233], a[100:103], v[36:39]
    buffer_load_dwordx4 a[92:95], v162, s[20:23], s92 offen offset:1024 sc1
    v_mfma_f32_16x16x32_bf16 v[36:39], v[226:229], a[96:99], v[36:39]
    v_mfma_f32_16x16x32_bf16 v[40:43], v[234:237], a[96:99], v[40:43]
    v_mfma_f32_16x16x32_bf16 v[40:43], v[238:241], a[100:103], v[40:43]
    v_mfma_f32_16x16x32_bf16 v[44:47], v[246:249], a[100:103], v[44:47]
    v_mfma_f32_16x16x32_bf16 v[44:47], v[242:245], a[96:99], v[44:47]
    s_waitcnt vmcnt(15)
    buffer_load_dwordx4 a[96:99], v160, s[20:23], s92 offen offset:1024 sc1
    v_mfma_f32_16x16x32_bf16 v[60:63], v[242:245], a[104:107], v[60:63]
    s_waitcnt vmcnt(15)
    v_mfma_f32_16x16x32_bf16 v[60:63], v[246:249], a[108:111], v[60:63]
    v_mfma_f32_16x16x32_bf16 v[56:59], v[238:241], a[108:111], v[56:59]
    buffer_load_dwordx4 a[100:103], v162, s[20:23], s92 offen offset:2048 sc1
    v_mfma_f32_16x16x32_bf16 v[56:59], v[234:237], a[104:107], v[56:59]
    v_mfma_f32_16x16x32_bf16 v[52:55], v[226:229], a[104:107], v[52:55]
    v_mfma_f32_16x16x32_bf16 v[52:55], v[230:233], a[108:111], v[52:55]
    v_mfma_f32_16x16x32_bf16 v[48:51], v[222:225], a[108:111], v[48:51]
    v_mfma_f32_16x16x32_bf16 v[48:51], v[218:221], a[104:107], v[48:51]
    s_waitcnt vmcnt(15)
    buffer_load_dwordx4 a[104:107], v160, s[20:23], s92 offen offset:2048 sc1
    v_mfma_f32_16x16x32_bf16 v[64:67], v[218:221], a[112:115], v[64:67]
    s_waitcnt vmcnt(15)
    v_mfma_f32_16x16x32_bf16 v[64:67], v[222:225], a[116:119], v[64:67]
    v_mfma_f32_16x16x32_bf16 v[68:71], v[230:233], a[116:119], v[68:71]
    buffer_load_dwordx4 a[108:111], v162, s[20:23], s92 offen offset:3072 sc1
    v_mfma_f32_16x16x32_bf16 v[68:71], v[226:229], a[112:115], v[68:71]
    v_mfma_f32_16x16x32_bf16 v[72:75], v[234:237], a[112:115], v[72:75]
    v_mfma_f32_16x16x32_bf16 v[72:75], v[238:241], a[116:119], v[72:75]
    v_mfma_f32_16x16x32_bf16 v[76:79], v[246:249], a[116:119], v[76:79]
    v_mfma_f32_16x16x32_bf16 v[76:79], v[242:245], a[112:115], v[76:79]
    s_waitcnt vmcnt(15)
    buffer_load_dwordx4 a[112:115], v160, s[20:23], s92 offen offset:3072 sc1
    v_mfma_f32_16x16x32_bf16 v[92:95], v[242:245], a[120:123], v[92:95]
    s_waitcnt vmcnt(15)
    v_mfma_f32_16x16x32_bf16 v[92:95], v[246:249], a[124:127], v[92:95]
    v_mfma_f32_16x16x32_bf16 v[88:91], v[238:241], a[124:127], v[88:91]
    buffer_load_dwordx4 a[116:119], v163, s[20:23], s92 offen sc1
    v_mfma_f32_16x16x32_bf16 v[88:91], v[234:237], a[120:123], v[88:91]
    v_mfma_f32_16x16x32_bf16 v[84:87], v[226:229], a[120:123], v[84:87]
    v_mfma_f32_16x16x32_bf16 v[84:87], v[230:233], a[124:127], v[84:87]
    v_mfma_f32_16x16x32_bf16 v[80:83], v[222:225], a[124:127], v[80:83]
    v_mfma_f32_16x16x32_bf16 v[80:83], v[218:221], a[120:123], v[80:83]
    s_waitcnt vmcnt(15)
    buffer_load_dwordx4 a[120:123], v161, s[20:23], s92 offen sc1
    v_mfma_f32_16x16x32_bf16 v[96:99], v[218:221], a[128:131], v[96:99]
    s_waitcnt vmcnt(15)
    v_mfma_f32_16x16x32_bf16 v[96:99], v[222:225], a[132:135], v[96:99]
    v_mfma_f32_16x16x32_bf16 v[100:103], v[230:233], a[132:135], v[100:103]
    buffer_load_dwordx4 a[124:127], v163, s[20:23], s92 offen offset:1024 sc1
    v_mfma_f32_16x16x32_bf16 v[100:103], v[226:229], a[128:131], v[100:103]
    v_mfma_f32_16x16x32_bf16 v[104:107], v[234:237], a[128:131], v[104:107]
    v_mfma_f32_16x16x32_bf16 v[104:107], v[238:241], a[132:135], v[104:107]
    v_mfma_f32_16x16x32_bf16 v[108:111], v[246:249], a[132:135], v[108:111]
    v_mfma_f32_16x16x32_bf16 v[108:111], v[242:245], a[128:131], v[108:111]
    s_waitcnt vmcnt(15)
    buffer_load_dwordx4 a[128:131], v161, s[20:23], s92 offen offset:1024 sc1
    v_mfma_f32_16x16x32_bf16 v[124:127], v[242:245], a[136:139], v[124:127]
    s_waitcnt vmcnt(15)
    v_mfma_f32_16x16x32_bf16 v[124:127], v[246:249], a[140:143], v[124:127]
    v_mfma_f32_16x16x32_bf16 v[120:123], v[238:241], a[140:143], v[120:123]
    buffer_load_dwordx4 a[132:135], v163, s[20:23], s92 offen offset:2048 sc1
    v_mfma_f32_16x16x32_bf16 v[120:123], v[234:237], a[136:139], v[120:123]
    v_mfma_f32_16x16x32_bf16 v[116:119], v[226:229], a[136:139], v[116:119]
    v_mfma_f32_16x16x32_bf16 v[116:119], v[230:233], a[140:143], v[116:119]
    v_mfma_f32_16x16x32_bf16 v[112:115], v[222:225], a[140:143], v[112:115]
    v_mfma_f32_16x16x32_bf16 v[112:115], v[218:221], a[136:139], v[112:115]
    s_waitcnt vmcnt(15)
    buffer_load_dwordx4 a[136:139], v161, s[20:23], s92 offen offset:2048 sc1
    v_mfma_f32_16x16x32_bf16 v[128:131], v[218:221], a[144:147], v[128:131]
    s_waitcnt vmcnt(15)
    v_mfma_f32_16x16x32_bf16 v[128:131], v[222:225], a[148:151], v[128:131]
    v_mfma_f32_16x16x32_bf16 v[132:135], v[230:233], a[148:151], v[132:135]
    buffer_load_dwordx4 a[140:143], v163, s[20:23], s92 offen offset:3072 sc1
    v_mfma_f32_16x16x32_bf16 v[132:135], v[226:229], a[144:147], v[132:135]
    v_mfma_f32_16x16x32_bf16 v[136:139], v[234:237], a[144:147], v[136:139]
    v_mfma_f32_16x16x32_bf16 v[136:139], v[238:241], a[148:151], v[136:139]
    v_mfma_f32_16x16x32_bf16 v[140:143], v[246:249], a[148:151], v[140:143]
    v_mfma_f32_16x16x32_bf16 v[140:143], v[242:245], a[144:147], v[140:143]
    s_waitcnt vmcnt(15)
    buffer_load_dwordx4 a[144:147], v161, s[20:23], s92 offen offset:3072 sc1
    v_mfma_f32_16x16x32_bf16 v[156:159], v[242:245], a[152:155], v[156:159]
    s_waitcnt vmcnt(15)
    v_mfma_f32_16x16x32_bf16 v[156:159], v[246:249], a[156:159], v[156:159]
    v_mfma_f32_16x16x32_bf16 v[152:155], v[238:241], a[156:159], v[152:155]
    buffer_load_dwordx4 a[148:151], v164, s[20:23], s92 offen sc1
    v_mfma_f32_16x16x32_bf16 v[152:155], v[234:237], a[152:155], v[152:155]
    v_mfma_f32_16x16x32_bf16 v[148:151], v[226:229], a[152:155], v[148:151]
    v_mfma_f32_16x16x32_bf16 v[148:151], v[230:233], a[156:159], v[148:151]
    v_mfma_f32_16x16x32_bf16 v[144:147], v[222:225], a[156:159], v[144:147]
    v_mfma_f32_16x16x32_bf16 v[144:147], v[218:221], a[152:155], v[144:147]
    s_waitcnt vmcnt(15)
    buffer_load_dwordx4 a[152:155], v162, s[20:23], s92 offen sc1
    buffer_load_dwordx4 a[156:159], v164, s[20:23], s92 offen offset:1024 sc1
    v_mfma_f32_16x16x32_bf16 v[16:19], a[0:3], a[88:91], v[16:19]
    s_waitcnt vmcnt(16)
    s_xor_b32 s69, s95, 13
    v_mfma_f32_16x16x32_bf16 v[16:19], a[4:7], a[92:95], v[16:19]
    s_mul_i32 s69, s69, 0x4800
    v_mfma_f32_16x16x32_bf16 v[20:23], a[12:15], a[92:95], v[20:23]
    s_add_u32 s85, s67, s69
    v_mfma_f32_16x16x32_bf16 v[20:23], a[8:11], a[88:91], v[20:23]
    v_mfma_f32_16x16x32_bf16 v[24:27], a[16:19], a[88:91], v[24:27]
    v_mfma_f32_16x16x32_bf16 v[24:27], a[20:23], a[92:95], v[24:27]
    v_mfma_f32_16x16x32_bf16 v[28:31], a[28:31], a[92:95], v[28:31]
    v_mfma_f32_16x16x32_bf16 v[28:31], a[24:27], a[88:91], v[28:31]
    s_waitcnt vmcnt(15)
    buffer_load_dwordx4 a[88:91], v160, s[20:23], s85 offen sc1
    v_mfma_f32_16x16x32_bf16 v[44:47], a[24:27], a[96:99], v[44:47]
    s_waitcnt vmcnt(15)
    v_mfma_f32_16x16x32_bf16 v[44:47], a[28:31], a[100:103], v[44:47]
    v_mfma_f32_16x16x32_bf16 v[40:43], a[20:23], a[100:103], v[40:43]
    buffer_load_dwordx4 a[92:95], v162, s[20:23], s85 offen offset:1024 sc1
    v_mfma_f32_16x16x32_bf16 v[40:43], a[16:19], a[96:99], v[40:43]
    v_mfma_f32_16x16x32_bf16 v[36:39], a[8:11], a[96:99], v[36:39]
    v_mfma_f32_16x16x32_bf16 v[36:39], a[12:15], a[100:103], v[36:39]
    v_mfma_f32_16x16x32_bf16 v[32:35], a[4:7], a[100:103], v[32:35]
    v_mfma_f32_16x16x32_bf16 v[32:35], a[0:3], a[96:99], v[32:35]
    s_waitcnt vmcnt(15)
    buffer_load_dwordx4 a[96:99], v160, s[20:23], s85 offen offset:1024 sc1
    v_mfma_f32_16x16x32_bf16 v[48:51], a[0:3], a[104:107], v[48:51]
    s_waitcnt vmcnt(15)
    v_mfma_f32_16x16x32_bf16 v[48:51], a[4:7], a[108:111], v[48:51]
    v_mfma_f32_16x16x32_bf16 v[52:55], a[12:15], a[108:111], v[52:55]
    buffer_load_dwordx4 a[100:103], v162, s[20:23], s85 offen offset:2048 sc1
    v_mfma_f32_16x16x32_bf16 v[52:55], a[8:11], a[104:107], v[52:55]
    v_mfma_f32_16x16x32_bf16 v[56:59], a[16:19], a[104:107], v[56:59]
    v_mfma_f32_16x16x32_bf16 v[56:59], a[20:23], a[108:111], v[56:59]
    v_mfma_f32_16x16x32_bf16 v[60:63], a[28:31], a[108:111], v[60:63]
    v_mfma_f32_16x16x32_bf16 v[60:63], a[24:27], a[104:107], v[60:63]
    s_waitcnt vmcnt(15)
    buffer_load_dwordx4 a[104:107], v160, s[20:23], s85 offen offset:2048 sc1
    v_mfma_f32_16x16x32_bf16 v[76:79], a[24:27], a[112:115], v[76:79]
    s_waitcnt vmcnt(15)
    v_mfma_f32_16x16x32_bf16 v[76:79], a[28:31], a[116:119], v[76:79]
    v_mfma_f32_16x16x32_bf16 v[72:75], a[20:23], a[116:119], v[72:75]
    buffer_load_dwordx4 a[108:111], v162, s[20:23], s85 offen offset:3072 sc1
    v_mfma_f32_16x16x32_bf16 v[72:75], a[16:19], a[112:115], v[72:75]
    v_mfma_f32_16x16x32_bf16 v[68:71], a[8:11], a[112:115], v[68:71]
    v_mfma_f32_16x16x32_bf16 v[68:71], a[12:15], a[116:119], v[68:71]
    v_mfma_f32_16x16x32_bf16 v[64:67], a[4:7], a[116:119], v[64:67]
    v_mfma_f32_16x16x32_bf16 v[64:67], a[0:3], a[112:115], v[64:67]
    s_waitcnt vmcnt(15)
    buffer_load_dwordx4 a[112:115], v160, s[20:23], s85 offen offset:3072 sc1
    v_mfma_f32_16x16x32_bf16 v[80:83], a[0:3], a[120:123], v[80:83]
    s_waitcnt vmcnt(15)
    v_mfma_f32_16x16x32_bf16 v[80:83], a[4:7], a[124:127], v[80:83]
    v_mfma_f32_16x16x32_bf16 v[84:87], a[12:15], a[124:127], v[84:87]
    buffer_load_dwordx4 a[116:119], v163, s[20:23], s85 offen sc1
    v_mfma_f32_16x16x32_bf16 v[84:87], a[8:11], a[120:123], v[84:87]
    v_mfma_f32_16x16x32_bf16 v[88:91], a[16:19], a[120:123], v[88:91]
    v_mfma_f32_16x16x32_bf16 v[88:91], a[20:23], a[124:127], v[88:91]
    v_mfma_f32_16x16x32_bf16 v[92:95], a[28:31], a[124:127], v[92:95]
    v_mfma_f32_16x16x32_bf16 v[92:95], a[24:27], a[120:123], v[92:95]
    s_waitcnt vmcnt(15)
    buffer_load_dwordx4 a[120:123], v161, s[20:23], s85 offen sc1
    v_mfma_f32_16x16x32_bf16 v[108:111], a[24:27], a[128:131], v[108:111]
    s_waitcnt vmcnt(15)
    v_mfma_f32_16x16x32_bf16 v[108:111], a[28:31], a[132:135], v[108:111]
    v_mfma_f32_16x16x32_bf16 v[104:107], a[20:23], a[132:135], v[104:107]
    buffer_load_dwordx4 a[124:127], v163, s[20:23], s85 offen offset:1024 sc1
    v_mfma_f32_16x16x32_bf16 v[104:107], a[16:19], a[128:131], v[104:107]
    v_mfma_f32_16x16x32_bf16 v[100:103], a[8:11], a[128:131], v[100:103]
    v_mfma_f32_16x16x32_bf16 v[100:103], a[12:15], a[132:135], v[100:103]
    v_mfma_f32_16x16x32_bf16 v[96:99], a[4:7], a[132:135], v[96:99]
    v_mfma_f32_16x16x32_bf16 v[96:99], a[0:3], a[128:131], v[96:99]
    s_waitcnt vmcnt(15)
    buffer_load_dwordx4 a[128:131], v161, s[20:23], s85 offen offset:1024 sc1
    v_mfma_f32_16x16x32_bf16 v[112:115], a[0:3], a[136:139], v[112:115]
    s_waitcnt vmcnt(15)
    v_mfma_f32_16x16x32_bf16 v[112:115], a[4:7], a[140:143], v[112:115]
    v_mfma_f32_16x16x32_bf16 v[116:119], a[12:15], a[140:143], v[116:119]
    buffer_load_dwordx4 a[132:135], v163, s[20:23], s85 offen offset:2048 sc1
    v_mfma_f32_16x16x32_bf16 v[116:119], a[8:11], a[136:139], v[116:119]
    v_mfma_f32_16x16x32_bf16 v[120:123], a[16:19], a[136:139], v[120:123]
    v_mfma_f32_16x16x32_bf16 v[120:123], a[20:23], a[140:143], v[120:123]
    v_mfma_f32_16x16x32_bf16 v[124:127], a[28:31], a[140:143], v[124:127]
    v_mfma_f32_16x16x32_bf16 v[124:127], a[24:27], a[136:139], v[124:127]
    s_waitcnt vmcnt(15)
    buffer_load_dwordx4 a[136:139], v161, s[20:23], s85 offen offset:2048 sc1
    v_mfma_f32_16x16x32_bf16 v[140:143], a[24:27], a[144:147], v[140:143]
    s_waitcnt vmcnt(15)
    v_mfma_f32_16x16x32_bf16 v[140:143], a[28:31], a[148:151], v[140:143]
    v_mfma_f32_16x16x32_bf16 v[136:139], a[20:23], a[148:151], v[136:139]
    buffer_load_dwordx4 a[140:143], v163, s[20:23], s85 offen offset:3072 sc1
    v_mfma_f32_16x16x32_bf16 v[136:139], a[16:19], a[144:147], v[136:139]
    v_mfma_f32_16x16x32_bf16 v[132:135], a[8:11], a[144:147], v[132:135]
    v_mfma_f32_16x16x32_bf16 v[132:135], a[12:15], a[148:151], v[132:135]
    v_mfma_f32_16x16x32_bf16 v[128:131], a[4:7], a[148:151], v[128:131]
    v_mfma_f32_16x16x32_bf16 v[128:131], a[0:3], a[144:147], v[128:131]
    s_waitcnt vmcnt(15)
    buffer_load_dwordx4 a[144:147], v161, s[20:23], s85 offen offset:3072 sc1
    v_mfma_f32_16x16x32_bf16 v[144:147], a[0:3], a[152:155], v[144:147]
    s_waitcnt vmcnt(15)
    v_mfma_f32_16x16x32_bf16 v[144:147], a[4:7], a[156:159], v[144:147]
    v_mfma_f32_16x16x32_bf16 v[148:151], a[12:15], a[156:159], v[148:151]
    buffer_load_dwordx4 a[148:151], v164, s[20:23], s85 offen sc1
    v_mfma_f32_16x16x32_bf16 v[148:151], a[8:11], a[152:155], v[148:151]
    v_mfma_f32_16x16x32_bf16 v[152:155], a[16:19], a[152:155], v[152:155]
    v_mfma_f32_16x16x32_bf16 v[152:155], a[20:23], a[156:159], v[152:155]
    v_mfma_f32_16x16x32_bf16 v[156:159], a[28:31], a[156:159], v[156:159]
    v_mfma_f32_16x16x32_bf16 v[156:159], a[24:27], a[152:155], v[156:159]
    s_waitcnt vmcnt(15)
    buffer_load_dwordx4 a[152:155], v162, s[20:23], s85 offen sc1
    buffer_load_dwordx4 a[156:159], v164, s[20:23], s85 offen offset:1024 sc1
    v_mfma_f32_16x16x32_bf16 v[28:31], a[56:59], a[88:91], v[28:31]
    s_waitcnt vmcnt(16)
    s_xor_b32 s69, s95, 14
    v_mfma_f32_16x16x32_bf16 v[28:31], a[60:63], a[92:95], v[28:31]
    s_mul_i32 s69, s69, 0x4800
    v_mfma_f32_16x16x32_bf16 v[24:27], a[52:55], a[92:95], v[24:27]
    s_add_u32 s92, s67, s69
    v_mfma_f32_16x16x32_bf16 v[24:27], a[48:51], a[88:91], v[24:27]
    s_xor_b32 s69, s95, 15
    v_mfma_f32_16x16x32_bf16 v[20:23], a[40:43], a[88:91], v[20:23]
    s_mul_i32 s69, s69, 0x4800
    v_mfma_f32_16x16x32_bf16 v[20:23], a[44:47], a[92:95], v[20:23]
    s_add_u32 s85, s67, s69
    v_mfma_f32_16x16x32_bf16 v[16:19], a[36:39], a[92:95], v[16:19]
    v_mfma_f32_16x16x32_bf16 v[16:19], a[32:35], a[88:91], v[16:19]
    s_waitcnt vmcnt(15)
    buffer_load_dwordx4 a[88:91], v160, s[20:23], s92 offen sc1
    v_mfma_f32_16x16x32_bf16 v[32:35], a[32:35], a[96:99], v[32:35]
    s_waitcnt vmcnt(15)
    v_mfma_f32_16x16x32_bf16 v[32:35], a[36:39], a[100:103], v[32:35]
    v_mfma_f32_16x16x32_bf16 v[36:39], a[44:47], a[100:103], v[36:39]
    buffer_load_dwordx4 a[92:95], v162, s[20:23], s92 offen offset:1024 sc1
    v_mfma_f32_16x16x32_bf16 v[36:39], a[40:43], a[96:99], v[36:39]
    v_mfma_f32_16x16x32_bf16 v[40:43], a[48:51], a[96:99], v[40:43]
    v_mfma_f32_16x16x32_bf16 v[40:43], a[52:55], a[100:103], v[40:43]
    v_mfma_f32_16x16x32_bf16 v[44:47], a[60:63], a[100:103], v[44:47]
    v_mfma_f32_16x16x32_bf16 v[44:47], a[56:59], a[96:99], v[44:47]
    s_waitcnt vmcnt(15)
    buffer_load_dwordx4 a[96:99], v160, s[20:23], s85 offen sc1
    v_mfma_f32_16x16x32_bf16 v[60:63], a[56:59], a[104:107], v[60:63]
    s_waitcnt vmcnt(15)
    v_mfma_f32_16x16x32_bf16 v[60:63], a[60:63], a[108:111], v[60:63]
    v_mfma_f32_16x16x32_bf16 v[56:59], a[52:55], a[108:111], v[56:59]
    buffer_load_dwordx4 a[100:103], v162, s[20:23], s85 offen offset:1024 sc1
    v_mfma_f32_16x16x32_bf16 v[56:59], a[48:51], a[104:107], v[56:59]
    v_mfma_f32_16x16x32_bf16 v[52:55], a[40:43], a[104:107], v[52:55]
    v_mfma_f32_16x16x32_bf16 v[52:55], a[44:47], a[108:111], v[52:55]
    v_mfma_f32_16x16x32_bf16 v[48:51], a[36:39], a[108:111], v[48:51]
    v_mfma_f32_16x16x32_bf16 v[48:51], a[32:35], a[104:107], v[48:51]
    s_waitcnt vmcnt(15)
    buffer_load_dwordx4 a[104:107], v160, s[20:23], s92 offen offset:1024 sc1
    v_mfma_f32_16x16x32_bf16 v[64:67], a[32:35], a[112:115], v[64:67]
    s_waitcnt vmcnt(15)
    v_mfma_f32_16x16x32_bf16 v[64:67], a[36:39], a[116:119], v[64:67]
    v_mfma_f32_16x16x32_bf16 v[68:71], a[44:47], a[116:119], v[68:71]
    buffer_load_dwordx4 a[108:111], v162, s[20:23], s92 offen offset:2048 sc1
    v_mfma_f32_16x16x32_bf16 v[68:71], a[40:43], a[112:115], v[68:71]
    v_mfma_f32_16x16x32_bf16 v[72:75], a[48:51], a[112:115], v[72:75]
    v_mfma_f32_16x16x32_bf16 v[72:75], a[52:55], a[116:119], v[72:75]
    v_mfma_f32_16x16x32_bf16 v[76:79], a[60:63], a[116:119], v[76:79]
    v_mfma_f32_16x16x32_bf16 v[76:79], a[56:59], a[112:115], v[76:79]
    s_waitcnt vmcnt(15)
    buffer_load_dwordx4 a[112:115], v160, s[20:23], s85 offen offset:1024 sc1
    v_mfma_f32_16x16x32_bf16 v[92:95], a[56:59], a[120:123], v[92:95]
    s_waitcnt vmcnt(15)
    v_mfma_f32_16x16x32_bf16 v[92:95], a[60:63], a[124:127], v[92:95]
    v_mfma_f32_16x16x32_bf16 v[88:91], a[52:55], a[124:127], v[88:91]
    buffer_load_dwordx4 a[116:119], v162, s[20:23], s85 offen offset:2048 sc1
    v_mfma_f32_16x16x32_bf16 v[88:91], a[48:51], a[120:123], v[88:91]
    v_mfma_f32_16x16x32_bf16 v[84:87], a[40:43], a[120:123], v[84:87]
    v_mfma_f32_16x16x32_bf16 v[84:87], a[44:47], a[124:127], v[84:87]
    v_mfma_f32_16x16x32_bf16 v[80:83], a[36:39], a[124:127], v[80:83]
    v_mfma_f32_16x16x32_bf16 v[80:83], a[32:35], a[120:123], v[80:83]
    s_waitcnt vmcnt(15)
    buffer_load_dwordx4 a[120:123], v160, s[20:23], s92 offen offset:2048 sc1
    v_mfma_f32_16x16x32_bf16 v[96:99], a[32:35], a[128:131], v[96:99]
    s_waitcnt vmcnt(15)
    v_mfma_f32_16x16x32_bf16 v[96:99], a[36:39], a[132:135], v[96:99]
    v_mfma_f32_16x16x32_bf16 v[100:103], a[44:47], a[132:135], v[100:103]
    buffer_load_dwordx4 a[124:127], v162, s[20:23], s92 offen offset:3072 sc1
    v_mfma_f32_16x16x32_bf16 v[100:103], a[40:43], a[128:131], v[100:103]
    v_mfma_f32_16x16x32_bf16 v[104:107], a[48:51], a[128:131], v[104:107]
    v_mfma_f32_16x16x32_bf16 v[104:107], a[52:55], a[132:135], v[104:107]
    v_mfma_f32_16x16x32_bf16 v[108:111], a[60:63], a[132:135], v[108:111]
    v_mfma_f32_16x16x32_bf16 v[108:111], a[56:59], a[128:131], v[108:111]
    s_waitcnt vmcnt(15)
    buffer_load_dwordx4 a[128:131], v160, s[20:23], s85 offen offset:2048 sc1
    v_mfma_f32_16x16x32_bf16 v[124:127], a[56:59], a[136:139], v[124:127]
    s_waitcnt vmcnt(15)
    v_mfma_f32_16x16x32_bf16 v[124:127], a[60:63], a[140:143], v[124:127]
    v_mfma_f32_16x16x32_bf16 v[120:123], a[52:55], a[140:143], v[120:123]
    buffer_load_dwordx4 a[132:135], v162, s[20:23], s85 offen offset:3072 sc1
    v_mfma_f32_16x16x32_bf16 v[120:123], a[48:51], a[136:139], v[120:123]
    v_mfma_f32_16x16x32_bf16 v[116:119], a[40:43], a[136:139], v[116:119]
    v_mfma_f32_16x16x32_bf16 v[116:119], a[44:47], a[140:143], v[116:119]
    v_mfma_f32_16x16x32_bf16 v[112:115], a[36:39], a[140:143], v[112:115]
    v_mfma_f32_16x16x32_bf16 v[112:115], a[32:35], a[136:139], v[112:115]
    s_waitcnt vmcnt(15)
    buffer_load_dwordx4 a[136:139], v160, s[20:23], s92 offen offset:3072 sc1
    v_mfma_f32_16x16x32_bf16 v[128:131], a[32:35], a[144:147], v[128:131]
    s_waitcnt vmcnt(15)
    v_mfma_f32_16x16x32_bf16 v[128:131], a[36:39], a[148:151], v[128:131]
    v_mfma_f32_16x16x32_bf16 v[132:135], a[44:47], a[148:151], v[132:135]
    buffer_load_dwordx4 a[140:143], v163, s[20:23], s92 offen sc1
    v_mfma_f32_16x16x32_bf16 v[132:135], a[40:43], a[144:147], v[132:135]
    v_mfma_f32_16x16x32_bf16 v[136:139], a[48:51], a[144:147], v[136:139]
    v_mfma_f32_16x16x32_bf16 v[136:139], a[52:55], a[148:151], v[136:139]
    v_mfma_f32_16x16x32_bf16 v[140:143], a[60:63], a[148:151], v[140:143]
    v_mfma_f32_16x16x32_bf16 v[140:143], a[56:59], a[144:147], v[140:143]
    s_waitcnt vmcnt(15)
    buffer_load_dwordx4 a[144:147], v160, s[20:23], s85 offen offset:3072 sc1
    v_mfma_f32_16x16x32_bf16 v[156:159], a[56:59], a[152:155], v[156:159]
    s_waitcnt vmcnt(15)
    v_mfma_f32_16x16x32_bf16 v[156:159], a[60:63], a[156:159], v[156:159]
    v_mfma_f32_16x16x32_bf16 v[152:155], a[52:55], a[156:159], v[152:155]
    buffer_load_dwordx4 a[148:151], v163, s[20:23], s85 offen sc1
    v_mfma_f32_16x16x32_bf16 v[152:155], a[48:51], a[152:155], v[152:155]
    v_mfma_f32_16x16x32_bf16 v[148:151], a[40:43], a[152:155], v[148:151]
    v_mfma_f32_16x16x32_bf16 v[148:151], a[44:47], a[156:159], v[148:151]
    v_mfma_f32_16x16x32_bf16 v[144:147], a[36:39], a[156:159], v[144:147]
    v_mfma_f32_16x16x32_bf16 v[144:147], a[32:35], a[152:155], v[144:147]
    s_waitcnt vmcnt(15)
    buffer_load_dwordx4 a[152:155], v161, s[20:23], s92 offen sc1
    buffer_load_dwordx4 a[156:159], v163, s[20:23], s92 offen offset:1024 sc1
    v_mfma_f32_16x16x32_bf16 v[16:19], a[192:195], a[88:91], v[16:19]
    s_waitcnt vmcnt(16)
    v_mfma_f32_16x16x32_bf16 v[16:19], a[196:199], a[92:95], v[16:19]
    v_mfma_f32_16x16x32_bf16 v[20:23], a[204:207], a[92:95], v[20:23]
    v_mfma_f32_16x16x32_bf16 v[20:23], a[200:203], a[88:91], v[20:23]
    v_mfma_f32_16x16x32_bf16 v[24:27], a[208:211], a[88:91], v[24:27]
    v_mfma_f32_16x16x32_bf16 v[24:27], a[212:215], a[92:95], v[24:27]
    v_mfma_f32_16x16x32_bf16 v[28:31], a[220:223], a[92:95], v[28:31]
    v_mfma_f32_16x16x32_bf16 v[28:31], a[216:219], a[88:91], v[28:31]
    s_waitcnt vmcnt(15)
    buffer_load_dwordx4 a[88:91], v161, s[20:23], s85 offen sc1
    v_mfma_f32_16x16x32_bf16 v[28:31], a[248:251], a[96:99], v[28:31]
    s_waitcnt vmcnt(15)
    v_mfma_f32_16x16x32_bf16 v[28:31], a[252:255], a[100:103], v[28:31]
    v_mfma_f32_16x16x32_bf16 v[24:27], a[244:247], a[100:103], v[24:27]
    buffer_load_dwordx4 a[92:95], v163, s[20:23], s85 offen offset:1024 sc1
    v_mfma_f32_16x16x32_bf16 v[24:27], a[240:243], a[96:99], v[24:27]
    v_mfma_f32_16x16x32_bf16 v[20:23], a[232:235], a[96:99], v[20:23]
    v_mfma_f32_16x16x32_bf16 v[20:23], a[236:239], a[100:103], v[20:23]
    v_mfma_f32_16x16x32_bf16 v[16:19], a[228:231], a[100:103], v[16:19]
    v_mfma_f32_16x16x32_bf16 v[16:19], a[224:227], a[96:99], v[16:19]
    s_waitcnt vmcnt(15)
    buffer_load_dwordx4 a[96:99], v161, s[20:23], s92 offen offset:1024 sc1
    v_mfma_f32_16x16x32_bf16 v[32:35], a[192:195], a[104:107], v[32:35]
    s_waitcnt vmcnt(15)
    v_mfma_f32_16x16x32_bf16 v[32:35], a[196:199], a[108:111], v[32:35]
    v_mfma_f32_16x16x32_bf16 v[36:39], a[204:207], a[108:111], v[36:39]
    buffer_load_dwordx4 a[100:103], v163, s[20:23], s92 offen offset:2048 sc1
    v_mfma_f32_16x16x32_bf16 v[36:39], a[200:203], a[104:107], v[36:39]
    ds_write_b128 v170, v[16:19]
    v_mfma_f32_16x16x32_bf16 v[40:43], a[208:211], a[104:107], v[40:43]
    v_mfma_f32_16x16x32_bf16 v[40:43], a[212:215], a[108:111], v[40:43]
    v_mfma_f32_16x16x32_bf16 v[44:47], a[220:223], a[108:111], v[44:47]
    v_mfma_f32_16x16x32_bf16 v[44:47], a[216:219], a[104:107], v[44:47]
    s_waitcnt vmcnt(15)
    ds_write_b128 v171, v[20:23]
    v_mfma_f32_16x16x32_bf16 v[44:47], a[248:251], a[112:115], v[44:47]
    s_waitcnt vmcnt(14)
    buffer_load_dwordx4 a[104:107], v161, s[20:23], s85 offen offset:1024 sc1
    v_mfma_f32_16x16x32_bf16 v[44:47], a[252:255], a[116:119], v[44:47]
    v_mfma_f32_16x16x32_bf16 v[40:43], a[244:247], a[116:119], v[40:43]
    buffer_load_dwordx4 a[108:111], v163, s[20:23], s85 offen offset:2048 sc1
    v_mfma_f32_16x16x32_bf16 v[40:43], a[240:243], a[112:115], v[40:43]
    ds_write_b128 v170, v[24:27] offset:128
    v_mfma_f32_16x16x32_bf16 v[36:39], a[232:235], a[112:115], v[36:39]
    v_mfma_f32_16x16x32_bf16 v[36:39], a[236:239], a[116:119], v[36:39]
    v_mfma_f32_16x16x32_bf16 v[32:35], a[228:231], a[116:119], v[32:35]
    v_mfma_f32_16x16x32_bf16 v[32:35], a[224:227], a[112:115], v[32:35]
    s_waitcnt vmcnt(15)
    ds_write_b128 v171, v[28:31] offset:128
    v_mfma_f32_16x16x32_bf16 v[48:51], a[192:195], a[120:123], v[48:51]
    s_waitcnt vmcnt(14)
    buffer_load_dwordx4 a[112:115], v161, s[20:23], s92 offen offset:2048 sc1
    v_mfma_f32_16x16x32_bf16 v[48:51], a[196:199], a[124:127], v[48:51]
    v_mfma_f32_16x16x32_bf16 v[52:55], a[204:207], a[124:127], v[52:55]
    buffer_load_dwordx4 a[116:119], v163, s[20:23], s92 offen offset:3072 sc1
    v_mfma_f32_16x16x32_bf16 v[52:55], a[200:203], a[120:123], v[52:55]
    ds_write_b128 v170, v[32:35] offset:4096
    v_mfma_f32_16x16x32_bf16 v[56:59], a[208:211], a[120:123], v[56:59]
    v_mfma_f32_16x16x32_bf16 v[56:59], a[212:215], a[124:127], v[56:59]
    v_mfma_f32_16x16x32_bf16 v[60:63], a[220:223], a[124:127], v[60:63]
    v_mfma_f32_16x16x32_bf16 v[60:63], a[216:219], a[120:123], v[60:63]
    s_waitcnt vmcnt(15)
    ds_write_b128 v171, v[36:39] offset:4096
    v_mfma_f32_16x16x32_bf16 v[60:63], a[248:251], a[128:131], v[60:63]
    s_waitcnt vmcnt(14)
    buffer_load_dwordx4 a[120:123], v161, s[20:23], s85 offen offset:2048 sc1
    v_mfma_f32_16x16x32_bf16 v[60:63], a[252:255], a[132:135], v[60:63]
    v_mfma_f32_16x16x32_bf16 v[56:59], a[244:247], a[132:135], v[56:59]
    buffer_load_dwordx4 a[124:127], v163, s[20:23], s85 offen offset:3072 sc1
    v_mfma_f32_16x16x32_bf16 v[56:59], a[240:243], a[128:131], v[56:59]
    ds_write_b128 v170, v[40:43] offset:4224
    v_mfma_f32_16x16x32_bf16 v[52:55], a[232:235], a[128:131], v[52:55]
    v_mfma_f32_16x16x32_bf16 v[52:55], a[236:239], a[132:135], v[52:55]
    v_mfma_f32_16x16x32_bf16 v[48:51], a[228:231], a[132:135], v[48:51]
    v_mfma_f32_16x16x32_bf16 v[48:51], a[224:227], a[128:131], v[48:51]
    s_waitcnt vmcnt(15)
    ds_write_b128 v171, v[44:47] offset:4224
    v_mfma_f32_16x16x32_bf16 v[64:67], a[192:195], a[136:139], v[64:67]
    s_waitcnt vmcnt(14)
    buffer_load_dwordx4 a[128:131], v161, s[20:23], s92 offen offset:3072 sc1
    v_mfma_f32_16x16x32_bf16 v[64:67], a[196:199], a[140:143], v[64:67]
    v_mfma_f32_16x16x32_bf16 v[68:71], a[204:207], a[140:143], v[68:71]
    buffer_load_dwordx4 a[132:135], v164, s[20:23], s92 offen sc1
    v_mfma_f32_16x16x32_bf16 v[68:71], a[200:203], a[136:139], v[68:71]
    ds_write_b128 v170, v[48:51] offset:32768
    v_mfma_f32_16x16x32_bf16 v[72:75], a[208:211], a[136:139], v[72:75]
    v_mfma_f32_16x16x32_bf16 v[72:75], a[212:215], a[140:143], v[72:75]
    v_mfma_f32_16x16x32_bf16 v[76:79], a[220:223], a[140:143], v[76:79]
    v_mfma_f32_16x16x32_bf16 v[76:79], a[216:219], a[136:139], v[76:79]
    s_waitcnt vmcnt(15)
    ds_write_b128 v171, v[52:55] offset:32768
    v_mfma_f32_16x16x32_bf16 v[76:79], a[248:251], a[144:147], v[76:79]
    s_waitcnt vmcnt(14)
    buffer_load_dwordx4 a[136:139], v161, s[20:23], s85 offen offset:3072 sc1
    v_mfma_f32_16x16x32_bf16 v[76:79], a[252:255], a[148:151], v[76:79]
    v_mfma_f32_16x16x32_bf16 v[72:75], a[244:247], a[148:151], v[72:75]
    buffer_load_dwordx4 a[140:143], v164, s[20:23], s85 offen sc1
    v_mfma_f32_16x16x32_bf16 v[72:75], a[240:243], a[144:147], v[72:75]
    ds_write_b128 v170, v[56:59] offset:32896
    v_mfma_f32_16x16x32_bf16 v[68:71], a[232:235], a[144:147], v[68:71]
    v_mfma_f32_16x16x32_bf16 v[68:71], a[236:239], a[148:151], v[68:71]
    v_mfma_f32_16x16x32_bf16 v[64:67], a[228:231], a[148:151], v[64:67]
    v_mfma_f32_16x16x32_bf16 v[64:67], a[224:227], a[144:147], v[64:67]
    s_waitcnt vmcnt(15)
    ds_write_b128 v171, v[60:63] offset:32896
    v_mfma_f32_16x16x32_bf16 v[80:83], a[192:195], a[152:155], v[80:83]
    s_waitcnt vmcnt(14)
    buffer_load_dwordx4 a[144:147], v162, s[20:23], s92 offen sc1
    v_mfma_f32_16x16x32_bf16 v[80:83], a[196:199], a[156:159], v[80:83]
    v_mfma_f32_16x16x32_bf16 v[84:87], a[204:207], a[156:159], v[84:87]
    buffer_load_dwordx4 a[148:151], v164, s[20:23], s92 offen offset:1024 sc1
    v_mfma_f32_16x16x32_bf16 v[84:87], a[200:203], a[152:155], v[84:87]
    ds_write_b128 v170, v[64:67] offset:36864
    v_mfma_f32_16x16x32_bf16 v[88:91], a[208:211], a[152:155], v[88:91]
    v_mfma_f32_16x16x32_bf16 v[88:91], a[212:215], a[156:159], v[88:91]
    v_mfma_f32_16x16x32_bf16 v[92:95], a[220:223], a[156:159], v[92:95]
    v_mfma_f32_16x16x32_bf16 v[92:95], a[216:219], a[152:155], v[92:95]
    s_waitcnt vmcnt(15)
    buffer_load_dwordx4 a[152:155], v162, s[20:23], s85 offen sc1
    buffer_load_dwordx4 a[156:159], v164, s[20:23], s85 offen offset:1024 sc1
    v_mfma_f32_16x16x32_bf16 v[92:95], a[248:251], a[88:91], v[92:95]
    s_waitcnt vmcnt(16)
    ds_write_b128 v171, v[68:71] offset:36864
    v_mfma_f32_16x16x32_bf16 v[92:95], a[252:255], a[92:95], v[92:95]
    v_mfma_f32_16x16x32_bf16 v[88:91], a[244:247], a[92:95], v[88:91]
    v_mfma_f32_16x16x32_bf16 v[88:91], a[240:243], a[88:91], v[88:91]
    ds_write_b128 v170, v[72:75] offset:36992
    v_mfma_f32_16x16x32_bf16 v[84:87], a[232:235], a[88:91], v[84:87]
    v_mfma_f32_16x16x32_bf16 v[84:87], a[236:239], a[92:95], v[84:87]
    v_mfma_f32_16x16x32_bf16 v[80:83], a[228:231], a[92:95], v[80:83]
    v_mfma_f32_16x16x32_bf16 v[80:83], a[224:227], a[88:91], v[80:83]
    s_waitcnt vmcnt(15)
    ds_write_b128 v171, v[76:79] offset:36992
    v_mfma_f32_16x16x32_bf16 v[96:99], a[192:195], a[96:99], v[96:99]
    s_waitcnt vmcnt(14)
    v_mfma_f32_16x16x32_bf16 v[96:99], a[196:199], a[100:103], v[96:99]
    v_mfma_f32_16x16x32_bf16 v[100:103], a[204:207], a[100:103], v[100:103]
    v_mfma_f32_16x16x32_bf16 v[100:103], a[200:203], a[96:99], v[100:103]
    s_nop 0
    ds_write_b128 v172, v[80:83]
    v_mfma_f32_16x16x32_bf16 v[104:107], a[208:211], a[96:99], v[104:107]
    v_mfma_f32_16x16x32_bf16 v[104:107], a[212:215], a[100:103], v[104:107]
    v_mfma_f32_16x16x32_bf16 v[108:111], a[220:223], a[100:103], v[108:111]
    v_mfma_f32_16x16x32_bf16 v[108:111], a[216:219], a[96:99], v[108:111]
    s_waitcnt vmcnt(13)
    ds_write_b128 v173, v[84:87]
    v_mfma_f32_16x16x32_bf16 v[108:111], a[248:251], a[104:107], v[108:111]
    s_waitcnt vmcnt(12)
    v_mfma_f32_16x16x32_bf16 v[108:111], a[252:255], a[108:111], v[108:111]
    v_mfma_f32_16x16x32_bf16 v[104:107], a[244:247], a[108:111], v[104:107]
    v_mfma_f32_16x16x32_bf16 v[104:107], a[240:243], a[104:107], v[104:107]
    ds_write_b128 v172, v[88:91] offset:128
    v_mfma_f32_16x16x32_bf16 v[100:103], a[232:235], a[104:107], v[100:103]
    v_mfma_f32_16x16x32_bf16 v[100:103], a[236:239], a[108:111], v[100:103]
    v_mfma_f32_16x16x32_bf16 v[96:99], a[228:231], a[108:111], v[96:99]
    v_mfma_f32_16x16x32_bf16 v[96:99], a[224:227], a[104:107], v[96:99]
    s_waitcnt vmcnt(11)
    ds_write_b128 v173, v[92:95] offset:128
    v_mfma_f32_16x16x32_bf16 v[112:115], a[192:195], a[112:115], v[112:115]
    s_waitcnt vmcnt(10)
    v_mfma_f32_16x16x32_bf16 v[112:115], a[196:199], a[116:119], v[112:115]
    v_mfma_f32_16x16x32_bf16 v[116:119], a[204:207], a[116:119], v[116:119]
    v_mfma_f32_16x16x32_bf16 v[116:119], a[200:203], a[112:115], v[116:119]
    s_nop 0
    ds_write_b128 v172, v[96:99] offset:4096
    v_mfma_f32_16x16x32_bf16 v[120:123], a[208:211], a[112:115], v[120:123]
    v_mfma_f32_16x16x32_bf16 v[120:123], a[212:215], a[116:119], v[120:123]
    v_mfma_f32_16x16x32_bf16 v[124:127], a[220:223], a[116:119], v[124:127]
    v_mfma_f32_16x16x32_bf16 v[124:127], a[216:219], a[112:115], v[124:127]
    s_waitcnt vmcnt(9)
    ds_write_b128 v173, v[100:103] offset:4096
    v_mfma_f32_16x16x32_bf16 v[124:127], a[248:251], a[120:123], v[124:127]
    s_waitcnt vmcnt(8)
    v_mfma_f32_16x16x32_bf16 v[124:127], a[252:255], a[124:127], v[124:127]
    v_mfma_f32_16x16x32_bf16 v[120:123], a[244:247], a[124:127], v[120:123]
    v_mfma_f32_16x16x32_bf16 v[120:123], a[240:243], a[120:123], v[120:123]
    ds_write_b128 v172, v[104:107] offset:4224
    v_mfma_f32_16x16x32_bf16 v[116:119], a[232:235], a[120:123], v[116:119]
    v_mfma_f32_16x16x32_bf16 v[116:119], a[236:239], a[124:127], v[116:119]
    v_mfma_f32_16x16x32_bf16 v[112:115], a[228:231], a[124:127], v[112:115]
    v_mfma_f32_16x16x32_bf16 v[112:115], a[224:227], a[120:123], v[112:115]
    s_waitcnt vmcnt(7)
    ds_write_b128 v173, v[108:111] offset:4224
    v_mfma_f32_16x16x32_bf16 v[128:131], a[192:195], a[128:131], v[128:131]
    s_waitcnt vmcnt(6)
    v_mfma_f32_16x16x32_bf16 v[128:131], a[196:199], a[132:135], v[128:131]
    v_mfma_f32_16x16x32_bf16 v[132:135], a[204:207], a[132:135], v[132:135]
    v_mfma_f32_16x16x32_bf16 v[132:135], a[200:203], a[128:131], v[132:135]
    s_nop 0
    ds_write_b128 v172, v[112:115] offset:32768
    v_mfma_f32_16x16x32_bf16 v[136:139], a[208:211], a[128:131], v[136:139]
    v_mfma_f32_16x16x32_bf16 v[136:139], a[212:215], a[132:135], v[136:139]
    v_mfma_f32_16x16x32_bf16 v[140:143], a[220:223], a[132:135], v[140:143]
    v_mfma_f32_16x16x32_bf16 v[140:143], a[216:219], a[128:131], v[140:143]
    s_waitcnt vmcnt(5)
    ds_write_b128 v173, v[116:119] offset:32768
    v_mfma_f32_16x16x32_bf16 v[140:143], a[248:251], a[136:139], v[140:143]
    s_waitcnt vmcnt(4)
    v_mfma_f32_16x16x32_bf16 v[140:143], a[252:255], a[140:143], v[140:143]
    v_mfma_f32_16x16x32_bf16 v[136:139], a[244:247], a[140:143], v[136:139]
    v_mfma_f32_16x16x32_bf16 v[136:139], a[240:243], a[136:139], v[136:139]
    ds_write_b128 v172, v[120:123] offset:32896
    v_mfma_f32_16x16x32_bf16 v[132:135], a[232:235], a[136:139], v[132:135]
    v_mfma_f32_16x16x32_bf16 v[132:135], a[236:239], a[140:143], v[132:135]
    v_mfma_f32_16x16x32_bf16 v[128:131], a[228:231], a[140:143], v[128:131]
    v_mfma_f32_16x16x32_bf16 v[128:131], a[224:227], a[136:139], v[128:131]
    s_waitcnt vmcnt(3)
    ds_write_b128 v173, v[124:127] offset:32896
    v_mfma_f32_16x16x32_bf16 v[144:147], a[192:195], a[144:147], v[144:147]
    s_waitcnt vmcnt(2)
    v_mfma_f32_16x16x32_bf16 v[144:147], a[196:199], a[148:151], v[144:147]
    v_mfma_f32_16x16x32_bf16 v[148:151], a[204:207], a[148:151], v[148:151]
    v_mfma_f32_16x16x32_bf16 v[148:151], a[200:203], a[144:147], v[148:151]
    s_nop 0
    ds_write_b128 v172, v[128:131] offset:36864
    v_mfma_f32_16x16x32_bf16 v[152:155], a[208:211], a[144:147], v[152:155]
    v_mfma_f32_16x16x32_bf16 v[152:155], a[212:215], a[148:151], v[152:155]
    v_mfma_f32_16x16x32_bf16 v[156:159], a[220:223], a[148:151], v[156:159]
    v_mfma_f32_16x16x32_bf16 v[156:159], a[216:219], a[144:147], v[156:159]
    s_waitcnt vmcnt(1)
    ds_write_b128 v173, v[132:135] offset:36864
    v_mfma_f32_16x16x32_bf16 v[156:159], a[248:251], a[152:155], v[156:159]
    s_waitcnt vmcnt(0)
    v_mfma_f32_16x16x32_bf16 v[156:159], a[252:255], a[156:159], v[156:159]
    v_mfma_f32_16x16x32_bf16 v[152:155], a[244:247], a[156:159], v[152:155]
    v_mfma_f32_16x16x32_bf16 v[152:155], a[240:243], a[152:155], v[152:155]
    ds_write_b128 v172, v[136:139] offset:36992
    v_mfma_f32_16x16x32_bf16 v[148:151], a[232:235], a[152:155], v[148:151]
    v_mfma_f32_16x16x32_bf16 v[148:151], a[236:239], a[156:159], v[148:151]
    v_mfma_f32_16x16x32_bf16 v[144:147], a[228:231], a[156:159], v[144:147]
    v_mfma_f32_16x16x32_bf16 v[144:147], a[224:227], a[152:155], v[144:147]
    ds_write_b128 v173, v[140:143] offset:36992
    s_nop 6
    ds_write_b128 v174, v[144:147]
    ds_write_b128 v175, v[148:151]
    ds_write_b128 v174, v[152:155] offset:128
    ds_write_b128 v175, v[156:159] offset:128
    s_mul_i32 s62, s3, 0x48000
    s_lshl_b32 s63, s94, 7
    s_add_u32 s62, s62, s63
    s_waitcnt lgkmcnt(0)
    s_barrier
    ds_read_b128 v[16:19], v176
    ds_read_b128 v[20:23], v177
    ds_read_b128 v[24:27], v176 offset:8192
    ds_read_b128 v[28:31], v177 offset:8192
    ds_read_b128 v[32:35], v176 offset:16384
    ds_read_b128 v[36:39], v177 offset:16384
    ds_read_b128 v[40:43], v176 offset:24576
    ds_read_b128 v[44:47], v177 offset:24576
    ds_read_b128 v[48:51], v176 offset:32768
    ds_read_b128 v[52:55], v177 offset:32768
    ds_read_b128 v[56:59], v176 offset:40960
    ds_read_b128 v[60:63], v177 offset:40960
    ds_read_b128 v[64:67], v176 offset:49152
    ds_read_b128 v[68:71], v177 offset:49152
    ds_read_b128 v[72:75], v176 offset:57344
    ds_read_b128 v[76:79], v177 offset:57344
    s_waitcnt lgkmcnt(13)
    v_pk_add_f32 v[16:17], v[16:17], v[24:25]
    v_pk_add_f32 v[18:19], v[18:19], v[26:27]
    s_waitcnt lgkmcnt(12)
    v_pk_add_f32 v[20:21], v[20:21], v[28:29]
    v_pk_add_f32 v[22:23], v[22:23], v[30:31]
    s_waitcnt lgkmcnt(9)
    v_pk_add_f32 v[32:33], v[32:33], v[40:41]
    v_pk_add_f32 v[34:35], v[34:35], v[42:43]
    s_waitcnt lgkmcnt(8)
    v_pk_add_f32 v[36:37], v[36:37], v[44:45]
    v_pk_add_f32 v[38:39], v[38:39], v[46:47]
    v_pk_add_f32 v[16:17], v[16:17], v[32:33]
    v_pk_add_f32 v[18:19], v[18:19], v[34:35]
    v_pk_add_f32 v[20:21], v[20:21], v[36:37]
    v_pk_add_f32 v[22:23], v[22:23], v[38:39]
    v_cvt_pk_bf16_f32 v192, v16, v17
    v_cvt_pk_bf16_f32 v193, v18, v19
    v_cvt_pk_bf16_f32 v194, v20, v21
    v_cvt_pk_bf16_f32 v195, v22, v23
    buffer_store_dwordx4 v[192:195], v182, s[28:31], s62 offen sc1
    s_add_u32 s62, s62, 0x10000
    ds_read_b128 v[80:83], v178
    ds_read_b128 v[84:87], v179
    ds_read_b128 v[88:91], v178 offset:8192
    ds_read_b128 v[92:95], v179 offset:8192
    ds_read_b128 v[96:99], v178 offset:16384
    ds_read_b128 v[100:103], v179 offset:16384
    ds_read_b128 v[104:107], v178 offset:24576
    ds_read_b128 v[108:111], v179 offset:24576
    s_waitcnt lgkmcnt(13)
    v_pk_add_f32 v[48:49], v[48:49], v[56:57]
    v_pk_add_f32 v[50:51], v[50:51], v[58:59]
    s_waitcnt lgkmcnt(12)
    v_pk_add_f32 v[52:53], v[52:53], v[60:61]
    v_pk_add_f32 v[54:55], v[54:55], v[62:63]
    s_waitcnt lgkmcnt(9)
    v_pk_add_f32 v[64:65], v[64:65], v[72:73]
    v_pk_add_f32 v[66:67], v[66:67], v[74:75]
    s_waitcnt lgkmcnt(8)
    v_pk_add_f32 v[68:69], v[68:69], v[76:77]
    v_pk_add_f32 v[70:71], v[70:71], v[78:79]
    v_pk_add_f32 v[48:49], v[48:49], v[64:65]
    v_pk_add_f32 v[50:51], v[50:51], v[66:67]
    v_pk_add_f32 v[52:53], v[52:53], v[68:69]
    v_pk_add_f32 v[54:55], v[54:55], v[70:71]
    v_cvt_pk_bf16_f32 v196, v48, v49
    v_cvt_pk_bf16_f32 v197, v50, v51
    v_cvt_pk_bf16_f32 v198, v52, v53
    v_cvt_pk_bf16_f32 v199, v54, v55
    buffer_store_dwordx4 v[196:199], v182, s[28:31], s62 offen sc1
    s_add_u32 s62, s62, 0x10000
    ds_read_b128 v[112:115], v178 offset:32768
    ds_read_b128 v[116:119], v179 offset:32768
    ds_read_b128 v[120:123], v178 offset:40960
    ds_read_b128 v[124:127], v179 offset:40960
    ds_read_b128 v[128:131], v178 offset:49152
    ds_read_b128 v[132:135], v179 offset:49152
    ds_read_b128 v[136:139], v178 offset:57344
    ds_read_b128 v[140:143], v179 offset:57344
    s_waitcnt lgkmcnt(13)
    v_pk_add_f32 v[80:81], v[80:81], v[88:89]
    v_pk_add_f32 v[82:83], v[82:83], v[90:91]
    s_waitcnt lgkmcnt(12)
    v_pk_add_f32 v[84:85], v[84:85], v[92:93]
    v_pk_add_f32 v[86:87], v[86:87], v[94:95]
    s_waitcnt lgkmcnt(9)
    v_pk_add_f32 v[96:97], v[96:97], v[104:105]
    v_pk_add_f32 v[98:99], v[98:99], v[106:107]
    s_waitcnt lgkmcnt(8)
    v_pk_add_f32 v[100:101], v[100:101], v[108:109]
    v_pk_add_f32 v[102:103], v[102:103], v[110:111]
    v_pk_add_f32 v[80:81], v[80:81], v[96:97]
    v_pk_add_f32 v[82:83], v[82:83], v[98:99]
    v_pk_add_f32 v[84:85], v[84:85], v[100:101]
    v_pk_add_f32 v[86:87], v[86:87], v[102:103]
    v_cvt_pk_bf16_f32 v200, v80, v81
    v_cvt_pk_bf16_f32 v201, v82, v83
    v_cvt_pk_bf16_f32 v202, v84, v85
    v_cvt_pk_bf16_f32 v203, v86, v87
    buffer_store_dwordx4 v[200:203], v182, s[28:31], s62 offen sc1
    s_add_u32 s62, s62, 0x10000
    ds_read_b128 v[16:19], v180
    ds_read_b128 v[20:23], v181
    ds_read_b128 v[24:27], v180 offset:8192
    ds_read_b128 v[28:31], v181 offset:8192
    ds_read_b128 v[32:35], v180 offset:16384
    ds_read_b128 v[36:39], v181 offset:16384
    ds_read_b128 v[40:43], v180 offset:24576
    ds_read_b128 v[44:47], v181 offset:24576
    s_waitcnt lgkmcnt(13)
    v_pk_add_f32 v[112:113], v[112:113], v[120:121]
    v_pk_add_f32 v[114:115], v[114:115], v[122:123]
    s_waitcnt lgkmcnt(12)
    v_pk_add_f32 v[116:117], v[116:117], v[124:125]
    v_pk_add_f32 v[118:119], v[118:119], v[126:127]
    s_waitcnt lgkmcnt(9)
    v_pk_add_f32 v[128:129], v[128:129], v[136:137]
    v_pk_add_f32 v[130:131], v[130:131], v[138:139]
    s_waitcnt lgkmcnt(8)
    v_pk_add_f32 v[132:133], v[132:133], v[140:141]
    v_pk_add_f32 v[134:135], v[134:135], v[142:143]
    v_pk_add_f32 v[112:113], v[112:113], v[128:129]
    v_pk_add_f32 v[114:115], v[114:115], v[130:131]
    v_pk_add_f32 v[116:117], v[116:117], v[132:133]
    v_pk_add_f32 v[118:119], v[118:119], v[134:135]
    v_cvt_pk_bf16_f32 v204, v112, v113
    v_cvt_pk_bf16_f32 v205, v114, v115
    v_cvt_pk_bf16_f32 v206, v116, v117
    v_cvt_pk_bf16_f32 v207, v118, v119
    buffer_store_dwordx4 v[204:207], v182, s[28:31], s62 offen sc1
    s_add_u32 s62, s62, 0x10000
    s_cmp_ge_u32 s56, 2
    s_cbranch_scc1 mha_fin
    s_waitcnt lgkmcnt(5)
    v_pk_add_f32 v[16:17], v[16:17], v[24:25]
    v_pk_add_f32 v[18:19], v[18:19], v[26:27]
    s_waitcnt lgkmcnt(4)
    v_pk_add_f32 v[20:21], v[20:21], v[28:29]
    v_pk_add_f32 v[22:23], v[22:23], v[30:31]
    s_waitcnt lgkmcnt(1)
    v_pk_add_f32 v[32:33], v[32:33], v[40:41]
    v_pk_add_f32 v[34:35], v[34:35], v[42:43]
    s_waitcnt lgkmcnt(0)
    v_pk_add_f32 v[36:37], v[36:37], v[44:45]
    v_pk_add_f32 v[38:39], v[38:39], v[46:47]
    v_pk_add_f32 v[16:17], v[16:17], v[32:33]
    v_pk_add_f32 v[18:19], v[18:19], v[34:35]
    v_pk_add_f32 v[20:21], v[20:21], v[36:37]
    v_pk_add_f32 v[22:23], v[22:23], v[38:39]
    v_cvt_pk_bf16_f32 v208, v16, v17
    v_cvt_pk_bf16_f32 v209, v18, v19
    v_cvt_pk_bf16_f32 v210, v20, v21
    v_cvt_pk_bf16_f32 v211, v22, v23
    buffer_store_dwordx4 v[208:211], v182, s[28:31], s62 offen sc1
mha_fin:
mha_end:
    s_endpgm
mha_code_end:
mha_gate:
    s_mov_b32 s64, 0x4000
    s_mov_b64 exec, 1
mha_gate_l:
    s_sleep 64
    buffer_load_dword v9, v8, s[32:35], s62 offen sc1
    s_waitcnt vmcnt(0)
    v_readfirstlane_b32 s63, v9
    s_sub_u32 s64, s64, 1
    s_cmp_eq_u32 s64, 0
    s_cbranch_scc1 mha_gate_x
    s_cmp_lt_u32 s63, 16
    s_cbranch_scc1 mha_gate_l
mha_gate_x:
    s_mov_b64 exec, -1
    s_branch mha_gate_ok
mha_fallback:
    s_waitcnt vmcnt(0)
    s_waitcnt lgkmcnt(0)
    s_barrier
    s_mov_b32 s66, -1
    v_and_b32 v12, 15, v0
    v_lshrrev_b32 v13, 4, v0
    v_lshlrev_b32 v12, 8, v12
    v_lshl_add_u32 v12, v13, 4, v12
    s_lshl_b32 s62, s58, 6
    v_add_u32 v10, s62, v12
    v_xor_b32 v11, 64, v10
    s_lshl_b32 s62, s58, 13
    s_sub_u32 s63, s77, s62
    s_mov_b32 s61, 32
mha_fb_loop1:
    buffer_load_dwordx4 a[160:163], v10, s[12:15], s63 offen
    buffer_load_dwordx4 a[164:167], v11, s[12:15], s63 offen
    buffer_load_dwordx4 a[168:171], v10, s[12:15], s63 offen offset:128
    buffer_load_dwordx4 a[172:175], v11, s[12:15], s63 offen offset:128
    s_waitcnt vmcnt(3)
    v_mfma_f32_16x16x32_bf16 v[16:19], a[160:163], v[160:163], 0
    s_waitcnt vmcnt(2)
    v_mfma_f32_16x16x32_bf16 v[16:19], a[164:167], v[164:167], v[16:19]
    s_waitcnt vmcnt(1)
    v_mfma_f32_16x16x32_bf16 v[16:19], a[168:171], v[168:171], v[16:19]
    s_waitcnt vmcnt(0)
    v_mfma_f32_16x16x32_bf16 v[16:19], a[172:175], v[172:175], v[16:19]
    v_mfma_f32_16x16x32_bf16 v[20:23], a[172:175], v[188:191], 0
    v_mfma_f32_16x16x32_bf16 v[20:23], a[168:171], v[184:187], v[20:23]
    v_mfma_f32_16x16x32_bf16 v[20:23], a[164:167], v[180:183], v[20:23]
    v_mfma_f32_16x16x32_bf16 v[20:23], a[160:163], v[176:179], v[20:23]
    v_mfma_f32_16x16x32_bf16 v[24:27], a[160:163], v[192:195], 0
    v_mfma_f32_16x16x32_bf16 v[24:27], a[164:167], v[196:199], v[24:27]
    v_mfma_f32_16x16x32_bf16 v[24:27], a[168:171], v[200:203], v[24:27]
    v_mfma_f32_16x16x32_bf16 v[24:27], a[172:175], v[204:207], v[24:27]
    v_mfma_f32_16x16x32_bf16 v[28:31], a[172:175], v[220:223], 0
    v_mfma_f32_16x16x32_bf16 v[28:31], a[168:171], v[216:219], v[28:31]
    v_mfma_f32_16x16x32_bf16 v[28:31], a[164:167], v[212:215], v[28:31]
    v_mfma_f32_16x16x32_bf16 v[28:31], a[160:163], v[208:211], v[28:31]
    v_mfma_f32_16x16x32_bf16 v[32:35], a[160:163], v[224:227], 0
    v_mfma_f32_16x16x32_bf16 v[32:35], a[164:167], v[228:231], v[32:35]
    v_mfma_f32_16x16x32_bf16 v[32:35], a[168:171], v[232:235], v[32:35]
    v_mfma_f32_16x16x32_bf16 v[32:35], a[172:175], v[236:239], v[32:35]
    v_max3_f32 v153, v153, v16, v17
    v_max3_f32 v153, v153, v18, v19
    v_max3_f32 v154, v154, v20, v21
    v_max3_f32 v154, v154, v22, v23
    v_max3_f32 v155, v155, v24, v25
    v_max3_f32 v155, v155, v26, v27
    v_max3_f32 v156, v156, v28, v29
    v_max3_f32 v156, v156, v30, v31
    v_max3_f32 v157, v157, v32, v33
    v_max3_f32 v157, v157, v34, v35
    s_add_u32 s63, s63, 0x1000
    s_sub_u32 s61, s61, 1
    s_cmp_lg_u32 s61, 0
    s_cbranch_scc1 mha_fb_loop1
    v_add_u32 v244, 0x10000, v244
    v_add_u32 v245, 0x10000, v245
    v_add_u32 v246, 0x10000, v246
    v_add_u32 v247, 0x10000, v247
    v_add_u32 v248, 0x10000, v248
    v_add_u32 v249, 0x10000, v249
    v_add_u32 v250, 0x10000, v250
    v_add_u32 v251, 0x10000, v251
    s_add_u32 m0, s78, 0x10000
    s_add_u32 s91, s77, 0
    s_xor_b32 s91, s91, s47
    buffer_load_dwordx4 v3, s[12:15], s91 offen nt lds
    buffer_load_dwordx4 v15, s[12:15], s91 offen offset:1024 nt lds
    buffer_load_dwordx4 v3, s[12:15], s91 offen offset:2048 nt lds
    buffer_load_dwordx4 v15, s[12:15], s91 offen offset:3072 nt lds
    s_add_u32 m0, m0, 0x1000
    s_add_u32 s91, s77, 0x1000
    s_xor_b32 s91, s91, s47
    buffer_load_dwordx4 v3, s[12:15], s91 offen nt lds
    buffer_load_dwordx4 v15, s[12:15], s91 offen offset:1024 nt lds
    buffer_load_dwordx4 v3, s[12:15], s91 offen offset:2048 nt lds
    buffer_load_dwordx4 v15, s[12:15], s91 offen offset:3072 nt lds
    s_add_u32 m0, s78, 0x18000
    s_add_u32 s91, s77, 0x4000
    s_xor_b32 s91, s91, s47
    buffer_load_dwordx4 v3, s[12:15], s91 offen nt lds
    buffer_load_dwordx4 v15, s[12:15], s91 offen offset:1024 nt lds
    buffer_load_dwordx4 v3, s[12:15], s91 offen offset:2048 nt lds
    buffer_load_dwordx4 v15, s[12:15], s91 offen offset:3072 nt lds
    s_add_u32 m0, m0, 0x1000
    s_add_u32 s91, s77, 0x5000
    s_xor_b32 s91, s91, s47
    buffer_load_dwordx4 v3, s[12:15], s91 offen nt lds
    buffer_load_dwordx4 v15, s[12:15], s91 offen offset:1024 nt lds
    buffer_load_dwordx4 v3, s[12:15], s91 offen offset:2048 nt lds
    buffer_load_dwordx4 v15, s[12:15], s91 offen offset:3072 nt lds
    s_add_u32 m0, s78, 0x20000
    s_add_u32 s91, s77, 0
    s_xor_b32 s91, s91, s47
    buffer_load_dwordx4 v3, s[16:19], s91 offen nt lds
    buffer_load_dwordx4 v15, s[16:19], s91 offen offset:1024 nt lds
    buffer_load_dwordx4 v3, s[16:19], s91 offen offset:2048 nt lds
    buffer_load_dwordx4 v15, s[16:19], s91 offen offset:3072 nt lds
    s_add_u32 m0, m0, 0x1000
    s_add_u32 s91, s77, 0x1000
    s_xor_b32 s91, s91, s47
    buffer_load_dwordx4 v3, s[16:19], s91 offen nt lds
    buffer_load_dwordx4 v15, s[16:19], s91 offen offset:1024 nt lds
    buffer_load_dwordx4 v3, s[16:19], s91 offen offset:2048 nt lds
    buffer_load_dwordx4 v15, s[16:19], s91 offen offset:3072 nt lds
    s_add_u32 m0, s78, 0
    s_add_u32 s91, s77, 0x8000
    s_xor_b32 s91, s91, s47
    buffer_load_dwordx4 v3, s[12:15], s91 offen nt lds
    buffer_load_dwordx4 v15, s[12:15], s91 offen offset:1024 nt lds
    buffer_load_dwordx4 v3, s[12:15], s91 offen offset:2048 nt lds
    buffer_load_dwordx4 v15, s[12:15], s91 offen offset:3072 nt lds
    s_add_u32 m0, m0, 0x1000
    s_add_u32 s91, s77, 0x9000
    s_xor_b32 s91, s91, s47
    buffer_load_dwordx4 v3, s[12:15], s91 offen nt lds
    buffer_load_dwordx4 v15, s[12:15], s91 offen offset:1024 nt lds
    buffer_load_dwordx4 v3, s[12:15], s91 offen offset:2048 nt lds
    buffer_load_dwordx4 v15, s[12:15], s91 offen offset:3072 nt lds
    s_add_u32 s90, s77, 0xc000
    s_xor_b32 s90, s90, s47
    buffer_load_dwordx4 a[192:195], v3, s[16:19], s90 offen nt
    s_add_u32 s90, s77, 0xc000
    s_xor_b32 s90, s90, s47
    buffer_load_dwordx4 a[196:199], v15, s[16:19], s90 offen offset:1024 nt
    s_add_u32 s90, s77, 0xc000
    s_xor_b32 s90, s90, s47
    buffer_load_dwordx4 a[200:203], v3, s[16:19], s90 offen offset:2048 nt
    s_add_u32 s90, s77, 0xc000
    s_xor_b32 s90, s90, s47
    buffer_load_dwordx4 a[204:207], v15, s[16:19], s90 offen offset:3072 nt
    s_add_u32 s90, s77, 0xd000
    s_xor_b32 s90, s90, s47
    buffer_load_dwordx4 a[208:211], v3, s[16:19], s90 offen nt
    s_add_u32 s90, s77, 0xd000
    s_xor_b32 s90, s90, s47
    buffer_load_dwordx4 a[212:215], v15, s[16:19], s90 offen offset:1024 nt
    s_add_u32 s90, s77, 0xd000
    s_xor_b32 s90, s90, s47
    buffer_load_dwordx4 a[216:219], v3, s[16:19], s90 offen offset:2048 nt
    s_add_u32 s90, s77, 0xd000
    s_xor_b32 s90, s90, s47
    buffer_load_dwordx4 a[220:223], v15, s[16:19], s90 offen offset:3072 nt
    s_add_u32 s90, s77, 0x14000
    s_xor_b32 s90, s90, s47
    buffer_load_dwordx4 a[224:227], v3, s[16:19], s90 offen nt
    s_add_u32 s90, s77, 0x14000
    s_xor_b32 s90, s90, s47
    buffer_load_dwordx4 a[228:231], v15, s[16:19], s90 offen offset:1024 nt
    s_add_u32 s90, s77, 0x14000
    s_xor_b32 s90, s90, s47
    buffer_load_dwordx4 a[232:235], v3, s[16:19], s90 offen offset:2048 nt
    s_add_u32 s90, s77, 0x14000
    s_xor_b32 s90, s90, s47
    buffer_load_dwordx4 a[236:239], v15, s[16:19], s90 offen offset:3072 nt
    s_add_u32 s90, s77, 0x15000
    s_xor_b32 s90, s90, s47
    buffer_load_dwordx4 a[240:243], v3, s[16:19], s90 offen nt
    s_add_u32 s90, s77, 0x15000
    s_xor_b32 s90, s90, s47
    buffer_load_dwordx4 a[244:247], v15, s[16:19], s90 offen offset:1024 nt
    s_add_u32 s90, s77, 0x15000
    s_xor_b32 s90, s90, s47
    buffer_load_dwordx4 a[248:251], v3, s[16:19], s90 offen offset:2048 nt
    s_add_u32 s90, s77, 0x15000
    s_xor_b32 s90, s90, s47
    buffer_load_dwordx4 a[252:255], v15, s[16:19], s90 offen offset:3072 nt
    s_waitcnt vmcnt(0)
    s_barrier
    s_branch mha_attn_entry
.section .rodata,"a"
.p2align 6
.amdhsa_kernel standalone__mha_block_cached__near_ridge_kernel
  .amdhsa_next_free_vgpr 512
  .amdhsa_next_free_sgpr 102
  .amdhsa_accum_offset 256
  .amdhsa_group_segment_fixed_size 0
  .amdhsa_kernarg_size 64
  .amdhsa_user_sgpr_count 2
  .amdhsa_user_sgpr_kernarg_segment_ptr 1
  .amdhsa_system_sgpr_workgroup_id_x 1
.end_amdhsa_kernel
```
